```python
import torch

def _softmax(x, axis=-1):
    return torch.softmax(x, dim=axis)
def _gelu(x):
    return torch.nn.functional.gelu(x, approximate="tanh")
def _silu(x):
    return torch.nn.functional.silu(x)
def _sigmoid(x):
    return torch.sigmoid(x)
def _layernorm(x, axis=-1, eps=1e-5):
    m = x.mean(dim=axis, keepdim=True)
    v = x.var(dim=axis, keepdim=True, unbiased=False)
    return (x - m) / torch.sqrt(v + eps)
def _scatter_add(tgt, idx, src, axis=0):
    return tgt.clone().index_add_(axis, idx, src)
def _segment_sum(src, seg, n):
    out = torch.zeros((n,) + src.shape[1:], dtype=src.dtype)
    return out.index_add_(0, seg, src)
def _pad(x, pw):
    flat = tuple(v for pair in reversed(pw) for v in pair)
    return torch.nn.functional.pad(x, flat)

kernel_name = 'interleave_layers__linear_kernel_hedgehog__sliding_local_dilated__prompt'

def setup_inputs():

    _w = (lambda a: (lambda t: t.to(torch.bfloat16) if t.is_floating_point() else t)(torch.as_tensor(a)))
    def _A_setup():
        B, S, D, H = 1, 2048, 1024, 32
        Dh = D // H
        return {
            "x": _w((lambda *s: torch.randn(*s, dtype=torch.bfloat16) * 0.05)(B, S, D)),
            "wqkv": _w((lambda *s: torch.randn(*s, dtype=torch.bfloat16) * 0.2)(D, 3 * D)),
            "w_phi": _w((lambda *s: torch.randn(*s, dtype=torch.bfloat16) * 0.2)(H, Dh, Dh) * (Dh ** -0.5)),
            "wo": _w((lambda *s: torch.randn(*s, dtype=torch.bfloat16) * 0.05)(D, D)),
        }
    _A_in = _A_setup()

    def _B_setup():
        B, S, D = 1, 2048, 1024
        return {
            "x": _w((lambda *s: torch.randn(*s, dtype=torch.bfloat16) * 0.05)(B, S, D)),
            "wqkv": _w((lambda *s: torch.randn(*s, dtype=torch.bfloat16) * 0.1)(D, 3 * D)),
            "wo": _w((lambda *s: torch.randn(*s, dtype=torch.bfloat16) * 0.05)(D, D)),
        }
    _B_in = _B_setup()

    return {
        "A_x": _A_in["x"],
        "A_wqkv": _A_in["wqkv"],
        "A_w_phi": _A_in["w_phi"],
        "A_wo": _A_in["wo"],
        "B_x": _B_in["x"],
        "B_wqkv": _B_in["wqkv"],
        "B_wo": _B_in["wo"],
    }

def reference(A_x, A_wqkv, A_w_phi, A_wo, B_x, B_wqkv, B_wo):
    def _A_ref(x, wqkv, w_phi, wo):
        B, S, D = x.shape
        H = 32; Dh = D // H
        qkv = (lambda x, *d: x.permute(*d))((x @ wqkv).reshape(B, S, 3, H, Dh), 2, 0, 3, 1, 4)
        q, k, v = qkv[0], qkv[1], qkv[2]
        pq = torch.einsum("bhsd,hdf->bhsf", q, w_phi)
        pk = torch.einsum("bhsd,hdf->bhsf", k, w_phi)
        phi_q = torch.concatenate([_softmax(pq, axis=-1), _softmax(-pq, axis=-1)], axis=-1)
        phi_k = torch.concatenate([_softmax(pk, axis=-1), _softmax(-pk, axis=-1)], axis=-1)
        kv = torch.einsum("bhsf,bhsd->bhfd", phi_k, v)
        z  = torch.einsum("bhsf->bhf", phi_k)
        num = torch.einsum("bhqf,bhfd->bhqd", phi_q, kv)
        den = torch.einsum("bhqf,bhf->bhq", phi_q, z)[..., None] + 1e-6
        o = num / den
        return (lambda x, *d: x.permute(*d))(o, 0, 2, 1, 3).reshape(B, S, D) @ wo

    def _B_ref(x, wqkv, wo):
        B, S, D = x.shape
        H = 32; Dh = D // H
        W, dil = 8, 2
        qkv = (lambda x, *d: x.permute(*d))((x @ wqkv).reshape(B, S, 3, H, Dh), 2, 0, 3, 1, 4)
        q, k, v = qkv[0], qkv[1], qkv[2]
        scale = Dh ** -0.5
        pos = torch.arange(S)
        off = torch.arange(W) * dil
        idx = pos[:, None] - off[None, :]
        mask = idx >= 0
        idx_c = torch.where(mask, idx, 0).reshape(-1)
        kg = k[:, :, idx_c, :].reshape(B, H, S, W, Dh)
        vg = v[:, :, idx_c, :].reshape(B, H, S, W, Dh)
        logits = torch.einsum("bhsd,bhswd->bhsw", q, kg) * scale
        logits = torch.where(mask[None, None, :, :], logits, -1e9)
        attn = _softmax(logits, axis=-1)
        o = torch.einsum("bhsw,bhswd->bhsd", attn, vg)
        return (lambda x, *d: x.permute(*d))(o, 0, 2, 1, 3).reshape(B, S, D) @ wo

    x = A_x
    x = x + _A_ref(_layernorm(x, axis=-1), A_wqkv, A_w_phi, A_wo)
    x = x + _B_ref(_layernorm(x, axis=-1), B_wqkv, B_wo)
    x = x + _A_ref(_layernorm(x, axis=-1), A_wqkv, A_w_phi, A_wo)
    x = x + _B_ref(_layernorm(x, axis=-1), B_wqkv, B_wo)
    return x
```

```asm
; @launch grid=(256,1,1) block=(256,1,1) lds=163840
.amdgcn_target "amdgcn-amd-amdhsa--gfx950"
.text
.globl interleave_layers__linear_kernel_hedgehog__sliding_local_dilated__prompt_kernel
.p2align 8
.type interleave_layers__linear_kernel_hedgehog__sliding_local_dilated__prompt_kernel,@function
interleave_layers__linear_kernel_hedgehog__sliding_local_dilated__prompt_kernel:
    s_cmp_ge_u32 s2, 256
    s_cbranch_scc1 L_exit
    s_getpc_b64 s[48:49]
L_pc:
    s_lshr_b32 s19, s2, 3
    s_mulk_i32 s19, 1280
    v_min_u32 v252, 9, v0
    v_lshl_add_u32 v252, v252, 7, s19
    global_load_dword v52, v252, s[48:49]
    s_load_dwordx16 s[64:79], s[0:1], 0
    s_load_dwordx4 s[80:83], s[0:1], 64
    s_and_b32 s13, s2, 7
    s_lshr_b32 s14, s2, 3
    s_lshl_b32 s27, s13, 5
    s_add_u32 s27, s27, s14
    v_lshrrev_b32 v1, 6, v0
    v_and_b32 v254, 63, v0
    v_readfirstlane_b32 s12, v1
    s_lshr_b32 s18, s27, 4
    s_and_b32 s17, s27, 15
    s_mul_i32 s57, s12, 6144
    v_lshrrev_b32 v203, 3, v254
    v_and_b32 v204, 7, v254
    v_lshlrev_b32 v204, 4, v204
    v_lshl_add_u32 v210, v203, 11, v204
    v_lshrrev_b32 v200, 2, v254
    v_and_b32 v201, 3, v254
    v_mul_u32_u24 v202, 6144, v200
    v_lshl_add_u32 v202, v201, 4, v202
    s_lshl_b32 s21, s18, 2
    s_add_u32 s21, s21, s12
    s_lshl_b32 s21, s21, 16
    s_lshl_b32 s23, s17, 7
    s_add_u32 s22, s21, s23
    s_lshl_b32 s25, s13, 2
    s_add_u32 s25, s25, s12
    s_mul_i32 s24, s25, 196608
    s_lshl_b32 s23, s14, 6
    s_add_u32 s24, s24, s23
    v_lshlrev_b32 v1, 4, v254
    v_and_b32 v60, 48, v254
    v_and_b32 v215, 15, v254
    s_lshl_b32 s20, s17, 11
    s_add_u32 s35, s20, 25165824
    s_mul_i32 s62, s14, 196608
    s_add_u32 s62, s62, s57
    s_mul_i32 s94, s13, 24576
    v_lshlrev_b32 v249, 7, v254
    s_lshl_b32 s19, s27, 2
    s_add_u32 s19, s19, s12
    s_mul_i32 s63, s19, 6144
    s_waitcnt lgkmcnt(0)
    s_mov_b32 s4, s82
    s_mov_b32 s5, s83
    s_mov_b32 s6, 33554432
    s_mov_b32 s7, 0x20000
    s_xor_b32 s26, s12, 0
    s_or_b32 s19, s14, s26
    s_cmp_lg_u32 s19, 0
    s_cbranch_scc1 L_p0a
    v_mov_b32 v204, 0
    v_mov_b32 v205, 0
    v_mov_b32 v206, 0
    v_mov_b32 v207, 0
    s_lshl_b32 s19, s13, 12
    buffer_store_dwordx4 v[204:207], v1, s[4:7], s19 offen offset:0 sc1
    buffer_store_dwordx4 v[204:207], v1, s[4:7], s19 offen offset:1024 sc1
    buffer_store_dwordx4 v[204:207], v1, s[4:7], s19 offen offset:2048 sc1
    buffer_store_dwordx4 v[204:207], v1, s[4:7], s19 offen offset:3072 sc1
    s_lshl_b32 s19, s13, 7
    s_add_u32 s19, s19, 32768
    s_mov_b64 exec, 0xff
    buffer_store_dwordx4 v[204:207], v1, s[4:7], s19 offen offset:0 sc1
    buffer_store_dwordx4 v[204:207], v1, s[4:7], s19 offen offset:1024 sc1
    s_mov_b64 exec, -1
L_p0a:
    s_mov_b32 s8, s66
    s_mov_b32 s9, s67
    s_mov_b32 s10, 6291456
    s_mov_b32 s11, 0x20000
    s_mov_b32 exec_lo, 0x08080808
    s_mov_b32 exec_hi, 0x0808
    buffer_load_dword v52, v249, s[8:11], s63 offen
    s_mov_b64 exec, -1
    s_mov_b32 s8, s64
    s_mov_b32 s9, s65
    s_mov_b32 s10, 4194304
    s_mov_b32 s11, 0x20000
    s_add_u32 m0, s57, 0
    s_add_u32 s19, s22, 0
    buffer_load_dwordx4 v210, s[8:11], s19 offen lds
    s_add_u32 m0, s57, 1024
    s_add_u32 s19, s22, 16384
    buffer_load_dwordx4 v210, s[8:11], s19 offen lds
    s_add_u32 m0, s57, 2048
    s_add_u32 s19, s22, 32768
    buffer_load_dwordx4 v210, s[8:11], s19 offen lds
    s_add_u32 m0, s57, 3072
    s_add_u32 s19, s22, 49152
    buffer_load_dwordx4 v210, s[8:11], s19 offen lds
    s_movk_i32 s19, 128
    s_load_dword s61, s[80:81], s19
    s_add_u32 s19, s21, s35
    s_load_dword s61, s[82:83], s19
    s_add_u32 s19, s62, s94
    s_add_u32 s19, s19, 8388608
    s_load_dword s61, s[82:83], s19
    s_mov_b32 s19, 0x1f0000
    s_load_dword s61, s[82:83], s19
    s_mov_b32 s19, s24
    s_load_dword s61, s[74:75], s19
    s_lshl_b32 s19, s18, 17
    s_load_dword s61, s[70:71], s19
    s_load_dword s61, s[76:77], s19
    s_or_b32 s19, s14, s26
    s_cmp_lg_u32 s19, 0
    s_cbranch_scc1 L_p0b
    s_mov_b32 s8, s80
    s_mov_b32 s9, s81
    s_mov_b32 s10, 256
    s_mov_b32 s11, 0x20000
    v_mov_b32 v204, 1
    s_lshl_b32 s19, s13, 4
    s_waitcnt vmcnt(5)
    s_mov_b64 exec, 1
    buffer_store_dword v204, off, s[8:11], s19 sc1
    s_mov_b64 exec, -1
L_p0b:
    s_mov_b32 s8, s68
    s_mov_b32 s9, s69
    s_mov_b32 s10, 65536
    s_mov_b32 s11, 0x20000
    s_add_u32 m0, s57, 4096
    s_lshl_b32 s19, s14, 11
    buffer_load_dwordx4 v1, s[8:11], s19 offen offset:0 lds
    buffer_load_dwordx4 v1, s[8:11], s19 offen offset:1024 lds
    s_mov_b32 s8, s66
    s_mov_b32 s9, s67
    s_mov_b32 s10, 6291456
    s_mov_b32 s11, 0x20000
    s_add_u32 m0, s57, 73728
    s_add_u32 s19, s24, 0
    buffer_load_dwordx4 v202, s[8:11], s19 offen lds
    s_add_u32 m0, s57, 74752
    s_add_u32 s19, s24, 98304
    buffer_load_dwordx4 v202, s[8:11], s19 offen lds
    s_add_u32 m0, s57, 75776
    s_add_u32 s19, s24, 2048
    buffer_load_dwordx4 v202, s[8:11], s19 offen lds
    s_add_u32 m0, s57, 76800
    s_add_u32 s19, s24, 100352
    buffer_load_dwordx4 v202, s[8:11], s19 offen lds
    s_add_u32 m0, s57, 77824
    s_add_u32 s19, s24, 4096
    buffer_load_dwordx4 v202, s[8:11], s19 offen lds
    s_add_u32 m0, s57, 78848
    s_add_u32 s19, s24, 102400
    buffer_load_dwordx4 v202, s[8:11], s19 offen lds
    v_lshl_add_u32 v214, v215, 7, v60
    v_add_u32 v214, s57, v214
    v_add_u32 v8, s21, v1
    v_add_u32 v9, 0x8000, v8
    s_lshr_b32 s21, s21, 8
    v_lshl_add_u32 v14, v215, 3, s21
    s_lshl_b32 s19, s17, 14
    s_add_u32 s56, s19, 1048576
    s_mov_b32 s36, 0xaaaaaaaa
    s_mov_b32 s37, 0xaaaaaaaa
    s_mov_b32 s38, 0xcccccccc
    s_mov_b32 s39, 0xcccccccc
    s_mov_b32 s40, 0x00f0000f
    s_mov_b32 s41, 0xf0000f00
    v_mov_b32 v40, 0x3f803f80
    v_mov_b32 v41, 0x3f803f80
    v_mov_b32 v42, 0x3f803f80
    v_mov_b32 v43, 0x3f803f80
    s_waitcnt vmcnt(8)
    ds_read_b128 v[16:19], v214 offset:0
    ds_read_b128 v[20:23], v214 offset:64
    ds_read_b128 v[24:27], v214 offset:2048
    ds_read_b128 v[28:31], v214 offset:2112
    v_add_u32 v10, s62, v1
    v_add_u32 v0, s57, v1
    v_and_b32 v209, 3, v200
    v_lshrrev_b32 v203, 1, v60
    v_add_u32 v209, v209, v203
    v_lshlrev_b32 v203, 6, v209
    v_lshl_add_u32 v205, v201, 3, v203
    v_add_u32 v205, s57, v205
    v_lshl_add_u32 v206, v201, 4, v203
    s_add_u32 s20, s57, 73728
    v_add_u32 v206, s20, v206
    v_lshrrev_b32 v203, 2, v215
    v_lshl_add_u32 v203, v203, 3, v201
    v_lshl_add_u32 v203, v203, 6, v60
    v_add_u32 v208, s20, v203
    v_lshl_add_u32 v61, v215, 11, v60
    s_waitcnt lgkmcnt(0)
    v_mfma_f32_16x16x32_bf16 v[164:167], v[16:19], v[16:19], 0
    buffer_store_dwordx4 v[16:19], v8, s[4:7], s35 offen offset:0 sc1
    v_mfma_f32_16x16x32_bf16 v[160:163], v[40:43], v[16:19], 0
    v_mfma_f32_16x16x32_bf16 v[164:167], v[20:23], v[20:23], v[164:167]
    buffer_store_dwordx4 v[20:23], v8, s[4:7], s35 offen offset:1024 sc1
    v_mfma_f32_16x16x32_bf16 v[160:163], v[40:43], v[20:23], v[160:163]
    v_mfma_f32_16x16x32_bf16 v[172:175], v[24:27], v[24:27], 0
    buffer_store_dwordx4 v[24:27], v9, s[4:7], s35 offen offset:0 sc1
    v_mfma_f32_16x16x32_bf16 v[168:171], v[40:43], v[24:27], 0
    v_mfma_f32_16x16x32_bf16 v[172:175], v[28:31], v[28:31], v[172:175]
    buffer_store_dwordx4 v[28:31], v9, s[4:7], s35 offen offset:1024 sc1
    v_mfma_f32_16x16x32_bf16 v[168:171], v[40:43], v[28:31], v[168:171]
    v_cndmask_b32 v164, v164, v165, s[36:37]
    v_cndmask_b32 v166, v166, v167, s[36:37]
    v_cndmask_b32 v161, v164, v166, s[38:39]
    s_mov_b64 exec, s[40:41]
    buffer_store_dwordx2 v[160:161], v14, s[4:7], s56 offen offset:0 sc1
    s_mov_b64 exec, -1
    v_cndmask_b32 v172, v172, v173, s[36:37]
    v_cndmask_b32 v174, v174, v175, s[36:37]
    v_cndmask_b32 v169, v172, v174, s[38:39]
    s_mov_b64 exec, s[40:41]
    buffer_store_dwordx2 v[168:169], v14, s[4:7], s56 offen offset:128 sc1
    s_mov_b64 exec, -1
    s_mov_b32 s8, s74
    s_mov_b32 s9, s75
    s_mov_b32 s10, 6291456
    s_mov_b32 s11, 0x20000
    s_mov_b32 exec_hi, 0xffff
    buffer_load_dword v52, v249, s[8:11], s63 offen
    s_mov_b64 exec, -1
    s_mov_b32 s20, 0x00010001
    s_mov_b32 s21, 0x00010001
    v_cndmask_b32 v96, 0, v40, s[20:21]
    v_cndmask_b32 v97, 0, v40, s[20:21]
    v_cndmask_b32 v98, 0, v40, s[20:21]
    v_cndmask_b32 v99, 0, v40, s[20:21]
    s_mov_b32 s20, 0x00020002
    s_mov_b32 s21, 0x00020002
    v_cndmask_b32 v100, 0, v40, s[20:21]
    v_cndmask_b32 v101, 0, v40, s[20:21]
    v_cndmask_b32 v102, 0, v40, s[20:21]
    v_cndmask_b32 v103, 0, v40, s[20:21]
    s_mov_b32 s20, 0x00040004
    s_mov_b32 s21, 0x00040004
    v_cndmask_b32 v104, 0, v40, s[20:21]
    v_cndmask_b32 v105, 0, v40, s[20:21]
    v_cndmask_b32 v106, 0, v40, s[20:21]
    v_cndmask_b32 v107, 0, v40, s[20:21]
    s_mov_b32 s20, 0x00080008
    s_mov_b32 s21, 0x00080008
    v_cndmask_b32 v108, 0, v40, s[20:21]
    v_cndmask_b32 v109, 0, v40, s[20:21]
    v_cndmask_b32 v110, 0, v40, s[20:21]
    v_cndmask_b32 v111, 0, v40, s[20:21]
    s_mov_b32 s20, 0x00100010
    s_mov_b32 s21, 0x00100010
    v_cndmask_b32 v112, 0, v40, s[20:21]
    v_cndmask_b32 v113, 0, v40, s[20:21]
    v_cndmask_b32 v114, 0, v40, s[20:21]
    v_cndmask_b32 v115, 0, v40, s[20:21]
    s_mov_b32 s20, 0x00200020
    s_mov_b32 s21, 0x00200020
    v_cndmask_b32 v116, 0, v40, s[20:21]
    v_cndmask_b32 v117, 0, v40, s[20:21]
    v_cndmask_b32 v118, 0, v40, s[20:21]
    v_cndmask_b32 v119, 0, v40, s[20:21]
    s_add_u32 s21, s94, 8388608
    s_add_u32 s23, s21, 4096
    s_lshl_b32 s19, s25, 6
    s_mul_i32 s20, s14, 12288
    s_add_u32 s19, s19, s20
    s_add_u32 s72, s19, 65536
    s_waitcnt vmcnt(13)
    ds_read_b64_tr_b16 v[32:33], v205 offset:4096
    ds_read_b64_tr_b16 v[34:35], v205 offset:4352
    ds_read_b64_tr_b16 v[36:37], v205 offset:4128
    ds_read_b64_tr_b16 v[38:39], v205 offset:4384
    s_waitcnt vmcnt(7)
    ds_read_b128 v[120:123], v208 offset:0
    ds_read_b128 v[124:127], v208 offset:256
    ds_read_b128 v[128:131], v208 offset:2048
    ds_read_b128 v[132:135], v208 offset:2304
    ds_read_b64_tr_b16 a[16:17], v206 offset:4096
    ds_read_b64_tr_b16 a[18:19], v206 offset:4352
    ds_read_b64_tr_b16 a[20:21], v206 offset:4104
    ds_read_b64_tr_b16 a[22:23], v206 offset:4360
    s_waitcnt lgkmcnt(6)
    v_mfma_f32_16x16x32_bf16 v[160:163], v[120:123], v[32:35], 0
    v_mfma_f32_16x16x32_bf16 v[164:167], v[124:127], v[32:35], 0
    v_mfma_f32_16x16x32_bf16 v[168:171], v[120:123], v[36:39], 0
    v_mfma_f32_16x16x32_bf16 v[172:175], v[124:127], v[36:39], 0
    s_waitcnt lgkmcnt(4)
    v_mfma_f32_16x16x32_bf16 v[176:179], v[128:131], v[32:35], 0
    v_mfma_f32_16x16x32_bf16 v[180:183], v[132:135], v[32:35], 0
    v_mfma_f32_16x16x32_bf16 v[184:187], v[128:131], v[36:39], 0
    v_mfma_f32_16x16x32_bf16 v[188:191], v[132:135], v[36:39], 0
    s_waitcnt lgkmcnt(0)
    buffer_store_dwordx4 a[16:19], v10, s[4:7], s23 offen offset:0 sc1
    v_mfma_f32_16x16x32_bf16 v[64:67], a[16:19], v[112:115], 0
    buffer_store_dwordx4 a[20:23], v10, s[4:7], s23 offen offset:1024 sc1
    v_mfma_f32_16x16x32_bf16 v[64:67], a[20:23], v[116:119], v[64:67]
    v_cvt_pk_bf16_f32 v136, v160, v161
    v_cvt_pk_bf16_f32 v137, v162, v163
    v_cvt_pk_bf16_f32 v138, v164, v165
    v_cvt_pk_bf16_f32 v139, v166, v167
    buffer_store_dwordx4 v[136:139], v10, s[4:7], s21 offen offset:0 sc1
    s_nop 0
    v_mfma_f32_16x16x32_bf16 v[64:67], v[136:139], v[96:99], v[64:67]
    v_cvt_pk_bf16_f32 v140, v168, v169
    v_cvt_pk_bf16_f32 v141, v170, v171
    v_cvt_pk_bf16_f32 v142, v172, v173
    v_cvt_pk_bf16_f32 v143, v174, v175
    buffer_store_dwordx4 v[140:143], v10, s[4:7], s21 offen offset:1024 sc1
    s_nop 0
    v_mfma_f32_16x16x32_bf16 v[64:67], v[140:143], v[100:103], v[64:67]
    v_cvt_pk_bf16_f32 v144, v176, v177
    v_cvt_pk_bf16_f32 v145, v178, v179
    v_cvt_pk_bf16_f32 v146, v180, v181
    v_cvt_pk_bf16_f32 v147, v182, v183
    buffer_store_dwordx4 v[144:147], v10, s[4:7], s21 offen offset:2048 sc1
    s_nop 0
    v_mfma_f32_16x16x32_bf16 v[64:67], v[144:147], v[104:107], v[64:67]
    v_cvt_pk_bf16_f32 v148, v184, v185
    v_cvt_pk_bf16_f32 v149, v186, v187
    v_cvt_pk_bf16_f32 v150, v188, v189
    v_cvt_pk_bf16_f32 v151, v190, v191
    buffer_store_dwordx4 v[148:151], v10, s[4:7], s21 offen offset:3072 sc1
    s_nop 0
    v_mfma_f32_16x16x32_bf16 v[64:67], v[148:151], v[108:111], v[64:67]
    v_accvgpr_write_b32 a0, v136
    v_accvgpr_write_b32 a1, v137
    v_accvgpr_write_b32 a2, v138
    v_accvgpr_write_b32 a3, v139
    v_accvgpr_write_b32 a4, v140
    v_accvgpr_write_b32 a5, v141
    v_accvgpr_write_b32 a6, v142
    v_accvgpr_write_b32 a7, v143
    v_accvgpr_write_b32 a8, v144
    v_accvgpr_write_b32 a9, v145
    v_accvgpr_write_b32 a10, v146
    v_accvgpr_write_b32 a11, v147
    v_accvgpr_write_b32 a12, v148
    v_accvgpr_write_b32 a13, v149
    v_accvgpr_write_b32 a14, v150
    v_accvgpr_write_b32 a15, v151
    s_mov_b32 exec_lo, 0x003f003f
    s_mov_b32 exec_hi, 0x003f003f
    buffer_store_dwordx4 v[64:67], v61, s[4:7], s72 offen sc1
    s_mov_b64 exec, -1
    s_mov_b32 s8, s80
    s_mov_b32 s9, s81
    s_mov_b32 s10, 256
    s_mov_b32 s11, 0x20000
    v_and_b32 v253, 7, v254
    v_lshlrev_b32 v253, 4, v253
    s_cmp_eq_u32 s12, 0
    s_cselect_b32 s19, 0, 1073741824
    buffer_load_dword v212, v253, s[8:11], s19 offen sc1
    s_barrier
    s_lshl_b32 s19, s18, 1
    s_and_b32 s22, s12, 1
    s_add_u32 s19, s19, s22
    s_lshl_b32 s20, s17, 1
    s_lshr_b32 s23, s12, 1
    s_add_u32 s20, s20, s23
    s_lshl_b32 s20, s20, 6
    s_lshl_b32 s3, s19, 12
    s_lshl_b32 s19, s19, 16
    s_add_u32 s19, s19, s20
    s_add_u32 s20, s19, 0x8000
    v_lshlrev_b32 v203, 11, v200
    v_lshl_add_u32 v207, v201, 4, v203
    s_mov_b32 s64, s19
    s_mov_b32 s65, s20
    s_mov_b32 s8, s70
    s_mov_b32 s9, s71
    s_mov_b32 s10, 2097152
    s_mov_b32 s11, 0x20000
    s_add_u32 m0, s57, 122880
    s_nop 0
    buffer_load_dwordx4 v207, s[8:11], s64 offen lds
    s_add_u32 m0, s57, 123904
    s_nop 0
    buffer_load_dwordx4 v207, s[8:11], s65 offen lds
    ds_write_b128 v0, a[0:3] offset:24576
    ds_write_b128 v0, a[4:7] offset:25600
    ds_write_b128 v0, a[8:11] offset:26624
    ds_write_b128 v0, a[12:15] offset:27648
    ds_write_b128 v0, a[16:19] offset:28672
    ds_write_b128 v0, a[20:23] offset:29696
    s_getreg_b32 s29, hwreg(HW_REG_XCC_ID, 0, 4)
    s_or_b32 s29, s29, 0x100
    v_mov_b32 v63, s29
    s_lshl_b32 s20, s27, 2
    s_add_u32 s20, s20, 32768
    s_cmp_eq_u32 s12, 0
    s_cselect_b32 s55, s20, 1073741824
    s_lshl_b32 s19, s23, 11
    s_add_u32 s3, s3, s19
    s_lshl_b32 s19, s17, 17
    s_add_u32 s3, s3, s19
    s_add_u32 s3, s3, 20971520
    s_lshl_b32 s20, s14, 15
    s_lshl_b32 s21, s12, 10
    s_add_u32 s20, s20, s21
    s_add_u32 s58, s20, 4273995776
    s_lshr_b32 s20, s20, 4
    s_add_u32 s59, s20, 1310720
    s_add_u32 s20, s13, 0
    s_and_b32 s20, s20, 7
    s_mul_i32 s94, s20, 24576
    s_lshl_b32 s20, s20, 12
    s_add_u32 s86, s20, 25165824
    s_add_u32 s20, s13, 1
    s_and_b32 s20, s20, 7
    s_mul_i32 s95, s20, 24576
    s_lshl_b32 s20, s20, 12
    s_add_u32 s87, s20, 25165824
    s_add_u32 s20, s13, 2
    s_and_b32 s20, s20, 7
    s_mul_i32 s96, s20, 24576
    s_lshl_b32 s20, s20, 12
    s_add_u32 s88, s20, 25165824
    s_add_u32 s20, s13, 3
    s_and_b32 s20, s20, 7
    s_mul_i32 s97, s20, 24576
    s_lshl_b32 s20, s20, 12
    s_add_u32 s89, s20, 25165824
    s_add_u32 s20, s13, 4
    s_and_b32 s20, s20, 7
    s_mul_i32 s98, s20, 24576
    s_lshl_b32 s20, s20, 12
    s_add_u32 s90, s20, 25165824
    s_add_u32 s20, s13, 5
    s_and_b32 s20, s20, 7
    s_mul_i32 s99, s20, 24576
    s_lshl_b32 s20, s20, 12
    s_add_u32 s91, s20, 25165824
    s_add_u32 s20, s13, 6
    s_and_b32 s20, s20, 7
    s_mul_i32 s100, s20, 24576
    s_lshl_b32 s20, s20, 12
    s_add_u32 s92, s20, 25165824
    s_add_u32 s20, s13, 7
    s_and_b32 s20, s20, 7
    s_mul_i32 s101, s20, 24576
    s_lshl_b32 s20, s20, 12
    s_add_u32 s93, s20, 25165824
    s_lshl_b32 s20, s27, 11
    s_add_u32 s60, s20, 2097152
    s_lshl_b32 s20, s14, 10
    s_add_u32 s34, s20, 29360128
    s_mov_b32 s19, s3
    s_load_dword s61, s[82:83], s19
    s_add_u32 s19, s58, s86
    s_load_dword s61, s[82:83], s19
    s_add_u32 s19, s3, 2097152
    s_load_dword s61, s[82:83], s19
    s_add_u32 s19, s62, s94
    s_add_u32 s19, s19, 14680064
    s_load_dword s61, s[82:83], s19
    s_mov_b32 s19, s60
    s_load_dword s61, s[82:83], s19
    s_lshl_b32 s19, s25, 17
    s_add_u32 s19, s19, s34
    s_load_dword s61, s[82:83], s19
    s_lshl_b32 s19, s18, 18
    s_lshl_b32 s20, s17, 7
    s_add_u32 s19, s19, s20
    s_load_dword s61, s[78:79], s19
    s_lshl_b32 s19, s13, 5
    v_add_u32 v203, s19, v254
    v_and_b32 v204, 7, v254
    v_lshl_add_u32 v204, v204, 5, s14
    s_mov_b32 s20, 0xffffffff
    s_mov_b32 s21, 0x00000000
    v_cndmask_b32 v211, v204, v203, s[20:21]
    v_lshlrev_b32 v211, 7, v211
    s_cmp_eq_u32 s12, 0
    s_cselect_b32 s19, 1, 0
    s_waitcnt vmcnt(2)
    v_cmp_ne_u32 vcc, s19, v212
    s_cbranch_vccnz L_goslow
L_gook:
    s_lshl_b32 s19, s27, 7
    s_cmp_eq_u32 s12, 0
    s_cselect_b32 s19, s19, 1073741824
    s_barrier
    s_mov_b64 exec, 1
    buffer_store_dword v63, off, s[4:7], s19 sc1
    s_mov_b64 exec, -1
    s_mov_b32 s8, s76
    s_mov_b32 s9, s77
    s_mov_b32 s10, 2097152
    s_mov_b32 s11, 0x20000
    s_add_u32 m0, s57, 124928
    s_nop 0
    buffer_load_dwordx4 v207, s[8:11], s64 offen lds
    s_add_u32 m0, s57, 125952
    s_nop 0
    buffer_load_dwordx4 v207, s[8:11], s65 offen lds
    s_mov_b32 s8, s74
    s_mov_b32 s9, s75
    s_mov_b32 s10, 6291456
    s_mov_b32 s11, 0x20000
    s_add_u32 m0, s57, 98304
    s_add_u32 s19, s24, 0
    buffer_load_dwordx4 v202, s[8:11], s19 offen lds
    s_add_u32 m0, s57, 99328
    s_add_u32 s19, s24, 98304
    buffer_load_dwordx4 v202, s[8:11], s19 offen lds
    s_add_u32 m0, s57, 100352
    s_add_u32 s19, s24, 2048
    buffer_load_dwordx4 v202, s[8:11], s19 offen lds
    s_add_u32 m0, s57, 101376
    s_add_u32 s19, s24, 100352
    buffer_load_dwordx4 v202, s[8:11], s19 offen lds
    s_add_u32 m0, s57, 102400
    s_add_u32 s19, s24, 4096
    buffer_load_dwordx4 v202, s[8:11], s19 offen lds
    s_add_u32 m0, s57, 103424
    s_add_u32 s19, s24, 102400
    buffer_load_dwordx4 v202, s[8:11], s19 offen lds
    s_cmp_eq_u32 s12, 0
    s_cselect_b32 s26, 0, 1073741824
    s_mov_b32 s42, 0x00010001
    s_mov_b32 s43, 0x00010001
    s_mov_b32 s44, 0xfff0ffff
    s_mov_b32 s45, 0xf000ff00
    s_mov_b32 s46, 0xffc0fffc
    s_mov_b32 s47, 0xc000fc00
    s_lshl_b32 s20, s25, 7
    s_add_u32 s32, s20, 40960
    s_lshl_b32 s21, s14, 2
    s_add_u32 s20, s20, s21
    s_add_u32 s31, s20, 36864
    s_lshl_b32 s20, s18, 1
    s_add_u32 s20, s20, s23
    s_lshl_b32 s20, s20, 7
    s_add_u32 s30, s20, 36864
    s_lshl_b32 s21, s17, 3
    s_lshl_b32 s19, s22, 2
    s_add_u32 s20, s20, s21
    s_add_u32 s20, s20, s19
    s_add_u32 s33, s20, 40960
    s_lshl_b32 s19, s13, 8
    s_add_u32 s54, s19, s59
    s_lshl_b32 s20, s22, 10
    s_lshl_b32 s21, s23, 19
    s_add_u32 s20, s20, s21
    s_add_u32 s73, s20, s60
    s_cmp_eq_u32 s12, 3
    s_cselect_b32 s16, s60, 1073741824
    s_sub_u32 s20, s60, 0x10000
    s_cmp_eq_u32 s12, 0
    s_cselect_b32 s20, s20, 1073741824
    s_cmp_eq_u32 s13, 0
    s_cselect_b32 s28, 1073741824, s20
    s_lshl_b32 s19, s13, 2
    s_lshl_b64 s[68:69], 15, s19
    s_or_b32 s68, s68, s69
    s_mov_b32 s69, 0
    s_sub_u32 s19, s31, s30
    s_lshr_b32 s20, s19, 2
    s_lshl_b32 s20, 1, s20
    s_cmp_lt_u32 s19, 128
    s_cselect_b32 s20, s20, 0
    s_andn2_b32 s82, 63, s20
    s_mov_b32 s83, 0
    s_sub_u32 s19, s33, s32
    s_lshr_b32 s20, s19, 2
    s_lshl_b32 s20, 1, s20
    s_cmp_lt_u32 s19, 128
    s_cselect_b32 s20, s20, 0
    s_andn2_b32 s66, s68, s20
    s_mov_b32 s67, 0
    s_lshl_b32 s2, s12, 11
    s_lshl_b32 s0, s12, 12
    s_or_b32 s19, s13, s12
    s_cmp_eq_u32 s19, 0
    s_cselect_b64 s[50:51], -1, 0
    v_add_u32 v2, 0x10000, v1
    v_add_u32 v3, 0x20000, v1
    v_add_u32 v34, 73728, v0
    v_and_b32 v12, 31, v254
    v_lshlrev_b32 v12, 2, v12
    s_lshl_b32 s20, s25, 17
    v_add_u32 v4, s20, v1
    v_add_u32 v5, 32768, v4
    v_add_u32 v6, 65536, v4
    v_add_u32 v7, 98304, v4
    s_lshl_b32 s20, s25, 9
    v_lshrrev_b32 v213, 5, v254
    v_lshl_add_u32 v13, v213, 17, s20
    v_lshl_add_u32 v13, v12, 2, v13
    s_lshl_b32 s20, s17, 17
    s_add_u32 s20, s20, s57
    v_add_u32 v11, s20, v1
    v_lshrrev_b32 v203, 4, v254
    v_xor_b32 v204, v203, v201
    v_lshlrev_b32 v204, 3, v204
    v_lshl_add_u32 v208, v200, 5, v204
    s_lshl_b32 s21, s12, 12
    v_lshrrev_b32 v204, 2, v215
    v_xor_b32 v203, v203, v204
    v_lshlrev_b32 v203, 3, v203
    v_lshl_add_u32 v203, v215, 5, v203
    v_add_u32 v48, s21, v203
    s_lshl_b32 s19, s23, 14
    s_lshl_b32 s20, s22, 9
    s_add_u32 s21, s19, s20
    v_add_u32 v49, s21, v208
    v_xor_b32 v32, 512, v49
    s_add_u32 s20, s20, 57344
    v_add_u32 v33, s20, v208
    s_lshl_b32 s20, s22, 3
    v_add_u32 v56, 147456, v60
    s_lshl_b32 s19, s23, 6
    s_add_u32 s19, s19, s20
    v_add_u32 v57, s19, v56
    s_lshl_b32 s19, s12, 10
    s_add_u32 s19, s19, 151552
    v_add_u32 v55, s19, v1
    v_add_u32 v36, s20, v55
    v_xor_b32 v37, 8, v36
    s_lshl_b32 s19, s12, 9
    s_add_u32 s19, s19, 148480
    v_lshl_add_u32 v203, v213, 2, s19
    v_lshl_add_u32 v58, v12, 1, v203
    v_lshl_add_u32 v59, v215, 2, s19
    v_add_u32 v51, s19, v60
    v_lshlrev_b32 v203, 2, v215
    v_add_u32 v53, 147520, v203
    v_and_b32 v203, 7, v215
    v_lshl_add_u32 v62, v203, 8, v60
    v_mov_b32 v203, 0xffff
    v_mov_b32 v204, 0xffff0000
    v_cndmask_b32 v203, v203, v204, s[36:37]
    v_cndmask_b32 v46, 0, v203, s[44:45]
    v_cndmask_b32 v47, 0, v203, s[46:47]
    v_xor_b32 v44, v203, v46
    v_xor_b32 v45, v203, v47
    s_add_u32 s21, s12, 4
    s_min_u32 s21, s21, 5
    s_mul_i32 s19, s14, 12288
    s_add_u32 s19, s19, 65536
    s_lshl_b32 s20, s12, 11
    s_add_u32 s52, s19, s20
    s_lshl_b32 s20, s21, 11
    s_add_u32 s53, s19, s20
    v_bfe_u32 v203, v254, 4, 1
    v_lshlrev_b32 v203, 3, v203
    v_lshl_add_u32 v203, v213, 2, v203
    v_lshl_add_u32 v203, v201, 4, v203
    v_add_u32 v203, 147520, v203
    s_lshl_b32 s20, s12, 6
    v_add_u32 v38, s20, v203
    s_lshl_b32 s20, s21, 6
    v_add_u32 v39, s20, v203
    s_lshl_b32 s19, s14, 2
    s_add_u32 s19, s19, s12
    s_lshl_b32 s21, s19, 7
    v_mov_b32 v35, s21
    s_lshr_b32 s20, s19, 3
    s_and_b32 s19, s19, 7
    s_lshl_b32 s21, s13, 4
    s_add_u32 s20, s20, s21
    s_lshl_b32 s20, s20, 15
    s_lshl_b32 s19, s19, 9
    s_add_u32 s19, s19, s20
    v_lshl_add_u32 v50, v60, 3, s19
    v_accvgpr_write_b32 a252, -1
    v_accvgpr_write_b32 a253, -1
    v_accvgpr_write_b32 a254, -1
    v_accvgpr_write_b32 a255, -1
    v_mov_b32 v63, 0
    s_add_u32 s19, s58, s86
    buffer_store_dwordx4 a[252:255], v1, s[4:7], s19 offen sc1
    s_mov_b64 exec, s[42:43]
    buffer_store_dwordx4 a[252:255], v60, s[4:7], s54 offen sc1
    s_mov_b64 exec, 1
    buffer_store_dword v63, off, s[4:7], s31 sc1
    buffer_store_dword v63, off, s[4:7], s33 sc1
    s_mov_b64 exec, -1
    s_waitcnt vmcnt(4)
    buffer_load_dword v212, v211, s[4:7], s26 offen sc1
    ds_read_b64_tr_b16 v[224:225], v206 offset:49152
    ds_read_b64_tr_b16 v[226:227], v206 offset:49408
    ds_read_b64_tr_b16 v[228:229], v206 offset:49160
    ds_read_b64_tr_b16 v[230:231], v206 offset:49416
    ds_read_b64_tr_b16 a[240:241], v206 offset:51200
    ds_read_b64_tr_b16 a[242:243], v206 offset:51456
    ds_read_b64_tr_b16 a[244:245], v206 offset:51208
    ds_read_b64_tr_b16 a[246:247], v206 offset:51464
    s_waitcnt lgkmcnt(0)
    buffer_store_dwordx4 v[224:227], v1, s[4:7], s3 offen offset:0 sc1
    buffer_store_dwordx4 v[228:231], v1, s[4:7], s3 offen offset:1024 sc1
    ds_read_b64_tr_b16 a[24:25], v206 offset:24576
    ds_read_b64_tr_b16 a[26:27], v206 offset:24832
    ds_read_b64_tr_b16 a[28:29], v206 offset:24584
    ds_read_b64_tr_b16 a[30:31], v206 offset:24840
    ds_read_b64_tr_b16 a[32:33], v206 offset:26624
    ds_read_b64_tr_b16 a[34:35], v206 offset:26880
    ds_read_b64_tr_b16 a[36:37], v206 offset:26632
    ds_read_b64_tr_b16 a[38:39], v206 offset:26888
    ds_read_b64_tr_b16 a[40:41], v206 offset:28672
    ds_read_b64_tr_b16 a[42:43], v206 offset:28928
    ds_read_b64_tr_b16 a[44:45], v206 offset:28680
    ds_read_b64_tr_b16 a[46:47], v206 offset:28936
    s_waitcnt lgkmcnt(10)
    v_mfma_f32_16x16x32_bf16 a[248:251], a[24:27], v[96:99], 0
    s_waitcnt lgkmcnt(8)
    v_mfma_f32_16x16x32_bf16 a[248:251], a[28:31], v[100:103], a[248:251]
    s_waitcnt lgkmcnt(6)
    v_mfma_f32_16x16x32_bf16 a[248:251], a[32:35], v[104:107], a[248:251]
    s_waitcnt lgkmcnt(4)
    v_mfma_f32_16x16x32_bf16 a[248:251], a[36:39], v[108:111], a[248:251]
    s_waitcnt lgkmcnt(2)
    v_mfma_f32_16x16x32_bf16 a[248:251], a[40:43], v[112:115], a[248:251]
    s_waitcnt lgkmcnt(0)
    v_mfma_f32_16x16x32_bf16 a[248:251], a[44:47], v[116:119], a[248:251]
    v_mov_b32 v63, 1
    s_waitcnt vmcnt(2)
    s_cmp_lg_u32 s12, 0
    s_cbranch_scc1 L_faok
    v_cmp_eq_u32 vcc, 0, v212
    s_cbranch_vccz L_fad
    s_mov_b32 s61, 1048576
L_spin_1:
    buffer_load_dword v212, v211, s[4:7], s26 offen sc1
    s_sub_u32 s61, s61, 1
    s_waitcnt vmcnt(0)
    v_cmp_eq_u32 vcc, 0, v212
    s_cbranch_scc1 L_spind_2
    s_cbranch_vccnz L_spin_1
L_spind_2:
L_fad:
    v_cmp_ne_u32 s[20:21], s29, v212
    s_nop 1
    v_mov_b32 v212, s20
    ds_write_b32 v56, v212
    s_waitcnt lgkmcnt(0)
L_faok:
    s_barrier
    ds_read_b32 v216, v56
L_layer0:
    ds_read_b128 v[192:195], v1 offset:24576
    ds_read_b128 v[196:199], v1 offset:25600
    ds_read_b128 v[200:203], v1 offset:26624
    ds_read_b128 v[204:207], v1 offset:27648
    ds_read_b128 v[208:211], v1 offset:28672
    ds_read_b128 v[212:215], v1 offset:29696
    buffer_load_dwordx4 a[48:51], v4, s[4:7], s86 offen offset:0 sc1
    buffer_load_dwordx4 a[52:55], v5, s[4:7], s86 offen offset:0 sc1
    buffer_load_dwordx4 a[56:59], v6, s[4:7], s86 offen offset:0 sc1
    buffer_load_dwordx4 a[60:63], v7, s[4:7], s86 offen offset:0 sc1
    buffer_load_dwordx4 a[64:67], v4, s[4:7], s86 offen offset:1024 sc1
    buffer_load_dwordx4 a[68:71], v5, s[4:7], s86 offen offset:1024 sc1
    buffer_load_dwordx4 a[72:75], v6, s[4:7], s86 offen offset:1024 sc1
    buffer_load_dwordx4 a[76:79], v7, s[4:7], s86 offen offset:1024 sc1
    buffer_load_dwordx4 a[80:83], v4, s[4:7], s86 offen offset:2048 sc1
    buffer_load_dwordx4 a[84:87], v5, s[4:7], s86 offen offset:2048 sc1
    buffer_load_dwordx4 a[88:91], v6, s[4:7], s86 offen offset:2048 sc1
    buffer_load_dwordx4 a[92:95], v7, s[4:7], s86 offen offset:2048 sc1
    s_add_u32 m0, s57, 49152
    s_add_u32 s63, s95, 8388608
    buffer_load_dwordx4 v10, s[4:7], s63 offen offset:0 lds
    buffer_load_dwordx4 v10, s[4:7], s63 offen offset:1024 lds
    buffer_load_dwordx4 v10, s[4:7], s63 offen offset:2048 lds
    buffer_load_dwordx4 v10, s[4:7], s63 offen offset:3072 lds
    s_add_u32 m0, s57, 53248
    s_add_u32 s63, s95, 8392704
    buffer_load_dwordx4 v10, s[4:7], s63 offen offset:0 lds
    buffer_load_dwordx4 v10, s[4:7], s63 offen offset:1024 lds
    s_waitcnt lgkmcnt(6)
    v_readfirstlane_b32 s15, v216
    s_waitcnt vmcnt(14)
    s_waitcnt lgkmcnt(5)
    v_mfma_f32_16x16x32_bf16 v[64:67], v[192:195], a[48:51], 0
    v_mfma_f32_16x16x32_bf16 v[68:71], v[192:195], a[52:55], 0
    buffer_load_dwordx4 a[96:99], v4, s[4:7], s86 offen offset:3072 sc1
    v_mfma_f32_16x16x32_bf16 v[72:75], v[192:195], a[56:59], 0
    v_mfma_f32_16x16x32_bf16 v[76:79], v[192:195], a[60:63], 0
    ds_read_b128 v[192:195], v1 offset:30720
    s_waitcnt lgkmcnt(5)
    v_mfma_f32_16x16x32_bf16 v[92:95], v[196:199], a[60:63], 0
    v_mfma_f32_16x16x32_bf16 v[88:91], v[196:199], a[56:59], 0
    buffer_load_dwordx4 a[100:103], v5, s[4:7], s86 offen offset:3072 sc1
    v_mfma_f32_16x16x32_bf16 v[84:87], v[196:199], a[52:55], 0
    v_mfma_f32_16x16x32_bf16 v[80:83], v[196:199], a[48:51], 0
    ds_read_b128 v[196:199], v1 offset:31744
    s_waitcnt lgkmcnt(5)
    v_mfma_f32_16x16x32_bf16 v[96:99], v[200:203], a[48:51], 0
    v_mfma_f32_16x16x32_bf16 v[100:103], v[200:203], a[52:55], 0
    buffer_load_dwordx4 a[104:107], v6, s[4:7], s86 offen offset:3072 sc1
    v_mfma_f32_16x16x32_bf16 v[104:107], v[200:203], a[56:59], 0
    v_mfma_f32_16x16x32_bf16 v[108:111], v[200:203], a[60:63], 0
    ds_read_b128 v[200:203], v1 offset:32768
    s_waitcnt lgkmcnt(5)
    v_mfma_f32_16x16x32_bf16 v[124:127], v[204:207], a[60:63], 0
    v_mfma_f32_16x16x32_bf16 v[120:123], v[204:207], a[56:59], 0
    buffer_load_dwordx4 a[108:111], v7, s[4:7], s86 offen offset:3072 sc1
    v_mfma_f32_16x16x32_bf16 v[116:119], v[204:207], a[52:55], 0
    v_mfma_f32_16x16x32_bf16 v[112:115], v[204:207], a[48:51], 0
    ds_read_b128 v[204:207], v1 offset:33792
    s_waitcnt lgkmcnt(5)
    v_mfma_f32_16x16x32_bf16 v[128:131], v[208:211], a[48:51], 0
    v_mfma_f32_16x16x32_bf16 v[132:135], v[208:211], a[52:55], 0
    v_mfma_f32_16x16x32_bf16 v[136:139], v[208:211], a[56:59], 0
    v_mfma_f32_16x16x32_bf16 v[140:143], v[208:211], a[60:63], 0
    ds_read_b128 v[208:211], v1 offset:34816
    s_waitcnt lgkmcnt(5)
    v_mfma_f32_16x16x32_bf16 v[156:159], v[212:215], a[60:63], 0
    v_mfma_f32_16x16x32_bf16 v[152:155], v[212:215], a[56:59], 0
    v_mfma_f32_16x16x32_bf16 v[148:151], v[212:215], a[52:55], 0
    v_mfma_f32_16x16x32_bf16 v[144:147], v[212:215], a[48:51], 0
    ds_read_b128 v[212:215], v1 offset:35840
    s_waitcnt vmcnt(14)
    s_waitcnt lgkmcnt(5)
    v_mfma_f32_16x16x32_bf16 v[64:67], v[192:195], a[64:67], v[64:67]
    v_mfma_f32_16x16x32_bf16 v[68:71], v[192:195], a[68:71], v[68:71]
    buffer_load_dwordx4 a[112:115], v4, s[4:7], s87 offen offset:0 sc1
    v_mfma_f32_16x16x32_bf16 v[72:75], v[192:195], a[72:75], v[72:75]
    v_mfma_f32_16x16x32_bf16 v[76:79], v[192:195], a[76:79], v[76:79]
    ds_read_b128 v[192:195], v1 offset:36864
    s_waitcnt lgkmcnt(5)
    v_mfma_f32_16x16x32_bf16 v[92:95], v[196:199], a[76:79], v[92:95]
    s_add_u32 m0, s57, 73728
    s_add_u32 s63, s96, 8388608
    v_mfma_f32_16x16x32_bf16 v[88:91], v[196:199], a[72:75], v[88:91]
    buffer_load_dwordx4 v10, s[4:7], s63 offen offset:0 lds
    v_mfma_f32_16x16x32_bf16 v[84:87], v[196:199], a[68:71], v[84:87]
    v_mfma_f32_16x16x32_bf16 v[80:83], v[196:199], a[64:67], v[80:83]
    ds_read_b128 v[196:199], v1 offset:37888
    s_waitcnt lgkmcnt(5)
    v_mfma_f32_16x16x32_bf16 v[96:99], v[200:203], a[64:67], v[96:99]
    v_mfma_f32_16x16x32_bf16 v[100:103], v[200:203], a[68:71], v[100:103]
    buffer_load_dwordx4 a[116:119], v5, s[4:7], s87 offen offset:0 sc1
    v_mfma_f32_16x16x32_bf16 v[104:107], v[200:203], a[72:75], v[104:107]
    v_mfma_f32_16x16x32_bf16 v[108:111], v[200:203], a[76:79], v[108:111]
    ds_read_b128 v[200:203], v1 offset:38912
    s_waitcnt lgkmcnt(5)
    v_mfma_f32_16x16x32_bf16 v[124:127], v[204:207], a[76:79], v[124:127]
    v_mfma_f32_16x16x32_bf16 v[120:123], v[204:207], a[72:75], v[120:123]
    buffer_load_dwordx4 a[120:123], v6, s[4:7], s87 offen offset:0 sc1
    v_mfma_f32_16x16x32_bf16 v[116:119], v[204:207], a[68:71], v[116:119]
    v_mfma_f32_16x16x32_bf16 v[112:115], v[204:207], a[64:67], v[112:115]
    ds_read_b128 v[204:207], v1 offset:39936
    s_waitcnt lgkmcnt(5)
    v_mfma_f32_16x16x32_bf16 v[128:131], v[208:211], a[64:67], v[128:131]
    s_mov_b32 s19, 1048576
    v_mfma_f32_16x16x32_bf16 v[132:135], v[208:211], a[68:71], v[132:135]
    buffer_load_dwordx4 v[160:163], v13, s[4:7], s19 offen sc1
    v_mfma_f32_16x16x32_bf16 v[136:139], v[208:211], a[72:75], v[136:139]
    v_mfma_f32_16x16x32_bf16 v[140:143], v[208:211], a[76:79], v[140:143]
    ds_read_b128 v[208:211], v1 offset:40960
    s_waitcnt lgkmcnt(5)
    v_mfma_f32_16x16x32_bf16 v[156:159], v[212:215], a[76:79], v[156:159]
    v_mfma_f32_16x16x32_bf16 v[152:155], v[212:215], a[72:75], v[152:155]
    buffer_load_dwordx4 a[124:127], v7, s[4:7], s87 offen offset:0 sc1
    v_mfma_f32_16x16x32_bf16 v[148:151], v[212:215], a[68:71], v[148:151]
    v_mfma_f32_16x16x32_bf16 v[144:147], v[212:215], a[64:67], v[144:147]
    ds_read_b128 v[212:215], v1 offset:41984
    s_waitcnt vmcnt(16)
    s_waitcnt lgkmcnt(5)
    v_mfma_f32_16x16x32_bf16 v[64:67], v[192:195], a[80:83], v[64:67]
    v_mfma_f32_16x16x32_bf16 v[68:71], v[192:195], a[84:87], v[68:71]
    buffer_load_dwordx4 a[128:131], v4, s[4:7], s87 offen offset:1024 sc1
    v_mfma_f32_16x16x32_bf16 v[72:75], v[192:195], a[88:91], v[72:75]
    v_mfma_f32_16x16x32_bf16 v[76:79], v[192:195], a[92:95], v[76:79]
    ds_read_b128 v[192:195], v1 offset:43008
    s_waitcnt lgkmcnt(5)
    v_mfma_f32_16x16x32_bf16 v[92:95], v[196:199], a[92:95], v[92:95]
    v_mfma_f32_16x16x32_bf16 v[88:91], v[196:199], a[88:91], v[88:91]
    buffer_load_dwordx4 v10, s[4:7], s63 offen offset:1024 lds
    v_mfma_f32_16x16x32_bf16 v[84:87], v[196:199], a[84:87], v[84:87]
    v_mfma_f32_16x16x32_bf16 v[80:83], v[196:199], a[80:83], v[80:83]
    ds_read_b128 v[196:199], v1 offset:44032
    s_waitcnt lgkmcnt(5)
    v_mfma_f32_16x16x32_bf16 v[96:99], v[200:203], a[80:83], v[96:99]
    v_mfma_f32_16x16x32_bf16 v[100:103], v[200:203], a[84:87], v[100:103]
    buffer_load_dwordx4 a[132:135], v5, s[4:7], s87 offen offset:1024 sc1
    v_mfma_f32_16x16x32_bf16 v[104:107], v[200:203], a[88:91], v[104:107]
    v_mfma_f32_16x16x32_bf16 v[108:111], v[200:203], a[92:95], v[108:111]
    ds_read_b128 v[200:203], v1 offset:45056
    s_waitcnt lgkmcnt(5)
    v_mfma_f32_16x16x32_bf16 v[124:127], v[204:207], a[92:95], v[124:127]
    v_mfma_f32_16x16x32_bf16 v[120:123], v[204:207], a[88:91], v[120:123]
    buffer_load_dwordx4 a[136:139], v6, s[4:7], s87 offen offset:1024 sc1
    v_mfma_f32_16x16x32_bf16 v[116:119], v[204:207], a[84:87], v[116:119]
    v_mfma_f32_16x16x32_bf16 v[112:115], v[204:207], a[80:83], v[112:115]
    ds_read_b128 v[204:207], v1 offset:46080
    s_waitcnt lgkmcnt(5)
    v_mfma_f32_16x16x32_bf16 v[128:131], v[208:211], a[80:83], v[128:131]
    v_mfma_f32_16x16x32_bf16 v[132:135], v[208:211], a[84:87], v[132:135]
    buffer_load_dwordx4 v10, s[4:7], s63 offen offset:2048 lds
    v_mfma_f32_16x16x32_bf16 v[136:139], v[208:211], a[88:91], v[136:139]
    v_mfma_f32_16x16x32_bf16 v[140:143], v[208:211], a[92:95], v[140:143]
    ds_read_b128 v[208:211], v1 offset:47104
    s_waitcnt lgkmcnt(5)
    v_mfma_f32_16x16x32_bf16 v[156:159], v[212:215], a[92:95], v[156:159]
    v_mfma_f32_16x16x32_bf16 v[152:155], v[212:215], a[88:91], v[152:155]
    buffer_load_dwordx4 a[140:143], v7, s[4:7], s87 offen offset:1024 sc1
    v_mfma_f32_16x16x32_bf16 v[148:151], v[212:215], a[84:87], v[148:151]
    v_mfma_f32_16x16x32_bf16 v[144:147], v[212:215], a[80:83], v[144:147]
    ds_read_b128 v[212:215], v1 offset:48128
    s_waitcnt vmcnt(12)
    s_barrier
    s_waitcnt lgkmcnt(5)
    v_mfma_f32_16x16x32_bf16 v[64:67], v[192:195], a[96:99], v[64:67]
    v_mfma_f32_16x16x32_bf16 v[68:71], v[192:195], a[100:103], v[68:71]
    buffer_load_dwordx4 a[48:51], v4, s[4:7], s87 offen offset:2048 sc1
    v_mfma_f32_16x16x32_bf16 v[72:75], v[192:195], a[104:107], v[72:75]
    v_mfma_f32_16x16x32_bf16 v[76:79], v[192:195], a[108:111], v[76:79]
    ds_read_b128 v[192:195], v1 offset:49152
    s_waitcnt lgkmcnt(5)
    v_mfma_f32_16x16x32_bf16 v[92:95], v[196:199], a[108:111], v[92:95]
    v_mfma_f32_16x16x32_bf16 v[88:91], v[196:199], a[104:107], v[88:91]
    buffer_load_dwordx4 v10, s[4:7], s63 offen offset:3072 lds
    v_mfma_f32_16x16x32_bf16 v[84:87], v[196:199], a[100:103], v[84:87]
    v_mfma_f32_16x16x32_bf16 v[80:83], v[196:199], a[96:99], v[80:83]
    ds_read_b128 v[196:199], v1 offset:50176
    s_waitcnt lgkmcnt(5)
    v_mfma_f32_16x16x32_bf16 v[96:99], v[200:203], a[96:99], v[96:99]
    v_mfma_f32_16x16x32_bf16 v[100:103], v[200:203], a[100:103], v[100:103]
    buffer_load_dwordx4 a[52:55], v5, s[4:7], s87 offen offset:2048 sc1
    v_mfma_f32_16x16x32_bf16 v[104:107], v[200:203], a[104:107], v[104:107]
    v_mfma_f32_16x16x32_bf16 v[108:111], v[200:203], a[108:111], v[108:111]
    ds_read_b128 v[200:203], v1 offset:51200
    s_waitcnt lgkmcnt(5)
    v_mfma_f32_16x16x32_bf16 v[124:127], v[204:207], a[108:111], v[124:127]
    v_mfma_f32_16x16x32_bf16 v[120:123], v[204:207], a[104:107], v[120:123]
    buffer_load_dwordx4 a[56:59], v6, s[4:7], s87 offen offset:2048 sc1
    v_mfma_f32_16x16x32_bf16 v[116:119], v[204:207], a[100:103], v[116:119]
    v_mfma_f32_16x16x32_bf16 v[112:115], v[204:207], a[96:99], v[112:115]
    ds_read_b128 v[204:207], v1 offset:52224
    s_waitcnt lgkmcnt(5)
    v_mfma_f32_16x16x32_bf16 v[128:131], v[208:211], a[96:99], v[128:131]
    s_mov_b32 s19, 1064960
    v_mfma_f32_16x16x32_bf16 v[132:135], v[208:211], a[100:103], v[132:135]
    buffer_load_dwordx4 v[164:167], v13, s[4:7], s19 offen sc1
    v_mfma_f32_16x16x32_bf16 v[136:139], v[208:211], a[104:107], v[136:139]
    v_mfma_f32_16x16x32_bf16 v[140:143], v[208:211], a[108:111], v[140:143]
    ds_read_b128 v[208:211], v1 offset:53248
    s_waitcnt lgkmcnt(5)
    v_mfma_f32_16x16x32_bf16 v[156:159], v[212:215], a[108:111], v[156:159]
    v_mfma_f32_16x16x32_bf16 v[152:155], v[212:215], a[104:107], v[152:155]
    buffer_load_dwordx4 a[60:63], v7, s[4:7], s87 offen offset:2048 sc1
    v_mfma_f32_16x16x32_bf16 v[148:151], v[212:215], a[100:103], v[148:151]
    v_mfma_f32_16x16x32_bf16 v[144:147], v[212:215], a[96:99], v[144:147]
    ds_read_b128 v[212:215], v1 offset:54272
    s_waitcnt vmcnt(12)
    s_waitcnt lgkmcnt(5)
    v_mfma_f32_16x16x32_bf16 v[64:67], v[192:195], a[112:115], v[64:67]
    v_mfma_f32_16x16x32_bf16 v[68:71], v[192:195], a[116:119], v[68:71]
    buffer_load_dwordx4 a[64:67], v4, s[4:7], s87 offen offset:3072 sc1
    v_mfma_f32_16x16x32_bf16 v[72:75], v[192:195], a[120:123], v[72:75]
    v_mfma_f32_16x16x32_bf16 v[76:79], v[192:195], a[124:127], v[76:79]
    ds_read_b128 v[192:195], v1 offset:55296
    s_waitcnt lgkmcnt(5)
    v_mfma_f32_16x16x32_bf16 v[92:95], v[196:199], a[124:127], v[92:95]
    s_add_u32 m0, s57, 77824
    s_add_u32 s63, s96, 8392704
    v_mfma_f32_16x16x32_bf16 v[88:91], v[196:199], a[120:123], v[88:91]
    buffer_load_dwordx4 v10, s[4:7], s63 offen offset:0 lds
    v_mfma_f32_16x16x32_bf16 v[84:87], v[196:199], a[116:119], v[84:87]
    v_mfma_f32_16x16x32_bf16 v[80:83], v[196:199], a[112:115], v[80:83]
    ds_read_b128 v[196:199], v1 offset:56320
    s_waitcnt lgkmcnt(5)
    v_mfma_f32_16x16x32_bf16 v[96:99], v[200:203], a[112:115], v[96:99]
    v_mfma_f32_16x16x32_bf16 v[100:103], v[200:203], a[116:119], v[100:103]
    buffer_load_dwordx4 a[68:71], v5, s[4:7], s87 offen offset:3072 sc1
    v_mfma_f32_16x16x32_bf16 v[104:107], v[200:203], a[120:123], v[104:107]
    v_mfma_f32_16x16x32_bf16 v[108:111], v[200:203], a[124:127], v[108:111]
    ds_read_b128 v[200:203], v1 offset:57344
    s_waitcnt lgkmcnt(5)
    v_mfma_f32_16x16x32_bf16 v[124:127], v[204:207], a[124:127], v[124:127]
    v_mfma_f32_16x16x32_bf16 v[120:123], v[204:207], a[120:123], v[120:123]
    buffer_load_dwordx4 a[72:75], v6, s[4:7], s87 offen offset:3072 sc1
    v_mfma_f32_16x16x32_bf16 v[116:119], v[204:207], a[116:119], v[116:119]
    s_mov_b64 exec, 1
    buffer_store_dword v63, off, s[4:7], s55 offset:0 sc1
    s_mov_b64 exec, -1
    v_mfma_f32_16x16x32_bf16 v[112:115], v[204:207], a[112:115], v[112:115]
    ds_read_b128 v[204:207], v1 offset:58368
    s_waitcnt lgkmcnt(5)
    v_mfma_f32_16x16x32_bf16 v[128:131], v[208:211], a[112:115], v[128:131]
    v_mfma_f32_16x16x32_bf16 v[132:135], v[208:211], a[116:119], v[132:135]
    buffer_load_dwordx4 v10, s[4:7], s63 offen offset:1024 lds
    v_mfma_f32_16x16x32_bf16 v[136:139], v[208:211], a[120:123], v[136:139]
    v_mfma_f32_16x16x32_bf16 v[140:143], v[208:211], a[124:127], v[140:143]
    ds_read_b128 v[208:211], v1 offset:59392
    s_waitcnt lgkmcnt(5)
    v_mfma_f32_16x16x32_bf16 v[156:159], v[212:215], a[124:127], v[156:159]
    v_mfma_f32_16x16x32_bf16 v[152:155], v[212:215], a[120:123], v[152:155]
    buffer_load_dwordx4 a[76:79], v7, s[4:7], s87 offen offset:3072 sc1
    v_mfma_f32_16x16x32_bf16 v[148:151], v[212:215], a[116:119], v[148:151]
    v_mfma_f32_16x16x32_bf16 v[144:147], v[212:215], a[112:115], v[144:147]
    ds_read_b128 v[212:215], v1 offset:60416
    s_waitcnt vmcnt(13)
    s_waitcnt lgkmcnt(5)
    v_mfma_f32_16x16x32_bf16 v[64:67], v[192:195], a[128:131], v[64:67]
    v_mfma_f32_16x16x32_bf16 v[68:71], v[192:195], a[132:135], v[68:71]
    buffer_load_dwordx4 a[80:83], v4, s[4:7], s88 offen offset:0 sc1
    v_mfma_f32_16x16x32_bf16 v[72:75], v[192:195], a[136:139], v[72:75]
    v_mfma_f32_16x16x32_bf16 v[76:79], v[192:195], a[140:143], v[76:79]
    ds_read_b128 v[192:195], v1 offset:61440
    s_waitcnt lgkmcnt(5)
    v_mfma_f32_16x16x32_bf16 v[92:95], v[196:199], a[140:143], v[92:95]
    s_add_u32 m0, s57, 98304
    s_add_u32 s63, s97, 8388608
    v_mfma_f32_16x16x32_bf16 v[88:91], v[196:199], a[136:139], v[88:91]
    buffer_load_dwordx4 v10, s[4:7], s63 offen offset:0 lds
    v_mfma_f32_16x16x32_bf16 v[84:87], v[196:199], a[132:135], v[84:87]
    v_mfma_f32_16x16x32_bf16 v[80:83], v[196:199], a[128:131], v[80:83]
    ds_read_b128 v[196:199], v1 offset:62464
    s_waitcnt lgkmcnt(5)
    v_mfma_f32_16x16x32_bf16 v[96:99], v[200:203], a[128:131], v[96:99]
    v_mfma_f32_16x16x32_bf16 v[100:103], v[200:203], a[132:135], v[100:103]
    buffer_load_dwordx4 a[84:87], v5, s[4:7], s88 offen offset:0 sc1
    v_mfma_f32_16x16x32_bf16 v[104:107], v[200:203], a[136:139], v[104:107]
    v_mfma_f32_16x16x32_bf16 v[108:111], v[200:203], a[140:143], v[108:111]
    ds_read_b128 v[200:203], v1 offset:63488
    s_waitcnt lgkmcnt(5)
    v_mfma_f32_16x16x32_bf16 v[124:127], v[204:207], a[140:143], v[124:127]
    v_mfma_f32_16x16x32_bf16 v[120:123], v[204:207], a[136:139], v[120:123]
    buffer_load_dwordx4 a[88:91], v6, s[4:7], s88 offen offset:0 sc1
    v_mfma_f32_16x16x32_bf16 v[116:119], v[204:207], a[132:135], v[116:119]
    buffer_load_dwordx4 v[224:227], v1, s[4:7], s52 offen offset:0 sc1
    v_mfma_f32_16x16x32_bf16 v[112:115], v[204:207], a[128:131], v[112:115]
    ds_read_b128 v[204:207], v1 offset:64512
    s_waitcnt lgkmcnt(5)
    v_mfma_f32_16x16x32_bf16 v[128:131], v[208:211], a[128:131], v[128:131]
    s_mov_b32 s19, 1081344
    v_mfma_f32_16x16x32_bf16 v[132:135], v[208:211], a[132:135], v[132:135]
    buffer_load_dwordx4 v[168:171], v13, s[4:7], s19 offen sc1
    v_mfma_f32_16x16x32_bf16 v[136:139], v[208:211], a[136:139], v[136:139]
    v_mfma_f32_16x16x32_bf16 v[140:143], v[208:211], a[140:143], v[140:143]
    ds_read_b128 v[208:211], v2 offset:0
    s_waitcnt lgkmcnt(5)
    v_mfma_f32_16x16x32_bf16 v[156:159], v[212:215], a[140:143], v[156:159]
    v_mfma_f32_16x16x32_bf16 v[152:155], v[212:215], a[136:139], v[152:155]
    buffer_load_dwordx4 a[92:95], v7, s[4:7], s88 offen offset:0 sc1
    v_mfma_f32_16x16x32_bf16 v[148:151], v[212:215], a[132:135], v[148:151]
    v_mfma_f32_16x16x32_bf16 v[144:147], v[212:215], a[128:131], v[144:147]
    ds_read_b128 v[212:215], v2 offset:1024
    s_waitcnt vmcnt(14)
    s_waitcnt lgkmcnt(5)
    v_mfma_f32_16x16x32_bf16 v[64:67], v[192:195], a[48:51], v[64:67]
    v_mfma_f32_16x16x32_bf16 v[68:71], v[192:195], a[52:55], v[68:71]
    buffer_load_dwordx4 a[96:99], v4, s[4:7], s88 offen offset:1024 sc1
    v_mfma_f32_16x16x32_bf16 v[72:75], v[192:195], a[56:59], v[72:75]
    v_mfma_f32_16x16x32_bf16 v[76:79], v[192:195], a[60:63], v[76:79]
    ds_read_b128 v[192:195], v2 offset:2048
    s_waitcnt lgkmcnt(5)
    v_mfma_f32_16x16x32_bf16 v[92:95], v[196:199], a[60:63], v[92:95]
    v_mfma_f32_16x16x32_bf16 v[88:91], v[196:199], a[56:59], v[88:91]
    buffer_load_dwordx4 v10, s[4:7], s63 offen offset:1024 lds
    v_mfma_f32_16x16x32_bf16 v[84:87], v[196:199], a[52:55], v[84:87]
    v_mfma_f32_16x16x32_bf16 v[80:83], v[196:199], a[48:51], v[80:83]
    ds_read_b128 v[196:199], v2 offset:3072
    s_waitcnt lgkmcnt(5)
    v_mfma_f32_16x16x32_bf16 v[96:99], v[200:203], a[48:51], v[96:99]
    v_mfma_f32_16x16x32_bf16 v[100:103], v[200:203], a[52:55], v[100:103]
    buffer_load_dwordx4 a[100:103], v5, s[4:7], s88 offen offset:1024 sc1
    v_mfma_f32_16x16x32_bf16 v[104:107], v[200:203], a[56:59], v[104:107]
    v_mfma_f32_16x16x32_bf16 v[108:111], v[200:203], a[60:63], v[108:111]
    ds_read_b128 v[200:203], v2 offset:4096
    s_waitcnt lgkmcnt(5)
    v_mfma_f32_16x16x32_bf16 v[124:127], v[204:207], a[60:63], v[124:127]
    v_mfma_f32_16x16x32_bf16 v[120:123], v[204:207], a[56:59], v[120:123]
    buffer_load_dwordx4 a[104:107], v6, s[4:7], s88 offen offset:1024 sc1
    v_mfma_f32_16x16x32_bf16 v[116:119], v[204:207], a[52:55], v[116:119]
    buffer_load_dwordx4 v[228:231], v1, s[4:7], s53 offen offset:0 sc1
    v_mfma_f32_16x16x32_bf16 v[112:115], v[204:207], a[48:51], v[112:115]
    ds_read_b128 v[204:207], v2 offset:5120
    s_waitcnt lgkmcnt(5)
    v_mfma_f32_16x16x32_bf16 v[128:131], v[208:211], a[48:51], v[128:131]
    v_mfma_f32_16x16x32_bf16 v[132:135], v[208:211], a[52:55], v[132:135]
    buffer_load_dwordx4 v10, s[4:7], s63 offen offset:2048 lds
    v_mfma_f32_16x16x32_bf16 v[136:139], v[208:211], a[56:59], v[136:139]
    v_mfma_f32_16x16x32_bf16 v[140:143], v[208:211], a[60:63], v[140:143]
    ds_read_b128 v[208:211], v2 offset:6144
    s_waitcnt lgkmcnt(5)
    v_mfma_f32_16x16x32_bf16 v[156:159], v[212:215], a[60:63], v[156:159]
    v_mfma_f32_16x16x32_bf16 v[152:155], v[212:215], a[56:59], v[152:155]
    buffer_load_dwordx4 a[108:111], v7, s[4:7], s88 offen offset:1024 sc1
    v_mfma_f32_16x16x32_bf16 v[148:151], v[212:215], a[52:55], v[148:151]
    v_mfma_f32_16x16x32_bf16 v[144:147], v[212:215], a[48:51], v[144:147]
    ds_read_b128 v[212:215], v2 offset:7168
    s_waitcnt vmcnt(14)
    s_barrier
    s_waitcnt lgkmcnt(5)
    v_mfma_f32_16x16x32_bf16 v[64:67], v[192:195], a[64:67], v[64:67]
    v_mfma_f32_16x16x32_bf16 v[68:71], v[192:195], a[68:71], v[68:71]
    buffer_load_dwordx4 a[112:115], v4, s[4:7], s88 offen offset:2048 sc1
    v_mfma_f32_16x16x32_bf16 v[72:75], v[192:195], a[72:75], v[72:75]
    v_mfma_f32_16x16x32_bf16 v[76:79], v[192:195], a[76:79], v[76:79]
    ds_read_b128 v[192:195], v2 offset:8192
    s_waitcnt lgkmcnt(5)
    v_mfma_f32_16x16x32_bf16 v[92:95], v[196:199], a[76:79], v[92:95]
    v_mfma_f32_16x16x32_bf16 v[88:91], v[196:199], a[72:75], v[88:91]
    buffer_load_dwordx4 v10, s[4:7], s63 offen offset:3072 lds
    v_mfma_f32_16x16x32_bf16 v[84:87], v[196:199], a[68:71], v[84:87]
    v_mfma_f32_16x16x32_bf16 v[80:83], v[196:199], a[64:67], v[80:83]
    ds_read_b128 v[196:199], v2 offset:9216
    s_waitcnt lgkmcnt(5)
    v_mfma_f32_16x16x32_bf16 v[96:99], v[200:203], a[64:67], v[96:99]
    v_mfma_f32_16x16x32_bf16 v[100:103], v[200:203], a[68:71], v[100:103]
    buffer_load_dwordx4 a[116:119], v5, s[4:7], s88 offen offset:2048 sc1
    v_mfma_f32_16x16x32_bf16 v[104:107], v[200:203], a[72:75], v[104:107]
    v_mfma_f32_16x16x32_bf16 v[108:111], v[200:203], a[76:79], v[108:111]
    ds_read_b128 v[200:203], v2 offset:10240
    s_waitcnt lgkmcnt(5)
    v_mfma_f32_16x16x32_bf16 v[124:127], v[204:207], a[76:79], v[124:127]
    v_mfma_f32_16x16x32_bf16 v[120:123], v[204:207], a[72:75], v[120:123]
    buffer_load_dwordx4 a[120:123], v6, s[4:7], s88 offen offset:2048 sc1
    v_mfma_f32_16x16x32_bf16 v[116:119], v[204:207], a[68:71], v[116:119]
    buffer_load_dwordx4 v[232:235], v1, s[4:7], s52 offen offset:1024 sc1
    v_mfma_f32_16x16x32_bf16 v[112:115], v[204:207], a[64:67], v[112:115]
    ds_read_b128 v[204:207], v2 offset:11264
    s_waitcnt lgkmcnt(5)
    v_mfma_f32_16x16x32_bf16 v[128:131], v[208:211], a[64:67], v[128:131]
    s_mov_b32 s19, 1097728
    v_mfma_f32_16x16x32_bf16 v[132:135], v[208:211], a[68:71], v[132:135]
    buffer_load_dwordx4 v[172:175], v13, s[4:7], s19 offen sc1
    v_mfma_f32_16x16x32_bf16 v[136:139], v[208:211], a[72:75], v[136:139]
    v_mfma_f32_16x16x32_bf16 v[140:143], v[208:211], a[76:79], v[140:143]
    ds_read_b128 v[208:211], v2 offset:12288
    s_waitcnt lgkmcnt(5)
    v_mfma_f32_16x16x32_bf16 v[156:159], v[212:215], a[76:79], v[156:159]
    v_mfma_f32_16x16x32_bf16 v[152:155], v[212:215], a[72:75], v[152:155]
    buffer_load_dwordx4 a[124:127], v7, s[4:7], s88 offen offset:2048 sc1
    v_mfma_f32_16x16x32_bf16 v[148:151], v[212:215], a[68:71], v[148:151]
    v_mfma_f32_16x16x32_bf16 v[144:147], v[212:215], a[64:67], v[144:147]
    ds_read_b128 v[212:215], v2 offset:13312
    s_waitcnt vmcnt(14)
    s_waitcnt lgkmcnt(5)
    v_mfma_f32_16x16x32_bf16 v[64:67], v[192:195], a[80:83], v[64:67]
    ds_read_b128 a[192:195], v34 offset:0
    v_mfma_f32_16x16x32_bf16 v[68:71], v[192:195], a[84:87], v[68:71]
    buffer_load_dwordx4 a[128:131], v4, s[4:7], s88 offen offset:3072 sc1
    v_mfma_f32_16x16x32_bf16 v[72:75], v[192:195], a[88:91], v[72:75]
    ds_read_b128 a[196:199], v34 offset:1024
    v_mfma_f32_16x16x32_bf16 v[76:79], v[192:195], a[92:95], v[76:79]
    ds_read_b128 v[192:195], v2 offset:14336
    s_waitcnt lgkmcnt(7)
    v_mfma_f32_16x16x32_bf16 v[92:95], v[196:199], a[92:95], v[92:95]
    s_add_u32 m0, s57, 102400
    s_add_u32 s63, s97, 8392704
    v_mfma_f32_16x16x32_bf16 v[88:91], v[196:199], a[88:91], v[88:91]
    buffer_load_dwordx4 v10, s[4:7], s63 offen offset:0 lds
    v_mfma_f32_16x16x32_bf16 v[84:87], v[196:199], a[84:87], v[84:87]
    ds_read_b128 a[200:203], v34 offset:2048
    v_mfma_f32_16x16x32_bf16 v[80:83], v[196:199], a[80:83], v[80:83]
    ds_read_b128 v[196:199], v2 offset:15360
    s_waitcnt lgkmcnt(8)
    v_mfma_f32_16x16x32_bf16 v[96:99], v[200:203], a[80:83], v[96:99]
    ds_read_b128 a[204:207], v34 offset:3072
    v_mfma_f32_16x16x32_bf16 v[100:103], v[200:203], a[84:87], v[100:103]
    buffer_load_dwordx4 a[132:135], v5, s[4:7], s88 offen offset:3072 sc1
    v_mfma_f32_16x16x32_bf16 v[104:107], v[200:203], a[88:91], v[104:107]
    ds_read_b128 a[208:211], v34 offset:4096
    v_mfma_f32_16x16x32_bf16 v[108:111], v[200:203], a[92:95], v[108:111]
    ds_read_b128 v[200:203], v2 offset:16384
    s_waitcnt lgkmcnt(10)
    v_mfma_f32_16x16x32_bf16 v[124:127], v[204:207], a[92:95], v[124:127]
    ds_read_b128 a[212:215], v34 offset:5120
    v_mfma_f32_16x16x32_bf16 v[120:123], v[204:207], a[88:91], v[120:123]
    buffer_load_dwordx4 a[136:139], v6, s[4:7], s88 offen offset:3072 sc1
    v_mfma_f32_16x16x32_bf16 v[116:119], v[204:207], a[84:87], v[116:119]
    buffer_load_dwordx4 v[236:239], v1, s[4:7], s53 offen offset:1024 sc1
    v_mfma_f32_16x16x32_bf16 v[112:115], v[204:207], a[80:83], v[112:115]
    ds_read_b128 v[204:207], v2 offset:17408
    s_waitcnt lgkmcnt(11)
    v_mfma_f32_16x16x32_bf16 v[128:131], v[208:211], a[80:83], v[128:131]
    v_mfma_f32_16x16x32_bf16 v[132:135], v[208:211], a[84:87], v[132:135]
    buffer_load_dwordx4 v10, s[4:7], s63 offen offset:1024 lds
    v_mfma_f32_16x16x32_bf16 v[136:139], v[208:211], a[88:91], v[136:139]
    v_mfma_f32_16x16x32_bf16 v[140:143], v[208:211], a[92:95], v[140:143]
    ds_read_b128 v[208:211], v2 offset:18432
    s_waitcnt lgkmcnt(11)
    v_mfma_f32_16x16x32_bf16 v[156:159], v[212:215], a[92:95], v[156:159]
    v_mfma_f32_16x16x32_bf16 v[152:155], v[212:215], a[88:91], v[152:155]
    buffer_load_dwordx4 a[140:143], v7, s[4:7], s88 offen offset:3072 sc1
    v_mfma_f32_16x16x32_bf16 v[148:151], v[212:215], a[84:87], v[148:151]
    v_mfma_f32_16x16x32_bf16 v[144:147], v[212:215], a[80:83], v[144:147]
    ds_read_b128 v[212:215], v2 offset:19456
    s_waitcnt vmcnt(14)
    s_waitcnt lgkmcnt(9)
    v_mfma_f32_16x16x32_bf16 v[64:67], v[192:195], a[96:99], v[64:67]
    v_mfma_f32_16x16x32_bf16 v[68:71], v[192:195], a[100:103], v[68:71]
    buffer_load_dwordx4 a[48:51], v4, s[4:7], s89 offen offset:0 sc1
    v_mfma_f32_16x16x32_bf16 v[72:75], v[192:195], a[104:107], v[72:75]
    v_mfma_f32_16x16x32_bf16 v[76:79], v[192:195], a[108:111], v[76:79]
    ds_read_b128 v[192:195], v2 offset:20480
    s_waitcnt lgkmcnt(8)
    v_mfma_f32_16x16x32_bf16 v[92:95], v[196:199], a[108:111], v[92:95]
    s_add_u32 m0, s57, 122880
    s_add_u32 s63, s98, 8388608
    v_mfma_f32_16x16x32_bf16 v[88:91], v[196:199], a[104:107], v[88:91]
    buffer_load_dwordx4 v10, s[4:7], s63 offen offset:0 lds
    v_mfma_f32_16x16x32_bf16 v[84:87], v[196:199], a[100:103], v[84:87]
    v_mfma_f32_16x16x32_bf16 v[80:83], v[196:199], a[96:99], v[80:83]
    ds_read_b128 v[196:199], v2 offset:21504
    s_waitcnt lgkmcnt(6)
    v_mfma_f32_16x16x32_bf16 v[96:99], v[200:203], a[96:99], v[96:99]
    v_mfma_f32_16x16x32_bf16 v[100:103], v[200:203], a[100:103], v[100:103]
    buffer_load_dwordx4 a[52:55], v5, s[4:7], s89 offen offset:0 sc1
    v_mfma_f32_16x16x32_bf16 v[104:107], v[200:203], a[104:107], v[104:107]
    v_mfma_f32_16x16x32_bf16 v[108:111], v[200:203], a[108:111], v[108:111]
    ds_read_b128 v[200:203], v2 offset:22528
    s_waitcnt lgkmcnt(5)
    v_mfma_f32_16x16x32_bf16 v[124:127], v[204:207], a[108:111], v[124:127]
    v_mfma_f32_16x16x32_bf16 v[120:123], v[204:207], a[104:107], v[120:123]
    buffer_load_dwordx4 a[56:59], v6, s[4:7], s89 offen offset:0 sc1
    v_mfma_f32_16x16x32_bf16 v[116:119], v[204:207], a[100:103], v[116:119]
    v_mfma_f32_16x16x32_bf16 v[112:115], v[204:207], a[96:99], v[112:115]
    ds_read_b128 v[204:207], v2 offset:23552
    s_waitcnt lgkmcnt(5)
    v_mfma_f32_16x16x32_bf16 v[128:131], v[208:211], a[96:99], v[128:131]
    s_mov_b32 s19, 1114112
    v_mfma_f32_16x16x32_bf16 v[132:135], v[208:211], a[100:103], v[132:135]
    buffer_load_dwordx4 v[176:179], v13, s[4:7], s19 offen sc1
    v_mfma_f32_16x16x32_bf16 v[136:139], v[208:211], a[104:107], v[136:139]
    v_mfma_f32_16x16x32_bf16 v[140:143], v[208:211], a[108:111], v[140:143]
    ds_read_b128 v[208:211], v2 offset:24576
    s_waitcnt lgkmcnt(5)
    v_mfma_f32_16x16x32_bf16 v[156:159], v[212:215], a[108:111], v[156:159]
    v_mfma_f32_16x16x32_bf16 v[152:155], v[212:215], a[104:107], v[152:155]
    buffer_load_dwordx4 a[60:63], v7, s[4:7], s89 offen offset:0 sc1
    v_mfma_f32_16x16x32_bf16 v[148:151], v[212:215], a[100:103], v[148:151]
    v_mfma_f32_16x16x32_bf16 v[144:147], v[212:215], a[96:99], v[144:147]
    ds_read_b128 v[212:215], v2 offset:25600
    s_waitcnt vmcnt(13)
    s_waitcnt lgkmcnt(5)
    v_mfma_f32_16x16x32_bf16 v[64:67], v[192:195], a[112:115], v[64:67]
    v_mfma_f32_16x16x32_bf16 v[68:71], v[192:195], a[116:119], v[68:71]
    buffer_load_dwordx4 a[64:67], v4, s[4:7], s89 offen offset:1024 sc1
    v_mfma_f32_16x16x32_bf16 v[72:75], v[192:195], a[120:123], v[72:75]
    v_mfma_f32_16x16x32_bf16 v[76:79], v[192:195], a[124:127], v[76:79]
    ds_read_b128 v[192:195], v2 offset:26624
    s_waitcnt lgkmcnt(5)
    v_mfma_f32_16x16x32_bf16 v[92:95], v[196:199], a[124:127], v[92:95]
    v_mfma_f32_16x16x32_bf16 v[88:91], v[196:199], a[120:123], v[88:91]
    buffer_load_dwordx4 v10, s[4:7], s63 offen offset:1024 lds
    v_mfma_f32_16x16x32_bf16 v[84:87], v[196:199], a[116:119], v[84:87]
    v_mfma_f32_16x16x32_bf16 v[80:83], v[196:199], a[112:115], v[80:83]
    ds_read_b128 v[196:199], v2 offset:27648
    s_waitcnt lgkmcnt(5)
    v_mfma_f32_16x16x32_bf16 v[96:99], v[200:203], a[112:115], v[96:99]
    v_mfma_f32_16x16x32_bf16 v[100:103], v[200:203], a[116:119], v[100:103]
    buffer_load_dwordx4 a[68:71], v5, s[4:7], s89 offen offset:1024 sc1
    v_mfma_f32_16x16x32_bf16 v[104:107], v[200:203], a[120:123], v[104:107]
    v_mfma_f32_16x16x32_bf16 v[108:111], v[200:203], a[124:127], v[108:111]
    ds_read_b128 v[200:203], v2 offset:28672
    s_waitcnt lgkmcnt(5)
    v_mfma_f32_16x16x32_bf16 v[124:127], v[204:207], a[124:127], v[124:127]
    v_mfma_f32_16x16x32_bf16 v[120:123], v[204:207], a[120:123], v[120:123]
    buffer_load_dwordx4 a[72:75], v6, s[4:7], s89 offen offset:1024 sc1
    v_mfma_f32_16x16x32_bf16 v[116:119], v[204:207], a[116:119], v[116:119]
    v_mfma_f32_16x16x32_bf16 v[112:115], v[204:207], a[112:115], v[112:115]
    ds_read_b128 v[204:207], v2 offset:29696
    s_waitcnt lgkmcnt(5)
    v_mfma_f32_16x16x32_bf16 v[128:131], v[208:211], a[112:115], v[128:131]
    v_mfma_f32_16x16x32_bf16 v[132:135], v[208:211], a[116:119], v[132:135]
    buffer_load_dwordx4 v10, s[4:7], s63 offen offset:2048 lds
    v_mfma_f32_16x16x32_bf16 v[136:139], v[208:211], a[120:123], v[136:139]
    v_mfma_f32_16x16x32_bf16 v[140:143], v[208:211], a[124:127], v[140:143]
    ds_read_b128 v[208:211], v2 offset:30720
    s_waitcnt lgkmcnt(5)
    v_mfma_f32_16x16x32_bf16 v[156:159], v[212:215], a[124:127], v[156:159]
    v_mfma_f32_16x16x32_bf16 v[152:155], v[212:215], a[120:123], v[152:155]
    buffer_load_dwordx4 a[76:79], v7, s[4:7], s89 offen offset:1024 sc1
    v_mfma_f32_16x16x32_bf16 v[148:151], v[212:215], a[116:119], v[148:151]
    v_mfma_f32_16x16x32_bf16 v[144:147], v[212:215], a[112:115], v[144:147]
    ds_read_b128 v[212:215], v2 offset:31744
    s_waitcnt vmcnt(12)
    s_barrier
    s_waitcnt lgkmcnt(5)
    v_mfma_f32_16x16x32_bf16 v[64:67], v[192:195], a[128:131], v[64:67]
    v_add_f32 v224, v224, v232
    v_add_f32 v225, v225, v233
    v_mfma_f32_16x16x32_bf16 v[68:71], v[192:195], a[132:135], v[68:71]
    buffer_load_dwordx4 a[80:83], v4, s[4:7], s89 offen offset:2048 sc1
    v_mfma_f32_16x16x32_bf16 v[72:75], v[192:195], a[136:139], v[72:75]
    v_add_f32 v226, v226, v234
    v_add_f32 v227, v227, v235
    v_mfma_f32_16x16x32_bf16 v[76:79], v[192:195], a[140:143], v[76:79]
    ds_read_b128 v[192:195], v2 offset:32768
    s_waitcnt lgkmcnt(5)
    v_mfma_f32_16x16x32_bf16 v[92:95], v[196:199], a[140:143], v[92:95]
    v_add_f32 v228, v228, v236
    v_add_f32 v229, v229, v237
    v_mfma_f32_16x16x32_bf16 v[88:91], v[196:199], a[136:139], v[88:91]
    buffer_load_dwordx4 v10, s[4:7], s63 offen offset:3072 lds
    v_mfma_f32_16x16x32_bf16 v[84:87], v[196:199], a[132:135], v[84:87]
    v_add_f32 v230, v230, v238
    v_add_f32 v231, v231, v239
    v_mfma_f32_16x16x32_bf16 v[80:83], v[196:199], a[128:131], v[80:83]
    ds_read_b128 v[196:199], v2 offset:33792
    s_waitcnt lgkmcnt(5)
    v_mfma_f32_16x16x32_bf16 v[96:99], v[200:203], a[128:131], v[96:99]
    v_add_f32_dpp v224, v224, v224 row_ror:8 row_mask:0xf bank_mask:0xf
    v_add_f32_dpp v225, v225, v225 row_ror:8 row_mask:0xf bank_mask:0xf
    v_mfma_f32_16x16x32_bf16 v[100:103], v[200:203], a[132:135], v[100:103]
    buffer_load_dwordx4 a[84:87], v5, s[4:7], s89 offen offset:2048 sc1
    v_mfma_f32_16x16x32_bf16 v[104:107], v[200:203], a[136:139], v[104:107]
    v_add_f32_dpp v226, v226, v226 row_ror:8 row_mask:0xf bank_mask:0xf
    v_add_f32_dpp v227, v227, v227 row_ror:8 row_mask:0xf bank_mask:0xf
    v_mfma_f32_16x16x32_bf16 v[108:111], v[200:203], a[140:143], v[108:111]
    ds_read_b128 v[200:203], v2 offset:34816
    s_waitcnt lgkmcnt(5)
    v_mfma_f32_16x16x32_bf16 v[124:127], v[204:207], a[140:143], v[124:127]
    v_add_f32_dpp v228, v228, v228 row_ror:8 row_mask:0xf bank_mask:0xf
    v_add_f32_dpp v229, v229, v229 row_ror:8 row_mask:0xf bank_mask:0xf
    v_mfma_f32_16x16x32_bf16 v[120:123], v[204:207], a[136:139], v[120:123]
    buffer_load_dwordx4 a[88:91], v6, s[4:7], s89 offen offset:2048 sc1
    v_mfma_f32_16x16x32_bf16 v[116:119], v[204:207], a[132:135], v[116:119]
    v_add_f32_dpp v230, v230, v230 row_ror:8 row_mask:0xf bank_mask:0xf
    v_add_f32_dpp v231, v231, v231 row_ror:8 row_mask:0xf bank_mask:0xf
    v_mfma_f32_16x16x32_bf16 v[112:115], v[204:207], a[128:131], v[112:115]
    ds_read_b128 v[204:207], v2 offset:35840
    s_waitcnt lgkmcnt(5)
    v_mfma_f32_16x16x32_bf16 v[128:131], v[208:211], a[128:131], v[128:131]
    s_mov_b32 s19, 1130496
    v_mfma_f32_16x16x32_bf16 v[132:135], v[208:211], a[132:135], v[132:135]
    buffer_load_dwordx4 v[180:183], v13, s[4:7], s19 offen sc1
    v_mfma_f32_16x16x32_bf16 v[136:139], v[208:211], a[136:139], v[136:139]
    v_add_f32_dpp v224, v224, v224 row_ror:4 row_mask:0xf bank_mask:0xf
    v_add_f32_dpp v225, v225, v225 row_ror:4 row_mask:0xf bank_mask:0xf
    v_mfma_f32_16x16x32_bf16 v[140:143], v[208:211], a[140:143], v[140:143]
    ds_read_b128 v[208:211], v2 offset:36864
    s_waitcnt lgkmcnt(5)
    v_mfma_f32_16x16x32_bf16 v[156:159], v[212:215], a[140:143], v[156:159]
    v_add_f32_dpp v226, v226, v226 row_ror:4 row_mask:0xf bank_mask:0xf
    v_add_f32_dpp v227, v227, v227 row_ror:4 row_mask:0xf bank_mask:0xf
    v_mfma_f32_16x16x32_bf16 v[152:155], v[212:215], a[136:139], v[152:155]
    buffer_load_dwordx4 a[92:95], v7, s[4:7], s89 offen offset:2048 sc1
    v_mfma_f32_16x16x32_bf16 v[148:151], v[212:215], a[132:135], v[148:151]
    v_add_f32_dpp v228, v228, v228 row_ror:4 row_mask:0xf bank_mask:0xf
    v_add_f32_dpp v229, v229, v229 row_ror:4 row_mask:0xf bank_mask:0xf
    v_mfma_f32_16x16x32_bf16 v[144:147], v[212:215], a[128:131], v[144:147]
    ds_read_b128 v[212:215], v2 offset:37888
    s_waitcnt vmcnt(12)
    s_waitcnt lgkmcnt(5)
    v_mfma_f32_16x16x32_bf16 v[64:67], v[192:195], a[48:51], v[64:67]
    v_add_f32_dpp v230, v230, v230 row_ror:4 row_mask:0xf bank_mask:0xf
    v_add_f32_dpp v231, v231, v231 row_ror:4 row_mask:0xf bank_mask:0xf
    v_mfma_f32_16x16x32_bf16 v[68:71], v[192:195], a[52:55], v[68:71]
    buffer_load_dwordx4 a[96:99], v4, s[4:7], s89 offen offset:3072 sc1
    v_mfma_f32_16x16x32_bf16 v[72:75], v[192:195], a[56:59], v[72:75]
    v_permlane32_swap_b32 v224, v225
    v_mfma_f32_16x16x32_bf16 v[76:79], v[192:195], a[60:63], v[76:79]
    ds_read_b128 v[192:195], v2 offset:38912
    s_waitcnt lgkmcnt(5)
    v_mfma_f32_16x16x32_bf16 v[92:95], v[196:199], a[60:63], v[92:95]
    s_add_u32 m0, s57, 126976
    s_add_u32 s63, s98, 8392704
    v_mfma_f32_16x16x32_bf16 v[88:91], v[196:199], a[56:59], v[88:91]
    buffer_load_dwordx4 v10, s[4:7], s63 offen offset:0 lds
    v_mfma_f32_16x16x32_bf16 v[84:87], v[196:199], a[52:55], v[84:87]
    v_permlane32_swap_b32 v226, v227
    v_mfma_f32_16x16x32_bf16 v[80:83], v[196:199], a[48:51], v[80:83]
    ds_read_b128 v[196:199], v2 offset:39936
    s_waitcnt lgkmcnt(5)
    v_mfma_f32_16x16x32_bf16 v[96:99], v[200:203], a[48:51], v[96:99]
    v_permlane32_swap_b32 v228, v229
    v_mfma_f32_16x16x32_bf16 v[100:103], v[200:203], a[52:55], v[100:103]
    buffer_load_dwordx4 a[100:103], v5, s[4:7], s89 offen offset:3072 sc1
    v_mfma_f32_16x16x32_bf16 v[104:107], v[200:203], a[56:59], v[104:107]
    v_permlane32_swap_b32 v230, v231
    v_mfma_f32_16x16x32_bf16 v[108:111], v[200:203], a[60:63], v[108:111]
    ds_read_b128 v[200:203], v2 offset:40960
    s_waitcnt lgkmcnt(5)
    v_mfma_f32_16x16x32_bf16 v[124:127], v[204:207], a[60:63], v[124:127]
    v_add_f32 v224, v224, v225
    v_add_f32 v226, v226, v227
    v_mfma_f32_16x16x32_bf16 v[120:123], v[204:207], a[56:59], v[120:123]
    buffer_load_dwordx4 a[104:107], v6, s[4:7], s89 offen offset:3072 sc1
    v_mfma_f32_16x16x32_bf16 v[116:119], v[204:207], a[52:55], v[116:119]
    v_add_f32 v228, v228, v229
    v_add_f32 v230, v230, v231
    v_mfma_f32_16x16x32_bf16 v[112:115], v[204:207], a[48:51], v[112:115]
    ds_read_b128 v[204:207], v2 offset:41984
    s_waitcnt lgkmcnt(5)
    v_mfma_f32_16x16x32_bf16 v[128:131], v[208:211], a[48:51], v[128:131]
    v_permlane16_swap_b32 v224, v226
    v_mfma_f32_16x16x32_bf16 v[132:135], v[208:211], a[52:55], v[132:135]
    buffer_load_dwordx4 v10, s[4:7], s63 offen offset:1024 lds
    v_mfma_f32_16x16x32_bf16 v[136:139], v[208:211], a[56:59], v[136:139]
    v_permlane16_swap_b32 v228, v230
    v_mfma_f32_16x16x32_bf16 v[140:143], v[208:211], a[60:63], v[140:143]
    ds_read_b128 v[208:211], v2 offset:43008
    s_waitcnt lgkmcnt(5)
    v_mfma_f32_16x16x32_bf16 v[156:159], v[212:215], a[60:63], v[156:159]
    v_add_f32 v224, v224, v226
    v_add_f32 v228, v228, v230
    v_mfma_f32_16x16x32_bf16 v[152:155], v[212:215], a[56:59], v[152:155]
    buffer_load_dwordx4 a[108:111], v7, s[4:7], s89 offen offset:3072 sc1
    v_mfma_f32_16x16x32_bf16 v[148:151], v[212:215], a[52:55], v[148:151]
    s_mov_b32 exec_lo, 0x000f000f
    s_mov_b32 exec_hi, 0x000f000f
    ds_write_b32 v38, v224 offset:0
    ds_write_b32 v39, v228 offset:0
    s_mov_b64 exec, -1
    v_mfma_f32_16x16x32_bf16 v[144:147], v[212:215], a[48:51], v[144:147]
    ds_read_b128 v[212:215], v2 offset:44032
    s_waitcnt vmcnt(12)
    s_waitcnt lgkmcnt(7)
    v_mfma_f32_16x16x32_bf16 v[64:67], v[192:195], a[64:67], v[64:67]
    s_add_u32 s52, s52, 393216
    s_add_u32 s53, s53, 393216
    v_mfma_f32_16x16x32_bf16 v[68:71], v[192:195], a[68:71], v[68:71]
    buffer_load_dwordx4 a[112:115], v4, s[4:7], s90 offen offset:0 sc1
    v_mfma_f32_16x16x32_bf16 v[72:75], v[192:195], a[72:75], v[72:75]
    ds_read_b128 a[144:147], v34 offset:24576
    v_mfma_f32_16x16x32_bf16 v[76:79], v[192:195], a[76:79], v[76:79]
    ds_read_b128 v[192:195], v2 offset:45056
    s_waitcnt lgkmcnt(8)
    v_mfma_f32_16x16x32_bf16 v[92:95], v[196:199], a[76:79], v[92:95]
    s_add_u32 m0, s57, 0
    s_add_u32 s63, s99, 8388608
    v_mfma_f32_16x16x32_bf16 v[88:91], v[196:199], a[72:75], v[88:91]
    buffer_load_dwordx4 v10, s[4:7], s63 offen offset:0 lds
    v_mfma_f32_16x16x32_bf16 v[84:87], v[196:199], a[68:71], v[84:87]
    ds_read_b128 a[148:151], v34 offset:25600
    v_mfma_f32_16x16x32_bf16 v[80:83], v[196:199], a[64:67], v[80:83]
    ds_read_b128 v[196:199], v2 offset:46080
    s_waitcnt lgkmcnt(9)
    v_mfma_f32_16x16x32_bf16 v[96:99], v[200:203], a[64:67], v[96:99]
    ds_read_b128 a[152:155], v34 offset:26624
    v_mfma_f32_16x16x32_bf16 v[100:103], v[200:203], a[68:71], v[100:103]
    buffer_load_dwordx4 a[116:119], v5, s[4:7], s90 offen offset:0 sc1
    v_mfma_f32_16x16x32_bf16 v[104:107], v[200:203], a[72:75], v[104:107]
    ds_read_b128 a[156:159], v34 offset:27648
    v_mfma_f32_16x16x32_bf16 v[108:111], v[200:203], a[76:79], v[108:111]
    ds_read_b128 v[200:203], v2 offset:47104
    s_waitcnt lgkmcnt(11)
    v_mfma_f32_16x16x32_bf16 v[124:127], v[204:207], a[76:79], v[124:127]
    ds_read_b128 a[160:163], v34 offset:28672
    v_mfma_f32_16x16x32_bf16 v[120:123], v[204:207], a[72:75], v[120:123]
    buffer_load_dwordx4 a[120:123], v6, s[4:7], s90 offen offset:0 sc1
    v_mfma_f32_16x16x32_bf16 v[116:119], v[204:207], a[68:71], v[116:119]
    ds_read_b128 a[164:167], v34 offset:29696
    v_mfma_f32_16x16x32_bf16 v[112:115], v[204:207], a[64:67], v[112:115]
    ds_read_b128 v[204:207], v2 offset:48128
    s_waitcnt lgkmcnt(13)
    v_mfma_f32_16x16x32_bf16 v[128:131], v[208:211], a[64:67], v[128:131]
    s_mov_b32 s19, 1146880
    v_mfma_f32_16x16x32_bf16 v[132:135], v[208:211], a[68:71], v[132:135]
    buffer_load_dwordx4 v[184:187], v13, s[4:7], s19 offen sc1
    v_mfma_f32_16x16x32_bf16 v[136:139], v[208:211], a[72:75], v[136:139]
    v_mfma_f32_16x16x32_bf16 v[140:143], v[208:211], a[76:79], v[140:143]
    ds_read_b128 v[208:211], v2 offset:49152
    s_waitcnt lgkmcnt(11)
    v_mfma_f32_16x16x32_bf16 v[156:159], v[212:215], a[76:79], v[156:159]
    v_mfma_f32_16x16x32_bf16 v[152:155], v[212:215], a[72:75], v[152:155]
    buffer_load_dwordx4 a[124:127], v7, s[4:7], s90 offen offset:0 sc1
    v_mfma_f32_16x16x32_bf16 v[148:151], v[212:215], a[68:71], v[148:151]
    v_mfma_f32_16x16x32_bf16 v[144:147], v[212:215], a[64:67], v[144:147]
    ds_read_b128 v[212:215], v2 offset:50176
    s_waitcnt vmcnt(12)
    s_waitcnt lgkmcnt(10)
    v_mfma_f32_16x16x32_bf16 v[64:67], v[192:195], a[80:83], v[64:67]
    v_mfma_f32_16x16x32_bf16 v[68:71], v[192:195], a[84:87], v[68:71]
    buffer_load_dwordx4 a[128:131], v4, s[4:7], s90 offen offset:1024 sc1
    v_mfma_f32_16x16x32_bf16 v[72:75], v[192:195], a[88:91], v[72:75]
    v_mfma_f32_16x16x32_bf16 v[76:79], v[192:195], a[92:95], v[76:79]
    ds_read_b128 v[192:195], v2 offset:51200
    s_waitcnt lgkmcnt(9)
    v_mfma_f32_16x16x32_bf16 v[92:95], v[196:199], a[92:95], v[92:95]
    v_mfma_f32_16x16x32_bf16 v[88:91], v[196:199], a[88:91], v[88:91]
    buffer_load_dwordx4 v10, s[4:7], s63 offen offset:1024 lds
    v_mfma_f32_16x16x32_bf16 v[84:87], v[196:199], a[84:87], v[84:87]
    v_mfma_f32_16x16x32_bf16 v[80:83], v[196:199], a[80:83], v[80:83]
    ds_read_b128 v[196:199], v2 offset:52224
    s_waitcnt lgkmcnt(7)
    v_mfma_f32_16x16x32_bf16 v[96:99], v[200:203], a[80:83], v[96:99]
    v_mfma_f32_16x16x32_bf16 v[100:103], v[200:203], a[84:87], v[100:103]
    buffer_load_dwordx4 a[132:135], v5, s[4:7], s90 offen offset:1024 sc1
    v_mfma_f32_16x16x32_bf16 v[104:107], v[200:203], a[88:91], v[104:107]
    v_mfma_f32_16x16x32_bf16 v[108:111], v[200:203], a[92:95], v[108:111]
    ds_read_b128 v[200:203], v2 offset:53248
    s_waitcnt lgkmcnt(5)
    v_mfma_f32_16x16x32_bf16 v[124:127], v[204:207], a[92:95], v[124:127]
    v_mfma_f32_16x16x32_bf16 v[120:123], v[204:207], a[88:91], v[120:123]
    buffer_load_dwordx4 a[136:139], v6, s[4:7], s90 offen offset:1024 sc1
    v_mfma_f32_16x16x32_bf16 v[116:119], v[204:207], a[84:87], v[116:119]
    v_mfma_f32_16x16x32_bf16 v[112:115], v[204:207], a[80:83], v[112:115]
    ds_read_b128 v[204:207], v2 offset:54272
    s_waitcnt lgkmcnt(5)
    v_mfma_f32_16x16x32_bf16 v[128:131], v[208:211], a[80:83], v[128:131]
    v_mfma_f32_16x16x32_bf16 v[132:135], v[208:211], a[84:87], v[132:135]
    buffer_load_dwordx4 v10, s[4:7], s63 offen offset:2048 lds
    v_mfma_f32_16x16x32_bf16 v[136:139], v[208:211], a[88:91], v[136:139]
    v_mfma_f32_16x16x32_bf16 v[140:143], v[208:211], a[92:95], v[140:143]
    ds_read_b128 v[208:211], v2 offset:55296
    s_waitcnt lgkmcnt(5)
    v_mfma_f32_16x16x32_bf16 v[156:159], v[212:215], a[92:95], v[156:159]
    v_mfma_f32_16x16x32_bf16 v[152:155], v[212:215], a[88:91], v[152:155]
    buffer_load_dwordx4 a[140:143], v7, s[4:7], s90 offen offset:1024 sc1
    v_mfma_f32_16x16x32_bf16 v[148:151], v[212:215], a[84:87], v[148:151]
    v_mfma_f32_16x16x32_bf16 v[144:147], v[212:215], a[80:83], v[144:147]
    ds_read_b128 v[212:215], v2 offset:56320
    s_waitcnt vmcnt(12)
    s_barrier
    s_waitcnt lgkmcnt(5)
    v_mfma_f32_16x16x32_bf16 v[64:67], v[192:195], a[96:99], v[64:67]
    v_mfma_f32_16x16x32_bf16 v[68:71], v[192:195], a[100:103], v[68:71]
    buffer_load_dwordx4 a[48:51], v4, s[4:7], s90 offen offset:2048 sc1
    v_mfma_f32_16x16x32_bf16 v[72:75], v[192:195], a[104:107], v[72:75]
    v_mfma_f32_16x16x32_bf16 v[76:79], v[192:195], a[108:111], v[76:79]
    ds_read_b128 v[192:195], v2 offset:57344
    s_waitcnt lgkmcnt(5)
    v_mfma_f32_16x16x32_bf16 v[92:95], v[196:199], a[108:111], v[92:95]
    v_mfma_f32_16x16x32_bf16 v[88:91], v[196:199], a[104:107], v[88:91]
    buffer_load_dwordx4 v10, s[4:7], s63 offen offset:3072 lds
    v_mfma_f32_16x16x32_bf16 v[84:87], v[196:199], a[100:103], v[84:87]
    v_mfma_f32_16x16x32_bf16 v[80:83], v[196:199], a[96:99], v[80:83]
    ds_read_b128 v[196:199], v2 offset:58368
    s_waitcnt lgkmcnt(5)
    v_mfma_f32_16x16x32_bf16 v[96:99], v[200:203], a[96:99], v[96:99]
    v_mfma_f32_16x16x32_bf16 v[100:103], v[200:203], a[100:103], v[100:103]
    buffer_load_dwordx4 a[52:55], v5, s[4:7], s90 offen offset:2048 sc1
    v_mfma_f32_16x16x32_bf16 v[104:107], v[200:203], a[104:107], v[104:107]
    v_mfma_f32_16x16x32_bf16 v[108:111], v[200:203], a[108:111], v[108:111]
    ds_read_b128 v[200:203], v2 offset:59392
    s_waitcnt lgkmcnt(5)
    v_mfma_f32_16x16x32_bf16 v[124:127], v[204:207], a[108:111], v[124:127]
    v_mfma_f32_16x16x32_bf16 v[120:123], v[204:207], a[104:107], v[120:123]
    buffer_load_dwordx4 a[56:59], v6, s[4:7], s90 offen offset:2048 sc1
    v_mfma_f32_16x16x32_bf16 v[116:119], v[204:207], a[100:103], v[116:119]
    v_mfma_f32_16x16x32_bf16 v[112:115], v[204:207], a[96:99], v[112:115]
    ds_read_b128 v[204:207], v2 offset:60416
    s_waitcnt lgkmcnt(5)
    v_mfma_f32_16x16x32_bf16 v[128:131], v[208:211], a[96:99], v[128:131]
    s_mov_b32 s19, 1163264
    v_mfma_f32_16x16x32_bf16 v[132:135], v[208:211], a[100:103], v[132:135]
    buffer_load_dwordx4 v[188:191], v13, s[4:7], s19 offen sc1
    v_mfma_f32_16x16x32_bf16 v[136:139], v[208:211], a[104:107], v[136:139]
    v_mfma_f32_16x16x32_bf16 v[140:143], v[208:211], a[108:111], v[140:143]
    ds_read_b128 v[208:211], v2 offset:61440
    s_waitcnt lgkmcnt(5)
    v_mfma_f32_16x16x32_bf16 v[156:159], v[212:215], a[108:111], v[156:159]
    v_mfma_f32_16x16x32_bf16 v[152:155], v[212:215], a[104:107], v[152:155]
    buffer_load_dwordx4 a[60:63], v7, s[4:7], s90 offen offset:2048 sc1
    v_mfma_f32_16x16x32_bf16 v[148:151], v[212:215], a[100:103], v[148:151]
    v_mfma_f32_16x16x32_bf16 v[144:147], v[212:215], a[96:99], v[144:147]
    ds_read_b128 v[212:215], v2 offset:62464
    s_waitcnt vmcnt(12)
    s_waitcnt lgkmcnt(5)
    v_mfma_f32_16x16x32_bf16 v[64:67], v[192:195], a[112:115], v[64:67]
    v_mfma_f32_16x16x32_bf16 v[68:71], v[192:195], a[116:119], v[68:71]
    buffer_load_dwordx4 a[64:67], v4, s[4:7], s90 offen offset:3072 sc1
    v_mfma_f32_16x16x32_bf16 v[72:75], v[192:195], a[120:123], v[72:75]
    v_mfma_f32_16x16x32_bf16 v[76:79], v[192:195], a[124:127], v[76:79]
    ds_read_b128 v[192:195], v2 offset:63488
    s_waitcnt lgkmcnt(5)
    v_mfma_f32_16x16x32_bf16 v[92:95], v[196:199], a[124:127], v[92:95]
    s_add_u32 m0, s57, 4096
    s_add_u32 s63, s99, 8392704
    v_mfma_f32_16x16x32_bf16 v[88:91], v[196:199], a[120:123], v[88:91]
    buffer_load_dwordx4 v10, s[4:7], s63 offen offset:0 lds
    v_mfma_f32_16x16x32_bf16 v[84:87], v[196:199], a[116:119], v[84:87]
    v_mfma_f32_16x16x32_bf16 v[80:83], v[196:199], a[112:115], v[80:83]
    ds_read_b128 v[196:199], v2 offset:64512
    s_waitcnt lgkmcnt(5)
    v_mfma_f32_16x16x32_bf16 v[96:99], v[200:203], a[112:115], v[96:99]
    v_mfma_f32_16x16x32_bf16 v[100:103], v[200:203], a[116:119], v[100:103]
    buffer_load_dwordx4 a[68:71], v5, s[4:7], s90 offen offset:3072 sc1
    v_mfma_f32_16x16x32_bf16 v[104:107], v[200:203], a[120:123], v[104:107]
    v_mfma_f32_16x16x32_bf16 v[108:111], v[200:203], a[124:127], v[108:111]
    ds_read_b128 v[200:203], v3 offset:0
    s_waitcnt lgkmcnt(5)
    v_mfma_f32_16x16x32_bf16 v[124:127], v[204:207], a[124:127], v[124:127]
    v_mfma_f32_16x16x32_bf16 v[120:123], v[204:207], a[120:123], v[120:123]
    buffer_load_dwordx4 a[72:75], v6, s[4:7], s90 offen offset:3072 sc1
    v_mfma_f32_16x16x32_bf16 v[116:119], v[204:207], a[116:119], v[116:119]
    v_mfma_f32_16x16x32_bf16 v[112:115], v[204:207], a[112:115], v[112:115]
    ds_read_b128 v[204:207], v3 offset:1024
    s_waitcnt lgkmcnt(5)
    v_mfma_f32_16x16x32_bf16 v[128:131], v[208:211], a[112:115], v[128:131]
    v_mfma_f32_16x16x32_bf16 v[132:135], v[208:211], a[116:119], v[132:135]
    buffer_load_dwordx4 v10, s[4:7], s63 offen offset:1024 lds
    v_mfma_f32_16x16x32_bf16 v[136:139], v[208:211], a[120:123], v[136:139]
    v_mfma_f32_16x16x32_bf16 v[140:143], v[208:211], a[124:127], v[140:143]
    ds_read_b128 v[208:211], v3 offset:2048
    s_waitcnt lgkmcnt(5)
    v_mfma_f32_16x16x32_bf16 v[156:159], v[212:215], a[124:127], v[156:159]
    v_mfma_f32_16x16x32_bf16 v[152:155], v[212:215], a[120:123], v[152:155]
    buffer_load_dwordx4 a[76:79], v7, s[4:7], s90 offen offset:3072 sc1
    v_mfma_f32_16x16x32_bf16 v[148:151], v[212:215], a[116:119], v[148:151]
    v_mfma_f32_16x16x32_bf16 v[144:147], v[212:215], a[112:115], v[144:147]
    ds_read_b128 v[212:215], v3 offset:3072
    s_waitcnt vmcnt(12)
    s_waitcnt lgkmcnt(5)
    v_mfma_f32_16x16x32_bf16 v[64:67], v[192:195], a[128:131], v[64:67]
    v_mfma_f32_16x16x32_bf16 v[68:71], v[192:195], a[132:135], v[68:71]
    buffer_load_dwordx4 a[80:83], v4, s[4:7], s91 offen offset:0 sc1
    v_mfma_f32_16x16x32_bf16 v[72:75], v[192:195], a[136:139], v[72:75]
    v_mfma_f32_16x16x32_bf16 v[76:79], v[192:195], a[140:143], v[76:79]
    ds_read_b128 v[192:195], v3 offset:4096
    s_waitcnt lgkmcnt(5)
    v_mfma_f32_16x16x32_bf16 v[92:95], v[196:199], a[140:143], v[92:95]
    v_mfma_f32_16x16x32_bf16 v[88:91], v[196:199], a[136:139], v[88:91]
    buffer_load_dwordx4 a[84:87], v5, s[4:7], s91 offen offset:0 sc1
    v_mfma_f32_16x16x32_bf16 v[84:87], v[196:199], a[132:135], v[84:87]
    v_mfma_f32_16x16x32_bf16 v[80:83], v[196:199], a[128:131], v[80:83]
    ds_read_b128 v[196:199], v3 offset:5120
    s_waitcnt lgkmcnt(5)
    v_mfma_f32_16x16x32_bf16 v[96:99], v[200:203], a[128:131], v[96:99]
    s_add_u32 m0, s57, 24576
    s_add_u32 s63, s100, 8388608
    v_mfma_f32_16x16x32_bf16 v[100:103], v[200:203], a[132:135], v[100:103]
    buffer_load_dwordx4 v10, s[4:7], s63 offen offset:0 lds
    v_mfma_f32_16x16x32_bf16 v[104:107], v[200:203], a[136:139], v[104:107]
    v_mfma_f32_16x16x32_bf16 v[108:111], v[200:203], a[140:143], v[108:111]
    ds_read_b128 v[200:203], v3 offset:6144
    s_waitcnt lgkmcnt(5)
    v_mfma_f32_16x16x32_bf16 v[124:127], v[204:207], a[140:143], v[124:127]
    v_mfma_f32_16x16x32_bf16 v[120:123], v[204:207], a[136:139], v[120:123]
    buffer_load_dwordx4 a[88:91], v6, s[4:7], s91 offen offset:0 sc1
    v_mfma_f32_16x16x32_bf16 v[116:119], v[204:207], a[132:135], v[116:119]
    s_mov_b32 s20, 32768
    buffer_load_dwordx4 v[216:219], v1, s[4:7], s20 offen sc1
    v_mfma_f32_16x16x32_bf16 v[112:115], v[204:207], a[128:131], v[112:115]
    ds_read_b128 v[204:207], v3 offset:7168
    s_waitcnt lgkmcnt(5)
    v_mfma_f32_16x16x32_bf16 v[128:131], v[208:211], a[128:131], v[128:131]
    v_mfma_f32_16x16x32_bf16 v[132:135], v[208:211], a[132:135], v[132:135]
    buffer_load_dwordx4 a[92:95], v7, s[4:7], s91 offen offset:0 sc1
    v_mfma_f32_16x16x32_bf16 v[136:139], v[208:211], a[136:139], v[136:139]
    v_mfma_f32_16x16x32_bf16 v[140:143], v[208:211], a[140:143], v[140:143]
    ds_read_b128 v[208:211], v3 offset:8192
    s_waitcnt lgkmcnt(5)
    v_mfma_f32_16x16x32_bf16 v[156:159], v[212:215], a[140:143], v[156:159]
    v_mfma_f32_16x16x32_bf16 v[152:155], v[212:215], a[136:139], v[152:155]
    v_mfma_f32_16x16x32_bf16 v[148:151], v[212:215], a[132:135], v[148:151]
    v_mfma_f32_16x16x32_bf16 v[144:147], v[212:215], a[128:131], v[144:147]
    ds_read_b128 v[212:215], v3 offset:9216
    s_waitcnt vmcnt(12)
    s_waitcnt lgkmcnt(5)
    v_mfma_f32_16x16x32_bf16 v[64:67], v[192:195], a[48:51], v[64:67]
    v_add_f32 v160, v160, v176
    v_add_f32 v161, v161, v177
    v_mfma_f32_16x16x32_bf16 v[68:71], v[192:195], a[52:55], v[68:71]
    buffer_load_dwordx4 a[96:99], v4, s[4:7], s91 offen offset:1024 sc1
    v_mfma_f32_16x16x32_bf16 v[72:75], v[192:195], a[56:59], v[72:75]
    v_add_f32 v162, v162, v178
    v_add_f32 v163, v163, v179
    v_mfma_f32_16x16x32_bf16 v[76:79], v[192:195], a[60:63], v[76:79]
    ds_read_b128 v[192:195], v3 offset:10240
    s_waitcnt lgkmcnt(5)
    v_mfma_f32_16x16x32_bf16 v[92:95], v[196:199], a[60:63], v[92:95]
    v_add_f32 v164, v164, v180
    v_add_f32 v165, v165, v181
    v_mfma_f32_16x16x32_bf16 v[88:91], v[196:199], a[56:59], v[88:91]
    buffer_load_dwordx4 v10, s[4:7], s63 offen offset:1024 lds
    v_mfma_f32_16x16x32_bf16 v[84:87], v[196:199], a[52:55], v[84:87]
    v_add_f32 v166, v166, v182
    v_add_f32 v167, v167, v183
    v_mfma_f32_16x16x32_bf16 v[80:83], v[196:199], a[48:51], v[80:83]
    ds_read_b128 v[196:199], v3 offset:11264
    s_waitcnt lgkmcnt(5)
    v_mfma_f32_16x16x32_bf16 v[96:99], v[200:203], a[48:51], v[96:99]
    v_add_f32 v168, v168, v184
    v_add_f32 v169, v169, v185
    v_mfma_f32_16x16x32_bf16 v[100:103], v[200:203], a[52:55], v[100:103]
    buffer_load_dwordx4 a[100:103], v5, s[4:7], s91 offen offset:1024 sc1
    v_mfma_f32_16x16x32_bf16 v[104:107], v[200:203], a[56:59], v[104:107]
    v_add_f32 v170, v170, v186
    v_add_f32 v171, v171, v187
    v_mfma_f32_16x16x32_bf16 v[108:111], v[200:203], a[60:63], v[108:111]
    ds_read_b128 v[200:203], v3 offset:12288
    s_waitcnt lgkmcnt(5)
    v_mfma_f32_16x16x32_bf16 v[124:127], v[204:207], a[60:63], v[124:127]
    v_add_f32 v172, v172, v188
    v_add_f32 v173, v173, v189
    v_mfma_f32_16x16x32_bf16 v[120:123], v[204:207], a[56:59], v[120:123]
    buffer_load_dwordx4 a[104:107], v6, s[4:7], s91 offen offset:1024 sc1
    v_mfma_f32_16x16x32_bf16 v[116:119], v[204:207], a[52:55], v[116:119]
    v_add_f32 v174, v174, v190
    v_add_f32 v175, v175, v191
    v_mfma_f32_16x16x32_bf16 v[112:115], v[204:207], a[48:51], v[112:115]
    ds_read_b128 v[204:207], v3 offset:13312
    s_waitcnt lgkmcnt(5)
    v_mfma_f32_16x16x32_bf16 v[128:131], v[208:211], a[48:51], v[128:131]
    v_add_f32 v160, v160, v168
    v_add_f32 v161, v161, v169
    v_mfma_f32_16x16x32_bf16 v[132:135], v[208:211], a[52:55], v[132:135]
    buffer_load_dwordx4 v10, s[4:7], s63 offen offset:2048 lds
    v_mfma_f32_16x16x32_bf16 v[136:139], v[208:211], a[56:59], v[136:139]
    v_add_f32 v162, v162, v170
    v_add_f32 v163, v163, v171
    v_mfma_f32_16x16x32_bf16 v[140:143], v[208:211], a[60:63], v[140:143]
    ds_read_b128 v[208:211], v3 offset:14336
    s_waitcnt lgkmcnt(5)
    v_mfma_f32_16x16x32_bf16 v[156:159], v[212:215], a[60:63], v[156:159]
    v_add_f32 v164, v164, v172
    v_add_f32 v165, v165, v173
    v_mfma_f32_16x16x32_bf16 v[152:155], v[212:215], a[56:59], v[152:155]
    buffer_load_dwordx4 a[108:111], v7, s[4:7], s91 offen offset:1024 sc1
    v_mfma_f32_16x16x32_bf16 v[148:151], v[212:215], a[52:55], v[148:151]
    v_add_f32 v166, v166, v174
    v_add_f32 v167, v167, v175
    v_mfma_f32_16x16x32_bf16 v[144:147], v[212:215], a[48:51], v[144:147]
    ds_read_b128 v[212:215], v3 offset:15360
    s_waitcnt vmcnt(12)
    s_barrier
    s_waitcnt lgkmcnt(5)
    v_mfma_f32_16x16x32_bf16 v[64:67], v[192:195], a[64:67], v[64:67]
    v_add_f32 v160, v160, v164
    v_add_f32 v161, v161, v165
    v_mfma_f32_16x16x32_bf16 v[68:71], v[192:195], a[68:71], v[68:71]
    buffer_load_dwordx4 a[112:115], v4, s[4:7], s91 offen offset:2048 sc1
    v_mfma_f32_16x16x32_bf16 v[72:75], v[192:195], a[72:75], v[72:75]
    v_add_f32 v162, v162, v166
    v_add_f32 v163, v163, v167
    v_mfma_f32_16x16x32_bf16 v[76:79], v[192:195], a[76:79], v[76:79]
    ds_read_b128 v[192:195], v1 offset:0
    s_waitcnt lgkmcnt(5)
    v_mfma_f32_16x16x32_bf16 v[92:95], v[196:199], a[76:79], v[92:95]
    s_nop 0
    v_mfma_f32_16x16x32_bf16 v[88:91], v[196:199], a[72:75], v[88:91]
    buffer_load_dwordx4 a[116:119], v5, s[4:7], s91 offen offset:2048 sc1
    v_mfma_f32_16x16x32_bf16 v[84:87], v[196:199], a[68:71], v[84:87]
    v_permlane32_swap_b32 v160, v162
    v_mfma_f32_16x16x32_bf16 v[80:83], v[196:199], a[64:67], v[80:83]
    ds_read_b128 v[196:199], v1 offset:1024
    s_waitcnt lgkmcnt(5)
    v_mfma_f32_16x16x32_bf16 v[96:99], v[200:203], a[64:67], v[96:99]
    v_permlane32_swap_b32 v161, v163
    v_mfma_f32_16x16x32_bf16 v[100:103], v[200:203], a[68:71], v[100:103]
    buffer_load_dwordx4 v10, s[4:7], s63 offen offset:3072 lds
    v_mfma_f32_16x16x32_bf16 v[104:107], v[200:203], a[72:75], v[104:107]
    v_add_f32 v160, v160, v162
    v_add_f32 v161, v161, v163
    v_mfma_f32_16x16x32_bf16 v[108:111], v[200:203], a[76:79], v[108:111]
    ds_read_b128 v[200:203], v1 offset:2048
    s_waitcnt lgkmcnt(5)
    v_mfma_f32_16x16x32_bf16 v[124:127], v[204:207], a[76:79], v[124:127]
    v_mul_f32 v163, 0xba800000, v160
    v_mul_f32 v161, 0x3a800000, v161
    v_mfma_f32_16x16x32_bf16 v[120:123], v[204:207], a[72:75], v[120:123]
    buffer_load_dwordx4 a[120:123], v6, s[4:7], s91 offen offset:2048 sc1
    v_mfma_f32_16x16x32_bf16 v[116:119], v[204:207], a[68:71], v[116:119]
    v_fma_f32 v161, -v163, v163, v161
    v_max_f32 v161, 0, v161
    v_mfma_f32_16x16x32_bf16 v[112:115], v[204:207], a[64:67], v[112:115]
    ds_read_b128 v[204:207], v1 offset:3072
    s_waitcnt lgkmcnt(5)
    v_mfma_f32_16x16x32_bf16 v[128:131], v[208:211], a[64:67], v[128:131]
    v_add_f32 v161, 0x3727c5ac, v161
    v_mfma_f32_16x16x32_bf16 v[132:135], v[208:211], a[68:71], v[132:135]
    buffer_load_dwordx4 a[124:127], v7, s[4:7], s91 offen offset:2048 sc1
    v_mfma_f32_16x16x32_bf16 v[136:139], v[208:211], a[72:75], v[136:139]
    v_rsq_f32 v162, v161
    v_mfma_f32_16x16x32_bf16 v[140:143], v[208:211], a[76:79], v[140:143]
    ds_read_b128 v[208:211], v1 offset:4096
    s_waitcnt lgkmcnt(5)
    v_mfma_f32_16x16x32_bf16 v[156:159], v[212:215], a[76:79], v[156:159]
    ds_write2_b32 v58, v162, v163 offset0:0 offset1:64
    v_mfma_f32_16x16x32_bf16 v[152:155], v[212:215], a[72:75], v[152:155]
    ds_read2_b32 v[160:161], v59 offset0:0 offset1:64
    v_mfma_f32_16x16x32_bf16 v[148:151], v[212:215], a[68:71], v[148:151]
    ds_read2_b32 v[162:163], v59 offset0:16 offset1:80
    v_mfma_f32_16x16x32_bf16 v[144:147], v[212:215], a[64:67], v[144:147]
    ds_read_b128 v[212:215], v1 offset:5120
    s_waitcnt vmcnt(11)
    s_waitcnt lgkmcnt(8)
    v_mfma_f32_16x16x32_bf16 v[64:67], v[192:195], a[80:83], v[64:67]
    ds_read2_b32 v[164:165], v59 offset0:32 offset1:96
    v_mfma_f32_16x16x32_bf16 v[68:71], v[192:195], a[84:87], v[68:71]
    buffer_load_dwordx4 a[128:131], v4, s[4:7], s91 offen offset:3072 sc1
    v_mfma_f32_16x16x32_bf16 v[72:75], v[192:195], a[88:91], v[72:75]
    v_and_b32 v216, v216, v217
    v_and_b32 v218, v218, v219
    v_and_b32 v216, v216, v218
    v_cmp_ne_u32 vcc, 1, v216
    s_cbranch_vccnz L_rt_3
L_rtd_4:
    v_mfma_f32_16x16x32_bf16 v[76:79], v[192:195], a[92:95], v[76:79]
    ds_read_b128 v[192:195], v1 offset:6144
    s_waitcnt lgkmcnt(9)
    v_mfma_f32_16x16x32_bf16 v[92:95], v[196:199], a[92:95], v[92:95]
    s_add_u32 m0, s57, 28672
    s_add_u32 s63, s100, 8392704
    v_mfma_f32_16x16x32_bf16 v[88:91], v[196:199], a[88:91], v[88:91]
    buffer_load_dwordx4 v10, s[4:7], s63 offen offset:0 lds
    v_mfma_f32_16x16x32_bf16 v[84:87], v[196:199], a[84:87], v[84:87]
    ds_read2_b32 v[166:167], v59 offset0:48 offset1:112
    v_mfma_f32_16x16x32_bf16 v[80:83], v[196:199], a[80:83], v[80:83]
    ds_read_b128 v[196:199], v1 offset:7168
    s_waitcnt lgkmcnt(10)
    v_mfma_f32_16x16x32_bf16 v[96:99], v[200:203], a[80:83], v[96:99]
    ds_read_b128 v[168:171], v56 offset:64
    v_mfma_f32_16x16x32_bf16 v[100:103], v[200:203], a[84:87], v[100:103]
    buffer_load_dwordx4 a[132:135], v5, s[4:7], s91 offen offset:3072 sc1
    v_mfma_f32_16x16x32_bf16 v[104:107], v[200:203], a[88:91], v[104:107]
    ds_read_b128 v[172:175], v56 offset:128
    v_mfma_f32_16x16x32_bf16 v[108:111], v[200:203], a[92:95], v[108:111]
    ds_read_b128 v[200:203], v1 offset:8192
    s_waitcnt lgkmcnt(12)
    v_mfma_f32_16x16x32_bf16 v[124:127], v[204:207], a[92:95], v[124:127]
    ds_read_b128 v[176:179], v56 offset:192
    v_mfma_f32_16x16x32_bf16 v[120:123], v[204:207], a[88:91], v[120:123]
    buffer_load_dwordx4 a[136:139], v6, s[4:7], s91 offen offset:3072 sc1
    v_mfma_f32_16x16x32_bf16 v[116:119], v[204:207], a[84:87], v[116:119]
    ds_read_b128 v[180:183], v56 offset:256
    v_mfma_f32_16x16x32_bf16 v[112:115], v[204:207], a[80:83], v[112:115]
    ds_read_b128 v[204:207], v1 offset:9216
    s_waitcnt lgkmcnt(14)
    v_mfma_f32_16x16x32_bf16 v[128:131], v[208:211], a[80:83], v[128:131]
    ds_read_b128 v[184:187], v56 offset:320
    v_mfma_f32_16x16x32_bf16 v[132:135], v[208:211], a[84:87], v[132:135]
    buffer_load_dwordx4 v10, s[4:7], s63 offen offset:1024 lds
    v_mfma_f32_16x16x32_bf16 v[136:139], v[208:211], a[88:91], v[136:139]
    ds_read_b128 v[188:191], v56 offset:384
    v_mfma_f32_16x16x32_bf16 v[140:143], v[208:211], a[92:95], v[140:143]
    ds_read_b128 v[208:211], v1 offset:10240
    s_waitcnt lgkmcnt(13)
    v_mfma_f32_16x16x32_bf16 v[156:159], v[212:215], a[92:95], v[156:159]
    v_mfma_f32_16x16x32_bf16 v[152:155], v[212:215], a[88:91], v[152:155]
    buffer_load_dwordx4 a[140:143], v7, s[4:7], s91 offen offset:3072 sc1
    v_mfma_f32_16x16x32_bf16 v[148:151], v[212:215], a[84:87], v[148:151]
    v_mfma_f32_16x16x32_bf16 v[144:147], v[212:215], a[80:83], v[144:147]
    ds_read_b128 v[212:215], v1 offset:11264
    s_waitcnt vmcnt(11)
    s_waitcnt lgkmcnt(12)
    v_mfma_f32_16x16x32_bf16 v[64:67], v[192:195], a[96:99], v[64:67]
    v_mfma_f32_16x16x32_bf16 v[68:71], v[192:195], a[100:103], v[68:71]
    buffer_load_dwordx4 a[48:51], v4, s[4:7], s92 offen offset:0 sc1
    v_mfma_f32_16x16x32_bf16 v[72:75], v[192:195], a[104:107], v[72:75]
    v_mfma_f32_16x16x32_bf16 v[76:79], v[192:195], a[108:111], v[76:79]
    ds_read_b128 v[192:195], v1 offset:12288
    s_waitcnt lgkmcnt(11)
    v_mfma_f32_16x16x32_bf16 v[92:95], v[196:199], a[108:111], v[92:95]
    v_mfma_f32_16x16x32_bf16 v[88:91], v[196:199], a[104:107], v[88:91]
    buffer_load_dwordx4 a[52:55], v5, s[4:7], s92 offen offset:0 sc1
    v_mfma_f32_16x16x32_bf16 v[84:87], v[196:199], a[100:103], v[84:87]
    v_mfma_f32_16x16x32_bf16 v[80:83], v[196:199], a[96:99], v[80:83]
    ds_read_b128 v[196:199], v1 offset:13312
    s_waitcnt lgkmcnt(9)
    v_mfma_f32_16x16x32_bf16 v[96:99], v[200:203], a[96:99], v[96:99]
    s_add_u32 m0, s57, 49152
    s_add_u32 s63, s101, 8388608
    v_mfma_f32_16x16x32_bf16 v[100:103], v[200:203], a[100:103], v[100:103]
    buffer_load_dwordx4 v10, s[4:7], s63 offen offset:0 lds
    v_mfma_f32_16x16x32_bf16 v[104:107], v[200:203], a[104:107], v[104:107]
    v_mfma_f32_16x16x32_bf16 v[108:111], v[200:203], a[108:111], v[108:111]
    ds_read_b128 v[200:203], v1 offset:14336
    s_waitcnt lgkmcnt(7)
    v_mfma_f32_16x16x32_bf16 v[124:127], v[204:207], a[108:111], v[124:127]
    v_mfma_f32_16x16x32_bf16 v[120:123], v[204:207], a[104:107], v[120:123]
    buffer_load_dwordx4 a[56:59], v6, s[4:7], s92 offen offset:0 sc1
    v_mfma_f32_16x16x32_bf16 v[116:119], v[204:207], a[100:103], v[116:119]
    v_mfma_f32_16x16x32_bf16 v[112:115], v[204:207], a[96:99], v[112:115]
    ds_read_b128 v[204:207], v1 offset:15360
    s_waitcnt lgkmcnt(5)
    v_mfma_f32_16x16x32_bf16 v[128:131], v[208:211], a[96:99], v[128:131]
    v_fmac_f32 v92, v172, v167
    v_fmac_f32 v93, v173, v167
    v_mfma_f32_16x16x32_bf16 v[132:135], v[208:211], a[100:103], v[132:135]
    buffer_load_dwordx4 a[60:63], v7, s[4:7], s92 offen offset:0 sc1
    v_mfma_f32_16x16x32_bf16 v[136:139], v[208:211], a[104:107], v[136:139]
    v_fmac_f32 v94, v174, v167
    v_fmac_f32 v95, v175, v167
    v_mfma_f32_16x16x32_bf16 v[140:143], v[208:211], a[108:111], v[140:143]
    ds_read_b128 v[208:211], v1 offset:16384
    s_waitcnt lgkmcnt(5)
    v_mfma_f32_16x16x32_bf16 v[156:159], v[212:215], a[108:111], v[156:159]
    v_fmac_f32 v108, v176, v167
    v_fmac_f32 v109, v177, v167
    v_mfma_f32_16x16x32_bf16 v[152:155], v[212:215], a[104:107], v[152:155]
    v_fmac_f32 v110, v178, v167
    v_fmac_f32 v111, v179, v167
    v_mfma_f32_16x16x32_bf16 v[148:151], v[212:215], a[100:103], v[148:151]
    v_fmac_f32 v104, v176, v165
    v_fmac_f32 v105, v177, v165
    v_mfma_f32_16x16x32_bf16 v[144:147], v[212:215], a[96:99], v[144:147]
    ds_read_b128 v[212:215], v1 offset:17408
    s_waitcnt vmcnt(11)
    s_waitcnt lgkmcnt(5)
    v_mfma_f32_16x16x32_bf16 v[64:67], v[192:195], a[112:115], v[64:67]
    v_fmac_f32 v124, v180, v167
    v_fmac_f32 v125, v181, v167
    v_mfma_f32_16x16x32_bf16 v[68:71], v[192:195], a[116:119], v[68:71]
    buffer_load_dwordx4 a[64:67], v4, s[4:7], s92 offen offset:1024 sc1
    v_mfma_f32_16x16x32_bf16 v[72:75], v[192:195], a[120:123], v[72:75]
    v_fmac_f32 v126, v182, v167
    v_fmac_f32 v127, v183, v167
    v_mfma_f32_16x16x32_bf16 v[76:79], v[192:195], a[124:127], v[76:79]
    ds_read_b128 v[192:195], v1 offset:18432
    s_waitcnt lgkmcnt(5)
    v_mfma_f32_16x16x32_bf16 v[92:95], v[196:199], a[124:127], v[92:95]
    v_fmac_f32 v140, v184, v167
    v_fmac_f32 v141, v185, v167
    v_mfma_f32_16x16x32_bf16 v[88:91], v[196:199], a[120:123], v[88:91]
    buffer_load_dwordx4 v10, s[4:7], s63 offen offset:1024 lds
    v_mfma_f32_16x16x32_bf16 v[84:87], v[196:199], a[116:119], v[84:87]
    v_fmac_f32 v142, v186, v167
    v_fmac_f32 v143, v187, v167
    v_mfma_f32_16x16x32_bf16 v[80:83], v[196:199], a[112:115], v[80:83]
    ds_read_b128 v[196:199], v1 offset:19456
    s_waitcnt lgkmcnt(5)
    v_mfma_f32_16x16x32_bf16 v[96:99], v[200:203], a[112:115], v[96:99]
    v_fmac_f32 v156, v188, v167
    v_fmac_f32 v157, v189, v167
    v_mfma_f32_16x16x32_bf16 v[100:103], v[200:203], a[116:119], v[100:103]
    buffer_load_dwordx4 a[68:71], v5, s[4:7], s92 offen offset:1024 sc1
    v_mfma_f32_16x16x32_bf16 v[104:107], v[200:203], a[120:123], v[104:107]
    v_fmac_f32 v158, v190, v167
    v_fmac_f32 v159, v191, v167
    v_mfma_f32_16x16x32_bf16 v[108:111], v[200:203], a[124:127], v[108:111]
    ds_read_b128 v[200:203], v1 offset:20480
    s_waitcnt lgkmcnt(5)
    v_mfma_f32_16x16x32_bf16 v[124:127], v[204:207], a[124:127], v[124:127]
    v_fmac_f32 v76, v168, v167
    v_fmac_f32 v77, v169, v167
    v_mfma_f32_16x16x32_bf16 v[120:123], v[204:207], a[120:123], v[120:123]
    buffer_load_dwordx4 a[72:75], v6, s[4:7], s92 offen offset:1024 sc1
    v_mfma_f32_16x16x32_bf16 v[116:119], v[204:207], a[116:119], v[116:119]
    v_fmac_f32 v78, v170, v167
    v_fmac_f32 v79, v171, v167
    v_mfma_f32_16x16x32_bf16 v[112:115], v[204:207], a[112:115], v[112:115]
    ds_read_b128 v[204:207], v1 offset:21504
    s_waitcnt lgkmcnt(5)
    v_mfma_f32_16x16x32_bf16 v[128:131], v[208:211], a[112:115], v[128:131]
    v_fmac_f32 v88, v172, v165
    v_fmac_f32 v89, v173, v165
    v_mfma_f32_16x16x32_bf16 v[132:135], v[208:211], a[116:119], v[132:135]
    buffer_load_dwordx4 v10, s[4:7], s63 offen offset:2048 lds
    v_mfma_f32_16x16x32_bf16 v[136:139], v[208:211], a[120:123], v[136:139]
    v_fmac_f32 v90, v174, v165
    v_fmac_f32 v91, v175, v165
    v_mfma_f32_16x16x32_bf16 v[140:143], v[208:211], a[124:127], v[140:143]
    ds_read_b128 v[208:211], v1 offset:22528
    s_waitcnt lgkmcnt(5)
    v_mfma_f32_16x16x32_bf16 v[156:159], v[212:215], a[124:127], v[156:159]
    v_fmac_f32 v106, v178, v165
    v_fmac_f32 v107, v179, v165
    v_mfma_f32_16x16x32_bf16 v[152:155], v[212:215], a[120:123], v[152:155]
    buffer_load_dwordx4 a[76:79], v7, s[4:7], s92 offen offset:1024 sc1
    v_mfma_f32_16x16x32_bf16 v[148:151], v[212:215], a[116:119], v[148:151]
    v_fmac_f32 v100, v176, v163
    v_fmac_f32 v101, v177, v163
    v_mfma_f32_16x16x32_bf16 v[144:147], v[212:215], a[112:115], v[144:147]
    ds_read_b128 v[212:215], v1 offset:23552
    s_waitcnt vmcnt(11)
    s_barrier
    s_waitcnt lgkmcnt(5)
    v_mfma_f32_16x16x32_bf16 v[64:67], v[192:195], a[128:131], v[64:67]
    v_fmac_f32 v120, v180, v165
    v_fmac_f32 v121, v181, v165
    v_mfma_f32_16x16x32_bf16 v[68:71], v[192:195], a[132:135], v[68:71]
    buffer_load_dwordx4 a[80:83], v4, s[4:7], s92 offen offset:2048 sc1
    v_mfma_f32_16x16x32_bf16 v[72:75], v[192:195], a[136:139], v[72:75]
    v_fmac_f32 v122, v182, v165
    v_fmac_f32 v123, v183, v165
    v_mfma_f32_16x16x32_bf16 v[76:79], v[192:195], a[140:143], v[76:79]
    ds_read_b128 v[192:195], v1 offset:24576
    s_waitcnt lgkmcnt(5)
    v_mfma_f32_16x16x32_bf16 v[92:95], v[196:199], a[140:143], v[92:95]
    v_fmac_f32 v136, v184, v165
    v_fmac_f32 v137, v185, v165
    v_mfma_f32_16x16x32_bf16 v[88:91], v[196:199], a[136:139], v[88:91]
    buffer_load_dwordx4 a[84:87], v5, s[4:7], s92 offen offset:2048 sc1
    v_mfma_f32_16x16x32_bf16 v[84:87], v[196:199], a[132:135], v[84:87]
    v_fmac_f32 v138, v186, v165
    v_fmac_f32 v139, v187, v165
    v_mfma_f32_16x16x32_bf16 v[80:83], v[196:199], a[128:131], v[80:83]
    ds_read_b128 v[196:199], v1 offset:25600
    s_waitcnt lgkmcnt(5)
    v_mfma_f32_16x16x32_bf16 v[96:99], v[200:203], a[128:131], v[96:99]
    v_fmac_f32 v152, v188, v165
    v_fmac_f32 v153, v189, v165
    v_mfma_f32_16x16x32_bf16 v[100:103], v[200:203], a[132:135], v[100:103]
    buffer_load_dwordx4 v10, s[4:7], s63 offen offset:3072 lds
    v_mfma_f32_16x16x32_bf16 v[104:107], v[200:203], a[136:139], v[104:107]
    v_fmac_f32 v154, v190, v165
    v_fmac_f32 v155, v191, v165
    v_mfma_f32_16x16x32_bf16 v[108:111], v[200:203], a[140:143], v[108:111]
    ds_read_b128 v[200:203], v1 offset:26624
    s_waitcnt lgkmcnt(5)
    v_mfma_f32_16x16x32_bf16 v[124:127], v[204:207], a[140:143], v[124:127]
    v_fmac_f32 v72, v168, v165
    v_fmac_f32 v73, v169, v165
    v_mfma_f32_16x16x32_bf16 v[120:123], v[204:207], a[136:139], v[120:123]
    buffer_load_dwordx4 a[88:91], v6, s[4:7], s92 offen offset:2048 sc1
    v_mfma_f32_16x16x32_bf16 v[116:119], v[204:207], a[132:135], v[116:119]
    v_fmac_f32 v74, v170, v165
    v_fmac_f32 v75, v171, v165
    v_mfma_f32_16x16x32_bf16 v[112:115], v[204:207], a[128:131], v[112:115]
    ds_read_b128 v[204:207], v1 offset:27648
    s_waitcnt lgkmcnt(5)
    v_mfma_f32_16x16x32_bf16 v[128:131], v[208:211], a[128:131], v[128:131]
    v_fmac_f32 v84, v172, v163
    v_fmac_f32 v85, v173, v163
    v_mfma_f32_16x16x32_bf16 v[132:135], v[208:211], a[132:135], v[132:135]
    buffer_load_dwordx4 a[92:95], v7, s[4:7], s92 offen offset:2048 sc1
    v_mfma_f32_16x16x32_bf16 v[136:139], v[208:211], a[136:139], v[136:139]
    v_fmac_f32 v86, v174, v163
    v_fmac_f32 v87, v175, v163
    v_mfma_f32_16x16x32_bf16 v[140:143], v[208:211], a[140:143], v[140:143]
    ds_read_b128 v[208:211], v1 offset:28672
    s_waitcnt lgkmcnt(5)
    v_mfma_f32_16x16x32_bf16 v[156:159], v[212:215], a[140:143], v[156:159]
    v_fmac_f32 v102, v178, v163
    v_fmac_f32 v103, v179, v163
    v_mfma_f32_16x16x32_bf16 v[152:155], v[212:215], a[136:139], v[152:155]
    v_fmac_f32 v96, v176, v161
    v_fmac_f32 v97, v177, v161
    v_mfma_f32_16x16x32_bf16 v[148:151], v[212:215], a[132:135], v[148:151]
    v_fmac_f32 v98, v178, v161
    v_fmac_f32 v99, v179, v161
    v_mfma_f32_16x16x32_bf16 v[144:147], v[212:215], a[128:131], v[144:147]
    ds_read_b128 v[212:215], v1 offset:29696
    s_waitcnt vmcnt(11)
    s_waitcnt lgkmcnt(5)
    v_mfma_f32_16x16x32_bf16 v[64:67], v[192:195], a[48:51], v[64:67]
    v_fmac_f32 v116, v180, v163
    v_fmac_f32 v117, v181, v163
    v_mfma_f32_16x16x32_bf16 v[68:71], v[192:195], a[52:55], v[68:71]
    buffer_load_dwordx4 a[96:99], v4, s[4:7], s92 offen offset:3072 sc1
    v_mfma_f32_16x16x32_bf16 v[72:75], v[192:195], a[56:59], v[72:75]
    v_fmac_f32 v118, v182, v163
    v_fmac_f32 v119, v183, v163
    v_mfma_f32_16x16x32_bf16 v[76:79], v[192:195], a[60:63], v[76:79]
    ds_read_b128 v[192:195], v1 offset:30720
    s_waitcnt lgkmcnt(5)
    v_mfma_f32_16x16x32_bf16 v[92:95], v[196:199], a[60:63], v[92:95]
    s_add_u32 m0, s57, 53248
    s_add_u32 s63, s101, 8392704
    v_mfma_f32_16x16x32_bf16 v[88:91], v[196:199], a[56:59], v[88:91]
    buffer_load_dwordx4 v10, s[4:7], s63 offen offset:0 lds
    v_mfma_f32_16x16x32_bf16 v[84:87], v[196:199], a[52:55], v[84:87]
    v_fmac_f32 v132, v184, v163
    v_fmac_f32 v133, v185, v163
    v_mfma_f32_16x16x32_bf16 v[80:83], v[196:199], a[48:51], v[80:83]
    ds_read_b128 v[196:199], v1 offset:31744
    s_waitcnt lgkmcnt(5)
    v_mfma_f32_16x16x32_bf16 v[96:99], v[200:203], a[48:51], v[96:99]
    v_fmac_f32 v148, v188, v163
    v_fmac_f32 v149, v189, v163
    v_mfma_f32_16x16x32_bf16 v[100:103], v[200:203], a[52:55], v[100:103]
    buffer_load_dwordx4 a[100:103], v5, s[4:7], s92 offen offset:3072 sc1
    v_mfma_f32_16x16x32_bf16 v[104:107], v[200:203], a[56:59], v[104:107]
    v_fmac_f32 v150, v190, v163
    v_fmac_f32 v151, v191, v163
    v_mfma_f32_16x16x32_bf16 v[108:111], v[200:203], a[60:63], v[108:111]
    ds_read_b128 v[200:203], v1 offset:32768
    s_waitcnt lgkmcnt(5)
    v_mfma_f32_16x16x32_bf16 v[124:127], v[204:207], a[60:63], v[124:127]
    v_fmac_f32 v68, v168, v163
    v_fmac_f32 v69, v169, v163
    v_mfma_f32_16x16x32_bf16 v[120:123], v[204:207], a[56:59], v[120:123]
    buffer_load_dwordx4 a[104:107], v6, s[4:7], s92 offen offset:3072 sc1
    v_mfma_f32_16x16x32_bf16 v[116:119], v[204:207], a[52:55], v[116:119]
    s_add_u32 s20, s48, L_epi0-L_pc
    s_addc_u32 s21, s49, 0
    global_load_dword v52, v35, s[20:21]
    v_mfma_f32_16x16x32_bf16 v[112:115], v[204:207], a[48:51], v[112:115]
    ds_read_b128 v[204:207], v1 offset:33792
    s_waitcnt lgkmcnt(5)
    v_mfma_f32_16x16x32_bf16 v[128:131], v[208:211], a[48:51], v[128:131]
    v_fmac_f32 v80, v172, v161
    v_fmac_f32 v81, v173, v161
    v_mfma_f32_16x16x32_bf16 v[132:135], v[208:211], a[52:55], v[132:135]
    buffer_load_dwordx4 v10, s[4:7], s63 offen offset:1024 lds
    v_mfma_f32_16x16x32_bf16 v[136:139], v[208:211], a[56:59], v[136:139]
    v_fmac_f32 v82, v174, v161
    v_fmac_f32 v83, v175, v161
    v_mfma_f32_16x16x32_bf16 v[140:143], v[208:211], a[60:63], v[140:143]
    ds_read_b128 v[208:211], v1 offset:34816
    s_waitcnt lgkmcnt(5)
    v_mfma_f32_16x16x32_bf16 v[156:159], v[212:215], a[60:63], v[156:159]
    v_mul_f32 v220, 0x3fb8aa3b, v160
    v_mul_f32 v221, 0x3fb8aa3b, v162
    v_mfma_f32_16x16x32_bf16 v[152:155], v[212:215], a[56:59], v[152:155]
    buffer_load_dwordx4 a[108:111], v7, s[4:7], s92 offen offset:3072 sc1
    v_mfma_f32_16x16x32_bf16 v[148:151], v[212:215], a[52:55], v[148:151]
    v_mul_f32 v222, 0x3fb8aa3b, v164
    v_mul_f32 v223, 0x3fb8aa3b, v166
    v_mfma_f32_16x16x32_bf16 v[144:147], v[212:215], a[48:51], v[144:147]
    ds_read_b128 v[212:215], v1 offset:35840
    s_waitcnt vmcnt(12)
    s_waitcnt lgkmcnt(5)
    v_mfma_f32_16x16x32_bf16 v[64:67], v[192:195], a[64:67], v[64:67]
    v_fmac_f32 v112, v180, v161
    v_fmac_f32 v113, v181, v161
    v_mfma_f32_16x16x32_bf16 v[68:71], v[192:195], a[68:71], v[68:71]
    buffer_load_dwordx4 a[112:115], v4, s[4:7], s93 offen offset:0 sc1
    v_mfma_f32_16x16x32_bf16 v[72:75], v[192:195], a[72:75], v[72:75]
    v_fmac_f32 v114, v182, v161
    v_fmac_f32 v115, v183, v161
    v_mfma_f32_16x16x32_bf16 v[76:79], v[192:195], a[76:79], v[76:79]
    ds_read_b128 v[192:195], v1 offset:36864
    s_waitcnt lgkmcnt(5)
    v_mfma_f32_16x16x32_bf16 v[92:95], v[196:199], a[76:79], v[92:95]
    s_add_u32 m0, s57, 73728
    s_mov_b32 s63, 21028864
    v_mfma_f32_16x16x32_bf16 v[88:91], v[196:199], a[72:75], v[88:91]
    buffer_load_dwordx4 v11, s[4:7], s63 offen offset:0 lds
    v_mfma_f32_16x16x32_bf16 v[84:87], v[196:199], a[68:71], v[84:87]
    v_fmac_f32 v134, v186, v163
    v_fmac_f32 v135, v187, v163
    v_mfma_f32_16x16x32_bf16 v[80:83], v[196:199], a[64:67], v[80:83]
    ds_read_b128 v[196:199], v1 offset:37888
    s_waitcnt lgkmcnt(5)
    v_mfma_f32_16x16x32_bf16 v[96:99], v[200:203], a[64:67], v[96:99]
    v_fmac_f32 v144, v188, v161
    v_fmac_f32 v145, v189, v161
    v_mfma_f32_16x16x32_bf16 v[100:103], v[200:203], a[68:71], v[100:103]
    buffer_load_dwordx4 a[116:119], v5, s[4:7], s93 offen offset:0 sc1
    v_mfma_f32_16x16x32_bf16 v[104:107], v[200:203], a[72:75], v[104:107]
    v_fmac_f32 v146, v190, v161
    v_fmac_f32 v147, v191, v161
    v_mfma_f32_16x16x32_bf16 v[108:111], v[200:203], a[76:79], v[108:111]
    ds_read_b128 v[200:203], v1 offset:38912
    s_waitcnt lgkmcnt(5)
    v_mfma_f32_16x16x32_bf16 v[124:127], v[204:207], a[76:79], v[124:127]
    v_fmac_f32 v70, v170, v163
    v_fmac_f32 v71, v171, v163
    v_mfma_f32_16x16x32_bf16 v[120:123], v[204:207], a[72:75], v[120:123]
    buffer_load_dwordx4 a[120:123], v6, s[4:7], s93 offen offset:0 sc1
    v_mfma_f32_16x16x32_bf16 v[116:119], v[204:207], a[68:71], v[116:119]
    v_fmac_f32 v64, v168, v161
    v_fmac_f32 v65, v169, v161
    v_mfma_f32_16x16x32_bf16 v[112:115], v[204:207], a[64:67], v[112:115]
    ds_read_b128 v[204:207], v1 offset:39936
    s_waitcnt lgkmcnt(5)
    v_mfma_f32_16x16x32_bf16 v[128:131], v[208:211], a[64:67], v[128:131]
    v_mfma_f32_16x16x32_bf16 v[132:135], v[208:211], a[68:71], v[132:135]
    buffer_load_dwordx4 v11, s[4:7], s63 offen offset:1024 lds
    v_mfma_f32_16x16x32_bf16 v[136:139], v[208:211], a[72:75], v[136:139]
    v_mfma_f32_16x16x32_bf16 v[140:143], v[208:211], a[76:79], v[140:143]
    ds_read_b128 v[208:211], v1 offset:40960
    s_waitcnt lgkmcnt(5)
    v_mfma_f32_16x16x32_bf16 v[156:159], v[212:215], a[76:79], v[156:159]
    v_mfma_f32_16x16x32_bf16 v[152:155], v[212:215], a[72:75], v[152:155]
    buffer_load_dwordx4 a[124:127], v7, s[4:7], s93 offen offset:0 sc1
    v_mfma_f32_16x16x32_bf16 v[148:151], v[212:215], a[68:71], v[148:151]
    v_mfma_f32_16x16x32_bf16 v[144:147], v[212:215], a[64:67], v[144:147]
    ds_read_b128 v[212:215], v1 offset:41984
    s_waitcnt vmcnt(13)
    s_waitcnt lgkmcnt(3)
    v_mfma_f32_16x16x32_bf16 v[96:99], v[200:203], a[80:83], v[96:99]
    v_fmac_f32 v128, v184, v161
    v_fmac_f32 v129, v185, v161
    v_mfma_f32_16x16x32_bf16 v[100:103], v[200:203], a[84:87], v[100:103]
    buffer_load_dwordx4 a[128:131], v4, s[4:7], s93 offen offset:1024 sc1
    v_mfma_f32_16x16x32_bf16 v[104:107], v[200:203], a[88:91], v[104:107]
    ds_read_b128 a[216:219], v1 offset:43008
    v_mfma_f32_16x16x32_bf16 v[108:111], v[200:203], a[92:95], v[108:111]
    ds_read_b128 v[200:203], v1 offset:45056
    s_waitcnt lgkmcnt(4)
    v_mfma_f32_16x16x32_bf16 v[124:127], v[204:207], a[92:95], v[124:127]
    v_mfma_f32_16x16x32_bf16 v[120:123], v[204:207], a[88:91], v[120:123]
    buffer_load_dwordx4 a[132:135], v5, s[4:7], s93 offen offset:1024 sc1
    v_mfma_f32_16x16x32_bf16 v[116:119], v[204:207], a[84:87], v[116:119]
    ds_read_b128 a[220:223], v1 offset:44032
    v_mfma_f32_16x16x32_bf16 v[112:115], v[204:207], a[80:83], v[112:115]
    ds_read_b128 v[204:207], v1 offset:46080
    s_waitcnt lgkmcnt(5)
    v_mfma_f32_16x16x32_bf16 v[128:131], v[208:211], a[80:83], v[128:131]
    v_mfma_f32_16x16x32_bf16 v[132:135], v[208:211], a[84:87], v[132:135]
    buffer_load_dwordx4 a[136:139], v6, s[4:7], s93 offen offset:1024 sc1
    v_mfma_f32_16x16x32_bf16 v[136:139], v[208:211], a[88:91], v[136:139]
    v_mfma_f32_16x16x32_bf16 v[140:143], v[208:211], a[92:95], v[140:143]
    ds_read_b128 v[208:211], v1 offset:47104
    s_waitcnt lgkmcnt(5)
    v_mfma_f32_16x16x32_bf16 v[156:159], v[212:215], a[92:95], v[156:159]
    v_mfma_f32_16x16x32_bf16 v[152:155], v[212:215], a[88:91], v[152:155]
    buffer_load_dwordx4 a[140:143], v7, s[4:7], s93 offen offset:1024 sc1
    v_mfma_f32_16x16x32_bf16 v[148:151], v[212:215], a[84:87], v[148:151]
    s_add_u32 s20, s48, L_ool-L_pc
    s_addc_u32 s21, s49, 0
    global_load_dword v52, v35, s[20:21]
    v_mfma_f32_16x16x32_bf16 v[144:147], v[212:215], a[80:83], v[144:147]
    ds_read_b128 v[212:215], v1 offset:48128
    s_waitcnt vmcnt(11)
    s_barrier
    s_waitcnt lgkmcnt(4)
    v_mfma_f32_16x16x32_bf16 v[96:99], v[200:203], a[96:99], v[96:99]
    v_fmac_f32 v130, v186, v161
    v_fmac_f32 v131, v187, v161
    v_mfma_f32_16x16x32_bf16 v[100:103], v[200:203], a[100:103], v[100:103]
    buffer_load_dwordx4 a[48:51], v4, s[4:7], s93 offen offset:2048 sc1
    v_mfma_f32_16x16x32_bf16 v[104:107], v[200:203], a[104:107], v[104:107]
    ds_read_b128 a[224:227], v1 offset:49152
    v_mfma_f32_16x16x32_bf16 v[108:111], v[200:203], a[108:111], v[108:111]
    ds_read_b128 v[200:203], v1 offset:51200
    s_waitcnt lgkmcnt(4)
    v_mfma_f32_16x16x32_bf16 v[124:127], v[204:207], a[108:111], v[124:127]
    v_fmac_f32 v66, v170, v161
    v_fmac_f32 v67, v171, v161
    v_mfma_f32_16x16x32_bf16 v[120:123], v[204:207], a[104:107], v[120:123]
    buffer_load_dwordx4 a[52:55], v5, s[4:7], s93 offen offset:2048 sc1
    v_mfma_f32_16x16x32_bf16 v[116:119], v[204:207], a[100:103], v[116:119]
    ds_read_b128 a[228:231], v1 offset:50176
    v_mfma_f32_16x16x32_bf16 v[112:115], v[204:207], a[96:99], v[112:115]
    ds_read_b128 v[204:207], v1 offset:52224
    s_waitcnt lgkmcnt(5)
    v_mfma_f32_16x16x32_bf16 v[128:131], v[208:211], a[96:99], v[128:131]
    v_mfma_f32_16x16x32_bf16 v[132:135], v[208:211], a[100:103], v[132:135]
    buffer_load_dwordx4 a[56:59], v6, s[4:7], s93 offen offset:2048 sc1
    v_mfma_f32_16x16x32_bf16 v[136:139], v[208:211], a[104:107], v[136:139]
    v_mfma_f32_16x16x32_bf16 v[140:143], v[208:211], a[108:111], v[140:143]
    ds_read_b128 v[208:211], v1 offset:53248
    s_waitcnt lgkmcnt(5)
    v_mfma_f32_16x16x32_bf16 v[156:159], v[212:215], a[108:111], v[156:159]
    v_mfma_f32_16x16x32_bf16 v[152:155], v[212:215], a[104:107], v[152:155]
    buffer_load_dwordx4 a[60:63], v7, s[4:7], s93 offen offset:2048 sc1
    v_mfma_f32_16x16x32_bf16 v[148:151], v[212:215], a[100:103], v[148:151]
    v_mfma_f32_16x16x32_bf16 v[144:147], v[212:215], a[96:99], v[144:147]
    ds_read_b128 v[212:215], v1 offset:54272
    s_waitcnt vmcnt(9)
    s_waitcnt lgkmcnt(4)
    v_mfma_f32_16x16x32_bf16 v[96:99], v[200:203], a[112:115], v[96:99]
    v_mfma_f32_16x16x32_bf16 v[100:103], v[200:203], a[116:119], v[100:103]
    buffer_load_dwordx4 a[64:67], v4, s[4:7], s93 offen offset:3072 sc1
    v_mfma_f32_16x16x32_bf16 v[104:107], v[200:203], a[120:123], v[104:107]
    ds_read_b128 a[232:235], v1 offset:55296
    v_mfma_f32_16x16x32_bf16 v[108:111], v[200:203], a[124:127], v[108:111]
    ds_read_b128 v[200:203], v1 offset:57344
    s_waitcnt lgkmcnt(4)
    v_mfma_f32_16x16x32_bf16 v[124:127], v[204:207], a[124:127], v[124:127]
    v_mfma_f32_16x16x32_bf16 v[120:123], v[204:207], a[120:123], v[120:123]
    buffer_load_dwordx4 a[68:71], v5, s[4:7], s93 offen offset:3072 sc1
    v_mfma_f32_16x16x32_bf16 v[116:119], v[204:207], a[116:119], v[116:119]
    ds_read_b128 a[236:239], v1 offset:56320
    v_mfma_f32_16x16x32_bf16 v[112:115], v[204:207], a[112:115], v[112:115]
    ds_read_b128 v[204:207], v1 offset:58368
    s_waitcnt lgkmcnt(5)
    v_mfma_f32_16x16x32_bf16 v[128:131], v[208:211], a[112:115], v[128:131]
    v_mfma_f32_16x16x32_bf16 v[132:135], v[208:211], a[116:119], v[132:135]
    buffer_load_dwordx4 a[72:75], v6, s[4:7], s93 offen offset:3072 sc1
    v_mfma_f32_16x16x32_bf16 v[136:139], v[208:211], a[120:123], v[136:139]
    v_mfma_f32_16x16x32_bf16 v[140:143], v[208:211], a[124:127], v[140:143]
    ds_read_b128 v[208:211], v1 offset:59392
    s_waitcnt lgkmcnt(5)
    v_mfma_f32_16x16x32_bf16 v[156:159], v[212:215], a[124:127], v[156:159]
    v_mfma_f32_16x16x32_bf16 v[152:155], v[212:215], a[120:123], v[152:155]
    buffer_load_dwordx4 a[76:79], v7, s[4:7], s93 offen offset:3072 sc1
    v_mfma_f32_16x16x32_bf16 v[148:151], v[212:215], a[116:119], v[148:151]
    v_mfma_f32_16x16x32_bf16 v[144:147], v[212:215], a[112:115], v[144:147]
    ds_read_b128 v[212:215], v1 offset:60416
    s_waitcnt vmcnt(9)
    s_waitcnt lgkmcnt(4)
    v_mfma_f32_16x16x32_bf16 v[96:99], v[200:203], a[128:131], v[96:99]
    v_mfma_f32_16x16x32_bf16 v[100:103], v[200:203], a[132:135], v[100:103]
    buffer_load_dwordx4 v11, s[4:7], s63 offen offset:2048 lds
    v_mfma_f32_16x16x32_bf16 v[104:107], v[200:203], a[136:139], v[104:107]
    ds_read_b128 a[168:171], v1 offset:61440
    v_mfma_f32_16x16x32_bf16 v[108:111], v[200:203], a[140:143], v[108:111]
    ds_read_b128 v[200:203], v1 offset:63488
    s_waitcnt lgkmcnt(4)
    v_mfma_f32_16x16x32_bf16 v[124:127], v[204:207], a[140:143], v[124:127]
    v_mfma_f32_16x16x32_bf16 v[120:123], v[204:207], a[136:139], v[120:123]
    buffer_load_dwordx4 v11, s[4:7], s63 offen offset:3072 lds
    v_mfma_f32_16x16x32_bf16 v[116:119], v[204:207], a[132:135], v[116:119]
    ds_read_b128 a[172:175], v1 offset:62464
    v_mfma_f32_16x16x32_bf16 v[112:115], v[204:207], a[128:131], v[112:115]
    ds_read_b128 v[204:207], v1 offset:64512
    s_waitcnt lgkmcnt(5)
    v_mfma_f32_16x16x32_bf16 v[128:131], v[208:211], a[128:131], v[128:131]
    s_add_u32 m0, s57, 77824
    s_mov_b32 s63, 21032960
    v_mfma_f32_16x16x32_bf16 v[132:135], v[208:211], a[132:135], v[132:135]
    buffer_load_dwordx4 v11, s[4:7], s63 offen offset:0 lds
    v_mfma_f32_16x16x32_bf16 v[136:139], v[208:211], a[136:139], v[136:139]
    v_mfma_f32_16x16x32_bf16 v[140:143], v[208:211], a[140:143], v[140:143]
    ds_read_b128 v[208:211], v2 offset:0
    s_waitcnt lgkmcnt(5)
    v_mfma_f32_16x16x32_bf16 v[156:159], v[212:215], a[140:143], v[156:159]
    v_mfma_f32_16x16x32_bf16 v[152:155], v[212:215], a[136:139], v[152:155]
    v_mfma_f32_16x16x32_bf16 v[148:151], v[212:215], a[132:135], v[148:151]
    v_mfma_f32_16x16x32_bf16 v[144:147], v[212:215], a[128:131], v[144:147]
    ds_read_b128 v[212:215], v2 offset:1024
    s_waitcnt vmcnt(7)
    s_waitcnt lgkmcnt(4)
    v_mfma_f32_16x16x32_bf16 v[96:99], v[200:203], a[48:51], v[96:99]
    v_mfma_f32_16x16x32_bf16 v[100:103], v[200:203], a[52:55], v[100:103]
    buffer_load_dwordx4 v11, s[4:7], s63 offen offset:1024 lds
    v_mfma_f32_16x16x32_bf16 v[104:107], v[200:203], a[56:59], v[104:107]
    ds_read_b128 a[176:179], v2 offset:2048
    v_mfma_f32_16x16x32_bf16 v[108:111], v[200:203], a[60:63], v[108:111]
    ds_read_b128 v[200:203], v2 offset:4096
    s_waitcnt lgkmcnt(4)
    v_mfma_f32_16x16x32_bf16 v[124:127], v[204:207], a[60:63], v[124:127]
    s_add_u32 m0, s57, 98304
    s_mov_b32 s63, 21053440
    v_mfma_f32_16x16x32_bf16 v[120:123], v[204:207], a[56:59], v[120:123]
    buffer_load_dwordx4 v11, s[4:7], s63 offen offset:0 lds
    v_mfma_f32_16x16x32_bf16 v[116:119], v[204:207], a[52:55], v[116:119]
    ds_read_b128 a[180:183], v2 offset:3072
    v_mfma_f32_16x16x32_bf16 v[112:115], v[204:207], a[48:51], v[112:115]
    ds_read_b128 v[204:207], v2 offset:5120
    s_waitcnt lgkmcnt(5)
    v_mfma_f32_16x16x32_bf16 v[128:131], v[208:211], a[48:51], v[128:131]
    v_mfma_f32_16x16x32_bf16 v[132:135], v[208:211], a[52:55], v[132:135]
    buffer_load_dwordx4 v11, s[4:7], s63 offen offset:1024 lds
    v_mfma_f32_16x16x32_bf16 v[136:139], v[208:211], a[56:59], v[136:139]
    v_mfma_f32_16x16x32_bf16 v[140:143], v[208:211], a[60:63], v[140:143]
    ds_read_b128 v[208:211], v2 offset:6144
    s_waitcnt lgkmcnt(5)
    v_mfma_f32_16x16x32_bf16 v[156:159], v[212:215], a[60:63], v[156:159]
    v_mfma_f32_16x16x32_bf16 v[152:155], v[212:215], a[56:59], v[152:155]
    v_mfma_f32_16x16x32_bf16 v[148:151], v[212:215], a[52:55], v[148:151]
    v_mfma_f32_16x16x32_bf16 v[144:147], v[212:215], a[48:51], v[144:147]
    ds_read_b128 v[212:215], v2 offset:7168
    s_waitcnt vmcnt(6)
    s_waitcnt lgkmcnt(4)
    v_mfma_f32_16x16x32_bf16 v[96:99], v[200:203], a[64:67], v[96:99]
    v_mfma_f32_16x16x32_bf16 v[100:103], v[200:203], a[68:71], v[100:103]
    buffer_load_dwordx4 v11, s[4:7], s63 offen offset:2048 lds
    v_mfma_f32_16x16x32_bf16 v[104:107], v[200:203], a[72:75], v[104:107]
    v_mfma_f32_16x16x32_bf16 v[108:111], v[200:203], a[76:79], v[108:111]
    s_waitcnt lgkmcnt(2)
    v_mfma_f32_16x16x32_bf16 v[124:127], v[204:207], a[76:79], v[124:127]
    v_mfma_f32_16x16x32_bf16 v[120:123], v[204:207], a[72:75], v[120:123]
    buffer_load_dwordx4 v11, s[4:7], s63 offen offset:3072 lds
    v_mfma_f32_16x16x32_bf16 v[116:119], v[204:207], a[68:71], v[116:119]
    v_mfma_f32_16x16x32_bf16 v[112:115], v[204:207], a[64:67], v[112:115]
    s_waitcnt lgkmcnt(1)
    v_mfma_f32_16x16x32_bf16 v[128:131], v[208:211], a[64:67], v[128:131]
    s_add_u32 m0, s57, 102400
    s_mov_b32 s63, 21057536
    v_mfma_f32_16x16x32_bf16 v[132:135], v[208:211], a[68:71], v[132:135]
    buffer_load_dwordx4 v11, s[4:7], s63 offen offset:0 lds
    v_mfma_f32_16x16x32_bf16 v[136:139], v[208:211], a[72:75], v[136:139]
    v_mfma_f32_16x16x32_bf16 v[140:143], v[208:211], a[76:79], v[140:143]
    s_waitcnt lgkmcnt(0)
    v_mfma_f32_16x16x32_bf16 v[156:159], v[212:215], a[76:79], v[156:159]
    v_mfma_f32_16x16x32_bf16 v[152:155], v[212:215], a[72:75], v[152:155]
    v_mfma_f32_16x16x32_bf16 v[148:151], v[212:215], a[68:71], v[148:151]
    v_mfma_f32_16x16x32_bf16 v[144:147], v[212:215], a[64:67], v[144:147]
L_epi0:
    s_waitcnt lgkmcnt(0)
    s_barrier
    buffer_load_dwordx4 v11, s[4:7], s63 offen offset:1024 lds
    v_max3_f32 v171, v108, v109, v110
    v_max3_f32 v171, v171, v111, v124
    v_max3_f32 v171, v171, v125, v126
    v_max_f32 v171, v171, v127
    v_min3_f32 v175, v108, v109, v110
    v_min3_f32 v175, v175, v111, v124
    v_min3_f32 v175, v175, v125, v126
    v_min_f32 v175, v175, v127
    v_max3_f32 v170, v104, v105, v106
    v_max3_f32 v170, v170, v107, v120
    v_max3_f32 v170, v170, v121, v122
    v_max_f32 v170, v170, v123
    v_min3_f32 v174, v104, v105, v106
    v_min3_f32 v174, v174, v107, v120
    v_min3_f32 v174, v174, v121, v122
    v_min_f32 v174, v174, v123
    v_max3_f32 v169, v100, v101, v102
    v_max3_f32 v169, v169, v103, v116
    v_max3_f32 v169, v169, v117, v118
    v_max_f32 v169, v169, v119
    v_min3_f32 v173, v100, v101, v102
    v_min3_f32 v173, v173, v103, v116
    v_min3_f32 v173, v173, v117, v118
    v_min_f32 v173, v173, v119
    v_max3_f32 v168, v96, v97, v98
    v_max3_f32 v168, v168, v99, v112
    v_max3_f32 v168, v168, v113, v114
    v_max_f32 v168, v168, v115
    s_add_u32 s65, s94, 14680064
    s_add_u32 s1, s65, 4096
    buffer_store_dwordx4 a[24:27], v10, s[4:7], s65 offen offset:0 sc1
    v_min3_f32 v172, v96, v97, v98
    v_min3_f32 v172, v172, v99, v112
    v_min3_f32 v172, v172, v113, v114
    v_min_f32 v172, v172, v115
    v_pk_mul_f32 v[128:129], v[128:129], v[160:161] op_sel:[0,0] op_sel_hi:[1,0]
    v_pk_mul_f32 v[130:131], v[130:131], v[160:161] op_sel:[0,0] op_sel_hi:[1,0]
    v_pk_mul_f32 v[144:145], v[144:145], v[160:161] op_sel:[0,0] op_sel_hi:[1,0]
    v_pk_mul_f32 v[146:147], v[146:147], v[160:161] op_sel:[0,0] op_sel_hi:[1,0]
    v_cvt_pk_bf16_f32 v128, v128, v129
    v_cvt_pk_bf16_f32 v129, v130, v131
    v_cvt_pk_bf16_f32 v130, v144, v145
    v_cvt_pk_bf16_f32 v131, v146, v147
    ds_write2st64_b64 v48, v[128:129], v[130:131] offset0:112 offset1:113
    v_pk_mul_f32 v[132:133], v[132:133], v[162:163] op_sel:[0,0] op_sel_hi:[1,0]
    v_pk_mul_f32 v[134:135], v[134:135], v[162:163] op_sel:[0,0] op_sel_hi:[1,0]
    v_pk_mul_f32 v[148:149], v[148:149], v[162:163] op_sel:[0,0] op_sel_hi:[1,0]
    v_pk_mul_f32 v[150:151], v[150:151], v[162:163] op_sel:[0,0] op_sel_hi:[1,0]
    v_cvt_pk_bf16_f32 v132, v132, v133
    v_cvt_pk_bf16_f32 v133, v134, v135
    v_cvt_pk_bf16_f32 v134, v148, v149
    v_cvt_pk_bf16_f32 v135, v150, v151
    ds_write2st64_b64 v48, v[132:133], v[134:135] offset0:114 offset1:115
    v_pk_mul_f32 v[136:137], v[136:137], v[164:165] op_sel:[0,0] op_sel_hi:[1,0]
    v_pk_mul_f32 v[138:139], v[138:139], v[164:165] op_sel:[0,0] op_sel_hi:[1,0]
    v_pk_mul_f32 v[152:153], v[152:153], v[164:165] op_sel:[0,0] op_sel_hi:[1,0]
    v_pk_mul_f32 v[154:155], v[154:155], v[164:165] op_sel:[0,0] op_sel_hi:[1,0]
    v_cvt_pk_bf16_f32 v136, v136, v137
    v_cvt_pk_bf16_f32 v137, v138, v139
    s_add_u32 m0, s57, 122880
    s_mov_b32 s63, 21078016
    buffer_load_dwordx4 v11, s[4:7], s63 offen offset:0 lds
    v_cvt_pk_bf16_f32 v138, v152, v153
    v_cvt_pk_bf16_f32 v139, v154, v155
    ds_write2st64_b64 v48, v[136:137], v[138:139] offset0:116 offset1:117
    v_pk_mul_f32 v[140:141], v[140:141], v[166:167] op_sel:[0,0] op_sel_hi:[1,0]
    v_pk_mul_f32 v[142:143], v[142:143], v[166:167] op_sel:[0,0] op_sel_hi:[1,0]
    v_pk_mul_f32 v[156:157], v[156:157], v[166:167] op_sel:[0,0] op_sel_hi:[1,0]
    v_pk_mul_f32 v[158:159], v[158:159], v[166:167] op_sel:[0,0] op_sel_hi:[1,0]
    v_cvt_pk_bf16_f32 v140, v140, v141
    v_cvt_pk_bf16_f32 v141, v142, v143
    v_cvt_pk_bf16_f32 v142, v156, v157
    v_cvt_pk_bf16_f32 v143, v158, v159
    ds_write2st64_b64 v48, v[140:141], v[142:143] offset0:118 offset1:119
    v_permlane32_swap_b32 v168, v169
    v_permlane32_swap_b32 v170, v171
    v_permlane32_swap_b32 v172, v173
    v_permlane32_swap_b32 v174, v175
    v_max_f32 v168, v168, v169
    v_max_f32 v170, v170, v171
    v_min_f32 v172, v172, v173
    v_min_f32 v174, v174, v175
    v_permlane16_swap_b32 v168, v170
    s_nop 0
    v_permlane16_swap_b32 v172, v174
    buffer_store_dwordx4 a[28:31], v10, s[4:7], s65 offen offset:1024 sc1
    v_max_f32 v169, v168, v170
    v_max_f32 v170, v168, v170
    v_min_f32 v173, v172, v174
    v_min_f32 v174, v172, v174
    v_permlane16_swap_b32 v169, v170
    s_nop 0
    v_permlane16_swap_b32 v173, v174
    v_mov_b32 v168, v169
    v_mov_b32 v171, v170
    v_mov_b32 v172, v173
    v_mov_b32 v175, v174
    v_permlane32_swap_b32 v168, v169
    v_permlane32_swap_b32 v170, v171
    v_permlane32_swap_b32 v172, v173
    v_permlane32_swap_b32 v174, v175
    v_mul_f32 v168, -v168, v220
    v_mul_f32 v172, v172, v220
    v_mul_f32 v169, -v169, v221
    v_mul_f32 v173, v173, v221
    v_mul_f32 v170, -v170, v222
    v_mul_f32 v174, v174, v222
    v_mul_f32 v171, -v171, v223
    v_mul_f32 v175, v175, v223
    buffer_load_dwordx4 v11, s[4:7], s63 offen offset:1024 lds
    v_pk_fma_f32 v[224:225], v[96:97], v[220:221], v[168:169] op_sel:[0,0,0] op_sel_hi:[1,0,0]
    v_pk_fma_f32 v[96:97], v[96:97], v[220:221], v[172:173] op_sel:[0,0,0] op_sel_hi:[1,0,0] neg_lo:[1,0,0] neg_hi:[1,0,0]
    v_pk_fma_f32 v[226:227], v[98:99], v[220:221], v[168:169] op_sel:[0,0,0] op_sel_hi:[1,0,0]
    v_pk_fma_f32 v[98:99], v[98:99], v[220:221], v[172:173] op_sel:[0,0,0] op_sel_hi:[1,0,0] neg_lo:[1,0,0] neg_hi:[1,0,0]
    v_pk_fma_f32 v[228:229], v[112:113], v[220:221], v[168:169] op_sel:[0,0,0] op_sel_hi:[1,0,0]
    v_pk_fma_f32 v[112:113], v[112:113], v[220:221], v[172:173] op_sel:[0,0,0] op_sel_hi:[1,0,0] neg_lo:[1,0,0] neg_hi:[1,0,0]
    v_pk_fma_f32 v[230:231], v[114:115], v[220:221], v[168:169] op_sel:[0,0,0] op_sel_hi:[1,0,0]
    v_pk_fma_f32 v[114:115], v[114:115], v[220:221], v[172:173] op_sel:[0,0,0] op_sel_hi:[1,0,0] neg_lo:[1,0,0] neg_hi:[1,0,0]
    v_pk_fma_f32 v[232:233], v[100:101], v[220:221], v[168:169] op_sel:[0,1,1] op_sel_hi:[1,1,1]
    v_pk_fma_f32 v[100:101], v[100:101], v[220:221], v[172:173] op_sel:[0,1,1] op_sel_hi:[1,1,1] neg_lo:[1,0,0] neg_hi:[1,0,0]
    v_pk_fma_f32 v[234:235], v[102:103], v[220:221], v[168:169] op_sel:[0,1,1] op_sel_hi:[1,1,1]
    v_pk_fma_f32 v[102:103], v[102:103], v[220:221], v[172:173] op_sel:[0,1,1] op_sel_hi:[1,1,1] neg_lo:[1,0,0] neg_hi:[1,0,0]
    v_pk_fma_f32 v[236:237], v[116:117], v[220:221], v[168:169] op_sel:[0,1,1] op_sel_hi:[1,1,1]
    v_pk_fma_f32 v[116:117], v[116:117], v[220:221], v[172:173] op_sel:[0,1,1] op_sel_hi:[1,1,1] neg_lo:[1,0,0] neg_hi:[1,0,0]
    v_pk_fma_f32 v[238:239], v[118:119], v[220:221], v[168:169] op_sel:[0,1,1] op_sel_hi:[1,1,1]
    v_pk_fma_f32 v[118:119], v[118:119], v[220:221], v[172:173] op_sel:[0,1,1] op_sel_hi:[1,1,1] neg_lo:[1,0,0] neg_hi:[1,0,0]
    v_pk_fma_f32 v[240:241], v[104:105], v[222:223], v[170:171] op_sel:[0,0,0] op_sel_hi:[1,0,0]
    v_pk_fma_f32 v[104:105], v[104:105], v[222:223], v[174:175] op_sel:[0,0,0] op_sel_hi:[1,0,0] neg_lo:[1,0,0] neg_hi:[1,0,0]
    v_pk_fma_f32 v[242:243], v[106:107], v[222:223], v[170:171] op_sel:[0,0,0] op_sel_hi:[1,0,0]
    v_pk_fma_f32 v[106:107], v[106:107], v[222:223], v[174:175] op_sel:[0,0,0] op_sel_hi:[1,0,0] neg_lo:[1,0,0] neg_hi:[1,0,0]
    v_pk_fma_f32 v[244:245], v[120:121], v[222:223], v[170:171] op_sel:[0,0,0] op_sel_hi:[1,0,0]
    v_pk_fma_f32 v[120:121], v[120:121], v[222:223], v[174:175] op_sel:[0,0,0] op_sel_hi:[1,0,0] neg_lo:[1,0,0] neg_hi:[1,0,0]
    v_pk_fma_f32 v[246:247], v[122:123], v[222:223], v[170:171] op_sel:[0,0,0] op_sel_hi:[1,0,0]
    v_pk_fma_f32 v[122:123], v[122:123], v[222:223], v[174:175] op_sel:[0,0,0] op_sel_hi:[1,0,0] neg_lo:[1,0,0] neg_hi:[1,0,0]
    v_pk_fma_f32 v[248:249], v[108:109], v[222:223], v[170:171] op_sel:[0,1,1] op_sel_hi:[1,1,1]
    v_pk_fma_f32 v[108:109], v[108:109], v[222:223], v[174:175] op_sel:[0,1,1] op_sel_hi:[1,1,1] neg_lo:[1,0,0] neg_hi:[1,0,0]
    v_pk_fma_f32 v[250:251], v[110:111], v[222:223], v[170:171] op_sel:[0,1,1] op_sel_hi:[1,1,1]
    v_pk_fma_f32 v[110:111], v[110:111], v[222:223], v[174:175] op_sel:[0,1,1] op_sel_hi:[1,1,1] neg_lo:[1,0,0] neg_hi:[1,0,0]
    buffer_store_dwordx4 a[32:35], v10, s[4:7], s65 offen offset:2048 sc1
    v_pk_fma_f32 v[252:253], v[124:125], v[222:223], v[170:171] op_sel:[0,1,1] op_sel_hi:[1,1,1]
    v_pk_fma_f32 v[124:125], v[124:125], v[222:223], v[174:175] op_sel:[0,1,1] op_sel_hi:[1,1,1] neg_lo:[1,0,0] neg_hi:[1,0,0]
    v_pk_fma_f32 v[254:255], v[126:127], v[222:223], v[170:171] op_sel:[0,1,1] op_sel_hi:[1,1,1]
    v_pk_fma_f32 v[126:127], v[126:127], v[222:223], v[174:175] op_sel:[0,1,1] op_sel_hi:[1,1,1] neg_lo:[1,0,0] neg_hi:[1,0,0]
    v_exp_f32 v224, v224
    v_exp_f32 v225, v225
    v_exp_f32 v226, v226
    v_exp_f32 v227, v227
    v_exp_f32 v228, v228
    v_exp_f32 v229, v229
    v_exp_f32 v230, v230
    v_exp_f32 v231, v231
    v_exp_f32 v96, v96
    v_exp_f32 v97, v97
    v_exp_f32 v98, v98
    v_exp_f32 v99, v99
    buffer_load_dwordx4 v11, s[4:7], s63 offen offset:2048 lds
    v_exp_f32 v112, v112
    v_exp_f32 v113, v113
    v_exp_f32 v114, v114
    v_exp_f32 v115, v115
    v_cvt_pk_bf16_f32 v200, v224, v225
    v_cvt_pk_bf16_f32 v201, v226, v227
    v_cvt_pk_bf16_f32 v202, v228, v229
    v_cvt_pk_bf16_f32 v203, v230, v231
    v_cvt_pk_bf16_f32 v144, v96, v97
    v_cvt_pk_bf16_f32 v145, v98, v99
    v_cvt_pk_bf16_f32 v146, v112, v113
    v_cvt_pk_bf16_f32 v147, v114, v115
    v_mfma_f32_16x16x32_bf16 v[168:171], v[40:43], v[200:203], 0
    s_nop 0
    v_mfma_f32_16x16x32_bf16 v[172:175], v[40:43], v[144:147], 0
    v_exp_f32 v232, v232
    v_exp_f32 v233, v233
    buffer_store_dwordx4 a[36:39], v10, s[4:7], s65 offen offset:3072 sc1
    v_exp_f32 v234, v234
    v_exp_f32 v235, v235
    v_exp_f32 v236, v236
    v_exp_f32 v237, v237
    v_exp_f32 v238, v238
    v_exp_f32 v239, v239
    v_exp_f32 v100, v100
    v_exp_f32 v101, v101
    v_exp_f32 v102, v102
    v_exp_f32 v103, v103
    v_exp_f32 v116, v116
    v_exp_f32 v117, v117
    v_exp_f32 v118, v118
    v_exp_f32 v119, v119
    buffer_load_dwordx4 v11, s[4:7], s63 offen offset:3072 lds
    v_rcp_f32 v184, v168
    v_rcp_f32 v185, v172
    s_nop 0
    v_pk_mul_f32 v[224:225], v[224:225], v[184:185] op_sel:[0,0] op_sel_hi:[1,0]
    v_pk_mul_f32 v[226:227], v[226:227], v[184:185] op_sel:[0,0] op_sel_hi:[1,0]
    v_pk_mul_f32 v[228:229], v[228:229], v[184:185] op_sel:[0,0] op_sel_hi:[1,0]
    v_pk_mul_f32 v[230:231], v[230:231], v[184:185] op_sel:[0,0] op_sel_hi:[1,0]
    v_cvt_pk_bf16_f32 v200, v224, v225
    v_cvt_pk_bf16_f32 v201, v226, v227
    v_cvt_pk_bf16_f32 v202, v228, v229
    v_cvt_pk_bf16_f32 v203, v230, v231
    ds_write2st64_b64 v48, v[200:201], v[202:203] offset0:48 offset1:49
    v_pk_mul_f32 v[96:97], v[96:97], v[184:185] op_sel:[0,1] op_sel_hi:[1,1]
    v_pk_mul_f32 v[98:99], v[98:99], v[184:185] op_sel:[0,1] op_sel_hi:[1,1]
    v_pk_mul_f32 v[112:113], v[112:113], v[184:185] op_sel:[0,1] op_sel_hi:[1,1]
    v_pk_mul_f32 v[114:115], v[114:115], v[184:185] op_sel:[0,1] op_sel_hi:[1,1]
    v_cvt_pk_bf16_f32 v144, v96, v97
    v_cvt_pk_bf16_f32 v145, v98, v99
    v_cvt_pk_bf16_f32 v146, v112, v113
    v_cvt_pk_bf16_f32 v147, v114, v115
    ds_write2st64_b64 v48, v[144:145], v[146:147] offset0:80 offset1:81
    v_cvt_pk_bf16_f32 v204, v232, v233
    v_cvt_pk_bf16_f32 v205, v234, v235
    v_cvt_pk_bf16_f32 v206, v236, v237
    v_cvt_pk_bf16_f32 v207, v238, v239
    v_cvt_pk_bf16_f32 v148, v100, v101
    v_cvt_pk_bf16_f32 v149, v102, v103
    buffer_store_dwordx4 a[40:43], v10, s[4:7], s1 offen offset:0 sc1
    v_cvt_pk_bf16_f32 v150, v116, v117
    v_cvt_pk_bf16_f32 v151, v118, v119
    v_mfma_f32_16x16x32_bf16 v[176:179], v[40:43], v[204:207], 0
    s_nop 0
    v_mfma_f32_16x16x32_bf16 v[180:183], v[40:43], v[148:151], 0
    v_exp_f32 v240, v240
    v_exp_f32 v241, v241
    v_exp_f32 v242, v242
    v_exp_f32 v243, v243
    v_exp_f32 v244, v244
    v_exp_f32 v245, v245
    v_exp_f32 v246, v246
    v_exp_f32 v247, v247
    v_exp_f32 v104, v104
    s_add_u32 m0, s57, 126976
    s_mov_b32 s63, 21082112
    buffer_load_dwordx4 v11, s[4:7], s63 offen offset:0 lds
    v_exp_f32 v105, v105
    v_exp_f32 v106, v106
    v_exp_f32 v107, v107
    v_exp_f32 v120, v120
    v_exp_f32 v121, v121
    v_exp_f32 v122, v122
    v_exp_f32 v123, v123
    v_rcp_f32 v186, v176
    v_rcp_f32 v187, v180
    s_nop 0
    v_pk_mul_f32 v[232:233], v[232:233], v[186:187] op_sel:[0,0] op_sel_hi:[1,0]
    v_pk_mul_f32 v[234:235], v[234:235], v[186:187] op_sel:[0,0] op_sel_hi:[1,0]
    v_pk_mul_f32 v[236:237], v[236:237], v[186:187] op_sel:[0,0] op_sel_hi:[1,0]
    v_pk_mul_f32 v[238:239], v[238:239], v[186:187] op_sel:[0,0] op_sel_hi:[1,0]
    v_cvt_pk_bf16_f32 v204, v232, v233
    v_cvt_pk_bf16_f32 v205, v234, v235
    v_cvt_pk_bf16_f32 v206, v236, v237
    v_cvt_pk_bf16_f32 v207, v238, v239
    ds_write2st64_b64 v48, v[204:205], v[206:207] offset0:50 offset1:51
    v_pk_mul_f32 v[100:101], v[100:101], v[186:187] op_sel:[0,1] op_sel_hi:[1,1]
    buffer_store_dwordx4 a[44:47], v10, s[4:7], s1 offen offset:1024 sc1
    v_pk_mul_f32 v[102:103], v[102:103], v[186:187] op_sel:[0,1] op_sel_hi:[1,1]
    v_pk_mul_f32 v[116:117], v[116:117], v[186:187] op_sel:[0,1] op_sel_hi:[1,1]
    v_pk_mul_f32 v[118:119], v[118:119], v[186:187] op_sel:[0,1] op_sel_hi:[1,1]
    v_cvt_pk_bf16_f32 v148, v100, v101
    v_cvt_pk_bf16_f32 v149, v102, v103
    v_cvt_pk_bf16_f32 v150, v116, v117
    v_cvt_pk_bf16_f32 v151, v118, v119
    ds_write2st64_b64 v48, v[148:149], v[150:151] offset0:82 offset1:83
    v_cvt_pk_bf16_f32 v208, v240, v241
    v_cvt_pk_bf16_f32 v209, v242, v243
    v_cvt_pk_bf16_f32 v210, v244, v245
    v_cvt_pk_bf16_f32 v211, v246, v247
    v_cvt_pk_bf16_f32 v152, v104, v105
    v_cvt_pk_bf16_f32 v153, v106, v107
    v_cvt_pk_bf16_f32 v154, v120, v121
    v_cvt_pk_bf16_f32 v155, v122, v123
    v_mfma_f32_16x16x32_bf16 v[168:171], v[40:43], v[208:211], 0
    s_nop 0
    v_mfma_f32_16x16x32_bf16 v[172:175], v[40:43], v[152:155], 0
    v_exp_f32 v248, v248
    v_exp_f32 v249, v249
    buffer_load_dwordx4 v11, s[4:7], s63 offen offset:1024 lds
    v_exp_f32 v250, v250
    v_exp_f32 v251, v251
    v_exp_f32 v252, v252
    v_exp_f32 v253, v253
    v_exp_f32 v254, v254
    v_exp_f32 v255, v255
    v_exp_f32 v108, v108
    v_exp_f32 v109, v109
    v_exp_f32 v110, v110
    v_exp_f32 v111, v111
    v_exp_f32 v124, v124
    v_exp_f32 v125, v125
    v_exp_f32 v126, v126
    v_exp_f32 v127, v127
    s_add_u32 m0, s57, 0
    s_mov_b32 s63, 20971520
    buffer_load_dwordx4 v11, s[4:7], s63 offen offset:0 lds
    v_cvt_pk_bf16_f32 v212, v248, v249
    v_cvt_pk_bf16_f32 v213, v250, v251
    v_cvt_pk_bf16_f32 v214, v252, v253
    v_cvt_pk_bf16_f32 v215, v254, v255
    v_cvt_pk_bf16_f32 v156, v108, v109
    v_cvt_pk_bf16_f32 v157, v110, v111
    v_cvt_pk_bf16_f32 v158, v124, v125
    v_cvt_pk_bf16_f32 v159, v126, v127
    v_mfma_f32_16x16x32_bf16 v[176:179], v[40:43], v[212:215], 0
    s_nop 0
    v_mfma_f32_16x16x32_bf16 v[180:183], v[40:43], v[156:159], 0
    v_rcp_f32 v188, v168
    v_rcp_f32 v189, v172
    s_nop 0
    v_pk_mul_f32 v[240:241], v[240:241], v[188:189] op_sel:[0,0] op_sel_hi:[1,0]
    v_pk_mul_f32 v[242:243], v[242:243], v[188:189] op_sel:[0,0] op_sel_hi:[1,0]
    v_pk_mul_f32 v[244:245], v[244:245], v[188:189] op_sel:[0,0] op_sel_hi:[1,0]
    v_pk_mul_f32 v[246:247], v[246:247], v[188:189] op_sel:[0,0] op_sel_hi:[1,0]
    v_cvt_pk_bf16_f32 v208, v240, v241
    v_cvt_pk_bf16_f32 v209, v242, v243
    v_cvt_pk_bf16_f32 v210, v244, v245
    v_cvt_pk_bf16_f32 v211, v246, v247
    ds_write2st64_b64 v48, v[208:209], v[210:211] offset0:52 offset1:53
    buffer_load_dwordx4 v11, s[4:7], s63 offen offset:1024 lds
    v_pk_mul_f32 v[104:105], v[104:105], v[188:189] op_sel:[0,1] op_sel_hi:[1,1]
    v_pk_mul_f32 v[106:107], v[106:107], v[188:189] op_sel:[0,1] op_sel_hi:[1,1]
    v_pk_mul_f32 v[120:121], v[120:121], v[188:189] op_sel:[0,1] op_sel_hi:[1,1]
    v_pk_mul_f32 v[122:123], v[122:123], v[188:189] op_sel:[0,1] op_sel_hi:[1,1]
    v_cvt_pk_bf16_f32 v152, v104, v105
    v_cvt_pk_bf16_f32 v153, v106, v107
    v_cvt_pk_bf16_f32 v154, v120, v121
    v_cvt_pk_bf16_f32 v155, v122, v123
    ds_write2st64_b64 v48, v[152:153], v[154:155] offset0:84 offset1:85
    v_rcp_f32 v190, v176
    v_rcp_f32 v191, v180
    s_nop 0
    v_pk_mul_f32 v[248:249], v[248:249], v[190:191] op_sel:[0,0] op_sel_hi:[1,0]
    v_pk_mul_f32 v[250:251], v[250:251], v[190:191] op_sel:[0,0] op_sel_hi:[1,0]
    v_pk_mul_f32 v[252:253], v[252:253], v[190:191] op_sel:[0,0] op_sel_hi:[1,0]
    v_pk_mul_f32 v[254:255], v[254:255], v[190:191] op_sel:[0,0] op_sel_hi:[1,0]
    v_cvt_pk_bf16_f32 v212, v248, v249
    v_cvt_pk_bf16_f32 v213, v250, v251
    v_cvt_pk_bf16_f32 v214, v252, v253
    v_cvt_pk_bf16_f32 v215, v254, v255
    ds_write2st64_b64 v48, v[212:213], v[214:215] offset0:54 offset1:55
    v_pk_mul_f32 v[108:109], v[108:109], v[190:191] op_sel:[0,1] op_sel_hi:[1,1]
    v_pk_mul_f32 v[110:111], v[110:111], v[190:191] op_sel:[0,1] op_sel_hi:[1,1]
    v_pk_mul_f32 v[124:125], v[124:125], v[190:191] op_sel:[0,1] op_sel_hi:[1,1]
    v_pk_mul_f32 v[126:127], v[126:127], v[190:191] op_sel:[0,1] op_sel_hi:[1,1]
    v_cvt_pk_bf16_f32 v156, v108, v109
    v_cvt_pk_bf16_f32 v157, v110, v111
    buffer_load_dwordx4 v11, s[4:7], s63 offen offset:2048 lds
    v_cvt_pk_bf16_f32 v158, v124, v125
    v_cvt_pk_bf16_f32 v159, v126, v127
    ds_write2st64_b64 v48, v[156:157], v[158:159] offset0:86 offset1:87
    buffer_load_dwordx4 v11, s[4:7], s63 offen offset:3072 lds
    s_add_u32 m0, s57, 4096
    s_mov_b32 s63, 20975616
    buffer_load_dwordx4 v11, s[4:7], s63 offen offset:0 lds
    buffer_load_dwordx4 v11, s[4:7], s63 offen offset:1024 lds
    s_add_u32 s21, s58, s86
    s_waitcnt lgkmcnt(0)
    s_barrier
    ds_read_b64_tr_b16 v[96:97], v49 offset:24576
    ds_read_b64_tr_b16 v[104:105], v33 offset:0
    ds_read_b64_tr_b16 v[98:99], v49 offset:25600
    ds_read_b64_tr_b16 v[106:107], v33 offset:1024
    ds_read_b64_tr_b16 v[100:101], v32 offset:24576
    ds_read_b64_tr_b16 v[102:103], v32 offset:25600
    ds_read_b64_tr_b16 v[112:113], v49 offset:26624
    ds_read_b64_tr_b16 v[120:121], v33 offset:2048
    ds_read_b64_tr_b16 v[114:115], v49 offset:27648
    ds_read_b64_tr_b16 v[122:123], v33 offset:3072
    ds_read_b64_tr_b16 v[116:117], v32 offset:26624
    ds_read_b64_tr_b16 v[118:119], v32 offset:27648
    ds_read_b64_tr_b16 v[128:129], v49 offset:28672
    ds_read_b64_tr_b16 v[136:137], v33 offset:4096
    v_mfma_f32_16x16x32_bf16 v[64:67], v[192:195], a[80:83], v[64:67]
    v_mfma_f32_16x16x32_bf16 v[68:71], v[192:195], a[84:87], v[68:71]
    v_mfma_f32_16x16x32_bf16 v[72:75], v[192:195], a[88:91], v[72:75]
    v_mfma_f32_16x16x32_bf16 v[76:79], v[192:195], a[92:95], v[76:79]
    s_waitcnt lgkmcnt(10)
    v_mfma_f32_16x16x32_bf16 v[168:171], v[96:99], v[104:107], 0
    ds_read_b64_tr_b16 v[130:131], v49 offset:29696
    ds_read_b64_tr_b16 v[138:139], v33 offset:5120
    v_mfma_f32_16x16x32_bf16 v[200:203], v[96:99], v[40:43], 0
    ds_read_b64_tr_b16 v[132:133], v32 offset:28672
    ds_read_b64_tr_b16 v[134:135], v32 offset:29696
    s_waitcnt lgkmcnt(12)
    v_mfma_f32_16x16x32_bf16 v[172:175], v[100:103], v[104:107], 0
    ds_read_b64_tr_b16 v[144:145], v49 offset:30720
    ds_read_b64_tr_b16 v[152:153], v33 offset:6144
    s_waitcnt lgkmcnt(10)
    v_mfma_f32_16x16x32_bf16 v[168:171], v[112:115], v[120:123], v[168:171]
    ds_read_b64_tr_b16 v[146:147], v49 offset:31744
    ds_read_b64_tr_b16 v[154:155], v33 offset:7168
    v_mfma_f32_16x16x32_bf16 v[200:203], v[112:115], v[40:43], v[200:203]
    ds_read_b64_tr_b16 v[148:149], v32 offset:30720
    ds_read_b64_tr_b16 v[150:151], v32 offset:31744
    s_waitcnt lgkmcnt(12)
    v_mfma_f32_16x16x32_bf16 v[172:175], v[116:119], v[120:123], v[172:175]
    ds_read_b64_tr_b16 v[96:97], v49 offset:32768
    ds_read_b64_tr_b16 v[104:105], v33 offset:8192
    s_waitcnt lgkmcnt(10)
    v_mfma_f32_16x16x32_bf16 v[168:171], v[128:131], v[136:139], v[168:171]
    ds_read_b64_tr_b16 v[98:99], v49 offset:33792
    ds_read_b64_tr_b16 v[106:107], v33 offset:9216
    v_mfma_f32_16x16x32_bf16 v[200:203], v[128:131], v[40:43], v[200:203]
    ds_read_b64_tr_b16 v[100:101], v32 offset:32768
    ds_read_b64_tr_b16 v[102:103], v32 offset:33792
    s_waitcnt lgkmcnt(12)
    v_mfma_f32_16x16x32_bf16 v[172:175], v[132:135], v[136:139], v[172:175]
    ds_read_b64_tr_b16 v[112:113], v49 offset:34816
    ds_read_b64_tr_b16 v[120:121], v33 offset:10240
    s_waitcnt lgkmcnt(10)
    v_mfma_f32_16x16x32_bf16 v[168:171], v[144:147], v[152:155], v[168:171]
    ds_read_b64_tr_b16 v[114:115], v49 offset:35840
    ds_read_b64_tr_b16 v[122:123], v33 offset:11264
    v_mfma_f32_16x16x32_bf16 v[200:203], v[144:147], v[40:43], v[200:203]
    ds_read_b64_tr_b16 v[116:117], v32 offset:34816
    ds_read_b64_tr_b16 v[118:119], v32 offset:35840
    s_waitcnt lgkmcnt(12)
    v_mfma_f32_16x16x32_bf16 v[172:175], v[148:151], v[152:155], v[172:175]
    ds_read_b64_tr_b16 v[128:129], v49 offset:36864
    ds_read_b64_tr_b16 v[136:137], v33 offset:12288
    s_waitcnt lgkmcnt(10)
    v_mfma_f32_16x16x32_bf16 v[168:171], v[96:99], v[104:107], v[168:171]
    ds_read_b64_tr_b16 v[130:131], v49 offset:37888
    ds_read_b64_tr_b16 v[138:139], v33 offset:13312
    v_mfma_f32_16x16x32_bf16 v[200:203], v[96:99], v[40:43], v[200:203]
    ds_read_b64_tr_b16 v[132:133], v32 offset:36864
    ds_read_b64_tr_b16 v[134:135], v32 offset:37888
    s_waitcnt lgkmcnt(12)
    v_mfma_f32_16x16x32_bf16 v[172:175], v[100:103], v[104:107], v[172:175]
    ds_read_b64_tr_b16 v[144:145], v49 offset:38912
    ds_read_b64_tr_b16 v[152:153], v33 offset:14336
    s_waitcnt lgkmcnt(10)
    v_mfma_f32_16x16x32_bf16 v[168:171], v[112:115], v[120:123], v[168:171]
    ds_read_b64_tr_b16 v[146:147], v49 offset:39936
    ds_read_b64_tr_b16 v[154:155], v33 offset:15360
    v_mfma_f32_16x16x32_bf16 v[200:203], v[112:115], v[40:43], v[200:203]
    ds_read_b64_tr_b16 v[148:149], v32 offset:38912
    ds_read_b64_tr_b16 v[150:151], v32 offset:39936
    s_waitcnt lgkmcnt(12)
    v_mfma_f32_16x16x32_bf16 v[172:175], v[116:119], v[120:123], v[172:175]
    s_waitcnt lgkmcnt(8)
    v_mfma_f32_16x16x32_bf16 v[168:171], v[128:131], v[136:139], v[168:171]
    v_mfma_f32_16x16x32_bf16 v[200:203], v[128:131], v[40:43], v[200:203]
    s_waitcnt lgkmcnt(6)
    v_mfma_f32_16x16x32_bf16 v[172:175], v[132:135], v[136:139], v[172:175]
    s_waitcnt lgkmcnt(2)
    v_mfma_f32_16x16x32_bf16 v[168:171], v[144:147], v[152:155], v[168:171]
    v_mfma_f32_16x16x32_bf16 v[200:203], v[144:147], v[40:43], v[200:203]
    s_waitcnt lgkmcnt(0)
    v_mfma_f32_16x16x32_bf16 v[172:175], v[148:151], v[152:155], v[172:175]
    v_mfma_f32_16x16x32_bf16 v[92:95], v[196:199], a[92:95], v[92:95]
    v_mfma_f32_16x16x32_bf16 v[88:91], v[196:199], a[88:91], v[88:91]
    s_barrier
    v_mfma_f32_16x16x32_bf16 v[84:87], v[196:199], a[84:87], v[84:87]
    v_mfma_f32_16x16x32_bf16 v[80:83], v[196:199], a[80:83], v[80:83]
    v_cvt_pk_bf16_f32 v192, v168, v169
    v_cvt_pk_bf16_f32 v193, v170, v171
    v_mfma_f32_16x16x32_bf16 v[64:67], a[216:219], a[96:99], v[64:67]
    v_cvt_pk_bf16_f32 v194, v172, v173
    v_cvt_pk_bf16_f32 v195, v174, v175
    v_mfma_f32_16x16x32_bf16 v[68:71], a[216:219], a[100:103], v[68:71]
    buffer_store_dwordx4 v[192:195], v1, s[4:7], s21 offen sc1
    v_mfma_f32_16x16x32_bf16 v[72:75], a[216:219], a[104:107], v[72:75]
    s_mov_b64 exec, s[42:43]
    buffer_store_dwordx4 v[200:203], v60, s[4:7], s54 offen sc1
    s_mov_b64 exec, -1
    v_mfma_f32_16x16x32_bf16 v[76:79], a[216:219], a[108:111], v[76:79]
    v_mfma_f32_16x16x32_bf16 v[92:95], a[220:223], a[108:111], v[92:95]
    v_mfma_f32_16x16x32_bf16 v[88:91], a[220:223], a[104:107], v[88:91]
    v_mfma_f32_16x16x32_bf16 v[84:87], a[220:223], a[100:103], v[84:87]
    v_mfma_f32_16x16x32_bf16 v[80:83], a[220:223], a[96:99], v[80:83]
    v_mfma_f32_16x16x32_bf16 v[64:67], a[224:227], a[112:115], v[64:67]
    s_add_u32 m0, s57, 24576
    s_mov_b32 s63, 20996096
    buffer_load_dwordx4 v11, s[4:7], s63 offen offset:0 lds
    v_mfma_f32_16x16x32_bf16 v[68:71], a[224:227], a[116:119], v[68:71]
    v_mfma_f32_16x16x32_bf16 v[72:75], a[224:227], a[120:123], v[72:75]
    v_mfma_f32_16x16x32_bf16 v[76:79], a[224:227], a[124:127], v[76:79]
    v_mfma_f32_16x16x32_bf16 v[92:95], a[228:231], a[124:127], v[92:95]
    v_mfma_f32_16x16x32_bf16 v[88:91], a[228:231], a[120:123], v[88:91]
    v_mfma_f32_16x16x32_bf16 v[84:87], a[228:231], a[116:119], v[84:87]
    buffer_load_dwordx4 v11, s[4:7], s63 offen offset:1024 lds
    v_mfma_f32_16x16x32_bf16 v[80:83], a[228:231], a[112:115], v[80:83]
    v_mfma_f32_16x16x32_bf16 v[64:67], a[232:235], a[128:131], v[64:67]
    v_mfma_f32_16x16x32_bf16 v[68:71], a[232:235], a[132:135], v[68:71]
    v_mfma_f32_16x16x32_bf16 v[72:75], a[232:235], a[136:139], v[72:75]
    v_mfma_f32_16x16x32_bf16 v[76:79], a[232:235], a[140:143], v[76:79]
    v_mfma_f32_16x16x32_bf16 v[92:95], a[236:239], a[140:143], v[92:95]
    buffer_load_dwordx4 v11, s[4:7], s63 offen offset:2048 lds
    v_mfma_f32_16x16x32_bf16 v[88:91], a[236:239], a[136:139], v[88:91]
    v_mfma_f32_16x16x32_bf16 v[84:87], a[236:239], a[132:135], v[84:87]
    v_mfma_f32_16x16x32_bf16 v[80:83], a[236:239], a[128:131], v[80:83]
    v_mfma_f32_16x16x32_bf16 v[64:67], a[168:171], a[48:51], v[64:67]
    v_mfma_f32_16x16x32_bf16 v[68:71], a[168:171], a[52:55], v[68:71]
    v_mfma_f32_16x16x32_bf16 v[72:75], a[168:171], a[56:59], v[72:75]
    buffer_load_dwordx4 v11, s[4:7], s63 offen offset:3072 lds
    v_mfma_f32_16x16x32_bf16 v[76:79], a[168:171], a[60:63], v[76:79]
    v_mfma_f32_16x16x32_bf16 v[92:95], a[172:175], a[60:63], v[92:95]
    v_mfma_f32_16x16x32_bf16 v[88:91], a[172:175], a[56:59], v[88:91]
    v_mfma_f32_16x16x32_bf16 v[84:87], a[172:175], a[52:55], v[84:87]
    v_mfma_f32_16x16x32_bf16 v[80:83], a[172:175], a[48:51], v[80:83]
    v_mfma_f32_16x16x32_bf16 v[64:67], a[176:179], a[64:67], v[64:67]
    s_add_u32 m0, s57, 28672
    s_mov_b32 s63, 21000192
    buffer_load_dwordx4 v11, s[4:7], s63 offen offset:0 lds
    v_mfma_f32_16x16x32_bf16 v[68:71], a[176:179], a[68:71], v[68:71]
    v_mfma_f32_16x16x32_bf16 v[72:75], a[176:179], a[72:75], v[72:75]
    v_mfma_f32_16x16x32_bf16 v[76:79], a[176:179], a[76:79], v[76:79]
    v_mfma_f32_16x16x32_bf16 v[92:95], a[180:183], a[76:79], v[92:95]
    v_mfma_f32_16x16x32_bf16 v[88:91], a[180:183], a[72:75], v[88:91]
    v_mfma_f32_16x16x32_bf16 v[84:87], a[180:183], a[68:71], v[84:87]
    buffer_load_dwordx4 v11, s[4:7], s63 offen offset:1024 lds
    v_mfma_f32_16x16x32_bf16 v[80:83], a[180:183], a[64:67], v[80:83]
    s_nop 2
    v_max3_f32 v199, v76, v77, v78
    v_max3_f32 v199, v199, v79, v92
    v_max3_f32 v199, v199, v93, v94
    v_max_f32 v199, v199, v95
    v_min3_f32 v203, v76, v77, v78
    v_min3_f32 v203, v203, v79, v92
    v_min3_f32 v203, v203, v93, v94
    v_min_f32 v203, v203, v95
    v_max3_f32 v198, v72, v73, v74
    v_max3_f32 v198, v198, v75, v88
    v_max3_f32 v198, v198, v89, v90
    v_max_f32 v198, v198, v91
    v_min3_f32 v202, v72, v73, v74
    v_min3_f32 v202, v202, v75, v88
    v_min3_f32 v202, v202, v89, v90
    v_min_f32 v202, v202, v91
    v_max3_f32 v197, v68, v69, v70
    v_max3_f32 v197, v197, v71, v84
    v_max3_f32 v197, v197, v85, v86
    s_add_u32 m0, s2, 49152
    s_sub_u32 s63, 21020672, s0
    buffer_load_dwordx4 v11, s[4:7], s63 offen offset:0 lds
    v_max_f32 v197, v197, v87
    v_min3_f32 v201, v68, v69, v70
    v_min3_f32 v201, v201, v71, v84
    v_min3_f32 v201, v201, v85, v86
    v_min_f32 v201, v201, v87
    v_max3_f32 v196, v64, v65, v66
    v_max3_f32 v196, v196, v67, v80
    v_max3_f32 v196, v196, v81, v82
    v_max_f32 v196, v196, v83
    v_min3_f32 v200, v64, v65, v66
    v_min3_f32 v200, v200, v67, v80
    v_min3_f32 v200, v200, v81, v82
    v_min_f32 v200, v200, v83
    v_permlane32_swap_b32 v196, v197
    v_permlane32_swap_b32 v198, v199
    v_permlane32_swap_b32 v200, v201
    v_permlane32_swap_b32 v202, v203
    v_max_f32 v196, v196, v197
    v_max_f32 v198, v198, v199
    buffer_load_dwordx4 v11, s[4:7], s63 offen offset:1024 lds
    v_min_f32 v200, v200, v201
    v_min_f32 v202, v202, v203
    v_permlane16_swap_b32 v196, v198
    s_nop 0
    v_permlane16_swap_b32 v200, v202
    v_max_f32 v197, v196, v198
    v_max_f32 v198, v196, v198
    v_min_f32 v201, v200, v202
    v_min_f32 v202, v200, v202
    v_permlane16_swap_b32 v197, v198
    s_nop 0
    v_permlane16_swap_b32 v201, v202
    v_mov_b32 v196, v197
    v_mov_b32 v199, v198
    v_mov_b32 v200, v201
    v_mov_b32 v203, v202
    v_permlane32_swap_b32 v196, v197
    v_permlane32_swap_b32 v198, v199
    v_permlane32_swap_b32 v200, v201
    v_permlane32_swap_b32 v202, v203
    v_mul_f32 v196, -v196, v220
    v_mul_f32 v200, v200, v220
    v_mul_f32 v197, -v197, v221
    v_mul_f32 v201, v201, v221
    v_mul_f32 v198, -v198, v222
    v_mul_f32 v202, v202, v222
    v_mul_f32 v199, -v199, v223
    v_mul_f32 v203, v203, v223
    v_pk_fma_f32 v[224:225], v[64:65], v[220:221], v[196:197] op_sel:[0,0,0] op_sel_hi:[1,0,0]
    v_pk_fma_f32 v[64:65], v[64:65], v[220:221], v[200:201] op_sel:[0,0,0] op_sel_hi:[1,0,0] neg_lo:[1,0,0] neg_hi:[1,0,0]
    v_pk_fma_f32 v[226:227], v[66:67], v[220:221], v[196:197] op_sel:[0,0,0] op_sel_hi:[1,0,0]
    v_pk_fma_f32 v[66:67], v[66:67], v[220:221], v[200:201] op_sel:[0,0,0] op_sel_hi:[1,0,0] neg_lo:[1,0,0] neg_hi:[1,0,0]
    v_pk_fma_f32 v[228:229], v[80:81], v[220:221], v[196:197] op_sel:[0,0,0] op_sel_hi:[1,0,0]
    v_pk_fma_f32 v[80:81], v[80:81], v[220:221], v[200:201] op_sel:[0,0,0] op_sel_hi:[1,0,0] neg_lo:[1,0,0] neg_hi:[1,0,0]
    v_pk_fma_f32 v[230:231], v[82:83], v[220:221], v[196:197] op_sel:[0,0,0] op_sel_hi:[1,0,0]
    v_pk_fma_f32 v[82:83], v[82:83], v[220:221], v[200:201] op_sel:[0,0,0] op_sel_hi:[1,0,0] neg_lo:[1,0,0] neg_hi:[1,0,0]
    v_pk_fma_f32 v[232:233], v[68:69], v[220:221], v[196:197] op_sel:[0,1,1] op_sel_hi:[1,1,1]
    v_pk_fma_f32 v[68:69], v[68:69], v[220:221], v[200:201] op_sel:[0,1,1] op_sel_hi:[1,1,1] neg_lo:[1,0,0] neg_hi:[1,0,0]
    v_pk_fma_f32 v[234:235], v[70:71], v[220:221], v[196:197] op_sel:[0,1,1] op_sel_hi:[1,1,1]
    v_pk_fma_f32 v[70:71], v[70:71], v[220:221], v[200:201] op_sel:[0,1,1] op_sel_hi:[1,1,1] neg_lo:[1,0,0] neg_hi:[1,0,0]
    v_pk_fma_f32 v[236:237], v[84:85], v[220:221], v[196:197] op_sel:[0,1,1] op_sel_hi:[1,1,1]
    v_pk_fma_f32 v[84:85], v[84:85], v[220:221], v[200:201] op_sel:[0,1,1] op_sel_hi:[1,1,1] neg_lo:[1,0,0] neg_hi:[1,0,0]
    v_pk_fma_f32 v[238:239], v[86:87], v[220:221], v[196:197] op_sel:[0,1,1] op_sel_hi:[1,1,1]
    v_pk_fma_f32 v[86:87], v[86:87], v[220:221], v[200:201] op_sel:[0,1,1] op_sel_hi:[1,1,1] neg_lo:[1,0,0] neg_hi:[1,0,0]
    v_pk_fma_f32 v[240:241], v[72:73], v[222:223], v[198:199] op_sel:[0,0,0] op_sel_hi:[1,0,0]
    v_pk_fma_f32 v[72:73], v[72:73], v[222:223], v[202:203] op_sel:[0,0,0] op_sel_hi:[1,0,0] neg_lo:[1,0,0] neg_hi:[1,0,0]
    v_pk_fma_f32 v[242:243], v[74:75], v[222:223], v[198:199] op_sel:[0,0,0] op_sel_hi:[1,0,0]
    v_pk_fma_f32 v[74:75], v[74:75], v[222:223], v[202:203] op_sel:[0,0,0] op_sel_hi:[1,0,0] neg_lo:[1,0,0] neg_hi:[1,0,0]
    v_pk_fma_f32 v[244:245], v[88:89], v[222:223], v[198:199] op_sel:[0,0,0] op_sel_hi:[1,0,0]
    v_pk_fma_f32 v[88:89], v[88:89], v[222:223], v[202:203] op_sel:[0,0,0] op_sel_hi:[1,0,0] neg_lo:[1,0,0] neg_hi:[1,0,0]
    v_pk_fma_f32 v[246:247], v[90:91], v[222:223], v[198:199] op_sel:[0,0,0] op_sel_hi:[1,0,0]
    v_pk_fma_f32 v[90:91], v[90:91], v[222:223], v[202:203] op_sel:[0,0,0] op_sel_hi:[1,0,0] neg_lo:[1,0,0] neg_hi:[1,0,0]
    v_pk_fma_f32 v[248:249], v[76:77], v[222:223], v[198:199] op_sel:[0,1,1] op_sel_hi:[1,1,1]
    v_pk_fma_f32 v[76:77], v[76:77], v[222:223], v[202:203] op_sel:[0,1,1] op_sel_hi:[1,1,1] neg_lo:[1,0,0] neg_hi:[1,0,0]
    v_pk_fma_f32 v[250:251], v[78:79], v[222:223], v[198:199] op_sel:[0,1,1] op_sel_hi:[1,1,1]
    v_pk_fma_f32 v[78:79], v[78:79], v[222:223], v[202:203] op_sel:[0,1,1] op_sel_hi:[1,1,1] neg_lo:[1,0,0] neg_hi:[1,0,0]
    v_pk_fma_f32 v[252:253], v[92:93], v[222:223], v[198:199] op_sel:[0,1,1] op_sel_hi:[1,1,1]
    v_pk_fma_f32 v[92:93], v[92:93], v[222:223], v[202:203] op_sel:[0,1,1] op_sel_hi:[1,1,1] neg_lo:[1,0,0] neg_hi:[1,0,0]
    v_pk_fma_f32 v[254:255], v[94:95], v[222:223], v[198:199] op_sel:[0,1,1] op_sel_hi:[1,1,1]
    v_pk_fma_f32 v[94:95], v[94:95], v[222:223], v[202:203] op_sel:[0,1,1] op_sel_hi:[1,1,1] neg_lo:[1,0,0] neg_hi:[1,0,0]
    v_exp_f32 v224, v224
    v_exp_f32 v225, v225
    v_exp_f32 v226, v226
    v_exp_f32 v227, v227
    v_exp_f32 v228, v228
    v_exp_f32 v229, v229
    v_exp_f32 v230, v230
    v_exp_f32 v231, v231
    v_exp_f32 v64, v64
    v_exp_f32 v65, v65
    v_exp_f32 v66, v66
    v_exp_f32 v67, v67
    v_exp_f32 v80, v80
    v_exp_f32 v81, v81
    v_exp_f32 v82, v82
    v_exp_f32 v83, v83
    v_cvt_pk_bf16_f32 v204, v224, v225
    v_cvt_pk_bf16_f32 v205, v226, v227
    v_cvt_pk_bf16_f32 v206, v228, v229
    v_cvt_pk_bf16_f32 v207, v230, v231
    v_cvt_pk_bf16_f32 v136, v64, v65
    v_cvt_pk_bf16_f32 v137, v66, v67
    v_cvt_pk_bf16_f32 v138, v80, v81
    v_cvt_pk_bf16_f32 v139, v82, v83
    v_mfma_f32_16x16x32_bf16 v[152:155], v[40:43], v[204:207], 0
    s_nop 0
    v_mfma_f32_16x16x32_bf16 v[156:159], v[40:43], v[136:139], 0
    v_exp_f32 v232, v232
    v_exp_f32 v233, v233
    v_exp_f32 v234, v234
    v_exp_f32 v235, v235
    v_exp_f32 v236, v236
    v_exp_f32 v237, v237
    v_exp_f32 v238, v238
    v_exp_f32 v239, v239
    v_exp_f32 v68, v68
    v_exp_f32 v69, v69
    v_exp_f32 v70, v70
    v_exp_f32 v71, v71
    v_exp_f32 v84, v84
    v_exp_f32 v85, v85
    v_exp_f32 v86, v86
    v_exp_f32 v87, v87
    v_rcp_f32 v184, v152
    v_rcp_f32 v185, v156
    s_nop 0
    v_pk_mul_f32 v[224:225], v[224:225], v[184:185] op_sel:[0,0] op_sel_hi:[1,0]
    v_pk_mul_f32 v[226:227], v[226:227], v[184:185] op_sel:[0,0] op_sel_hi:[1,0]
    v_pk_mul_f32 v[228:229], v[228:229], v[184:185] op_sel:[0,0] op_sel_hi:[1,0]
    v_pk_mul_f32 v[230:231], v[230:231], v[184:185] op_sel:[0,0] op_sel_hi:[1,0]
    v_cvt_pk_bf16_f32 v204, v224, v225
    v_cvt_pk_bf16_f32 v205, v226, v227
    v_cvt_pk_bf16_f32 v206, v228, v229
    v_cvt_pk_bf16_f32 v207, v230, v231
    v_pk_mul_f32 v[64:65], v[64:65], v[184:185] op_sel:[0,1] op_sel_hi:[1,1]
    v_pk_mul_f32 v[66:67], v[66:67], v[184:185] op_sel:[0,1] op_sel_hi:[1,1]
    v_pk_mul_f32 v[80:81], v[80:81], v[184:185] op_sel:[0,1] op_sel_hi:[1,1]
    v_pk_mul_f32 v[82:83], v[82:83], v[184:185] op_sel:[0,1] op_sel_hi:[1,1]
    v_cvt_pk_bf16_f32 v136, v64, v65
    v_cvt_pk_bf16_f32 v137, v66, v67
    v_cvt_pk_bf16_f32 v138, v80, v81
    v_cvt_pk_bf16_f32 v139, v82, v83
    v_cvt_pk_bf16_f32 v208, v232, v233
    v_cvt_pk_bf16_f32 v209, v234, v235
    v_cvt_pk_bf16_f32 v210, v236, v237
    v_cvt_pk_bf16_f32 v211, v238, v239
    v_cvt_pk_bf16_f32 v140, v68, v69
    v_cvt_pk_bf16_f32 v141, v70, v71
    v_cvt_pk_bf16_f32 v142, v84, v85
    v_cvt_pk_bf16_f32 v143, v86, v87
    v_mfma_f32_16x16x32_bf16 v[176:179], v[40:43], v[208:211], 0
    s_nop 0
    v_mfma_f32_16x16x32_bf16 v[180:183], v[40:43], v[140:143], 0
    s_add_u32 s19, s58, s87
    buffer_load_dwordx4 v[96:99], v1, s[4:7], s19 offen sc1
    s_add_u32 s19, s58, s88
    buffer_load_dwordx4 v[100:103], v1, s[4:7], s19 offen sc1
    s_add_u32 s19, s58, s89
    buffer_load_dwordx4 v[104:107], v1, s[4:7], s19 offen sc1
    s_add_u32 s19, s58, s90
    buffer_load_dwordx4 v[108:111], v1, s[4:7], s19 offen sc1
    s_add_u32 s19, s58, s91
    buffer_load_dwordx4 v[112:115], v1, s[4:7], s19 offen sc1
    s_add_u32 s19, s58, s92
    buffer_load_dwordx4 v[116:119], v1, s[4:7], s19 offen sc1
    s_add_u32 s19, s58, s93
    buffer_load_dwordx4 v[120:123], v1, s[4:7], s19 offen sc1
    buffer_load_dwordx4 v[192:195], v62, s[4:7], s59 offen sc1
    v_exp_f32 v240, v240
    v_exp_f32 v241, v241
    v_exp_f32 v242, v242
    v_exp_f32 v243, v243
    v_exp_f32 v244, v244
    v_exp_f32 v245, v245
    v_exp_f32 v246, v246
    v_exp_f32 v247, v247
    v_exp_f32 v72, v72
    v_exp_f32 v73, v73
    v_exp_f32 v74, v74
    v_exp_f32 v75, v75
    v_exp_f32 v88, v88
    v_exp_f32 v89, v89
    v_exp_f32 v90, v90
    v_exp_f32 v91, v91
    v_rcp_f32 v186, v176
    v_rcp_f32 v187, v180
    s_nop 0
    v_pk_mul_f32 v[232:233], v[232:233], v[186:187] op_sel:[0,0] op_sel_hi:[1,0]
    v_pk_mul_f32 v[234:235], v[234:235], v[186:187] op_sel:[0,0] op_sel_hi:[1,0]
    v_pk_mul_f32 v[236:237], v[236:237], v[186:187] op_sel:[0,0] op_sel_hi:[1,0]
    v_pk_mul_f32 v[238:239], v[238:239], v[186:187] op_sel:[0,0] op_sel_hi:[1,0]
    v_cvt_pk_bf16_f32 v208, v232, v233
    v_cvt_pk_bf16_f32 v209, v234, v235
    v_cvt_pk_bf16_f32 v210, v236, v237
    v_cvt_pk_bf16_f32 v211, v238, v239
    v_pk_mul_f32 v[68:69], v[68:69], v[186:187] op_sel:[0,1] op_sel_hi:[1,1]
    v_pk_mul_f32 v[70:71], v[70:71], v[186:187] op_sel:[0,1] op_sel_hi:[1,1]
    v_pk_mul_f32 v[84:85], v[84:85], v[186:187] op_sel:[0,1] op_sel_hi:[1,1]
    v_pk_mul_f32 v[86:87], v[86:87], v[186:187] op_sel:[0,1] op_sel_hi:[1,1]
    v_cvt_pk_bf16_f32 v140, v68, v69
    v_cvt_pk_bf16_f32 v141, v70, v71
    s_add_u32 s64, s3, 2097152
    buffer_store_dwordx4 a[240:243], v1, s[4:7], s64 offen sc1
    v_cvt_pk_bf16_f32 v142, v84, v85
    v_cvt_pk_bf16_f32 v143, v86, v87
    v_cvt_pk_bf16_f32 v212, v240, v241
    v_cvt_pk_bf16_f32 v213, v242, v243
    v_cvt_pk_bf16_f32 v214, v244, v245
    v_cvt_pk_bf16_f32 v215, v246, v247
    v_cvt_pk_bf16_f32 v144, v72, v73
    v_cvt_pk_bf16_f32 v145, v74, v75
    v_cvt_pk_bf16_f32 v146, v88, v89
    v_cvt_pk_bf16_f32 v147, v90, v91
    v_mfma_f32_16x16x32_bf16 v[152:155], v[40:43], v[212:215], 0
    s_nop 0
    v_mfma_f32_16x16x32_bf16 v[156:159], v[40:43], v[144:147], 0
    v_exp_f32 v248, v248
    v_exp_f32 v249, v249
    v_exp_f32 v250, v250
    v_exp_f32 v251, v251
    v_exp_f32 v252, v252
    v_exp_f32 v253, v253
    v_exp_f32 v254, v254
    v_exp_f32 v255, v255
    v_exp_f32 v76, v76
    v_exp_f32 v77, v77
    v_exp_f32 v78, v78
    v_exp_f32 v79, v79
    v_exp_f32 v92, v92
    v_exp_f32 v93, v93
    v_exp_f32 v94, v94
    v_exp_f32 v95, v95
    buffer_store_dwordx4 a[244:247], v1, s[4:7], s64 offen offset:1024 sc1
    s_add_u32 s64, s72, 393216
    s_mov_b32 exec_lo, 0x003f003f
    s_mov_b32 exec_hi, 0x003f003f
    buffer_store_dwordx4 a[248:251], v61, s[4:7], s64 offen sc1
    s_mov_b64 exec, -1
    v_cvt_pk_bf16_f32 v216, v248, v249
    v_cvt_pk_bf16_f32 v217, v250, v251
    v_cvt_pk_bf16_f32 v218, v252, v253
    v_cvt_pk_bf16_f32 v219, v254, v255
    v_cvt_pk_bf16_f32 v148, v76, v77
    v_cvt_pk_bf16_f32 v149, v78, v79
    v_cvt_pk_bf16_f32 v150, v92, v93
    v_cvt_pk_bf16_f32 v151, v94, v95
    v_mfma_f32_16x16x32_bf16 v[176:179], v[40:43], v[216:219], 0
    s_nop 0
    v_mfma_f32_16x16x32_bf16 v[180:183], v[40:43], v[148:151], 0
    s_andn2_b64 s[20:21], s[40:41], s[38:39]
    s_and_b64 s[22:23], s[40:41], s[38:39]
    v_or_b32 v128, v46, v44
    v_and_b32 v128, v128, v40
    v_cndmask_b32 v130, 0, v128, s[20:21]
    v_cndmask_b32 v131, 0, v128, s[22:23]
    v_mov_b32 v128, 0
    v_mov_b32 v129, 0
    v_mov_b32 v132, 0
    v_mov_b32 v133, 0
    v_rcp_f32 v188, v152
    v_rcp_f32 v189, v156
    s_nop 0
    v_pk_mul_f32 v[240:241], v[240:241], v[188:189] op_sel:[0,0] op_sel_hi:[1,0]
    v_pk_mul_f32 v[242:243], v[242:243], v[188:189] op_sel:[0,0] op_sel_hi:[1,0]
    v_pk_mul_f32 v[244:245], v[244:245], v[188:189] op_sel:[0,0] op_sel_hi:[1,0]
    v_pk_mul_f32 v[246:247], v[246:247], v[188:189] op_sel:[0,0] op_sel_hi:[1,0]
    v_cvt_pk_bf16_f32 v212, v240, v241
    v_cvt_pk_bf16_f32 v213, v242, v243
    v_cvt_pk_bf16_f32 v214, v244, v245
    v_cvt_pk_bf16_f32 v215, v246, v247
    v_pk_mul_f32 v[72:73], v[72:73], v[188:189] op_sel:[0,1] op_sel_hi:[1,1]
    v_pk_mul_f32 v[74:75], v[74:75], v[188:189] op_sel:[0,1] op_sel_hi:[1,1]
    v_pk_mul_f32 v[88:89], v[88:89], v[188:189] op_sel:[0,1] op_sel_hi:[1,1]
    v_pk_mul_f32 v[90:91], v[90:91], v[188:189] op_sel:[0,1] op_sel_hi:[1,1]
    v_cvt_pk_bf16_f32 v144, v72, v73
    v_cvt_pk_bf16_f32 v145, v74, v75
    v_cvt_pk_bf16_f32 v146, v88, v89
    v_cvt_pk_bf16_f32 v147, v90, v91
    v_rcp_f32 v190, v176
    v_rcp_f32 v191, v180
    buffer_store_dwordx4 a[252:255], v1, s[4:7], s73 offen sc1
    v_pk_mul_f32 v[248:249], v[248:249], v[190:191] op_sel:[0,0] op_sel_hi:[1,0]
    v_pk_mul_f32 v[250:251], v[250:251], v[190:191] op_sel:[0,0] op_sel_hi:[1,0]
    v_pk_mul_f32 v[252:253], v[252:253], v[190:191] op_sel:[0,0] op_sel_hi:[1,0]
    v_pk_mul_f32 v[254:255], v[254:255], v[190:191] op_sel:[0,0] op_sel_hi:[1,0]
    v_cvt_pk_bf16_f32 v216, v248, v249
    v_cvt_pk_bf16_f32 v217, v250, v251
    v_cvt_pk_bf16_f32 v218, v252, v253
    v_cvt_pk_bf16_f32 v219, v254, v255
    v_pk_mul_f32 v[76:77], v[76:77], v[190:191] op_sel:[0,1] op_sel_hi:[1,1]
    v_pk_mul_f32 v[78:79], v[78:79], v[190:191] op_sel:[0,1] op_sel_hi:[1,1]
    v_pk_mul_f32 v[92:93], v[92:93], v[190:191] op_sel:[0,1] op_sel_hi:[1,1]
    v_pk_mul_f32 v[94:95], v[94:95], v[190:191] op_sel:[0,1] op_sel_hi:[1,1]
    v_cvt_pk_bf16_f32 v148, v76, v77
    v_cvt_pk_bf16_f32 v149, v78, v79
    v_cvt_pk_bf16_f32 v150, v92, v93
    v_cvt_pk_bf16_f32 v151, v94, v95
    s_add_u32 s64, s58, s86
    s_add_u32 s64, s64, 0x100000
    buffer_store_dwordx4 a[252:255], v1, s[4:7], s64 offen sc1
    s_add_u32 s64, s54, 0x10000
    s_mov_b64 exec, s[42:43]
    buffer_store_dwordx4 a[252:255], v60, s[4:7], s64 offen sc1
    s_mov_b64 exec, -1
    s_mov_b32 s61, 1048576
    s_waitcnt vmcnt(13)
L_kvc0_0:
    v_cmp_eq_u32 vcc, -1, v96
    s_cbranch_vccnz L_kvs0_0
L_kvo0_0:
    v_mfma_f32_16x16x32_bf16 v[168:171], v[130:133], v[96:99], v[168:171]
    v_mfma_f32_16x16x32_bf16 v[172:175], v[128:131], v[96:99], v[172:175]
    s_waitcnt vmcnt(12)
L_kvc0_1:
    v_cmp_eq_u32 vcc, -1, v100
    s_cbranch_vccnz L_kvs0_1
L_kvo0_1:
    v_mfma_f32_16x16x32_bf16 v[168:171], v[130:133], v[100:103], v[168:171]
    v_mfma_f32_16x16x32_bf16 v[172:175], v[128:131], v[100:103], v[172:175]
    s_waitcnt vmcnt(11)
L_kvc0_2:
    v_cmp_eq_u32 vcc, -1, v104
    s_cbranch_vccnz L_kvs0_2
L_kvo0_2:
    v_mfma_f32_16x16x32_bf16 v[168:171], v[130:133], v[104:107], v[168:171]
    v_mfma_f32_16x16x32_bf16 v[172:175], v[128:131], v[104:107], v[172:175]
    s_waitcnt vmcnt(10)
L_kvc0_3:
    v_cmp_eq_u32 vcc, -1, v108
    s_cbranch_vccnz L_kvs0_3
L_kvo0_3:
    v_mfma_f32_16x16x32_bf16 v[168:171], v[130:133], v[108:111], v[168:171]
    v_mfma_f32_16x16x32_bf16 v[172:175], v[128:131], v[108:111], v[172:175]
    s_waitcnt vmcnt(9)
L_kvc0_4:
    v_cmp_eq_u32 vcc, -1, v112
    s_cbranch_vccnz L_kvs0_4
L_kvo0_4:
    v_mfma_f32_16x16x32_bf16 v[168:171], v[130:133], v[112:115], v[168:171]
    v_mfma_f32_16x16x32_bf16 v[172:175], v[128:131], v[112:115], v[172:175]
    s_waitcnt vmcnt(8)
L_kvc0_5:
    v_cmp_eq_u32 vcc, -1, v116
    s_cbranch_vccnz L_kvs0_5
L_kvo0_5:
    v_mfma_f32_16x16x32_bf16 v[168:171], v[130:133], v[116:119], v[168:171]
    v_mfma_f32_16x16x32_bf16 v[172:175], v[128:131], v[116:119], v[172:175]
    s_waitcnt vmcnt(7)
L_kvc0_6:
    v_cmp_eq_u32 vcc, -1, v120
    s_cbranch_vccnz L_kvs0_6
L_kvo0_6:
    v_mfma_f32_16x16x32_bf16 v[168:171], v[130:133], v[120:123], v[168:171]
    v_mfma_f32_16x16x32_bf16 v[172:175], v[128:131], v[120:123], v[172:175]
    s_waitcnt vmcnt(6)
L_kvc0_7:
    v_cmp_eq_u32 vcc, -1, v192
    s_cbranch_vccnz L_kvs0_7
L_kvo0_7:
    v_add_f32_dpp v192, v192, v192 row_ror:4 row_mask:0xf bank_mask:0xf
    v_add_f32_dpp v193, v193, v193 row_ror:4 row_mask:0xf bank_mask:0xf
    v_add_f32_dpp v194, v194, v194 row_ror:4 row_mask:0xf bank_mask:0xf
    v_add_f32_dpp v195, v195, v195 row_ror:4 row_mask:0xf bank_mask:0xf
    v_add_f32_dpp v192, v192, v192 row_ror:2 row_mask:0xf bank_mask:0xf
    v_add_f32_dpp v193, v193, v193 row_ror:2 row_mask:0xf bank_mask:0xf
    v_add_f32_dpp v194, v194, v194 row_ror:2 row_mask:0xf bank_mask:0xf
    v_add_f32_dpp v195, v195, v195 row_ror:2 row_mask:0xf bank_mask:0xf
    v_cvt_pk_bf16_f32 v196, v168, v169
    v_cvt_pk_bf16_f32 v197, v170, v171
    v_cvt_pk_bf16_f32 v198, v172, v173
    v_cvt_pk_bf16_f32 v199, v174, v175
    ds_write_b64 v36, v[196:197]
    ds_write_b64 v37, v[198:199]
    v_add_f32_dpp v192, v192, v192 row_ror:1 row_mask:0xf bank_mask:0xf
    v_add_f32_dpp v193, v193, v193 row_ror:1 row_mask:0xf bank_mask:0xf
    v_add_f32_dpp v194, v194, v194 row_ror:1 row_mask:0xf bank_mask:0xf
    v_add_f32_dpp v195, v195, v195 row_ror:1 row_mask:0xf bank_mask:0xf
    v_cvt_pk_bf16_f32 v192, v192, v193
    v_cvt_pk_bf16_f32 v193, v194, v195
    s_mov_b64 exec, s[42:43]
    ds_write_b64 v57, v[192:193] offset:10240
    s_mov_b64 exec, -1
    s_waitcnt lgkmcnt(0)
    s_barrier
    ds_read_b128 v[184:187], v56 offset:10240
    ds_read_b128 v[188:191], v56 offset:10304
    ds_read_b128 v[168:171], v3 offset:20480
    ds_read_b128 v[172:175], v3 offset:21504
    ds_read_b128 v[176:179], v3 offset:22528
    ds_read_b128 v[180:183], v3 offset:23552
    s_add_u32 s58, s58, 0x100000
    s_add_u32 s59, s59, 0x10000
    s_add_u32 s54, s54, 0x10000
    s_waitcnt lgkmcnt(4)
    v_mfma_f32_16x16x32_bf16 v[64:67], v[184:187], v[204:207], 0
    v_mfma_f32_16x16x32_bf16 v[68:71], v[184:187], v[208:211], 0
    v_mfma_f32_16x16x32_bf16 v[72:75], v[184:187], v[212:215], 0
    v_mfma_f32_16x16x32_bf16 v[76:79], v[184:187], v[216:219], 0
    v_mfma_f32_16x16x32_bf16 v[64:67], v[188:191], v[136:139], v[64:67]
    v_mfma_f32_16x16x32_bf16 v[68:71], v[188:191], v[140:143], v[68:71]
    v_mfma_f32_16x16x32_bf16 v[72:75], v[188:191], v[144:147], v[72:75]
    v_mfma_f32_16x16x32_bf16 v[76:79], v[188:191], v[148:151], v[76:79]
    s_waitcnt lgkmcnt(0)
    v_mfma_f32_16x16x32_bf16 v[96:99], v[168:171], v[204:207], 0
    v_mfma_f32_16x16x32_bf16 v[100:103], v[172:175], v[204:207], 0
    v_mfma_f32_16x16x32_bf16 v[96:99], v[176:179], v[136:139], v[96:99]
    v_mfma_f32_16x16x32_bf16 v[100:103], v[180:183], v[136:139], v[100:103]
    v_mfma_f32_16x16x32_bf16 v[104:107], v[168:171], v[208:211], 0
    v_add_f32 v64, 0x358637bd, v64
    v_rcp_f32 v64, v64
    v_mfma_f32_16x16x32_bf16 v[108:111], v[172:175], v[208:211], 0
    v_add_f32 v68, 0x358637bd, v68
    v_rcp_f32 v68, v68
    v_mfma_f32_16x16x32_bf16 v[104:107], v[176:179], v[140:143], v[104:107]
    v_add_f32 v72, 0x358637bd, v72
    v_rcp_f32 v72, v72
    v_mfma_f32_16x16x32_bf16 v[108:111], v[180:183], v[140:143], v[108:111]
    v_add_f32 v76, 0x358637bd, v76
    v_rcp_f32 v76, v76
    v_mfma_f32_16x16x32_bf16 v[112:115], v[168:171], v[212:215], 0
    v_mul_f32 v96, v96, v64
    v_mul_f32 v97, v97, v64
    v_mul_f32 v98, v98, v64
    v_mfma_f32_16x16x32_bf16 v[116:119], v[172:175], v[212:215], 0
    v_mul_f32 v99, v99, v64
    v_mul_f32 v100, v100, v64
    v_mul_f32 v101, v101, v64
    v_mfma_f32_16x16x32_bf16 v[112:115], v[176:179], v[144:147], v[112:115]
    v_mul_f32 v102, v102, v64
    v_mul_f32 v103, v103, v64
    v_cvt_pk_bf16_f32 v224, v96, v97
    v_mfma_f32_16x16x32_bf16 v[116:119], v[180:183], v[144:147], v[116:119]
    v_cvt_pk_bf16_f32 v225, v98, v99
    v_cvt_pk_bf16_f32 v226, v100, v101
    v_cvt_pk_bf16_f32 v227, v102, v103
    buffer_store_dwordx4 v[224:227], v4, s[4:7], s34 offen sc1
    v_mfma_f32_16x16x32_bf16 v[120:123], v[168:171], v[216:219], 0
    v_mul_f32 v104, v104, v68
    v_mul_f32 v105, v105, v68
    v_mul_f32 v106, v106, v68
    v_mfma_f32_16x16x32_bf16 v[124:127], v[172:175], v[216:219], 0
    v_mul_f32 v107, v107, v68
    v_mul_f32 v108, v108, v68
    v_mul_f32 v109, v109, v68
    v_mfma_f32_16x16x32_bf16 v[120:123], v[176:179], v[148:151], v[120:123]
    v_mul_f32 v110, v110, v68
    v_mul_f32 v111, v111, v68
    v_cvt_pk_bf16_f32 v228, v104, v105
    v_mfma_f32_16x16x32_bf16 v[124:127], v[180:183], v[148:151], v[124:127]
    v_cvt_pk_bf16_f32 v229, v106, v107
    v_cvt_pk_bf16_f32 v230, v108, v109
    v_cvt_pk_bf16_f32 v231, v110, v111
    buffer_store_dwordx4 v[228:231], v5, s[4:7], s34 offen sc1
    v_pk_mul_f32 v[112:113], v[112:113], v[72:73] op_sel:[0,0] op_sel_hi:[1,0]
    v_pk_mul_f32 v[114:115], v[114:115], v[72:73] op_sel:[0,0] op_sel_hi:[1,0]
    v_pk_mul_f32 v[116:117], v[116:117], v[72:73] op_sel:[0,0] op_sel_hi:[1,0]
    v_pk_mul_f32 v[118:119], v[118:119], v[72:73] op_sel:[0,0] op_sel_hi:[1,0]
    v_cvt_pk_bf16_f32 v232, v112, v113
    v_cvt_pk_bf16_f32 v233, v114, v115
    v_cvt_pk_bf16_f32 v234, v116, v117
    v_cvt_pk_bf16_f32 v235, v118, v119
    buffer_store_dwordx4 v[232:235], v6, s[4:7], s34 offen sc1
    v_pk_mul_f32 v[120:121], v[120:121], v[76:77] op_sel:[0,0] op_sel_hi:[1,0]
    v_pk_mul_f32 v[122:123], v[122:123], v[76:77] op_sel:[0,0] op_sel_hi:[1,0]
    v_pk_mul_f32 v[124:125], v[124:125], v[76:77] op_sel:[0,0] op_sel_hi:[1,0]
    v_pk_mul_f32 v[126:127], v[126:127], v[76:77] op_sel:[0,0] op_sel_hi:[1,0]
    v_cvt_pk_bf16_f32 v236, v120, v121
    v_cvt_pk_bf16_f32 v237, v122, v123
    v_cvt_pk_bf16_f32 v238, v124, v125
    v_cvt_pk_bf16_f32 v239, v126, v127
    buffer_store_dwordx4 v[236:239], v7, s[4:7], s34 offen sc1
    v_mov_b32 v63, 1
    v_lshlrev_b32 v64, 16, v16
    v_and_b32 v65, 0xffff0000, v16
    v_lshlrev_b32 v66, 16, v17
    buffer_load_dword v216, v12, s[4:7], s30 offen sc1
    v_and_b32 v67, 0xffff0000, v17
    v_lshlrev_b32 v72, 16, v18
    v_and_b32 v73, 0xffff0000, v18
    v_lshlrev_b32 v74, 16, v19
    v_and_b32 v75, 0xffff0000, v19
    v_lshlrev_b32 v80, 16, v20
    v_and_b32 v81, 0xffff0000, v20
    v_lshlrev_b32 v82, 16, v21
    v_and_b32 v83, 0xffff0000, v21
    v_lshlrev_b32 v88, 16, v22
    v_and_b32 v89, 0xffff0000, v22
    v_lshlrev_b32 v90, 16, v23
    v_and_b32 v91, 0xffff0000, v23
    v_lshlrev_b32 v68, 16, v24
    v_and_b32 v69, 0xffff0000, v24
    v_lshlrev_b32 v70, 16, v25
    v_and_b32 v71, 0xffff0000, v25
    v_lshlrev_b32 v76, 16, v26
    v_and_b32 v77, 0xffff0000, v26
    v_lshlrev_b32 v78, 16, v27
    v_and_b32 v79, 0xffff0000, v27
    v_lshlrev_b32 v84, 16, v28
    v_and_b32 v85, 0xffff0000, v28
    v_lshlrev_b32 v86, 16, v29
    v_and_b32 v87, 0xffff0000, v29
    v_lshlrev_b32 v92, 16, v30
    v_and_b32 v93, 0xffff0000, v30
    v_lshlrev_b32 v94, 16, v31
    v_and_b32 v95, 0xffff0000, v31
    s_mov_b64 exec, 1
    s_waitcnt vmcnt(1)
    s_cmp_lg_u32 s15, 0
    s_cbranch_scc1 L_slow_6
    buffer_store_dword v63, off, s[4:7], s31
L_done_7:
    s_mov_b64 exec, -1
    s_waitcnt vmcnt(1)
    s_mov_b64 exec, s[82:83]
    v_cmp_gt_u32 vcc, 1, v216
    s_mov_b64 exec, -1
    s_cbranch_vccz L_hd_5
    s_mov_b32 s61, 1048576
L_spin_8:
    buffer_load_dword v216, v12, s[4:7], s30 offen sc1
    s_sub_u32 s61, s61, 1
    s_waitcnt vmcnt(0)
    s_mov_b64 exec, 63
    v_cmp_gt_u32 vcc, 1, v216
    s_mov_b64 exec, -1
    s_cbranch_scc1 L_spind_9
    s_cbranch_vccnz L_spin_8
L_spind_9:
L_hd_5:
    s_mov_b32 s62, 29360128
    buffer_load_dwordx4 a[80:83], v8, s[4:7], s62 offen offset:0 sc1
    buffer_load_dwordx4 a[84:87], v9, s[4:7], s62 offen offset:0 sc1
    buffer_load_dwordx4 a[88:91], v8, s[4:7], s62 offen offset:1024 sc1
    buffer_load_dword v216, v12, s[4:7], s30 offen sc1
    buffer_load_dwordx4 a[92:95], v9, s[4:7], s62 offen offset:1024 sc1
    buffer_load_dwordx4 a[96:99], v8, s[4:7], s62 offen offset:2048 sc1
    buffer_load_dwordx4 a[100:103], v9, s[4:7], s62 offen offset:2048 sc1
    buffer_load_dwordx4 a[104:107], v8, s[4:7], s62 offen offset:3072 sc1
    buffer_load_dwordx4 a[108:111], v9, s[4:7], s62 offen offset:3072 sc1
    s_mov_b32 s62, 29364224
    buffer_load_dwordx4 a[112:115], v8, s[4:7], s62 offen offset:0 sc1
    buffer_load_dwordx4 a[116:119], v9, s[4:7], s62 offen offset:0 sc1
    buffer_load_dwordx4 a[120:123], v8, s[4:7], s62 offen offset:1024 sc1
    buffer_load_dwordx4 a[124:127], v9, s[4:7], s62 offen offset:1024 sc1
    s_barrier
    ds_read_b128 a[48:51], v1 offset:0
    ds_read_b128 a[52:55], v1 offset:1024
    ds_read_b128 a[56:59], v1 offset:2048
    ds_read_b128 a[60:63], v1 offset:3072
    ds_read_b128 a[64:67], v1 offset:4096
    ds_read_b128 a[68:71], v1 offset:5120
    ds_read_b128 a[72:75], v1 offset:6144
    ds_read_b128 a[76:79], v1 offset:7168
    s_waitcnt vmcnt(9)
    v_cmp_gt_u32 vcc, 1, v216
    s_cbranch_vccnz L_p2_10
L_p2_10_r:
    s_mov_b64 exec, 1
    buffer_store_dword v63, off, s[4:7], s55 offset:1024 sc1
    s_mov_b64 exec, -1
    s_waitcnt lgkmcnt(7)
    v_mfma_f32_16x16x32_bf16 v[64:67], a[48:51], a[80:83], v[64:67]
    buffer_load_dwordx4 a[128:131], v8, s[4:7], s62 offen offset:2048 sc1
    v_mfma_f32_16x16x32_bf16 v[68:71], a[48:51], a[84:87], v[68:71]
    ds_read_b128 a[48:51], v1 offset:8192
    s_waitcnt lgkmcnt(7)
    v_mfma_f32_16x16x32_bf16 v[76:79], a[52:55], a[84:87], v[76:79]
    v_mfma_f32_16x16x32_bf16 v[72:75], a[52:55], a[80:83], v[72:75]
    ds_read_b128 a[52:55], v1 offset:9216
    s_waitcnt lgkmcnt(7)
    v_mfma_f32_16x16x32_bf16 v[80:83], a[56:59], a[80:83], v[80:83]
    buffer_load_dwordx4 a[132:135], v9, s[4:7], s62 offen offset:2048 sc1
    v_mfma_f32_16x16x32_bf16 v[84:87], a[56:59], a[84:87], v[84:87]
    ds_read_b128 a[56:59], v1 offset:10240
    s_waitcnt lgkmcnt(7)
    v_mfma_f32_16x16x32_bf16 v[92:95], a[60:63], a[84:87], v[92:95]
    v_mfma_f32_16x16x32_bf16 v[88:91], a[60:63], a[80:83], v[88:91]
    ds_read_b128 a[60:63], v1 offset:11264
    s_waitcnt vmcnt(11)
    s_waitcnt lgkmcnt(7)
    v_mfma_f32_16x16x32_bf16 v[64:67], a[64:67], a[88:91], v[64:67]
    buffer_load_dwordx4 a[80:83], v8, s[4:7], s62 offen offset:3072 sc1
    v_mfma_f32_16x16x32_bf16 v[68:71], a[64:67], a[92:95], v[68:71]
    ds_read_b128 a[64:67], v1 offset:12288
    s_waitcnt lgkmcnt(7)
    v_mfma_f32_16x16x32_bf16 v[76:79], a[68:71], a[92:95], v[76:79]
    v_mfma_f32_16x16x32_bf16 v[72:75], a[68:71], a[88:91], v[72:75]
    ds_read_b128 a[68:71], v1 offset:13312
    s_waitcnt lgkmcnt(7)
    v_mfma_f32_16x16x32_bf16 v[80:83], a[72:75], a[88:91], v[80:83]
    buffer_load_dwordx4 a[84:87], v9, s[4:7], s62 offen offset:3072 sc1
    v_mfma_f32_16x16x32_bf16 v[84:87], a[72:75], a[92:95], v[84:87]
    ds_read_b128 a[72:75], v1 offset:14336
    s_waitcnt lgkmcnt(7)
    v_mfma_f32_16x16x32_bf16 v[92:95], a[76:79], a[92:95], v[92:95]
    v_mfma_f32_16x16x32_bf16 v[88:91], a[76:79], a[88:91], v[88:91]
    ds_read_b128 a[76:79], v1 offset:15360
    s_waitcnt vmcnt(11)
    s_waitcnt lgkmcnt(7)
    v_mfma_f32_16x16x32_bf16 v[64:67], a[48:51], a[96:99], v[64:67]
    s_mov_b32 s62, 29368320
    buffer_load_dwordx4 a[88:91], v8, s[4:7], s62 offen offset:0 sc1
    v_mfma_f32_16x16x32_bf16 v[68:71], a[48:51], a[100:103], v[68:71]
    ds_read_b128 a[48:51], v1 offset:16384
    s_waitcnt lgkmcnt(7)
    v_mfma_f32_16x16x32_bf16 v[76:79], a[52:55], a[100:103], v[76:79]
    v_mfma_f32_16x16x32_bf16 v[72:75], a[52:55], a[96:99], v[72:75]
    ds_read_b128 a[52:55], v1 offset:17408
    s_waitcnt lgkmcnt(7)
    v_mfma_f32_16x16x32_bf16 v[80:83], a[56:59], a[96:99], v[80:83]
    buffer_load_dwordx4 a[92:95], v9, s[4:7], s62 offen offset:0 sc1
    v_mfma_f32_16x16x32_bf16 v[84:87], a[56:59], a[100:103], v[84:87]
    ds_read_b128 a[56:59], v1 offset:18432
    s_waitcnt lgkmcnt(7)
    v_mfma_f32_16x16x32_bf16 v[92:95], a[60:63], a[100:103], v[92:95]
    v_mfma_f32_16x16x32_bf16 v[88:91], a[60:63], a[96:99], v[88:91]
    ds_read_b128 a[60:63], v1 offset:19456
    s_waitcnt vmcnt(11)
    s_waitcnt lgkmcnt(7)
    v_mfma_f32_16x16x32_bf16 v[64:67], a[64:67], a[104:107], v[64:67]
    buffer_load_dwordx4 a[96:99], v8, s[4:7], s62 offen offset:1024 sc1
    v_mfma_f32_16x16x32_bf16 v[68:71], a[64:67], a[108:111], v[68:71]
    ds_read_b128 a[64:67], v1 offset:20480
    s_waitcnt lgkmcnt(7)
    v_mfma_f32_16x16x32_bf16 v[76:79], a[68:71], a[108:111], v[76:79]
    v_mfma_f32_16x16x32_bf16 v[72:75], a[68:71], a[104:107], v[72:75]
    ds_read_b128 a[68:71], v1 offset:21504
    s_waitcnt lgkmcnt(7)
    v_mfma_f32_16x16x32_bf16 v[80:83], a[72:75], a[104:107], v[80:83]
    buffer_load_dwordx4 a[100:103], v9, s[4:7], s62 offen offset:1024 sc1
    v_mfma_f32_16x16x32_bf16 v[84:87], a[72:75], a[108:111], v[84:87]
    ds_read_b128 a[72:75], v1 offset:22528
    s_waitcnt lgkmcnt(7)
    v_mfma_f32_16x16x32_bf16 v[92:95], a[76:79], a[108:111], v[92:95]
    v_mfma_f32_16x16x32_bf16 v[88:91], a[76:79], a[104:107], v[88:91]
    ds_read_b128 a[76:79], v1 offset:23552
    s_waitcnt vmcnt(11)
    s_waitcnt lgkmcnt(7)
    v_mfma_f32_16x16x32_bf16 v[64:67], a[48:51], a[112:115], v[64:67]
    buffer_load_dwordx4 a[104:107], v8, s[4:7], s62 offen offset:2048 sc1
    v_mfma_f32_16x16x32_bf16 v[68:71], a[48:51], a[116:119], v[68:71]
    ds_read_b128 a[48:51], v1 offset:24576
    s_waitcnt lgkmcnt(7)
    v_mfma_f32_16x16x32_bf16 v[76:79], a[52:55], a[116:119], v[76:79]
    v_mfma_f32_16x16x32_bf16 v[72:75], a[52:55], a[112:115], v[72:75]
    ds_read_b128 a[52:55], v1 offset:25600
    s_waitcnt lgkmcnt(7)
    v_mfma_f32_16x16x32_bf16 v[80:83], a[56:59], a[112:115], v[80:83]
    buffer_load_dwordx4 a[108:111], v9, s[4:7], s62 offen offset:2048 sc1
    v_mfma_f32_16x16x32_bf16 v[84:87], a[56:59], a[116:119], v[84:87]
    ds_read_b128 a[56:59], v1 offset:26624
    s_waitcnt lgkmcnt(7)
    v_mfma_f32_16x16x32_bf16 v[92:95], a[60:63], a[116:119], v[92:95]
    v_mfma_f32_16x16x32_bf16 v[88:91], a[60:63], a[112:115], v[88:91]
    ds_read_b128 a[60:63], v1 offset:27648
    s_waitcnt vmcnt(11)
    s_waitcnt lgkmcnt(7)
    v_mfma_f32_16x16x32_bf16 v[64:67], a[64:67], a[120:123], v[64:67]
    buffer_load_dwordx4 a[112:115], v8, s[4:7], s62 offen offset:3072 sc1
    v_mfma_f32_16x16x32_bf16 v[68:71], a[64:67], a[124:127], v[68:71]
    ds_read_b128 a[64:67], v1 offset:28672
    s_waitcnt lgkmcnt(7)
    v_mfma_f32_16x16x32_bf16 v[76:79], a[68:71], a[124:127], v[76:79]
    v_mfma_f32_16x16x32_bf16 v[72:75], a[68:71], a[120:123], v[72:75]
    ds_read_b128 a[68:71], v1 offset:29696
    s_waitcnt lgkmcnt(7)
    v_mfma_f32_16x16x32_bf16 v[80:83], a[72:75], a[120:123], v[80:83]
    buffer_load_dwordx4 a[116:119], v9, s[4:7], s62 offen offset:3072 sc1
    v_mfma_f32_16x16x32_bf16 v[84:87], a[72:75], a[124:127], v[84:87]
    ds_read_b128 a[72:75], v1 offset:30720
    s_waitcnt lgkmcnt(7)
    v_mfma_f32_16x16x32_bf16 v[92:95], a[76:79], a[124:127], v[92:95]
    v_mfma_f32_16x16x32_bf16 v[88:91], a[76:79], a[120:123], v[88:91]
    ds_read_b128 a[76:79], v1 offset:31744
    s_waitcnt vmcnt(10)
    s_waitcnt lgkmcnt(7)
    v_mfma_f32_16x16x32_bf16 v[64:67], a[48:51], a[128:131], v[64:67]
    s_mov_b32 s62, 29372416
    buffer_load_dwordx4 a[120:123], v8, s[4:7], s62 offen offset:0 sc1
    v_mfma_f32_16x16x32_bf16 v[68:71], a[48:51], a[132:135], v[68:71]
    ds_read_b128 a[48:51], v1 offset:32768
    s_waitcnt lgkmcnt(7)
    v_mfma_f32_16x16x32_bf16 v[76:79], a[52:55], a[132:135], v[76:79]
    v_mfma_f32_16x16x32_bf16 v[72:75], a[52:55], a[128:131], v[72:75]
    ds_read_b128 a[52:55], v1 offset:33792
    s_waitcnt lgkmcnt(7)
    v_mfma_f32_16x16x32_bf16 v[80:83], a[56:59], a[128:131], v[80:83]
    buffer_load_dwordx4 a[124:127], v9, s[4:7], s62 offen offset:0 sc1
    v_mfma_f32_16x16x32_bf16 v[84:87], a[56:59], a[132:135], v[84:87]
    ds_read_b128 a[56:59], v1 offset:34816
    s_waitcnt lgkmcnt(7)
    v_mfma_f32_16x16x32_bf16 v[92:95], a[60:63], a[132:135], v[92:95]
    v_mfma_f32_16x16x32_bf16 v[88:91], a[60:63], a[128:131], v[88:91]
    ds_read_b128 a[60:63], v1 offset:35840
    s_waitcnt vmcnt(10)
    s_waitcnt lgkmcnt(7)
    v_mfma_f32_16x16x32_bf16 v[64:67], a[64:67], a[80:83], v[64:67]
    buffer_load_dwordx4 a[128:131], v8, s[4:7], s62 offen offset:1024 sc1
    v_mfma_f32_16x16x32_bf16 v[68:71], a[64:67], a[84:87], v[68:71]
    ds_read_b128 a[64:67], v1 offset:36864
    s_waitcnt lgkmcnt(7)
    v_mfma_f32_16x16x32_bf16 v[76:79], a[68:71], a[84:87], v[76:79]
    v_mfma_f32_16x16x32_bf16 v[72:75], a[68:71], a[80:83], v[72:75]
    ds_read_b128 a[68:71], v1 offset:37888
    s_waitcnt lgkmcnt(7)
    v_mfma_f32_16x16x32_bf16 v[80:83], a[72:75], a[80:83], v[80:83]
    buffer_load_dwordx4 a[132:135], v9, s[4:7], s62 offen offset:1024 sc1
    v_mfma_f32_16x16x32_bf16 v[84:87], a[72:75], a[84:87], v[84:87]
    ds_read_b128 a[72:75], v1 offset:38912
    s_waitcnt lgkmcnt(7)
    v_mfma_f32_16x16x32_bf16 v[92:95], a[76:79], a[84:87], v[92:95]
    v_mfma_f32_16x16x32_bf16 v[88:91], a[76:79], a[80:83], v[88:91]
    ds_read_b128 a[76:79], v1 offset:39936
    s_waitcnt vmcnt(10)
    s_waitcnt lgkmcnt(7)
    v_mfma_f32_16x16x32_bf16 v[64:67], a[48:51], a[88:91], v[64:67]
    buffer_load_dwordx4 a[80:83], v8, s[4:7], s62 offen offset:2048 sc1
    v_mfma_f32_16x16x32_bf16 v[68:71], a[48:51], a[92:95], v[68:71]
    ds_read_b128 a[48:51], v1 offset:40960
    s_waitcnt lgkmcnt(7)
    v_mfma_f32_16x16x32_bf16 v[76:79], a[52:55], a[92:95], v[76:79]
    v_mfma_f32_16x16x32_bf16 v[72:75], a[52:55], a[88:91], v[72:75]
    ds_read_b128 a[52:55], v1 offset:41984
    s_waitcnt lgkmcnt(7)
    v_mfma_f32_16x16x32_bf16 v[80:83], a[56:59], a[88:91], v[80:83]
    buffer_load_dwordx4 a[84:87], v9, s[4:7], s62 offen offset:2048 sc1
    v_mfma_f32_16x16x32_bf16 v[84:87], a[56:59], a[92:95], v[84:87]
    ds_read_b128 a[56:59], v1 offset:43008
    s_waitcnt lgkmcnt(7)
    v_mfma_f32_16x16x32_bf16 v[92:95], a[60:63], a[92:95], v[92:95]
    v_mfma_f32_16x16x32_bf16 v[88:91], a[60:63], a[88:91], v[88:91]
    ds_read_b128 a[60:63], v1 offset:44032
    s_waitcnt vmcnt(10)
    s_waitcnt lgkmcnt(7)
    v_mfma_f32_16x16x32_bf16 v[64:67], a[64:67], a[96:99], v[64:67]
    buffer_load_dwordx4 a[88:91], v8, s[4:7], s62 offen offset:3072 sc1
    v_mfma_f32_16x16x32_bf16 v[68:71], a[64:67], a[100:103], v[68:71]
    ds_read_b128 a[64:67], v1 offset:45056
    s_waitcnt lgkmcnt(7)
    v_mfma_f32_16x16x32_bf16 v[76:79], a[68:71], a[100:103], v[76:79]
    v_mfma_f32_16x16x32_bf16 v[72:75], a[68:71], a[96:99], v[72:75]
    ds_read_b128 a[68:71], v1 offset:46080
    s_waitcnt lgkmcnt(7)
    v_mfma_f32_16x16x32_bf16 v[80:83], a[72:75], a[96:99], v[80:83]
    buffer_load_dwordx4 a[92:95], v9, s[4:7], s62 offen offset:3072 sc1
    v_mfma_f32_16x16x32_bf16 v[84:87], a[72:75], a[100:103], v[84:87]
    ds_read_b128 a[72:75], v1 offset:47104
    s_waitcnt lgkmcnt(7)
    v_mfma_f32_16x16x32_bf16 v[92:95], a[76:79], a[100:103], v[92:95]
    v_mfma_f32_16x16x32_bf16 v[88:91], a[76:79], a[96:99], v[88:91]
    ds_read_b128 a[76:79], v1 offset:48128
    s_waitcnt vmcnt(10)
    s_waitcnt lgkmcnt(7)
    v_mfma_f32_16x16x32_bf16 v[64:67], a[48:51], a[104:107], v[64:67]
    s_mov_b32 s62, 29376512
    buffer_load_dwordx4 a[96:99], v8, s[4:7], s62 offen offset:0 sc1
    v_mfma_f32_16x16x32_bf16 v[68:71], a[48:51], a[108:111], v[68:71]
    ds_read_b128 a[48:51], v1 offset:49152
    s_waitcnt lgkmcnt(7)
    v_mfma_f32_16x16x32_bf16 v[76:79], a[52:55], a[108:111], v[76:79]
    v_mfma_f32_16x16x32_bf16 v[72:75], a[52:55], a[104:107], v[72:75]
    ds_read_b128 a[52:55], v1 offset:50176
    s_waitcnt lgkmcnt(7)
    v_mfma_f32_16x16x32_bf16 v[80:83], a[56:59], a[104:107], v[80:83]
    buffer_load_dwordx4 a[100:103], v9, s[4:7], s62 offen offset:0 sc1
    v_mfma_f32_16x16x32_bf16 v[84:87], a[56:59], a[108:111], v[84:87]
    ds_read_b128 a[56:59], v1 offset:51200
    s_waitcnt lgkmcnt(7)
    v_mfma_f32_16x16x32_bf16 v[92:95], a[60:63], a[108:111], v[92:95]
    v_mfma_f32_16x16x32_bf16 v[88:91], a[60:63], a[104:107], v[88:91]
    ds_read_b128 a[60:63], v1 offset:52224
    s_waitcnt vmcnt(10)
    s_waitcnt lgkmcnt(7)
    v_mfma_f32_16x16x32_bf16 v[64:67], a[64:67], a[112:115], v[64:67]
    buffer_load_dwordx4 a[104:107], v8, s[4:7], s62 offen offset:1024 sc1
    v_mfma_f32_16x16x32_bf16 v[68:71], a[64:67], a[116:119], v[68:71]
    ds_read_b128 a[64:67], v1 offset:53248
    s_waitcnt lgkmcnt(7)
    v_mfma_f32_16x16x32_bf16 v[76:79], a[68:71], a[116:119], v[76:79]
    v_mfma_f32_16x16x32_bf16 v[72:75], a[68:71], a[112:115], v[72:75]
    ds_read_b128 a[68:71], v1 offset:54272
    s_waitcnt lgkmcnt(7)
    v_mfma_f32_16x16x32_bf16 v[80:83], a[72:75], a[112:115], v[80:83]
    buffer_load_dwordx4 a[108:111], v9, s[4:7], s62 offen offset:1024 sc1
    v_mfma_f32_16x16x32_bf16 v[84:87], a[72:75], a[116:119], v[84:87]
    ds_read_b128 a[72:75], v1 offset:55296
    s_waitcnt lgkmcnt(7)
    v_mfma_f32_16x16x32_bf16 v[92:95], a[76:79], a[116:119], v[92:95]
    v_mfma_f32_16x16x32_bf16 v[88:91], a[76:79], a[112:115], v[88:91]
    ds_read_b128 a[76:79], v1 offset:56320
    s_waitcnt vmcnt(10)
    s_waitcnt lgkmcnt(7)
    v_mfma_f32_16x16x32_bf16 v[64:67], a[48:51], a[120:123], v[64:67]
    buffer_load_dwordx4 a[112:115], v8, s[4:7], s62 offen offset:2048 sc1
    v_mfma_f32_16x16x32_bf16 v[68:71], a[48:51], a[124:127], v[68:71]
    ds_read_b128 a[48:51], v2 offset:8192
    s_waitcnt lgkmcnt(7)
    v_mfma_f32_16x16x32_bf16 v[76:79], a[52:55], a[124:127], v[76:79]
    v_mfma_f32_16x16x32_bf16 v[72:75], a[52:55], a[120:123], v[72:75]
    ds_read_b128 a[52:55], v2 offset:9216
    s_waitcnt lgkmcnt(7)
    v_mfma_f32_16x16x32_bf16 v[80:83], a[56:59], a[120:123], v[80:83]
    buffer_load_dwordx4 a[116:119], v9, s[4:7], s62 offen offset:2048 sc1
    v_mfma_f32_16x16x32_bf16 v[84:87], a[56:59], a[124:127], v[84:87]
    ds_read_b128 a[56:59], v2 offset:10240
    s_waitcnt lgkmcnt(7)
    v_mfma_f32_16x16x32_bf16 v[92:95], a[60:63], a[124:127], v[92:95]
    v_mfma_f32_16x16x32_bf16 v[88:91], a[60:63], a[120:123], v[88:91]
    ds_read_b128 a[60:63], v2 offset:11264
    s_waitcnt vmcnt(10)
    s_waitcnt lgkmcnt(7)
    v_mfma_f32_16x16x32_bf16 v[64:67], a[64:67], a[128:131], v[64:67]
    buffer_load_dwordx4 a[120:123], v8, s[4:7], s62 offen offset:3072 sc1
    v_mfma_f32_16x16x32_bf16 v[68:71], a[64:67], a[132:135], v[68:71]
    ds_read_b128 a[64:67], v2 offset:12288
    s_waitcnt lgkmcnt(7)
    v_mfma_f32_16x16x32_bf16 v[76:79], a[68:71], a[132:135], v[76:79]
    v_mfma_f32_16x16x32_bf16 v[72:75], a[68:71], a[128:131], v[72:75]
    ds_read_b128 a[68:71], v2 offset:13312
    s_waitcnt lgkmcnt(7)
    v_mfma_f32_16x16x32_bf16 v[80:83], a[72:75], a[128:131], v[80:83]
    buffer_load_dwordx4 a[124:127], v9, s[4:7], s62 offen offset:3072 sc1
    v_mfma_f32_16x16x32_bf16 v[84:87], a[72:75], a[132:135], v[84:87]
    ds_read_b128 a[72:75], v2 offset:14336
    s_waitcnt lgkmcnt(7)
    v_mfma_f32_16x16x32_bf16 v[92:95], a[76:79], a[132:135], v[92:95]
    v_mfma_f32_16x16x32_bf16 v[88:91], a[76:79], a[128:131], v[88:91]
    ds_read_b128 a[76:79], v2 offset:15360
    s_waitcnt vmcnt(10)
    s_waitcnt lgkmcnt(7)
    v_mfma_f32_16x16x32_bf16 v[64:67], a[48:51], a[80:83], v[64:67]
    s_mov_b32 s62, 29380608
    buffer_load_dwordx4 a[128:131], v8, s[4:7], s62 offen offset:0 sc1
    v_mfma_f32_16x16x32_bf16 v[68:71], a[48:51], a[84:87], v[68:71]
    ds_read_b128 a[48:51], v2 offset:16384
    s_waitcnt lgkmcnt(7)
    v_mfma_f32_16x16x32_bf16 v[76:79], a[52:55], a[84:87], v[76:79]
    v_mfma_f32_16x16x32_bf16 v[72:75], a[52:55], a[80:83], v[72:75]
    ds_read_b128 a[52:55], v2 offset:17408
    buffer_load_dword v52, v50, s[4:7], s86 offen sc1
    s_waitcnt lgkmcnt(7)
    v_mfma_f32_16x16x32_bf16 v[80:83], a[56:59], a[80:83], v[80:83]
    buffer_load_dwordx4 a[132:135], v9, s[4:7], s62 offen offset:0 sc1
    v_mfma_f32_16x16x32_bf16 v[84:87], a[56:59], a[84:87], v[84:87]
    ds_read_b128 a[56:59], v2 offset:18432
    s_waitcnt lgkmcnt(7)
    v_mfma_f32_16x16x32_bf16 v[92:95], a[60:63], a[84:87], v[92:95]
    v_mfma_f32_16x16x32_bf16 v[88:91], a[60:63], a[80:83], v[88:91]
    ds_read_b128 a[60:63], v2 offset:19456
    s_waitcnt vmcnt(11)
    s_barrier
    s_waitcnt lgkmcnt(7)
    v_mfma_f32_16x16x32_bf16 v[64:67], a[64:67], a[88:91], v[64:67]
    buffer_load_dwordx4 a[80:83], v8, s[4:7], s62 offen offset:1024 sc1
    v_mfma_f32_16x16x32_bf16 v[68:71], a[64:67], a[92:95], v[68:71]
    ds_read_b128 a[64:67], v2 offset:20480
    s_waitcnt lgkmcnt(7)
    v_mfma_f32_16x16x32_bf16 v[76:79], a[68:71], a[92:95], v[76:79]
    v_mfma_f32_16x16x32_bf16 v[72:75], a[68:71], a[88:91], v[72:75]
    ds_read_b128 a[68:71], v2 offset:21504
    s_waitcnt lgkmcnt(7)
    v_mfma_f32_16x16x32_bf16 v[80:83], a[72:75], a[88:91], v[80:83]
    buffer_load_dwordx4 a[84:87], v9, s[4:7], s62 offen offset:1024 sc1
    v_mfma_f32_16x16x32_bf16 v[84:87], a[72:75], a[92:95], v[84:87]
    ds_read_b128 a[72:75], v2 offset:22528
    s_waitcnt lgkmcnt(7)
    v_mfma_f32_16x16x32_bf16 v[92:95], a[76:79], a[92:95], v[92:95]
    v_mfma_f32_16x16x32_bf16 v[88:91], a[76:79], a[88:91], v[88:91]
    ds_read_b128 a[76:79], v2 offset:23552
    s_waitcnt vmcnt(11)
    s_waitcnt lgkmcnt(7)
    v_mfma_f32_16x16x32_bf16 v[64:67], a[48:51], a[96:99], v[64:67]
    buffer_load_dwordx4 a[88:91], v8, s[4:7], s62 offen offset:2048 sc1
    v_mfma_f32_16x16x32_bf16 v[68:71], a[48:51], a[100:103], v[68:71]
    ds_read_b128 a[48:51], v2 offset:24576
    s_waitcnt lgkmcnt(7)
    v_mfma_f32_16x16x32_bf16 v[76:79], a[52:55], a[100:103], v[76:79]
    v_mfma_f32_16x16x32_bf16 v[72:75], a[52:55], a[96:99], v[72:75]
    ds_read_b128 a[52:55], v2 offset:25600
    s_waitcnt lgkmcnt(7)
    v_mfma_f32_16x16x32_bf16 v[80:83], a[56:59], a[96:99], v[80:83]
    buffer_load_dwordx4 a[92:95], v9, s[4:7], s62 offen offset:2048 sc1
    v_mfma_f32_16x16x32_bf16 v[84:87], a[56:59], a[100:103], v[84:87]
    ds_read_b128 a[56:59], v2 offset:26624
    s_waitcnt lgkmcnt(7)
    v_mfma_f32_16x16x32_bf16 v[92:95], a[60:63], a[100:103], v[92:95]
    v_mfma_f32_16x16x32_bf16 v[88:91], a[60:63], a[96:99], v[88:91]
    ds_read_b128 a[60:63], v2 offset:27648
    s_waitcnt vmcnt(11)
    s_waitcnt lgkmcnt(7)
    v_mfma_f32_16x16x32_bf16 v[64:67], a[64:67], a[104:107], v[64:67]
    buffer_load_dwordx4 a[96:99], v8, s[4:7], s62 offen offset:3072 sc1
    v_mfma_f32_16x16x32_bf16 v[68:71], a[64:67], a[108:111], v[68:71]
    ds_read_b128 a[64:67], v2 offset:28672
    s_waitcnt lgkmcnt(7)
    v_mfma_f32_16x16x32_bf16 v[76:79], a[68:71], a[108:111], v[76:79]
    v_mfma_f32_16x16x32_bf16 v[72:75], a[68:71], a[104:107], v[72:75]
    ds_read_b128 a[68:71], v2 offset:29696
    s_waitcnt lgkmcnt(7)
    v_mfma_f32_16x16x32_bf16 v[80:83], a[72:75], a[104:107], v[80:83]
    buffer_load_dwordx4 a[100:103], v9, s[4:7], s62 offen offset:3072 sc1
    v_mfma_f32_16x16x32_bf16 v[84:87], a[72:75], a[108:111], v[84:87]
    ds_read_b128 a[72:75], v2 offset:30720
    s_waitcnt lgkmcnt(7)
    v_mfma_f32_16x16x32_bf16 v[92:95], a[76:79], a[108:111], v[92:95]
    v_mfma_f32_16x16x32_bf16 v[88:91], a[76:79], a[104:107], v[88:91]
    ds_read_b128 a[76:79], v2 offset:31744
    s_waitcnt vmcnt(11)
    s_waitcnt lgkmcnt(7)
    v_mfma_f32_16x16x32_bf16 v[64:67], a[48:51], a[112:115], v[64:67]
    s_mov_b32 s62, 29384704
    buffer_load_dwordx4 a[104:107], v8, s[4:7], s62 offen offset:0 sc1
    v_mfma_f32_16x16x32_bf16 v[68:71], a[48:51], a[116:119], v[68:71]
    ds_read_b128 a[48:51], v2 offset:32768
    s_waitcnt lgkmcnt(7)
    v_mfma_f32_16x16x32_bf16 v[76:79], a[52:55], a[116:119], v[76:79]
    v_mfma_f32_16x16x32_bf16 v[72:75], a[52:55], a[112:115], v[72:75]
    ds_read_b128 a[52:55], v2 offset:33792
    s_add_u32 s20, s48, L_layer1-L_pc
    s_addc_u32 s21, s49, 0
    global_load_dword v52, v35, s[20:21]
    s_waitcnt lgkmcnt(7)
    v_mfma_f32_16x16x32_bf16 v[80:83], a[56:59], a[112:115], v[80:83]
    buffer_load_dwordx4 a[108:111], v9, s[4:7], s62 offen offset:0 sc1
    v_mfma_f32_16x16x32_bf16 v[84:87], a[56:59], a[116:119], v[84:87]
    ds_read_b128 a[56:59], v2 offset:34816
    s_waitcnt lgkmcnt(7)
    v_mfma_f32_16x16x32_bf16 v[92:95], a[60:63], a[116:119], v[92:95]
    v_mfma_f32_16x16x32_bf16 v[88:91], a[60:63], a[112:115], v[88:91]
    ds_read_b128 a[60:63], v2 offset:35840
    s_waitcnt vmcnt(12)
    s_mov_b32 s20, 33792
    buffer_load_dwordx4 v[216:219], v1, s[4:7], s20 offen sc1
    s_waitcnt lgkmcnt(7)
    v_mfma_f32_16x16x32_bf16 v[64:67], a[64:67], a[120:123], v[64:67]
    buffer_load_dwordx4 a[112:115], v8, s[4:7], s62 offen offset:1024 sc1
    v_mfma_f32_16x16x32_bf16 v[68:71], a[64:67], a[124:127], v[68:71]
    ds_read_b128 a[64:67], v2 offset:36864
    s_waitcnt lgkmcnt(7)
    v_mfma_f32_16x16x32_bf16 v[76:79], a[68:71], a[124:127], v[76:79]
    v_mfma_f32_16x16x32_bf16 v[72:75], a[68:71], a[120:123], v[72:75]
    ds_read_b128 a[68:71], v2 offset:37888
    s_waitcnt lgkmcnt(7)
    v_mfma_f32_16x16x32_bf16 v[80:83], a[72:75], a[120:123], v[80:83]
    buffer_load_dwordx4 a[116:119], v9, s[4:7], s62 offen offset:1024 sc1
    v_mfma_f32_16x16x32_bf16 v[84:87], a[72:75], a[124:127], v[84:87]
    ds_read_b128 a[72:75], v2 offset:38912
    s_waitcnt lgkmcnt(7)
    v_mfma_f32_16x16x32_bf16 v[92:95], a[76:79], a[124:127], v[92:95]
    v_mfma_f32_16x16x32_bf16 v[88:91], a[76:79], a[120:123], v[88:91]
    ds_read_b128 a[76:79], v2 offset:39936
    s_waitcnt vmcnt(12)
    s_waitcnt lgkmcnt(7)
    v_mfma_f32_16x16x32_bf16 v[64:67], a[48:51], a[128:131], v[64:67]
    buffer_load_dwordx4 a[120:123], v8, s[4:7], s62 offen offset:2048 sc1
    v_mfma_f32_16x16x32_bf16 v[68:71], a[48:51], a[132:135], v[68:71]
    ds_read_b128 a[48:51], v2 offset:40960
    s_waitcnt lgkmcnt(7)
    v_mfma_f32_16x16x32_bf16 v[76:79], a[52:55], a[132:135], v[76:79]
    v_mfma_f32_16x16x32_bf16 v[72:75], a[52:55], a[128:131], v[72:75]
    ds_read_b128 a[52:55], v2 offset:41984
    s_waitcnt lgkmcnt(7)
    v_mfma_f32_16x16x32_bf16 v[80:83], a[56:59], a[128:131], v[80:83]
    buffer_load_dwordx4 a[124:127], v9, s[4:7], s62 offen offset:2048 sc1
    v_mfma_f32_16x16x32_bf16 v[84:87], a[56:59], a[132:135], v[84:87]
    ds_read_b128 a[56:59], v2 offset:43008
    s_waitcnt lgkmcnt(7)
    v_mfma_f32_16x16x32_bf16 v[92:95], a[60:63], a[132:135], v[92:95]
    v_mfma_f32_16x16x32_bf16 v[88:91], a[60:63], a[128:131], v[88:91]
    ds_read_b128 a[60:63], v2 offset:44032
    s_waitcnt vmcnt(12)
    s_waitcnt lgkmcnt(7)
    v_mfma_f32_16x16x32_bf16 v[64:67], a[64:67], a[80:83], v[64:67]
    buffer_load_dwordx4 a[128:131], v8, s[4:7], s62 offen offset:3072 sc1
    v_mfma_f32_16x16x32_bf16 v[68:71], a[64:67], a[84:87], v[68:71]
    ds_read_b128 a[64:67], v2 offset:45056
    s_waitcnt lgkmcnt(7)
    v_mfma_f32_16x16x32_bf16 v[76:79], a[68:71], a[84:87], v[76:79]
    v_mfma_f32_16x16x32_bf16 v[72:75], a[68:71], a[80:83], v[72:75]
    ds_read_b128 a[68:71], v2 offset:46080
    s_waitcnt lgkmcnt(7)
    v_mfma_f32_16x16x32_bf16 v[80:83], a[72:75], a[80:83], v[80:83]
    buffer_load_dwordx4 a[132:135], v9, s[4:7], s62 offen offset:3072 sc1
    v_mfma_f32_16x16x32_bf16 v[84:87], a[72:75], a[84:87], v[84:87]
    ds_read_b128 a[72:75], v2 offset:47104
    s_waitcnt lgkmcnt(7)
    v_mfma_f32_16x16x32_bf16 v[92:95], a[76:79], a[84:87], v[92:95]
    v_mfma_f32_16x16x32_bf16 v[88:91], a[76:79], a[80:83], v[88:91]
    ds_read_b128 a[76:79], v2 offset:48128
    s_waitcnt vmcnt(12)
    s_waitcnt lgkmcnt(7)
    v_mfma_f32_16x16x32_bf16 v[64:67], a[48:51], a[88:91], v[64:67]
    s_mov_b32 s62, 29388800
    buffer_load_dwordx4 a[80:83], v8, s[4:7], s62 offen offset:0 sc1
    v_mfma_f32_16x16x32_bf16 v[68:71], a[48:51], a[92:95], v[68:71]
    ds_read_b128 a[48:51], v2 offset:49152
    s_waitcnt lgkmcnt(7)
    v_mfma_f32_16x16x32_bf16 v[76:79], a[52:55], a[92:95], v[76:79]
    v_mfma_f32_16x16x32_bf16 v[72:75], a[52:55], a[88:91], v[72:75]
    ds_read_b128 a[52:55], v2 offset:50176
    s_waitcnt lgkmcnt(7)
    v_mfma_f32_16x16x32_bf16 v[80:83], a[56:59], a[88:91], v[80:83]
    buffer_load_dwordx4 a[84:87], v9, s[4:7], s62 offen offset:0 sc1
    v_mfma_f32_16x16x32_bf16 v[84:87], a[56:59], a[92:95], v[84:87]
    ds_read_b128 a[56:59], v2 offset:51200
    s_waitcnt lgkmcnt(7)
    v_mfma_f32_16x16x32_bf16 v[92:95], a[60:63], a[92:95], v[92:95]
    v_mfma_f32_16x16x32_bf16 v[88:91], a[60:63], a[88:91], v[88:91]
    ds_read_b128 a[60:63], v2 offset:52224
    s_waitcnt vmcnt(12)
    s_waitcnt lgkmcnt(7)
    v_mfma_f32_16x16x32_bf16 v[64:67], a[64:67], a[96:99], v[64:67]
    buffer_load_dwordx4 a[88:91], v8, s[4:7], s62 offen offset:1024 sc1
    v_mfma_f32_16x16x32_bf16 v[68:71], a[64:67], a[100:103], v[68:71]
    ds_read_b128 a[64:67], v2 offset:53248
    s_waitcnt lgkmcnt(7)
    v_mfma_f32_16x16x32_bf16 v[76:79], a[68:71], a[100:103], v[76:79]
    v_mfma_f32_16x16x32_bf16 v[72:75], a[68:71], a[96:99], v[72:75]
    ds_read_b128 a[68:71], v2 offset:54272
    s_waitcnt lgkmcnt(7)
    v_mfma_f32_16x16x32_bf16 v[80:83], a[72:75], a[96:99], v[80:83]
    buffer_load_dwordx4 a[92:95], v8, s[4:7], s62 offen offset:2048 sc1
    v_mfma_f32_16x16x32_bf16 v[84:87], a[72:75], a[100:103], v[84:87]
    ds_read_b128 a[72:75], v2 offset:55296
    s_waitcnt lgkmcnt(7)
    v_mfma_f32_16x16x32_bf16 v[92:95], a[76:79], a[100:103], v[92:95]
    v_mfma_f32_16x16x32_bf16 v[88:91], a[76:79], a[96:99], v[88:91]
    ds_read_b128 a[76:79], v2 offset:56320
    s_waitcnt vmcnt(11)
    s_waitcnt lgkmcnt(7)
    v_mfma_f32_16x16x32_bf16 v[64:67], a[48:51], a[104:107], v[64:67]
    buffer_load_dwordx4 a[96:99], v8, s[4:7], s62 offen offset:3072 sc1
    v_mfma_f32_16x16x32_bf16 v[68:71], a[48:51], a[108:111], v[68:71]
    ds_read_b128 a[48:51], v2 offset:57344
    s_waitcnt lgkmcnt(7)
    v_mfma_f32_16x16x32_bf16 v[76:79], a[52:55], a[108:111], v[76:79]
    v_mfma_f32_16x16x32_bf16 v[72:75], a[52:55], a[104:107], v[72:75]
    ds_read_b128 a[52:55], v2 offset:58368
    s_waitcnt lgkmcnt(7)
    v_mfma_f32_16x16x32_bf16 v[80:83], a[56:59], a[104:107], v[80:83]
    buffer_load_dwordx4 a[100:103], v9, s[4:7], s62 offen offset:1024 sc1
    v_mfma_f32_16x16x32_bf16 v[84:87], a[56:59], a[108:111], v[84:87]
    ds_read_b128 a[56:59], v2 offset:59392
    s_waitcnt lgkmcnt(7)
    v_mfma_f32_16x16x32_bf16 v[92:95], a[60:63], a[108:111], v[92:95]
    v_mfma_f32_16x16x32_bf16 v[88:91], a[60:63], a[104:107], v[88:91]
    ds_read_b128 a[60:63], v2 offset:60416
    s_waitcnt vmcnt(10)
    v_and_b32 v216, v216, v217
    v_and_b32 v218, v218, v219
    v_and_b32 v216, v216, v218
    v_cmp_ne_u32 vcc, 1, v216
    s_cbranch_vccnz L_rt_11
L_rtd_12:
    s_waitcnt lgkmcnt(7)
    v_mfma_f32_16x16x32_bf16 v[64:67], a[64:67], a[112:115], v[64:67]
    buffer_load_dwordx4 a[104:107], v9, s[4:7], s62 offen offset:2048 sc1
    v_mfma_f32_16x16x32_bf16 v[68:71], a[64:67], a[116:119], v[68:71]
    ds_read_b128 a[64:67], v2 offset:61440
    s_waitcnt lgkmcnt(7)
    v_mfma_f32_16x16x32_bf16 v[76:79], a[68:71], a[116:119], v[76:79]
    v_mfma_f32_16x16x32_bf16 v[72:75], a[68:71], a[112:115], v[72:75]
    ds_read_b128 a[68:71], v2 offset:62464
    s_waitcnt lgkmcnt(7)
    v_mfma_f32_16x16x32_bf16 v[80:83], a[72:75], a[112:115], v[80:83]
    buffer_load_dwordx4 a[108:111], v9, s[4:7], s62 offen offset:3072 sc1
    v_mfma_f32_16x16x32_bf16 v[84:87], a[72:75], a[116:119], v[84:87]
    ds_read_b128 a[72:75], v2 offset:63488
    s_waitcnt lgkmcnt(7)
    v_mfma_f32_16x16x32_bf16 v[92:95], a[76:79], a[116:119], v[92:95]
    v_mfma_f32_16x16x32_bf16 v[88:91], a[76:79], a[112:115], v[88:91]
    ds_read_b128 a[76:79], v2 offset:64512
    s_waitcnt vmcnt(10)
    s_waitcnt lgkmcnt(7)
    v_mfma_f32_16x16x32_bf16 v[64:67], a[48:51], a[120:123], v[64:67]
    s_add_u32 m0, s57, 49152
    s_add_u32 s63, s95, 14680064
    buffer_load_dwordx4 v10, s[4:7], s63 offen offset:0 lds
    v_mfma_f32_16x16x32_bf16 v[68:71], a[48:51], a[124:127], v[68:71]
    ds_read_b128 a[48:51], v3 offset:0
    s_waitcnt lgkmcnt(7)
    v_mfma_f32_16x16x32_bf16 v[76:79], a[52:55], a[124:127], v[76:79]
    v_mfma_f32_16x16x32_bf16 v[72:75], a[52:55], a[120:123], v[72:75]
    ds_read_b128 a[52:55], v3 offset:1024
    s_waitcnt lgkmcnt(7)
    v_mfma_f32_16x16x32_bf16 v[80:83], a[56:59], a[120:123], v[80:83]
    buffer_load_dwordx4 v10, s[4:7], s63 offen offset:1024 lds
    v_mfma_f32_16x16x32_bf16 v[84:87], a[56:59], a[124:127], v[84:87]
    ds_read_b128 a[56:59], v3 offset:2048
    s_waitcnt lgkmcnt(7)
    v_mfma_f32_16x16x32_bf16 v[92:95], a[60:63], a[124:127], v[92:95]
    v_mfma_f32_16x16x32_bf16 v[88:91], a[60:63], a[120:123], v[88:91]
    ds_read_b128 a[60:63], v3 offset:3072
    s_waitcnt vmcnt(10)
    s_waitcnt lgkmcnt(7)
    v_mfma_f32_16x16x32_bf16 v[64:67], a[64:67], a[128:131], v[64:67]
    buffer_load_dwordx4 v10, s[4:7], s63 offen offset:2048 lds
    v_mfma_f32_16x16x32_bf16 v[68:71], a[64:67], a[132:135], v[68:71]
    ds_read_b128 a[64:67], v3 offset:4096
    s_waitcnt lgkmcnt(7)
    v_mfma_f32_16x16x32_bf16 v[76:79], a[68:71], a[132:135], v[76:79]
    v_mfma_f32_16x16x32_bf16 v[72:75], a[68:71], a[128:131], v[72:75]
    ds_read_b128 a[68:71], v3 offset:5120
    s_waitcnt lgkmcnt(7)
    v_mfma_f32_16x16x32_bf16 v[80:83], a[72:75], a[128:131], v[80:83]
    buffer_load_dwordx4 v10, s[4:7], s63 offen offset:3072 lds
    v_mfma_f32_16x16x32_bf16 v[84:87], a[72:75], a[132:135], v[84:87]
    ds_read_b128 a[72:75], v3 offset:6144
    s_waitcnt lgkmcnt(7)
    v_mfma_f32_16x16x32_bf16 v[92:95], a[76:79], a[132:135], v[92:95]
    v_mfma_f32_16x16x32_bf16 v[88:91], a[76:79], a[128:131], v[88:91]
    ds_read_b128 a[76:79], v3 offset:7168
    s_waitcnt vmcnt(10)
    s_waitcnt lgkmcnt(7)
    v_mfma_f32_16x16x32_bf16 v[64:67], a[48:51], a[80:83], v[64:67]
    s_add_u32 m0, s57, 53248
    s_add_u32 s63, s95, 14684160
    buffer_load_dwordx4 v10, s[4:7], s63 offen offset:0 lds
    v_mfma_f32_16x16x32_bf16 v[68:71], a[48:51], a[84:87], v[68:71]
    ds_read_b128 a[48:51], v3 offset:8192
    s_waitcnt lgkmcnt(7)
    v_mfma_f32_16x16x32_bf16 v[76:79], a[52:55], a[84:87], v[76:79]
    v_mfma_f32_16x16x32_bf16 v[72:75], a[52:55], a[80:83], v[72:75]
    ds_read_b128 a[52:55], v3 offset:9216
    s_waitcnt lgkmcnt(7)
    v_mfma_f32_16x16x32_bf16 v[80:83], a[56:59], a[80:83], v[80:83]
    buffer_load_dwordx4 v10, s[4:7], s63 offen offset:1024 lds
    v_mfma_f32_16x16x32_bf16 v[84:87], a[56:59], a[84:87], v[84:87]
    ds_read_b128 a[56:59], v3 offset:10240
    s_waitcnt lgkmcnt(7)
    v_mfma_f32_16x16x32_bf16 v[92:95], a[60:63], a[84:87], v[92:95]
    v_mfma_f32_16x16x32_bf16 v[88:91], a[60:63], a[80:83], v[88:91]
    ds_read_b128 a[60:63], v3 offset:11264
    s_waitcnt vmcnt(11)
    s_waitcnt lgkmcnt(7)
    v_mfma_f32_16x16x32_bf16 v[64:67], a[64:67], a[88:91], v[64:67]
    ds_read_b128 a[64:67], v3 offset:12288
    s_waitcnt lgkmcnt(7)
    v_mfma_f32_16x16x32_bf16 v[72:75], a[68:71], a[88:91], v[72:75]
    ds_read_b128 a[68:71], v3 offset:13312
    s_waitcnt lgkmcnt(7)
    v_mfma_f32_16x16x32_bf16 v[80:83], a[72:75], a[88:91], v[80:83]
    ds_read_b128 a[72:75], v3 offset:14336
    s_waitcnt lgkmcnt(7)
    v_mfma_f32_16x16x32_bf16 v[88:91], a[76:79], a[88:91], v[88:91]
    ds_read_b128 a[76:79], v3 offset:15360
    s_waitcnt vmcnt(10)
    s_waitcnt lgkmcnt(7)
    v_mfma_f32_16x16x32_bf16 v[64:67], a[48:51], a[92:95], v[64:67]
    ds_read_b128 a[48:51], v3 offset:4096
    s_waitcnt lgkmcnt(7)
    v_mfma_f32_16x16x32_bf16 v[72:75], a[52:55], a[92:95], v[72:75]
    ds_read_b128 a[52:55], v3 offset:5120
    s_waitcnt lgkmcnt(7)
    v_mfma_f32_16x16x32_bf16 v[80:83], a[56:59], a[92:95], v[80:83]
    ds_read_b128 a[56:59], v3 offset:6144
    s_waitcnt lgkmcnt(7)
    v_mfma_f32_16x16x32_bf16 v[88:91], a[60:63], a[92:95], v[88:91]
    ds_read_b128 a[60:63], v3 offset:7168
    s_waitcnt vmcnt(9)
    s_waitcnt lgkmcnt(7)
    v_mfma_f32_16x16x32_bf16 v[64:67], a[64:67], a[96:99], v[64:67]
    ds_read_b128 a[64:67], v3 offset:8192
    s_waitcnt lgkmcnt(7)
    v_mfma_f32_16x16x32_bf16 v[72:75], a[68:71], a[96:99], v[72:75]
    ds_read_b128 a[68:71], v3 offset:9216
    s_waitcnt lgkmcnt(7)
    v_mfma_f32_16x16x32_bf16 v[80:83], a[72:75], a[96:99], v[80:83]
    ds_read_b128 a[72:75], v3 offset:10240
    s_waitcnt lgkmcnt(7)
    v_mfma_f32_16x16x32_bf16 v[88:91], a[76:79], a[96:99], v[88:91]
    ds_read_b128 a[76:79], v3 offset:11264
    s_waitcnt vmcnt(8)
    s_waitcnt lgkmcnt(7)
    v_mfma_f32_16x16x32_bf16 v[68:71], a[48:51], a[100:103], v[68:71]
    ds_read_b128 a[48:51], v3 offset:12288
    s_waitcnt lgkmcnt(7)
    v_mfma_f32_16x16x32_bf16 v[76:79], a[52:55], a[100:103], v[76:79]
    v_cvt_pk_bf16_f32 v16, v64, v65
    v_cvt_pk_bf16_f32 v17, v66, v67
    ds_read_b128 a[52:55], v3 offset:13312
    s_waitcnt lgkmcnt(7)
    v_mfma_f32_16x16x32_bf16 v[84:87], a[56:59], a[100:103], v[84:87]
    v_cvt_pk_bf16_f32 v18, v72, v73
    v_cvt_pk_bf16_f32 v19, v74, v75
    ds_read_b128 a[56:59], v3 offset:14336
    s_waitcnt lgkmcnt(7)
    v_mfma_f32_16x16x32_bf16 v[92:95], a[60:63], a[100:103], v[92:95]
    v_cvt_pk_bf16_f32 v20, v80, v81
    v_cvt_pk_bf16_f32 v21, v82, v83
    ds_read_b128 a[60:63], v3 offset:15360
    s_waitcnt vmcnt(7)
    s_waitcnt lgkmcnt(7)
    v_mfma_f32_16x16x32_bf16 v[68:71], a[64:67], a[104:107], v[68:71]
    v_cvt_pk_bf16_f32 v22, v88, v89
    v_cvt_pk_bf16_f32 v23, v90, v91
    s_waitcnt lgkmcnt(6)
    v_mfma_f32_16x16x32_bf16 v[76:79], a[68:71], a[104:107], v[76:79]
    v_mfma_f32_16x16x32_bf16 v[164:167], v[16:19], v[16:19], 0
    s_waitcnt lgkmcnt(5)
    v_mfma_f32_16x16x32_bf16 v[84:87], a[72:75], a[104:107], v[84:87]
    s_cmp_lg_u32 s15, 0
    s_cbranch_scc1 L_slow_13
    buffer_store_dwordx4 v[16:19], v8, s[4:7], s35 offen offset:0
L_done_14:
    s_waitcnt lgkmcnt(4)
    v_mfma_f32_16x16x32_bf16 v[92:95], a[76:79], a[104:107], v[92:95]
    v_mfma_f32_16x16x32_bf16 v[160:163], v[40:43], v[16:19], 0
    s_waitcnt vmcnt(7)
    s_waitcnt lgkmcnt(3)
    v_mfma_f32_16x16x32_bf16 v[68:71], a[48:51], a[108:111], v[68:71]
    v_mfma_f32_16x16x32_bf16 v[164:167], v[20:23], v[20:23], v[164:167]
    s_waitcnt lgkmcnt(2)
    v_mfma_f32_16x16x32_bf16 v[76:79], a[52:55], a[108:111], v[76:79]
    s_cmp_lg_u32 s15, 0
    s_cbranch_scc1 L_slow_15
    buffer_store_dwordx4 v[20:23], v8, s[4:7], s35 offen offset:1024
L_done_16:
    s_waitcnt lgkmcnt(1)
    v_mfma_f32_16x16x32_bf16 v[84:87], a[56:59], a[108:111], v[84:87]
    v_mfma_f32_16x16x32_bf16 v[160:163], v[40:43], v[20:23], v[160:163]
    s_waitcnt lgkmcnt(0)
    v_mfma_f32_16x16x32_bf16 v[92:95], a[60:63], a[108:111], v[92:95]
    s_cmp_lg_u32 s15, 0
    s_cbranch_scc1 L_slow_17
    v_cndmask_b32 v164, v164, v165, s[36:37]
    v_cndmask_b32 v166, v166, v167, s[36:37]
    s_nop 1
    v_cndmask_b32 v161, v164, v166, s[38:39]
    s_mov_b64 exec, s[40:41]
    buffer_store_dwordx2 v[160:161], v14, s[4:7], s56 offen offset:0
    s_mov_b64 exec, -1
L_done_18:
    v_cvt_pk_bf16_f32 v24, v68, v69
    v_cvt_pk_bf16_f32 v25, v70, v71
    v_cvt_pk_bf16_f32 v26, v76, v77
    v_cvt_pk_bf16_f32 v27, v78, v79
    v_cvt_pk_bf16_f32 v28, v84, v85
    v_cvt_pk_bf16_f32 v29, v86, v87
    v_cvt_pk_bf16_f32 v30, v92, v93
    v_cvt_pk_bf16_f32 v31, v94, v95
    s_cmp_lg_u32 s15, 0
    s_cbranch_scc1 L_slow_19
    v_mfma_f32_16x16x32_bf16 v[172:175], v[24:27], v[24:27], 0
    buffer_store_dwordx4 v[24:27], v9, s[4:7], s35 offen offset:0
    v_mfma_f32_16x16x32_bf16 v[168:171], v[40:43], v[24:27], 0
    v_mfma_f32_16x16x32_bf16 v[172:175], v[28:31], v[28:31], v[172:175]
    buffer_store_dwordx4 v[28:31], v9, s[4:7], s35 offen offset:1024
    v_mfma_f32_16x16x32_bf16 v[168:171], v[40:43], v[28:31], v[168:171]
    s_nop 5
    v_cndmask_b32 v172, v172, v173, s[36:37]
    v_cndmask_b32 v174, v174, v175, s[36:37]
    v_cndmask_b32 v169, v172, v174, s[38:39]
    s_mov_b64 exec, s[40:41]
    buffer_store_dwordx2 v[168:169], v14, s[4:7], s56 offen offset:128
    s_mov_b64 exec, -1
L_done_20:
    ds_write_b128 v0, a[24:27] offset:24576
    ds_write_b128 v0, a[28:31] offset:25600
    ds_write_b128 v0, a[32:35] offset:26624
    ds_write_b128 v0, a[36:39] offset:27648
    buffer_load_dword v216, v12, s[4:7], s32 offen sc1
    ds_write_b128 v0, a[40:43] offset:28672
    ds_write_b128 v0, a[44:47] offset:29696
    s_mov_b64 exec, 1
    s_waitcnt vmcnt(1)
    s_cmp_lg_u32 s15, 0
    s_cbranch_scc1 L_slow_22
    buffer_store_dword v63, off, s[4:7], s33
L_done_23:
    s_mov_b64 exec, -1
    s_waitcnt vmcnt(1)
    s_mov_b64 exec, s[66:67]
    v_cmp_gt_u32 vcc, 1, v216
    s_mov_b64 exec, -1
    s_cbranch_vccz L_hd_21
    s_mov_b32 s61, 1048576
L_spin_24:
    buffer_load_dword v216, v12, s[4:7], s32 offen sc1
    s_sub_u32 s61, s61, 1
    s_waitcnt vmcnt(0)
    s_mov_b64 exec, s[68:69]
    v_cmp_gt_u32 vcc, 1, v216
    s_mov_b64 exec, -1
    s_cbranch_scc1 L_spind_25
    s_cbranch_vccnz L_spin_24
L_spind_25:
L_hd_21:
L_layer1:
    buffer_load_dwordx4 a[48:51], v4, s[4:7], s86 offen offset:0 sc1
    buffer_load_dwordx4 a[52:55], v5, s[4:7], s86 offen offset:0 sc1
    buffer_load_dwordx4 a[56:59], v6, s[4:7], s86 offen offset:0 sc1
    buffer_load_dwordx4 a[60:63], v7, s[4:7], s86 offen offset:0 sc1
    buffer_load_dwordx4 a[64:67], v4, s[4:7], s86 offen offset:1024 sc1
    buffer_load_dwordx4 a[68:71], v5, s[4:7], s86 offen offset:1024 sc1
    buffer_load_dwordx4 a[72:75], v6, s[4:7], s86 offen offset:1024 sc1
    buffer_load_dwordx4 a[76:79], v7, s[4:7], s86 offen offset:1024 sc1
    buffer_load_dwordx4 a[80:83], v4, s[4:7], s86 offen offset:2048 sc1
    buffer_load_dwordx4 a[84:87], v5, s[4:7], s86 offen offset:2048 sc1
    buffer_load_dwordx4 a[88:91], v6, s[4:7], s86 offen offset:2048 sc1
    buffer_load_dwordx4 a[92:95], v7, s[4:7], s86 offen offset:2048 sc1
    buffer_load_dword v216, v12, s[4:7], s32 offen sc1
    s_waitcnt lgkmcnt(0)
    s_barrier
    ds_read_b128 v[192:195], v1 offset:24576
    ds_read_b128 v[196:199], v1 offset:25600
    ds_read_b128 v[200:203], v1 offset:26624
    ds_read_b128 v[204:207], v1 offset:27648
    ds_read_b128 v[208:211], v1 offset:28672
    ds_read_b128 v[212:215], v1 offset:29696
    s_waitcnt vmcnt(9)
    s_waitcnt lgkmcnt(5)
    v_mfma_f32_16x16x32_bf16 v[64:67], v[192:195], a[48:51], 0
    v_mfma_f32_16x16x32_bf16 v[68:71], v[192:195], a[52:55], 0
    buffer_load_dwordx4 a[96:99], v4, s[4:7], s86 offen offset:3072 sc1
    v_mfma_f32_16x16x32_bf16 v[72:75], v[192:195], a[56:59], 0
    v_mfma_f32_16x16x32_bf16 v[76:79], v[192:195], a[60:63], 0
    ds_read_b128 v[192:195], v1 offset:30720
    s_waitcnt lgkmcnt(5)
    v_mfma_f32_16x16x32_bf16 v[92:95], v[196:199], a[60:63], 0
    v_mfma_f32_16x16x32_bf16 v[88:91], v[196:199], a[56:59], 0
    buffer_load_dwordx4 a[100:103], v5, s[4:7], s86 offen offset:3072 sc1
    v_mfma_f32_16x16x32_bf16 v[84:87], v[196:199], a[52:55], 0
    v_mfma_f32_16x16x32_bf16 v[80:83], v[196:199], a[48:51], 0
    ds_read_b128 v[196:199], v1 offset:31744
    s_waitcnt lgkmcnt(5)
    v_mfma_f32_16x16x32_bf16 v[96:99], v[200:203], a[48:51], 0
    v_mfma_f32_16x16x32_bf16 v[100:103], v[200:203], a[52:55], 0
    buffer_load_dwordx4 a[104:107], v6, s[4:7], s86 offen offset:3072 sc1
    v_mfma_f32_16x16x32_bf16 v[104:107], v[200:203], a[56:59], 0
    v_mfma_f32_16x16x32_bf16 v[108:111], v[200:203], a[60:63], 0
    ds_read_b128 v[200:203], v1 offset:32768
    s_waitcnt lgkmcnt(5)
    v_mfma_f32_16x16x32_bf16 v[124:127], v[204:207], a[60:63], 0
    v_mfma_f32_16x16x32_bf16 v[120:123], v[204:207], a[56:59], 0
    buffer_load_dwordx4 a[108:111], v7, s[4:7], s86 offen offset:3072 sc1
    v_mfma_f32_16x16x32_bf16 v[116:119], v[204:207], a[52:55], 0
    v_mfma_f32_16x16x32_bf16 v[112:115], v[204:207], a[48:51], 0
    ds_read_b128 v[204:207], v1 offset:33792
    s_waitcnt lgkmcnt(5)
    v_mfma_f32_16x16x32_bf16 v[128:131], a[48:51], v[208:211], 0
    v_mfma_f32_16x16x32_bf16 v[132:135], a[52:55], v[208:211], 0
    v_mfma_f32_16x16x32_bf16 v[136:139], a[56:59], v[208:211], 0
    v_mfma_f32_16x16x32_bf16 v[140:143], a[60:63], v[208:211], 0
    ds_read_b128 v[208:211], v1 offset:34816
    s_waitcnt lgkmcnt(5)
    v_mfma_f32_16x16x32_bf16 v[156:159], a[60:63], v[212:215], 0
    v_mfma_f32_16x16x32_bf16 v[152:155], a[56:59], v[212:215], 0
    v_mfma_f32_16x16x32_bf16 v[148:151], a[52:55], v[212:215], 0
    v_mfma_f32_16x16x32_bf16 v[144:147], a[48:51], v[212:215], 0
    ds_read_b128 v[212:215], v1 offset:35840
    s_waitcnt vmcnt(9)
    s_waitcnt vmcnt(4)
    v_cmp_gt_u32 vcc, 1, v216
    s_cbranch_vccnz L_p2_26
L_p2_26_r:
    s_waitcnt lgkmcnt(5)
    v_mfma_f32_16x16x32_bf16 v[64:67], v[192:195], a[64:67], v[64:67]
    v_mfma_f32_16x16x32_bf16 v[68:71], v[192:195], a[68:71], v[68:71]
    buffer_load_dwordx4 a[48:51], v4, s[4:7], s87 offen offset:0 sc1
    v_mfma_f32_16x16x32_bf16 v[72:75], v[192:195], a[72:75], v[72:75]
    v_mfma_f32_16x16x32_bf16 v[76:79], v[192:195], a[76:79], v[76:79]
    ds_read_b128 v[192:195], v1 offset:36864
    s_waitcnt lgkmcnt(5)
    v_mfma_f32_16x16x32_bf16 v[92:95], v[196:199], a[76:79], v[92:95]
    s_add_u32 m0, s57, 73728
    s_add_u32 s63, s96, 14680064
    v_mfma_f32_16x16x32_bf16 v[88:91], v[196:199], a[72:75], v[88:91]
    buffer_load_dwordx4 v10, s[4:7], s63 offen offset:0 lds
    v_mfma_f32_16x16x32_bf16 v[84:87], v[196:199], a[68:71], v[84:87]
    v_mfma_f32_16x16x32_bf16 v[80:83], v[196:199], a[64:67], v[80:83]
    ds_read_b128 v[196:199], v1 offset:37888
    s_waitcnt lgkmcnt(5)
    v_mfma_f32_16x16x32_bf16 v[96:99], v[200:203], a[64:67], v[96:99]
    v_mfma_f32_16x16x32_bf16 v[100:103], v[200:203], a[68:71], v[100:103]
    buffer_load_dwordx4 a[52:55], v5, s[4:7], s87 offen offset:0 sc1
    v_mfma_f32_16x16x32_bf16 v[104:107], v[200:203], a[72:75], v[104:107]
    v_mfma_f32_16x16x32_bf16 v[108:111], v[200:203], a[76:79], v[108:111]
    ds_read_b128 v[200:203], v1 offset:38912
    s_waitcnt lgkmcnt(5)
    v_mfma_f32_16x16x32_bf16 v[124:127], v[204:207], a[76:79], v[124:127]
    v_mfma_f32_16x16x32_bf16 v[120:123], v[204:207], a[72:75], v[120:123]
    buffer_load_dwordx4 a[56:59], v6, s[4:7], s87 offen offset:0 sc1
    v_mfma_f32_16x16x32_bf16 v[116:119], v[204:207], a[68:71], v[116:119]
    v_mfma_f32_16x16x32_bf16 v[112:115], v[204:207], a[64:67], v[112:115]
    ds_read_b128 v[204:207], v1 offset:39936
    s_waitcnt lgkmcnt(5)
    v_mfma_f32_16x16x32_bf16 v[128:131], a[64:67], v[208:211], v[128:131]
    v_mfma_f32_16x16x32_bf16 v[132:135], a[68:71], v[208:211], v[132:135]
    buffer_load_dwordx4 v10, s[4:7], s63 offen offset:1024 lds
    v_mfma_f32_16x16x32_bf16 v[136:139], a[72:75], v[208:211], v[136:139]
    v_mfma_f32_16x16x32_bf16 v[140:143], a[76:79], v[208:211], v[140:143]
    ds_read_b128 v[208:211], v1 offset:40960
    s_waitcnt lgkmcnt(5)
    v_mfma_f32_16x16x32_bf16 v[156:159], a[76:79], v[212:215], v[156:159]
    v_mfma_f32_16x16x32_bf16 v[152:155], a[72:75], v[212:215], v[152:155]
    buffer_load_dwordx4 a[60:63], v7, s[4:7], s87 offen offset:0 sc1
    v_mfma_f32_16x16x32_bf16 v[148:151], a[68:71], v[212:215], v[148:151]
    v_mfma_f32_16x16x32_bf16 v[144:147], a[64:67], v[212:215], v[144:147]
    ds_read_b128 v[212:215], v1 offset:41984
    s_waitcnt lgkmcnt(5)
    v_mfma_f32_16x16x32_bf16 v[64:67], v[192:195], a[80:83], v[64:67]
    v_mfma_f32_16x16x32_bf16 v[68:71], v[192:195], a[84:87], v[68:71]
    buffer_load_dwordx4 a[64:67], v4, s[4:7], s87 offen offset:1024 sc1
    v_mfma_f32_16x16x32_bf16 v[72:75], v[192:195], a[88:91], v[72:75]
    v_mfma_f32_16x16x32_bf16 v[76:79], v[192:195], a[92:95], v[76:79]
    ds_read_b128 v[192:195], v1 offset:43008
    s_waitcnt lgkmcnt(5)
    v_mfma_f32_16x16x32_bf16 v[92:95], v[196:199], a[92:95], v[92:95]
    v_mfma_f32_16x16x32_bf16 v[88:91], v[196:199], a[88:91], v[88:91]
    buffer_load_dwordx4 v10, s[4:7], s63 offen offset:2048 lds
    v_mfma_f32_16x16x32_bf16 v[84:87], v[196:199], a[84:87], v[84:87]
    v_mfma_f32_16x16x32_bf16 v[80:83], v[196:199], a[80:83], v[80:83]
    ds_read_b128 v[196:199], v1 offset:44032
    s_waitcnt lgkmcnt(5)
    v_mfma_f32_16x16x32_bf16 v[96:99], v[200:203], a[80:83], v[96:99]
    v_mfma_f32_16x16x32_bf16 v[100:103], v[200:203], a[84:87], v[100:103]
    buffer_load_dwordx4 a[68:71], v5, s[4:7], s87 offen offset:1024 sc1
    v_mfma_f32_16x16x32_bf16 v[104:107], v[200:203], a[88:91], v[104:107]
    v_mfma_f32_16x16x32_bf16 v[108:111], v[200:203], a[92:95], v[108:111]
    ds_read_b128 v[200:203], v1 offset:45056
    s_waitcnt lgkmcnt(5)
    v_mfma_f32_16x16x32_bf16 v[124:127], v[204:207], a[92:95], v[124:127]
    v_mfma_f32_16x16x32_bf16 v[120:123], v[204:207], a[88:91], v[120:123]
    buffer_load_dwordx4 a[72:75], v6, s[4:7], s87 offen offset:1024 sc1
    v_mfma_f32_16x16x32_bf16 v[116:119], v[204:207], a[84:87], v[116:119]
    v_mfma_f32_16x16x32_bf16 v[112:115], v[204:207], a[80:83], v[112:115]
    ds_read_b128 v[204:207], v1 offset:46080
    s_waitcnt lgkmcnt(5)
    v_mfma_f32_16x16x32_bf16 v[128:131], a[80:83], v[208:211], v[128:131]
    s_mov_b32 s19, 1048576
    v_mfma_f32_16x16x32_bf16 v[132:135], a[84:87], v[208:211], v[132:135]
    buffer_load_dwordx4 v[160:163], v13, s[4:7], s19 offen sc1
    v_mfma_f32_16x16x32_bf16 v[136:139], a[88:91], v[208:211], v[136:139]
    v_mfma_f32_16x16x32_bf16 v[140:143], a[92:95], v[208:211], v[140:143]
    ds_read_b128 v[208:211], v1 offset:47104
    s_waitcnt lgkmcnt(5)
    v_mfma_f32_16x16x32_bf16 v[156:159], a[92:95], v[212:215], v[156:159]
    v_mfma_f32_16x16x32_bf16 v[152:155], a[88:91], v[212:215], v[152:155]
    buffer_load_dwordx4 a[76:79], v7, s[4:7], s87 offen offset:1024 sc1
    v_mfma_f32_16x16x32_bf16 v[148:151], a[84:87], v[212:215], v[148:151]
    v_mfma_f32_16x16x32_bf16 v[144:147], a[80:83], v[212:215], v[144:147]
    ds_read_b128 v[212:215], v1 offset:48128
    s_waitcnt vmcnt(12)
    s_barrier
    s_waitcnt lgkmcnt(5)
    v_mfma_f32_16x16x32_bf16 v[64:67], v[192:195], a[96:99], v[64:67]
    v_mfma_f32_16x16x32_bf16 v[68:71], v[192:195], a[100:103], v[68:71]
    buffer_load_dwordx4 a[80:83], v4, s[4:7], s87 offen offset:2048 sc1
    v_mfma_f32_16x16x32_bf16 v[72:75], v[192:195], a[104:107], v[72:75]
    v_mfma_f32_16x16x32_bf16 v[76:79], v[192:195], a[108:111], v[76:79]
    ds_read_b128 v[192:195], v1 offset:49152
    s_waitcnt lgkmcnt(5)
    v_mfma_f32_16x16x32_bf16 v[92:95], v[196:199], a[108:111], v[92:95]
    v_mfma_f32_16x16x32_bf16 v[88:91], v[196:199], a[104:107], v[88:91]
    buffer_load_dwordx4 v10, s[4:7], s63 offen offset:3072 lds
    v_mfma_f32_16x16x32_bf16 v[84:87], v[196:199], a[100:103], v[84:87]
    v_mfma_f32_16x16x32_bf16 v[80:83], v[196:199], a[96:99], v[80:83]
    ds_read_b128 v[196:199], v1 offset:50176
    s_waitcnt lgkmcnt(5)
    v_mfma_f32_16x16x32_bf16 v[96:99], v[200:203], a[96:99], v[96:99]
    v_mfma_f32_16x16x32_bf16 v[100:103], v[200:203], a[100:103], v[100:103]
    buffer_load_dwordx4 a[84:87], v5, s[4:7], s87 offen offset:2048 sc1
    v_mfma_f32_16x16x32_bf16 v[104:107], v[200:203], a[104:107], v[104:107]
    v_mfma_f32_16x16x32_bf16 v[108:111], v[200:203], a[108:111], v[108:111]
    ds_read_b128 v[200:203], v1 offset:51200
    s_waitcnt lgkmcnt(5)
    v_mfma_f32_16x16x32_bf16 v[124:127], v[204:207], a[108:111], v[124:127]
    v_mfma_f32_16x16x32_bf16 v[120:123], v[204:207], a[104:107], v[120:123]
    buffer_load_dwordx4 a[88:91], v6, s[4:7], s87 offen offset:2048 sc1
    v_mfma_f32_16x16x32_bf16 v[116:119], v[204:207], a[100:103], v[116:119]
    v_mfma_f32_16x16x32_bf16 v[112:115], v[204:207], a[96:99], v[112:115]
    ds_read_b128 v[204:207], v1 offset:52224
    s_waitcnt lgkmcnt(5)
    v_mfma_f32_16x16x32_bf16 v[128:131], a[96:99], v[208:211], v[128:131]
    s_add_u32 m0, s57, 77824
    s_add_u32 s63, s96, 14684160
    v_mfma_f32_16x16x32_bf16 v[132:135], a[100:103], v[208:211], v[132:135]
    buffer_load_dwordx4 v10, s[4:7], s63 offen offset:0 lds
    v_mfma_f32_16x16x32_bf16 v[136:139], a[104:107], v[208:211], v[136:139]
    v_mfma_f32_16x16x32_bf16 v[140:143], a[108:111], v[208:211], v[140:143]
    ds_read_b128 v[208:211], v1 offset:53248
    s_waitcnt lgkmcnt(5)
    v_mfma_f32_16x16x32_bf16 v[156:159], a[108:111], v[212:215], v[156:159]
    v_mfma_f32_16x16x32_bf16 v[152:155], a[104:107], v[212:215], v[152:155]
    buffer_load_dwordx4 a[92:95], v7, s[4:7], s87 offen offset:2048 sc1
    v_mfma_f32_16x16x32_bf16 v[148:151], a[100:103], v[212:215], v[148:151]
    v_mfma_f32_16x16x32_bf16 v[144:147], a[96:99], v[212:215], v[144:147]
    ds_read_b128 v[212:215], v1 offset:54272
    s_waitcnt vmcnt(12)
    s_waitcnt lgkmcnt(5)
    v_mfma_f32_16x16x32_bf16 v[64:67], v[192:195], a[48:51], v[64:67]
    v_mfma_f32_16x16x32_bf16 v[68:71], v[192:195], a[52:55], v[68:71]
    buffer_load_dwordx4 a[96:99], v4, s[4:7], s87 offen offset:3072 sc1
    v_mfma_f32_16x16x32_bf16 v[72:75], v[192:195], a[56:59], v[72:75]
    v_mfma_f32_16x16x32_bf16 v[76:79], v[192:195], a[60:63], v[76:79]
    ds_read_b128 v[192:195], v1 offset:55296
    s_waitcnt lgkmcnt(5)
    v_mfma_f32_16x16x32_bf16 v[92:95], v[196:199], a[60:63], v[92:95]
    v_mfma_f32_16x16x32_bf16 v[88:91], v[196:199], a[56:59], v[88:91]
    buffer_load_dwordx4 v10, s[4:7], s63 offen offset:1024 lds
    v_mfma_f32_16x16x32_bf16 v[84:87], v[196:199], a[52:55], v[84:87]
    v_mfma_f32_16x16x32_bf16 v[80:83], v[196:199], a[48:51], v[80:83]
    ds_read_b128 v[196:199], v1 offset:56320
    s_waitcnt lgkmcnt(5)
    v_mfma_f32_16x16x32_bf16 v[96:99], v[200:203], a[48:51], v[96:99]
    v_mfma_f32_16x16x32_bf16 v[100:103], v[200:203], a[52:55], v[100:103]
    buffer_load_dwordx4 a[100:103], v5, s[4:7], s87 offen offset:3072 sc1
    v_mfma_f32_16x16x32_bf16 v[104:107], v[200:203], a[56:59], v[104:107]
    v_mfma_f32_16x16x32_bf16 v[108:111], v[200:203], a[60:63], v[108:111]
    ds_read_b128 v[200:203], v1 offset:57344
    s_waitcnt lgkmcnt(5)
    v_mfma_f32_16x16x32_bf16 v[124:127], v[204:207], a[60:63], v[124:127]
    v_mfma_f32_16x16x32_bf16 v[120:123], v[204:207], a[56:59], v[120:123]
    buffer_load_dwordx4 a[104:107], v6, s[4:7], s87 offen offset:3072 sc1
    v_mfma_f32_16x16x32_bf16 v[116:119], v[204:207], a[52:55], v[116:119]
    buffer_load_dwordx4 v[224:227], v1, s[4:7], s52 offen offset:0 sc1
    v_mfma_f32_16x16x32_bf16 v[112:115], v[204:207], a[48:51], v[112:115]
    ds_read_b128 v[204:207], v1 offset:58368
    s_waitcnt lgkmcnt(5)
    v_mfma_f32_16x16x32_bf16 v[128:131], a[48:51], v[208:211], v[128:131]
    s_mov_b32 s19, 1064960
    v_mfma_f32_16x16x32_bf16 v[132:135], a[52:55], v[208:211], v[132:135]
    buffer_load_dwordx4 v[164:167], v13, s[4:7], s19 offen sc1
    v_mfma_f32_16x16x32_bf16 v[136:139], a[56:59], v[208:211], v[136:139]
    v_mfma_f32_16x16x32_bf16 v[140:143], a[60:63], v[208:211], v[140:143]
    ds_read_b128 v[208:211], v1 offset:59392
    s_waitcnt lgkmcnt(5)
    v_mfma_f32_16x16x32_bf16 v[156:159], a[60:63], v[212:215], v[156:159]
    v_mfma_f32_16x16x32_bf16 v[152:155], a[56:59], v[212:215], v[152:155]
    buffer_load_dwordx4 a[108:111], v7, s[4:7], s87 offen offset:3072 sc1
    v_mfma_f32_16x16x32_bf16 v[148:151], a[52:55], v[212:215], v[148:151]
    v_mfma_f32_16x16x32_bf16 v[144:147], a[48:51], v[212:215], v[144:147]
    ds_read_b128 v[212:215], v1 offset:60416
    s_waitcnt vmcnt(13)
    s_waitcnt lgkmcnt(5)
    v_mfma_f32_16x16x32_bf16 v[64:67], v[192:195], a[64:67], v[64:67]
    v_mfma_f32_16x16x32_bf16 v[68:71], v[192:195], a[68:71], v[68:71]
    buffer_load_dwordx4 a[48:51], v4, s[4:7], s88 offen offset:0 sc1
    v_mfma_f32_16x16x32_bf16 v[72:75], v[192:195], a[72:75], v[72:75]
    v_mfma_f32_16x16x32_bf16 v[76:79], v[192:195], a[76:79], v[76:79]
    ds_read_b128 v[192:195], v1 offset:61440
    s_waitcnt lgkmcnt(5)
    v_mfma_f32_16x16x32_bf16 v[92:95], v[196:199], a[76:79], v[92:95]
    s_add_u32 m0, s57, 98304
    s_add_u32 s63, s97, 14680064
    v_mfma_f32_16x16x32_bf16 v[88:91], v[196:199], a[72:75], v[88:91]
    buffer_load_dwordx4 v10, s[4:7], s63 offen offset:0 lds
    v_mfma_f32_16x16x32_bf16 v[84:87], v[196:199], a[68:71], v[84:87]
    v_mfma_f32_16x16x32_bf16 v[80:83], v[196:199], a[64:67], v[80:83]
    ds_read_b128 v[196:199], v1 offset:62464
    s_waitcnt lgkmcnt(5)
    v_mfma_f32_16x16x32_bf16 v[96:99], v[200:203], a[64:67], v[96:99]
    v_mfma_f32_16x16x32_bf16 v[100:103], v[200:203], a[68:71], v[100:103]
    buffer_load_dwordx4 a[52:55], v5, s[4:7], s88 offen offset:0 sc1
    v_mfma_f32_16x16x32_bf16 v[104:107], v[200:203], a[72:75], v[104:107]
    v_mfma_f32_16x16x32_bf16 v[108:111], v[200:203], a[76:79], v[108:111]
    ds_read_b128 v[200:203], v1 offset:63488
    s_waitcnt lgkmcnt(5)
    v_mfma_f32_16x16x32_bf16 v[124:127], v[204:207], a[76:79], v[124:127]
    v_mfma_f32_16x16x32_bf16 v[120:123], v[204:207], a[72:75], v[120:123]
    buffer_load_dwordx4 a[56:59], v6, s[4:7], s88 offen offset:0 sc1
    v_mfma_f32_16x16x32_bf16 v[116:119], v[204:207], a[68:71], v[116:119]
    buffer_load_dwordx4 v[228:231], v1, s[4:7], s53 offen offset:0 sc1
    v_mfma_f32_16x16x32_bf16 v[112:115], v[204:207], a[64:67], v[112:115]
    ds_read_b128 v[204:207], v1 offset:64512
    s_waitcnt lgkmcnt(5)
    v_mfma_f32_16x16x32_bf16 v[128:131], a[64:67], v[208:211], v[128:131]
    v_mfma_f32_16x16x32_bf16 v[132:135], a[68:71], v[208:211], v[132:135]
    buffer_load_dwordx4 v10, s[4:7], s63 offen offset:1024 lds
    v_mfma_f32_16x16x32_bf16 v[136:139], a[72:75], v[208:211], v[136:139]
    v_mfma_f32_16x16x32_bf16 v[140:143], a[76:79], v[208:211], v[140:143]
    ds_read_b128 v[208:211], v2 offset:0
    s_waitcnt lgkmcnt(5)
    v_mfma_f32_16x16x32_bf16 v[156:159], a[76:79], v[212:215], v[156:159]
    v_mfma_f32_16x16x32_bf16 v[152:155], a[72:75], v[212:215], v[152:155]
    buffer_load_dwordx4 a[60:63], v7, s[4:7], s88 offen offset:0 sc1
    v_mfma_f32_16x16x32_bf16 v[148:151], a[68:71], v[212:215], v[148:151]
    v_mfma_f32_16x16x32_bf16 v[144:147], a[64:67], v[212:215], v[144:147]
    ds_read_b128 v[212:215], v2 offset:1024
    s_waitcnt vmcnt(14)
    s_waitcnt lgkmcnt(5)
    v_mfma_f32_16x16x32_bf16 v[64:67], v[192:195], a[80:83], v[64:67]
    v_mfma_f32_16x16x32_bf16 v[68:71], v[192:195], a[84:87], v[68:71]
    buffer_load_dwordx4 a[64:67], v4, s[4:7], s88 offen offset:1024 sc1
    v_mfma_f32_16x16x32_bf16 v[72:75], v[192:195], a[88:91], v[72:75]
    v_mfma_f32_16x16x32_bf16 v[76:79], v[192:195], a[92:95], v[76:79]
    ds_read_b128 v[192:195], v2 offset:2048
    s_waitcnt lgkmcnt(5)
    v_mfma_f32_16x16x32_bf16 v[92:95], v[196:199], a[92:95], v[92:95]
    v_mfma_f32_16x16x32_bf16 v[88:91], v[196:199], a[88:91], v[88:91]
    buffer_load_dwordx4 v10, s[4:7], s63 offen offset:2048 lds
    v_mfma_f32_16x16x32_bf16 v[84:87], v[196:199], a[84:87], v[84:87]
    v_mfma_f32_16x16x32_bf16 v[80:83], v[196:199], a[80:83], v[80:83]
    ds_read_b128 v[196:199], v2 offset:3072
    s_waitcnt lgkmcnt(5)
    v_mfma_f32_16x16x32_bf16 v[96:99], v[200:203], a[80:83], v[96:99]
    v_mfma_f32_16x16x32_bf16 v[100:103], v[200:203], a[84:87], v[100:103]
    buffer_load_dwordx4 a[68:71], v5, s[4:7], s88 offen offset:1024 sc1
    v_mfma_f32_16x16x32_bf16 v[104:107], v[200:203], a[88:91], v[104:107]
    v_mfma_f32_16x16x32_bf16 v[108:111], v[200:203], a[92:95], v[108:111]
    ds_read_b128 v[200:203], v2 offset:4096
    s_waitcnt lgkmcnt(5)
    v_mfma_f32_16x16x32_bf16 v[124:127], v[204:207], a[92:95], v[124:127]
    v_mfma_f32_16x16x32_bf16 v[120:123], v[204:207], a[88:91], v[120:123]
    buffer_load_dwordx4 a[72:75], v6, s[4:7], s88 offen offset:1024 sc1
    v_mfma_f32_16x16x32_bf16 v[116:119], v[204:207], a[84:87], v[116:119]
    buffer_load_dwordx4 v[232:235], v1, s[4:7], s52 offen offset:1024 sc1
    v_mfma_f32_16x16x32_bf16 v[112:115], v[204:207], a[80:83], v[112:115]
    ds_read_b128 v[204:207], v2 offset:5120
    s_waitcnt lgkmcnt(5)
    v_mfma_f32_16x16x32_bf16 v[128:131], a[80:83], v[208:211], v[128:131]
    s_mov_b32 s19, 1081344
    v_mfma_f32_16x16x32_bf16 v[132:135], a[84:87], v[208:211], v[132:135]
    buffer_load_dwordx4 v[168:171], v13, s[4:7], s19 offen sc1
    v_mfma_f32_16x16x32_bf16 v[136:139], a[88:91], v[208:211], v[136:139]
    v_mfma_f32_16x16x32_bf16 v[140:143], a[92:95], v[208:211], v[140:143]
    ds_read_b128 v[208:211], v2 offset:6144
    s_waitcnt lgkmcnt(5)
    v_mfma_f32_16x16x32_bf16 v[156:159], a[92:95], v[212:215], v[156:159]
    v_mfma_f32_16x16x32_bf16 v[152:155], a[88:91], v[212:215], v[152:155]
    buffer_load_dwordx4 a[76:79], v7, s[4:7], s88 offen offset:1024 sc1
    v_mfma_f32_16x16x32_bf16 v[148:151], a[84:87], v[212:215], v[148:151]
    v_mfma_f32_16x16x32_bf16 v[144:147], a[80:83], v[212:215], v[144:147]
    ds_read_b128 v[212:215], v2 offset:7168
    s_waitcnt vmcnt(14)
    s_barrier
    s_waitcnt lgkmcnt(5)
    v_mfma_f32_16x16x32_bf16 v[64:67], v[192:195], a[96:99], v[64:67]
    v_mfma_f32_16x16x32_bf16 v[68:71], v[192:195], a[100:103], v[68:71]
    buffer_load_dwordx4 a[80:83], v4, s[4:7], s88 offen offset:2048 sc1
    v_mfma_f32_16x16x32_bf16 v[72:75], v[192:195], a[104:107], v[72:75]
    v_mfma_f32_16x16x32_bf16 v[76:79], v[192:195], a[108:111], v[76:79]
    ds_read_b128 v[192:195], v2 offset:8192
    s_waitcnt lgkmcnt(5)
    v_mfma_f32_16x16x32_bf16 v[92:95], v[196:199], a[108:111], v[92:95]
    v_mfma_f32_16x16x32_bf16 v[88:91], v[196:199], a[104:107], v[88:91]
    buffer_load_dwordx4 v10, s[4:7], s63 offen offset:3072 lds
    v_mfma_f32_16x16x32_bf16 v[84:87], v[196:199], a[100:103], v[84:87]
    v_mfma_f32_16x16x32_bf16 v[80:83], v[196:199], a[96:99], v[80:83]
    ds_read_b128 v[196:199], v2 offset:9216
    s_waitcnt lgkmcnt(5)
    v_mfma_f32_16x16x32_bf16 v[96:99], v[200:203], a[96:99], v[96:99]
    v_mfma_f32_16x16x32_bf16 v[100:103], v[200:203], a[100:103], v[100:103]
    buffer_load_dwordx4 a[84:87], v5, s[4:7], s88 offen offset:2048 sc1
    v_mfma_f32_16x16x32_bf16 v[104:107], v[200:203], a[104:107], v[104:107]
    v_mfma_f32_16x16x32_bf16 v[108:111], v[200:203], a[108:111], v[108:111]
    ds_read_b128 v[200:203], v2 offset:10240
    s_waitcnt lgkmcnt(5)
    v_mfma_f32_16x16x32_bf16 v[124:127], v[204:207], a[108:111], v[124:127]
    v_mfma_f32_16x16x32_bf16 v[120:123], v[204:207], a[104:107], v[120:123]
    buffer_load_dwordx4 a[88:91], v6, s[4:7], s88 offen offset:2048 sc1
    v_mfma_f32_16x16x32_bf16 v[116:119], v[204:207], a[100:103], v[116:119]
    buffer_load_dwordx4 v[236:239], v1, s[4:7], s53 offen offset:1024 sc1
    v_mfma_f32_16x16x32_bf16 v[112:115], v[204:207], a[96:99], v[112:115]
    ds_read_b128 v[204:207], v2 offset:11264
    s_waitcnt lgkmcnt(5)
    v_mfma_f32_16x16x32_bf16 v[128:131], a[96:99], v[208:211], v[128:131]
    s_add_u32 m0, s57, 102400
    s_add_u32 s63, s97, 14684160
    v_mfma_f32_16x16x32_bf16 v[132:135], a[100:103], v[208:211], v[132:135]
    buffer_load_dwordx4 v10, s[4:7], s63 offen offset:0 lds
    v_mfma_f32_16x16x32_bf16 v[136:139], a[104:107], v[208:211], v[136:139]
    v_mfma_f32_16x16x32_bf16 v[140:143], a[108:111], v[208:211], v[140:143]
    ds_read_b128 v[208:211], v2 offset:12288
    s_waitcnt lgkmcnt(5)
    v_mfma_f32_16x16x32_bf16 v[156:159], a[108:111], v[212:215], v[156:159]
    v_mfma_f32_16x16x32_bf16 v[152:155], a[104:107], v[212:215], v[152:155]
    buffer_load_dwordx4 a[92:95], v7, s[4:7], s88 offen offset:2048 sc1
    v_mfma_f32_16x16x32_bf16 v[148:151], a[100:103], v[212:215], v[148:151]
    v_mfma_f32_16x16x32_bf16 v[144:147], a[96:99], v[212:215], v[144:147]
    ds_read_b128 v[212:215], v2 offset:13312
    s_waitcnt vmcnt(14)
    s_waitcnt lgkmcnt(5)
    v_mfma_f32_16x16x32_bf16 v[64:67], v[192:195], a[48:51], v[64:67]
    ds_read_b128 a[216:219], v34 offset:0
    v_mfma_f32_16x16x32_bf16 v[68:71], v[192:195], a[52:55], v[68:71]
    buffer_load_dwordx4 a[96:99], v4, s[4:7], s88 offen offset:3072 sc1
    v_mfma_f32_16x16x32_bf16 v[72:75], v[192:195], a[56:59], v[72:75]
    ds_read_b128 a[220:223], v34 offset:1024
    v_mfma_f32_16x16x32_bf16 v[76:79], v[192:195], a[60:63], v[76:79]
    ds_read_b128 v[192:195], v2 offset:14336
    s_waitcnt lgkmcnt(7)
    v_mfma_f32_16x16x32_bf16 v[92:95], v[196:199], a[60:63], v[92:95]
    ds_read_b128 a[224:227], v34 offset:2048
    v_mfma_f32_16x16x32_bf16 v[88:91], v[196:199], a[56:59], v[88:91]
    buffer_load_dwordx4 v10, s[4:7], s63 offen offset:1024 lds
    v_mfma_f32_16x16x32_bf16 v[84:87], v[196:199], a[52:55], v[84:87]
    ds_read_b128 a[228:231], v34 offset:3072
    v_mfma_f32_16x16x32_bf16 v[80:83], v[196:199], a[48:51], v[80:83]
    ds_read_b128 v[196:199], v2 offset:15360
    s_waitcnt lgkmcnt(9)
    v_mfma_f32_16x16x32_bf16 v[96:99], v[200:203], a[48:51], v[96:99]
    ds_read_b128 a[232:235], v34 offset:4096
    v_mfma_f32_16x16x32_bf16 v[100:103], v[200:203], a[52:55], v[100:103]
    buffer_load_dwordx4 a[100:103], v5, s[4:7], s88 offen offset:3072 sc1
    v_mfma_f32_16x16x32_bf16 v[104:107], v[200:203], a[56:59], v[104:107]
    ds_read_b128 a[236:239], v34 offset:5120
    v_mfma_f32_16x16x32_bf16 v[108:111], v[200:203], a[60:63], v[108:111]
    ds_read_b128 v[200:203], v2 offset:16384
    s_waitcnt lgkmcnt(11)
    v_mfma_f32_16x16x32_bf16 v[124:127], v[204:207], a[60:63], v[124:127]
    v_mfma_f32_16x16x32_bf16 v[120:123], v[204:207], a[56:59], v[120:123]
    buffer_load_dwordx4 a[104:107], v6, s[4:7], s88 offen offset:3072 sc1
    v_mfma_f32_16x16x32_bf16 v[116:119], v[204:207], a[52:55], v[116:119]
    v_mfma_f32_16x16x32_bf16 v[112:115], v[204:207], a[48:51], v[112:115]
    ds_read_b128 v[204:207], v2 offset:17408
    s_waitcnt lgkmcnt(11)
    v_mfma_f32_16x16x32_bf16 v[128:131], a[48:51], v[208:211], v[128:131]
    s_mov_b32 s19, 1097728
    v_mfma_f32_16x16x32_bf16 v[132:135], a[52:55], v[208:211], v[132:135]
    buffer_load_dwordx4 v[172:175], v13, s[4:7], s19 offen sc1
    v_mfma_f32_16x16x32_bf16 v[136:139], a[56:59], v[208:211], v[136:139]
    v_mfma_f32_16x16x32_bf16 v[140:143], a[60:63], v[208:211], v[140:143]
    ds_read_b128 v[208:211], v2 offset:18432
    s_waitcnt lgkmcnt(11)
    v_mfma_f32_16x16x32_bf16 v[156:159], a[60:63], v[212:215], v[156:159]
    v_mfma_f32_16x16x32_bf16 v[152:155], a[56:59], v[212:215], v[152:155]
    buffer_load_dwordx4 a[108:111], v7, s[4:7], s88 offen offset:3072 sc1
    v_mfma_f32_16x16x32_bf16 v[148:151], a[52:55], v[212:215], v[148:151]
    v_mfma_f32_16x16x32_bf16 v[144:147], a[48:51], v[212:215], v[144:147]
    ds_read_b128 v[212:215], v2 offset:19456
    s_waitcnt vmcnt(13)
    s_waitcnt lgkmcnt(9)
    v_mfma_f32_16x16x32_bf16 v[64:67], v[192:195], a[64:67], v[64:67]
    v_mfma_f32_16x16x32_bf16 v[68:71], v[192:195], a[68:71], v[68:71]
    buffer_load_dwordx4 a[48:51], v4, s[4:7], s89 offen offset:0 sc1
    v_mfma_f32_16x16x32_bf16 v[72:75], v[192:195], a[72:75], v[72:75]
    v_mfma_f32_16x16x32_bf16 v[76:79], v[192:195], a[76:79], v[76:79]
    ds_read_b128 v[192:195], v2 offset:20480
    s_waitcnt lgkmcnt(7)
    v_mfma_f32_16x16x32_bf16 v[92:95], v[196:199], a[76:79], v[92:95]
    s_add_u32 m0, s57, 122880
    s_add_u32 s63, s98, 14680064
    v_mfma_f32_16x16x32_bf16 v[88:91], v[196:199], a[72:75], v[88:91]
    buffer_load_dwordx4 v10, s[4:7], s63 offen offset:0 lds
    v_mfma_f32_16x16x32_bf16 v[84:87], v[196:199], a[68:71], v[84:87]
    v_mfma_f32_16x16x32_bf16 v[80:83], v[196:199], a[64:67], v[80:83]
    ds_read_b128 v[196:199], v2 offset:21504
    s_waitcnt lgkmcnt(5)
    v_mfma_f32_16x16x32_bf16 v[96:99], v[200:203], a[64:67], v[96:99]
    v_mfma_f32_16x16x32_bf16 v[100:103], v[200:203], a[68:71], v[100:103]
    buffer_load_dwordx4 a[52:55], v5, s[4:7], s89 offen offset:0 sc1
    v_mfma_f32_16x16x32_bf16 v[104:107], v[200:203], a[72:75], v[104:107]
    v_mfma_f32_16x16x32_bf16 v[108:111], v[200:203], a[76:79], v[108:111]
    ds_read_b128 v[200:203], v2 offset:22528
    s_waitcnt lgkmcnt(5)
    v_mfma_f32_16x16x32_bf16 v[124:127], v[204:207], a[76:79], v[124:127]
    v_mfma_f32_16x16x32_bf16 v[120:123], v[204:207], a[72:75], v[120:123]
    buffer_load_dwordx4 a[56:59], v6, s[4:7], s89 offen offset:0 sc1
    v_mfma_f32_16x16x32_bf16 v[116:119], v[204:207], a[68:71], v[116:119]
    v_mfma_f32_16x16x32_bf16 v[112:115], v[204:207], a[64:67], v[112:115]
    ds_read_b128 v[204:207], v2 offset:23552
    s_waitcnt lgkmcnt(5)
    v_mfma_f32_16x16x32_bf16 v[128:131], a[64:67], v[208:211], v[128:131]
    v_mfma_f32_16x16x32_bf16 v[132:135], a[68:71], v[208:211], v[132:135]
    buffer_load_dwordx4 v10, s[4:7], s63 offen offset:1024 lds
    v_mfma_f32_16x16x32_bf16 v[136:139], a[72:75], v[208:211], v[136:139]
    v_mfma_f32_16x16x32_bf16 v[140:143], a[76:79], v[208:211], v[140:143]
    ds_read_b128 v[208:211], v2 offset:24576
    s_waitcnt lgkmcnt(5)
    v_mfma_f32_16x16x32_bf16 v[156:159], a[76:79], v[212:215], v[156:159]
    v_mfma_f32_16x16x32_bf16 v[152:155], a[72:75], v[212:215], v[152:155]
    buffer_load_dwordx4 a[60:63], v7, s[4:7], s89 offen offset:0 sc1
    v_mfma_f32_16x16x32_bf16 v[148:151], a[68:71], v[212:215], v[148:151]
    v_mfma_f32_16x16x32_bf16 v[144:147], a[64:67], v[212:215], v[144:147]
    ds_read_b128 v[212:215], v2 offset:25600
    s_waitcnt vmcnt(12)
    s_waitcnt lgkmcnt(5)
    v_mfma_f32_16x16x32_bf16 v[64:67], v[192:195], a[80:83], v[64:67]
    v_add_f32 v224, v224, v232
    v_add_f32 v225, v225, v233
    v_mfma_f32_16x16x32_bf16 v[68:71], v[192:195], a[84:87], v[68:71]
    buffer_load_dwordx4 a[64:67], v4, s[4:7], s89 offen offset:1024 sc1
    v_mfma_f32_16x16x32_bf16 v[72:75], v[192:195], a[88:91], v[72:75]
    v_add_f32 v226, v226, v234
    v_add_f32 v227, v227, v235
    v_mfma_f32_16x16x32_bf16 v[76:79], v[192:195], a[92:95], v[76:79]
    ds_read_b128 v[192:195], v2 offset:26624
    s_waitcnt lgkmcnt(5)
    v_mfma_f32_16x16x32_bf16 v[92:95], v[196:199], a[92:95], v[92:95]
    v_add_f32 v228, v228, v236
    v_add_f32 v229, v229, v237
    v_mfma_f32_16x16x32_bf16 v[88:91], v[196:199], a[88:91], v[88:91]
    buffer_load_dwordx4 v10, s[4:7], s63 offen offset:2048 lds
    v_mfma_f32_16x16x32_bf16 v[84:87], v[196:199], a[84:87], v[84:87]
    v_add_f32 v230, v230, v238
    v_add_f32 v231, v231, v239
    v_mfma_f32_16x16x32_bf16 v[80:83], v[196:199], a[80:83], v[80:83]
    ds_read_b128 v[196:199], v2 offset:27648
    s_waitcnt lgkmcnt(5)
    v_mfma_f32_16x16x32_bf16 v[96:99], v[200:203], a[80:83], v[96:99]
    v_add_f32_dpp v224, v224, v224 row_ror:8 row_mask:0xf bank_mask:0xf
    v_add_f32_dpp v225, v225, v225 row_ror:8 row_mask:0xf bank_mask:0xf
    v_mfma_f32_16x16x32_bf16 v[100:103], v[200:203], a[84:87], v[100:103]
    buffer_load_dwordx4 a[68:71], v5, s[4:7], s89 offen offset:1024 sc1
    v_mfma_f32_16x16x32_bf16 v[104:107], v[200:203], a[88:91], v[104:107]
    v_add_f32_dpp v226, v226, v226 row_ror:8 row_mask:0xf bank_mask:0xf
    v_add_f32_dpp v227, v227, v227 row_ror:8 row_mask:0xf bank_mask:0xf
    v_mfma_f32_16x16x32_bf16 v[108:111], v[200:203], a[92:95], v[108:111]
    ds_read_b128 v[200:203], v2 offset:28672
    s_waitcnt lgkmcnt(5)
    v_mfma_f32_16x16x32_bf16 v[124:127], v[204:207], a[92:95], v[124:127]
    v_add_f32_dpp v228, v228, v228 row_ror:8 row_mask:0xf bank_mask:0xf
    v_add_f32_dpp v229, v229, v229 row_ror:8 row_mask:0xf bank_mask:0xf
    v_mfma_f32_16x16x32_bf16 v[120:123], v[204:207], a[88:91], v[120:123]
    buffer_load_dwordx4 a[72:75], v6, s[4:7], s89 offen offset:1024 sc1
    v_mfma_f32_16x16x32_bf16 v[116:119], v[204:207], a[84:87], v[116:119]
    v_add_f32_dpp v230, v230, v230 row_ror:8 row_mask:0xf bank_mask:0xf
    v_add_f32_dpp v231, v231, v231 row_ror:8 row_mask:0xf bank_mask:0xf
    v_mfma_f32_16x16x32_bf16 v[112:115], v[204:207], a[80:83], v[112:115]
    ds_read_b128 v[204:207], v2 offset:29696
    s_waitcnt lgkmcnt(5)
    v_mfma_f32_16x16x32_bf16 v[128:131], a[80:83], v[208:211], v[128:131]
    s_mov_b32 s19, 1114112
    v_mfma_f32_16x16x32_bf16 v[132:135], a[84:87], v[208:211], v[132:135]
    buffer_load_dwordx4 v[176:179], v13, s[4:7], s19 offen sc1
    v_mfma_f32_16x16x32_bf16 v[136:139], a[88:91], v[208:211], v[136:139]
    v_add_f32_dpp v224, v224, v224 row_ror:4 row_mask:0xf bank_mask:0xf
    v_add_f32_dpp v225, v225, v225 row_ror:4 row_mask:0xf bank_mask:0xf
    v_mfma_f32_16x16x32_bf16 v[140:143], a[92:95], v[208:211], v[140:143]
    ds_read_b128 v[208:211], v2 offset:30720
    s_waitcnt lgkmcnt(5)
    v_mfma_f32_16x16x32_bf16 v[156:159], a[92:95], v[212:215], v[156:159]
    v_add_f32_dpp v226, v226, v226 row_ror:4 row_mask:0xf bank_mask:0xf
    v_add_f32_dpp v227, v227, v227 row_ror:4 row_mask:0xf bank_mask:0xf
    v_mfma_f32_16x16x32_bf16 v[152:155], a[88:91], v[212:215], v[152:155]
    buffer_load_dwordx4 a[76:79], v7, s[4:7], s89 offen offset:1024 sc1
    v_mfma_f32_16x16x32_bf16 v[148:151], a[84:87], v[212:215], v[148:151]
    v_add_f32_dpp v228, v228, v228 row_ror:4 row_mask:0xf bank_mask:0xf
    v_add_f32_dpp v229, v229, v229 row_ror:4 row_mask:0xf bank_mask:0xf
    v_mfma_f32_16x16x32_bf16 v[144:147], a[80:83], v[212:215], v[144:147]
    ds_read_b128 v[212:215], v2 offset:31744
    s_waitcnt vmcnt(12)
    s_barrier
    s_waitcnt lgkmcnt(5)
    v_mfma_f32_16x16x32_bf16 v[64:67], v[192:195], a[96:99], v[64:67]
    v_add_f32_dpp v230, v230, v230 row_ror:4 row_mask:0xf bank_mask:0xf
    v_add_f32_dpp v231, v231, v231 row_ror:4 row_mask:0xf bank_mask:0xf
    v_mfma_f32_16x16x32_bf16 v[68:71], v[192:195], a[100:103], v[68:71]
    buffer_load_dwordx4 a[80:83], v4, s[4:7], s89 offen offset:2048 sc1
    v_mfma_f32_16x16x32_bf16 v[72:75], v[192:195], a[104:107], v[72:75]
    v_permlane32_swap_b32 v224, v225
    v_mfma_f32_16x16x32_bf16 v[76:79], v[192:195], a[108:111], v[76:79]
    ds_read_b128 v[192:195], v2 offset:32768
    s_waitcnt lgkmcnt(5)
    v_mfma_f32_16x16x32_bf16 v[92:95], v[196:199], a[108:111], v[92:95]
    v_permlane32_swap_b32 v226, v227
    v_mfma_f32_16x16x32_bf16 v[88:91], v[196:199], a[104:107], v[88:91]
    buffer_load_dwordx4 v10, s[4:7], s63 offen offset:3072 lds
    v_mfma_f32_16x16x32_bf16 v[84:87], v[196:199], a[100:103], v[84:87]
    v_permlane32_swap_b32 v228, v229
    v_mfma_f32_16x16x32_bf16 v[80:83], v[196:199], a[96:99], v[80:83]
    ds_read_b128 v[196:199], v2 offset:33792
    s_waitcnt lgkmcnt(5)
    v_mfma_f32_16x16x32_bf16 v[96:99], v[200:203], a[96:99], v[96:99]
    v_permlane32_swap_b32 v230, v231
    v_mfma_f32_16x16x32_bf16 v[100:103], v[200:203], a[100:103], v[100:103]
    buffer_load_dwordx4 a[84:87], v5, s[4:7], s89 offen offset:2048 sc1
    v_mfma_f32_16x16x32_bf16 v[104:107], v[200:203], a[104:107], v[104:107]
    v_add_f32 v224, v224, v225
    v_add_f32 v226, v226, v227
    v_mfma_f32_16x16x32_bf16 v[108:111], v[200:203], a[108:111], v[108:111]
    ds_read_b128 v[200:203], v2 offset:34816
    s_waitcnt lgkmcnt(5)
    v_mfma_f32_16x16x32_bf16 v[124:127], v[204:207], a[108:111], v[124:127]
    v_add_f32 v228, v228, v229
    v_add_f32 v230, v230, v231
    v_mfma_f32_16x16x32_bf16 v[120:123], v[204:207], a[104:107], v[120:123]
    buffer_load_dwordx4 a[88:91], v6, s[4:7], s89 offen offset:2048 sc1
    v_mfma_f32_16x16x32_bf16 v[116:119], v[204:207], a[100:103], v[116:119]
    v_permlane16_swap_b32 v224, v226
    v_mfma_f32_16x16x32_bf16 v[112:115], v[204:207], a[96:99], v[112:115]
    ds_read_b128 v[204:207], v2 offset:35840
    s_waitcnt lgkmcnt(5)
    v_mfma_f32_16x16x32_bf16 v[128:131], a[96:99], v[208:211], v[128:131]
    s_add_u32 m0, s57, 126976
    s_add_u32 s63, s98, 14684160
    v_mfma_f32_16x16x32_bf16 v[132:135], a[100:103], v[208:211], v[132:135]
    buffer_load_dwordx4 v10, s[4:7], s63 offen offset:0 lds
    v_mfma_f32_16x16x32_bf16 v[136:139], a[104:107], v[208:211], v[136:139]
    v_permlane16_swap_b32 v228, v230
    v_mfma_f32_16x16x32_bf16 v[140:143], a[108:111], v[208:211], v[140:143]
    ds_read_b128 v[208:211], v2 offset:36864
    s_waitcnt lgkmcnt(5)
    v_mfma_f32_16x16x32_bf16 v[156:159], a[108:111], v[212:215], v[156:159]
    v_add_f32 v224, v224, v226
    v_add_f32 v228, v228, v230
    v_mfma_f32_16x16x32_bf16 v[152:155], a[104:107], v[212:215], v[152:155]
    buffer_load_dwordx4 a[92:95], v7, s[4:7], s89 offen offset:2048 sc1
    v_mfma_f32_16x16x32_bf16 v[148:151], a[100:103], v[212:215], v[148:151]
    s_mov_b32 exec_lo, 0x000f000f
    s_mov_b32 exec_hi, 0x000f000f
    ds_write_b32 v38, v224 offset:384
    ds_write_b32 v39, v228 offset:384
    s_mov_b64 exec, -1
    v_mfma_f32_16x16x32_bf16 v[144:147], a[96:99], v[212:215], v[144:147]
    ds_read_b128 v[212:215], v2 offset:37888
    s_waitcnt vmcnt(12)
    s_waitcnt lgkmcnt(7)
    v_mfma_f32_16x16x32_bf16 v[64:67], v[192:195], a[48:51], v[64:67]
    s_add_u32 s52, s52, 393216
    s_add_u32 s53, s53, 393216
    v_mfma_f32_16x16x32_bf16 v[68:71], v[192:195], a[52:55], v[68:71]
    buffer_load_dwordx4 a[96:99], v4, s[4:7], s89 offen offset:3072 sc1
    v_mfma_f32_16x16x32_bf16 v[72:75], v[192:195], a[56:59], v[72:75]
    ds_read_b128 a[168:171], v34 offset:24576
    v_mfma_f32_16x16x32_bf16 v[76:79], v[192:195], a[60:63], v[76:79]
    ds_read_b128 v[192:195], v2 offset:38912
    s_waitcnt lgkmcnt(8)
    v_mfma_f32_16x16x32_bf16 v[92:95], v[196:199], a[60:63], v[92:95]
    ds_read_b128 a[172:175], v34 offset:25600
    v_mfma_f32_16x16x32_bf16 v[88:91], v[196:199], a[56:59], v[88:91]
    buffer_load_dwordx4 v10, s[4:7], s63 offen offset:1024 lds
    v_mfma_f32_16x16x32_bf16 v[84:87], v[196:199], a[52:55], v[84:87]
    ds_read_b128 a[176:179], v34 offset:26624
    v_mfma_f32_16x16x32_bf16 v[80:83], v[196:199], a[48:51], v[80:83]
    ds_read_b128 v[196:199], v2 offset:39936
    s_waitcnt lgkmcnt(10)
    v_mfma_f32_16x16x32_bf16 v[96:99], v[200:203], a[48:51], v[96:99]
    ds_read_b128 a[180:183], v34 offset:27648
    v_mfma_f32_16x16x32_bf16 v[100:103], v[200:203], a[52:55], v[100:103]
    buffer_load_dwordx4 a[100:103], v5, s[4:7], s89 offen offset:3072 sc1
    v_mfma_f32_16x16x32_bf16 v[104:107], v[200:203], a[56:59], v[104:107]
    ds_read_b128 a[184:187], v34 offset:28672
    v_mfma_f32_16x16x32_bf16 v[108:111], v[200:203], a[60:63], v[108:111]
    ds_read_b128 v[200:203], v2 offset:40960
    s_waitcnt lgkmcnt(12)
    v_mfma_f32_16x16x32_bf16 v[124:127], v[204:207], a[60:63], v[124:127]
    ds_read_b128 a[188:191], v34 offset:29696
    v_mfma_f32_16x16x32_bf16 v[120:123], v[204:207], a[56:59], v[120:123]
    buffer_load_dwordx4 a[104:107], v6, s[4:7], s89 offen offset:3072 sc1
    v_mfma_f32_16x16x32_bf16 v[116:119], v[204:207], a[52:55], v[116:119]
    v_mfma_f32_16x16x32_bf16 v[112:115], v[204:207], a[48:51], v[112:115]
    ds_read_b128 v[204:207], v2 offset:41984
    s_waitcnt lgkmcnt(13)
    v_mfma_f32_16x16x32_bf16 v[128:131], a[48:51], v[208:211], v[128:131]
    s_mov_b32 s19, 1130496
    v_mfma_f32_16x16x32_bf16 v[132:135], a[52:55], v[208:211], v[132:135]
    buffer_load_dwordx4 v[180:183], v13, s[4:7], s19 offen sc1
    v_mfma_f32_16x16x32_bf16 v[136:139], a[56:59], v[208:211], v[136:139]
    v_mfma_f32_16x16x32_bf16 v[140:143], a[60:63], v[208:211], v[140:143]
    ds_read_b128 v[208:211], v2 offset:43008
    s_waitcnt lgkmcnt(11)
    v_mfma_f32_16x16x32_bf16 v[156:159], a[60:63], v[212:215], v[156:159]
    v_mfma_f32_16x16x32_bf16 v[152:155], a[56:59], v[212:215], v[152:155]
    buffer_load_dwordx4 a[108:111], v7, s[4:7], s89 offen offset:3072 sc1
    v_mfma_f32_16x16x32_bf16 v[148:151], a[52:55], v[212:215], v[148:151]
    v_mfma_f32_16x16x32_bf16 v[144:147], a[48:51], v[212:215], v[144:147]
    ds_read_b128 v[212:215], v2 offset:44032
    s_waitcnt vmcnt(12)
    s_waitcnt lgkmcnt(10)
    v_mfma_f32_16x16x32_bf16 v[64:67], v[192:195], a[64:67], v[64:67]
    v_mfma_f32_16x16x32_bf16 v[68:71], v[192:195], a[68:71], v[68:71]
    buffer_load_dwordx4 a[48:51], v4, s[4:7], s90 offen offset:0 sc1
    v_mfma_f32_16x16x32_bf16 v[72:75], v[192:195], a[72:75], v[72:75]
    v_mfma_f32_16x16x32_bf16 v[76:79], v[192:195], a[76:79], v[76:79]
    ds_read_b128 v[192:195], v2 offset:45056
    s_waitcnt lgkmcnt(8)
    v_mfma_f32_16x16x32_bf16 v[92:95], v[196:199], a[76:79], v[92:95]
    s_add_u32 m0, s57, 0
    s_add_u32 s63, s99, 14680064
    v_mfma_f32_16x16x32_bf16 v[88:91], v[196:199], a[72:75], v[88:91]
    buffer_load_dwordx4 v10, s[4:7], s63 offen offset:0 lds
    v_mfma_f32_16x16x32_bf16 v[84:87], v[196:199], a[68:71], v[84:87]
    v_mfma_f32_16x16x32_bf16 v[80:83], v[196:199], a[64:67], v[80:83]
    ds_read_b128 v[196:199], v2 offset:46080
    s_waitcnt lgkmcnt(6)
    v_mfma_f32_16x16x32_bf16 v[96:99], v[200:203], a[64:67], v[96:99]
    v_mfma_f32_16x16x32_bf16 v[100:103], v[200:203], a[68:71], v[100:103]
    buffer_load_dwordx4 a[52:55], v5, s[4:7], s90 offen offset:0 sc1
    v_mfma_f32_16x16x32_bf16 v[104:107], v[200:203], a[72:75], v[104:107]
    v_mfma_f32_16x16x32_bf16 v[108:111], v[200:203], a[76:79], v[108:111]
    ds_read_b128 v[200:203], v2 offset:47104
    s_waitcnt lgkmcnt(5)
    v_mfma_f32_16x16x32_bf16 v[124:127], v[204:207], a[76:79], v[124:127]
    v_mfma_f32_16x16x32_bf16 v[120:123], v[204:207], a[72:75], v[120:123]
    buffer_load_dwordx4 a[56:59], v6, s[4:7], s90 offen offset:0 sc1
    v_mfma_f32_16x16x32_bf16 v[116:119], v[204:207], a[68:71], v[116:119]
    v_mfma_f32_16x16x32_bf16 v[112:115], v[204:207], a[64:67], v[112:115]
    ds_read_b128 v[204:207], v2 offset:48128
    s_waitcnt lgkmcnt(5)
    v_mfma_f32_16x16x32_bf16 v[128:131], a[64:67], v[208:211], v[128:131]
    v_mfma_f32_16x16x32_bf16 v[132:135], a[68:71], v[208:211], v[132:135]
    buffer_load_dwordx4 v10, s[4:7], s63 offen offset:1024 lds
    v_mfma_f32_16x16x32_bf16 v[136:139], a[72:75], v[208:211], v[136:139]
    v_mfma_f32_16x16x32_bf16 v[140:143], a[76:79], v[208:211], v[140:143]
    ds_read_b128 v[208:211], v2 offset:49152
    s_waitcnt lgkmcnt(5)
    v_mfma_f32_16x16x32_bf16 v[156:159], a[76:79], v[212:215], v[156:159]
    v_mfma_f32_16x16x32_bf16 v[152:155], a[72:75], v[212:215], v[152:155]
    buffer_load_dwordx4 a[60:63], v7, s[4:7], s90 offen offset:0 sc1
    v_mfma_f32_16x16x32_bf16 v[148:151], a[68:71], v[212:215], v[148:151]
    v_mfma_f32_16x16x32_bf16 v[144:147], a[64:67], v[212:215], v[144:147]
    ds_read_b128 v[212:215], v2 offset:50176
    s_waitcnt vmcnt(12)
    s_waitcnt lgkmcnt(5)
    v_mfma_f32_16x16x32_bf16 v[64:67], v[192:195], a[80:83], v[64:67]
    v_mfma_f32_16x16x32_bf16 v[68:71], v[192:195], a[84:87], v[68:71]
    buffer_load_dwordx4 a[64:67], v4, s[4:7], s90 offen offset:1024 sc1
    v_mfma_f32_16x16x32_bf16 v[72:75], v[192:195], a[88:91], v[72:75]
    v_mfma_f32_16x16x32_bf16 v[76:79], v[192:195], a[92:95], v[76:79]
    ds_read_b128 v[192:195], v2 offset:51200
    s_waitcnt lgkmcnt(5)
    v_mfma_f32_16x16x32_bf16 v[92:95], v[196:199], a[92:95], v[92:95]
    v_mfma_f32_16x16x32_bf16 v[88:91], v[196:199], a[88:91], v[88:91]
    buffer_load_dwordx4 v10, s[4:7], s63 offen offset:2048 lds
    v_mfma_f32_16x16x32_bf16 v[84:87], v[196:199], a[84:87], v[84:87]
    v_mfma_f32_16x16x32_bf16 v[80:83], v[196:199], a[80:83], v[80:83]
    ds_read_b128 v[196:199], v2 offset:52224
    s_waitcnt lgkmcnt(5)
    v_mfma_f32_16x16x32_bf16 v[96:99], v[200:203], a[80:83], v[96:99]
    v_mfma_f32_16x16x32_bf16 v[100:103], v[200:203], a[84:87], v[100:103]
    buffer_load_dwordx4 a[68:71], v5, s[4:7], s90 offen offset:1024 sc1
    v_mfma_f32_16x16x32_bf16 v[104:107], v[200:203], a[88:91], v[104:107]
    v_mfma_f32_16x16x32_bf16 v[108:111], v[200:203], a[92:95], v[108:111]
    ds_read_b128 v[200:203], v2 offset:53248
    s_waitcnt lgkmcnt(5)
    v_mfma_f32_16x16x32_bf16 v[124:127], v[204:207], a[92:95], v[124:127]
    v_mfma_f32_16x16x32_bf16 v[120:123], v[204:207], a[88:91], v[120:123]
    buffer_load_dwordx4 a[72:75], v6, s[4:7], s90 offen offset:1024 sc1
    v_mfma_f32_16x16x32_bf16 v[116:119], v[204:207], a[84:87], v[116:119]
    v_mfma_f32_16x16x32_bf16 v[112:115], v[204:207], a[80:83], v[112:115]
    ds_read_b128 v[204:207], v2 offset:54272
    s_waitcnt lgkmcnt(5)
    v_mfma_f32_16x16x32_bf16 v[128:131], a[80:83], v[208:211], v[128:131]
    s_mov_b32 s19, 1146880
    v_mfma_f32_16x16x32_bf16 v[132:135], a[84:87], v[208:211], v[132:135]
    buffer_load_dwordx4 v[184:187], v13, s[4:7], s19 offen sc1
    v_mfma_f32_16x16x32_bf16 v[136:139], a[88:91], v[208:211], v[136:139]
    v_mfma_f32_16x16x32_bf16 v[140:143], a[92:95], v[208:211], v[140:143]
    ds_read_b128 v[208:211], v2 offset:55296
    s_waitcnt lgkmcnt(5)
    v_mfma_f32_16x16x32_bf16 v[156:159], a[92:95], v[212:215], v[156:159]
    v_mfma_f32_16x16x32_bf16 v[152:155], a[88:91], v[212:215], v[152:155]
    buffer_load_dwordx4 a[76:79], v7, s[4:7], s90 offen offset:1024 sc1
    v_mfma_f32_16x16x32_bf16 v[148:151], a[84:87], v[212:215], v[148:151]
    v_mfma_f32_16x16x32_bf16 v[144:147], a[80:83], v[212:215], v[144:147]
    ds_read_b128 v[212:215], v2 offset:56320
    s_waitcnt vmcnt(12)
    s_barrier
    s_waitcnt lgkmcnt(5)
    v_mfma_f32_16x16x32_bf16 v[64:67], v[192:195], a[96:99], v[64:67]
    v_mfma_f32_16x16x32_bf16 v[68:71], v[192:195], a[100:103], v[68:71]
    buffer_load_dwordx4 a[80:83], v4, s[4:7], s90 offen offset:2048 sc1
    v_mfma_f32_16x16x32_bf16 v[72:75], v[192:195], a[104:107], v[72:75]
    v_mfma_f32_16x16x32_bf16 v[76:79], v[192:195], a[108:111], v[76:79]
    ds_read_b128 v[192:195], v2 offset:57344
    s_waitcnt lgkmcnt(5)
    v_mfma_f32_16x16x32_bf16 v[92:95], v[196:199], a[108:111], v[92:95]
    v_mfma_f32_16x16x32_bf16 v[88:91], v[196:199], a[104:107], v[88:91]
    buffer_load_dwordx4 v10, s[4:7], s63 offen offset:3072 lds
    v_mfma_f32_16x16x32_bf16 v[84:87], v[196:199], a[100:103], v[84:87]
    v_mfma_f32_16x16x32_bf16 v[80:83], v[196:199], a[96:99], v[80:83]
    ds_read_b128 v[196:199], v2 offset:58368
    s_waitcnt lgkmcnt(5)
    v_mfma_f32_16x16x32_bf16 v[96:99], v[200:203], a[96:99], v[96:99]
    v_mfma_f32_16x16x32_bf16 v[100:103], v[200:203], a[100:103], v[100:103]
    buffer_load_dwordx4 a[84:87], v5, s[4:7], s90 offen offset:2048 sc1
    v_mfma_f32_16x16x32_bf16 v[104:107], v[200:203], a[104:107], v[104:107]
    v_mfma_f32_16x16x32_bf16 v[108:111], v[200:203], a[108:111], v[108:111]
    ds_read_b128 v[200:203], v2 offset:59392
    s_waitcnt lgkmcnt(5)
    v_mfma_f32_16x16x32_bf16 v[124:127], v[204:207], a[108:111], v[124:127]
    v_mfma_f32_16x16x32_bf16 v[120:123], v[204:207], a[104:107], v[120:123]
    buffer_load_dwordx4 a[88:91], v6, s[4:7], s90 offen offset:2048 sc1
    v_mfma_f32_16x16x32_bf16 v[116:119], v[204:207], a[100:103], v[116:119]
    v_mfma_f32_16x16x32_bf16 v[112:115], v[204:207], a[96:99], v[112:115]
    ds_read_b128 v[204:207], v2 offset:60416
    s_waitcnt lgkmcnt(5)
    v_mfma_f32_16x16x32_bf16 v[128:131], a[96:99], v[208:211], v[128:131]
    s_add_u32 m0, s57, 4096
    s_add_u32 s63, s99, 14684160
    v_mfma_f32_16x16x32_bf16 v[132:135], a[100:103], v[208:211], v[132:135]
    buffer_load_dwordx4 v10, s[4:7], s63 offen offset:0 lds
    v_mfma_f32_16x16x32_bf16 v[136:139], a[104:107], v[208:211], v[136:139]
    v_mfma_f32_16x16x32_bf16 v[140:143], a[108:111], v[208:211], v[140:143]
    ds_read_b128 v[208:211], v2 offset:61440
    s_waitcnt lgkmcnt(5)
    v_mfma_f32_16x16x32_bf16 v[156:159], a[108:111], v[212:215], v[156:159]
    v_mfma_f32_16x16x32_bf16 v[152:155], a[104:107], v[212:215], v[152:155]
    buffer_load_dwordx4 a[92:95], v7, s[4:7], s90 offen offset:2048 sc1
    v_mfma_f32_16x16x32_bf16 v[148:151], a[100:103], v[212:215], v[148:151]
    v_mfma_f32_16x16x32_bf16 v[144:147], a[96:99], v[212:215], v[144:147]
    ds_read_b128 v[212:215], v2 offset:62464
    s_waitcnt vmcnt(12)
    s_waitcnt lgkmcnt(5)
    v_mfma_f32_16x16x32_bf16 v[64:67], v[192:195], a[48:51], v[64:67]
    v_mfma_f32_16x16x32_bf16 v[68:71], v[192:195], a[52:55], v[68:71]
    buffer_load_dwordx4 a[96:99], v4, s[4:7], s90 offen offset:3072 sc1
    v_mfma_f32_16x16x32_bf16 v[72:75], v[192:195], a[56:59], v[72:75]
    v_mfma_f32_16x16x32_bf16 v[76:79], v[192:195], a[60:63], v[76:79]
    ds_read_b128 v[192:195], v2 offset:63488
    s_waitcnt lgkmcnt(5)
    v_mfma_f32_16x16x32_bf16 v[92:95], v[196:199], a[60:63], v[92:95]
    v_mfma_f32_16x16x32_bf16 v[88:91], v[196:199], a[56:59], v[88:91]
    buffer_load_dwordx4 v10, s[4:7], s63 offen offset:1024 lds
    v_mfma_f32_16x16x32_bf16 v[84:87], v[196:199], a[52:55], v[84:87]
    v_mfma_f32_16x16x32_bf16 v[80:83], v[196:199], a[48:51], v[80:83]
    ds_read_b128 v[196:199], v2 offset:64512
    s_waitcnt lgkmcnt(5)
    v_mfma_f32_16x16x32_bf16 v[96:99], v[200:203], a[48:51], v[96:99]
    v_mfma_f32_16x16x32_bf16 v[100:103], v[200:203], a[52:55], v[100:103]
    buffer_load_dwordx4 a[100:103], v5, s[4:7], s90 offen offset:3072 sc1
    v_mfma_f32_16x16x32_bf16 v[104:107], v[200:203], a[56:59], v[104:107]
    v_mfma_f32_16x16x32_bf16 v[108:111], v[200:203], a[60:63], v[108:111]
    ds_read_b128 v[200:203], v3 offset:0
    s_waitcnt lgkmcnt(5)
    v_mfma_f32_16x16x32_bf16 v[124:127], v[204:207], a[60:63], v[124:127]
    v_mfma_f32_16x16x32_bf16 v[120:123], v[204:207], a[56:59], v[120:123]
    buffer_load_dwordx4 a[104:107], v6, s[4:7], s90 offen offset:3072 sc1
    v_mfma_f32_16x16x32_bf16 v[116:119], v[204:207], a[52:55], v[116:119]
    v_mfma_f32_16x16x32_bf16 v[112:115], v[204:207], a[48:51], v[112:115]
    ds_read_b128 v[204:207], v3 offset:1024
    s_waitcnt lgkmcnt(5)
    v_mfma_f32_16x16x32_bf16 v[128:131], a[48:51], v[208:211], v[128:131]
    s_mov_b32 s19, 1163264
    v_mfma_f32_16x16x32_bf16 v[132:135], a[52:55], v[208:211], v[132:135]
    buffer_load_dwordx4 v[188:191], v13, s[4:7], s19 offen sc1
    v_mfma_f32_16x16x32_bf16 v[136:139], a[56:59], v[208:211], v[136:139]
    v_mfma_f32_16x16x32_bf16 v[140:143], a[60:63], v[208:211], v[140:143]
    ds_read_b128 v[208:211], v3 offset:2048
    s_waitcnt lgkmcnt(5)
    v_mfma_f32_16x16x32_bf16 v[156:159], a[60:63], v[212:215], v[156:159]
    v_mfma_f32_16x16x32_bf16 v[152:155], a[56:59], v[212:215], v[152:155]
    buffer_load_dwordx4 a[108:111], v7, s[4:7], s90 offen offset:3072 sc1
    v_mfma_f32_16x16x32_bf16 v[148:151], a[52:55], v[212:215], v[148:151]
    v_mfma_f32_16x16x32_bf16 v[144:147], a[48:51], v[212:215], v[144:147]
    ds_read_b128 v[212:215], v3 offset:3072
    s_waitcnt vmcnt(12)
    s_waitcnt lgkmcnt(5)
    v_mfma_f32_16x16x32_bf16 v[64:67], v[192:195], a[64:67], v[64:67]
    v_mfma_f32_16x16x32_bf16 v[68:71], v[192:195], a[68:71], v[68:71]
    buffer_load_dwordx4 a[48:51], v4, s[4:7], s91 offen offset:0 sc1
    v_mfma_f32_16x16x32_bf16 v[72:75], v[192:195], a[72:75], v[72:75]
    v_mfma_f32_16x16x32_bf16 v[76:79], v[192:195], a[76:79], v[76:79]
    ds_read_b128 v[192:195], v3 offset:4096
    s_waitcnt lgkmcnt(5)
    v_mfma_f32_16x16x32_bf16 v[92:95], v[196:199], a[76:79], v[92:95]
    s_add_u32 m0, s57, 24576
    s_add_u32 s63, s100, 14680064
    v_mfma_f32_16x16x32_bf16 v[88:91], v[196:199], a[72:75], v[88:91]
    buffer_load_dwordx4 v10, s[4:7], s63 offen offset:0 lds
    v_mfma_f32_16x16x32_bf16 v[84:87], v[196:199], a[68:71], v[84:87]
    v_mfma_f32_16x16x32_bf16 v[80:83], v[196:199], a[64:67], v[80:83]
    ds_read_b128 v[196:199], v3 offset:5120
    s_waitcnt lgkmcnt(5)
    v_mfma_f32_16x16x32_bf16 v[96:99], v[200:203], a[64:67], v[96:99]
    v_mfma_f32_16x16x32_bf16 v[100:103], v[200:203], a[68:71], v[100:103]
    buffer_load_dwordx4 a[52:55], v5, s[4:7], s91 offen offset:0 sc1
    v_mfma_f32_16x16x32_bf16 v[104:107], v[200:203], a[72:75], v[104:107]
    v_mfma_f32_16x16x32_bf16 v[108:111], v[200:203], a[76:79], v[108:111]
    ds_read_b128 v[200:203], v3 offset:6144
    s_waitcnt lgkmcnt(5)
    v_mfma_f32_16x16x32_bf16 v[124:127], v[204:207], a[76:79], v[124:127]
    v_mfma_f32_16x16x32_bf16 v[120:123], v[204:207], a[72:75], v[120:123]
    buffer_load_dwordx4 a[56:59], v6, s[4:7], s91 offen offset:0 sc1
    v_mfma_f32_16x16x32_bf16 v[116:119], v[204:207], a[68:71], v[116:119]
    v_mfma_f32_16x16x32_bf16 v[112:115], v[204:207], a[64:67], v[112:115]
    ds_read_b128 v[204:207], v3 offset:7168
    s_waitcnt lgkmcnt(5)
    v_mfma_f32_16x16x32_bf16 v[128:131], a[64:67], v[208:211], v[128:131]
    v_mfma_f32_16x16x32_bf16 v[132:135], a[68:71], v[208:211], v[132:135]
    buffer_load_dwordx4 v10, s[4:7], s63 offen offset:1024 lds
    v_mfma_f32_16x16x32_bf16 v[136:139], a[72:75], v[208:211], v[136:139]
    v_mfma_f32_16x16x32_bf16 v[140:143], a[76:79], v[208:211], v[140:143]
    ds_read_b128 v[208:211], v3 offset:8192
    s_waitcnt lgkmcnt(5)
    v_mfma_f32_16x16x32_bf16 v[156:159], a[76:79], v[212:215], v[156:159]
    v_mfma_f32_16x16x32_bf16 v[152:155], a[72:75], v[212:215], v[152:155]
    buffer_load_dwordx4 a[60:63], v7, s[4:7], s91 offen offset:0 sc1
    v_mfma_f32_16x16x32_bf16 v[148:151], a[68:71], v[212:215], v[148:151]
    v_mfma_f32_16x16x32_bf16 v[144:147], a[64:67], v[212:215], v[144:147]
    ds_read_b128 v[212:215], v3 offset:9216
    s_waitcnt vmcnt(12)
    s_waitcnt lgkmcnt(5)
    v_mfma_f32_16x16x32_bf16 v[64:67], v[192:195], a[80:83], v[64:67]
    v_mfma_f32_16x16x32_bf16 v[68:71], v[192:195], a[84:87], v[68:71]
    buffer_load_dwordx4 a[64:67], v4, s[4:7], s91 offen offset:1024 sc1
    v_mfma_f32_16x16x32_bf16 v[72:75], v[192:195], a[88:91], v[72:75]
    v_mfma_f32_16x16x32_bf16 v[76:79], v[192:195], a[92:95], v[76:79]
    ds_read_b128 v[192:195], v3 offset:10240
    s_waitcnt lgkmcnt(5)
    v_mfma_f32_16x16x32_bf16 v[92:95], v[196:199], a[92:95], v[92:95]
    v_mfma_f32_16x16x32_bf16 v[88:91], v[196:199], a[88:91], v[88:91]
    buffer_load_dwordx4 a[68:71], v5, s[4:7], s91 offen offset:1024 sc1
    v_mfma_f32_16x16x32_bf16 v[84:87], v[196:199], a[84:87], v[84:87]
    v_mfma_f32_16x16x32_bf16 v[80:83], v[196:199], a[80:83], v[80:83]
    ds_read_b128 v[196:199], v3 offset:11264
    s_waitcnt lgkmcnt(5)
    v_mfma_f32_16x16x32_bf16 v[96:99], v[200:203], a[80:83], v[96:99]
    v_mfma_f32_16x16x32_bf16 v[100:103], v[200:203], a[84:87], v[100:103]
    buffer_load_dwordx4 v10, s[4:7], s63 offen offset:2048 lds
    v_mfma_f32_16x16x32_bf16 v[104:107], v[200:203], a[88:91], v[104:107]
    v_mfma_f32_16x16x32_bf16 v[108:111], v[200:203], a[92:95], v[108:111]
    ds_read_b128 v[200:203], v3 offset:12288
    s_waitcnt lgkmcnt(5)
    v_mfma_f32_16x16x32_bf16 v[124:127], v[204:207], a[92:95], v[124:127]
    v_mfma_f32_16x16x32_bf16 v[120:123], v[204:207], a[88:91], v[120:123]
    buffer_load_dwordx4 a[72:75], v6, s[4:7], s91 offen offset:1024 sc1
    v_mfma_f32_16x16x32_bf16 v[116:119], v[204:207], a[84:87], v[116:119]
    v_mfma_f32_16x16x32_bf16 v[112:115], v[204:207], a[80:83], v[112:115]
    ds_read_b128 v[204:207], v3 offset:13312
    s_waitcnt lgkmcnt(5)
    v_mfma_f32_16x16x32_bf16 v[128:131], a[80:83], v[208:211], v[128:131]
    v_mfma_f32_16x16x32_bf16 v[132:135], a[84:87], v[208:211], v[132:135]
    buffer_load_dwordx4 a[76:79], v7, s[4:7], s91 offen offset:1024 sc1
    v_mfma_f32_16x16x32_bf16 v[136:139], a[88:91], v[208:211], v[136:139]
    v_mfma_f32_16x16x32_bf16 v[140:143], a[92:95], v[208:211], v[140:143]
    ds_read_b128 v[208:211], v3 offset:14336
    s_waitcnt lgkmcnt(5)
    v_mfma_f32_16x16x32_bf16 v[156:159], a[92:95], v[212:215], v[156:159]
    v_mfma_f32_16x16x32_bf16 v[152:155], a[88:91], v[212:215], v[152:155]
    v_mfma_f32_16x16x32_bf16 v[148:151], a[84:87], v[212:215], v[148:151]
    v_mfma_f32_16x16x32_bf16 v[144:147], a[80:83], v[212:215], v[144:147]
    ds_read_b128 v[212:215], v3 offset:15360
    s_waitcnt vmcnt(11)
    s_barrier
    s_waitcnt lgkmcnt(5)
    v_mfma_f32_16x16x32_bf16 v[64:67], v[192:195], a[96:99], v[64:67]
    v_add_f32 v160, v160, v176
    v_add_f32 v161, v161, v177
    v_mfma_f32_16x16x32_bf16 v[68:71], v[192:195], a[100:103], v[68:71]
    buffer_load_dwordx4 a[80:83], v4, s[4:7], s91 offen offset:2048 sc1
    v_mfma_f32_16x16x32_bf16 v[72:75], v[192:195], a[104:107], v[72:75]
    v_add_f32 v162, v162, v178
    v_add_f32 v163, v163, v179
    v_mfma_f32_16x16x32_bf16 v[76:79], v[192:195], a[108:111], v[76:79]
    ds_read_b128 v[192:195], v1 offset:0
    s_waitcnt lgkmcnt(5)
    v_mfma_f32_16x16x32_bf16 v[92:95], v[196:199], a[108:111], v[92:95]
    v_add_f32 v164, v164, v180
    v_add_f32 v165, v165, v181
    v_mfma_f32_16x16x32_bf16 v[88:91], v[196:199], a[104:107], v[88:91]
    buffer_load_dwordx4 v10, s[4:7], s63 offen offset:3072 lds
    v_mfma_f32_16x16x32_bf16 v[84:87], v[196:199], a[100:103], v[84:87]
    v_add_f32 v166, v166, v182
    v_add_f32 v167, v167, v183
    v_mfma_f32_16x16x32_bf16 v[80:83], v[196:199], a[96:99], v[80:83]
    ds_read_b128 v[196:199], v1 offset:1024
    s_waitcnt lgkmcnt(5)
    v_mfma_f32_16x16x32_bf16 v[96:99], v[200:203], a[96:99], v[96:99]
    v_add_f32 v168, v168, v184
    v_add_f32 v169, v169, v185
    v_mfma_f32_16x16x32_bf16 v[100:103], v[200:203], a[100:103], v[100:103]
    buffer_load_dwordx4 a[84:87], v5, s[4:7], s91 offen offset:2048 sc1
    v_mfma_f32_16x16x32_bf16 v[104:107], v[200:203], a[104:107], v[104:107]
    v_add_f32 v170, v170, v186
    v_add_f32 v171, v171, v187
    v_mfma_f32_16x16x32_bf16 v[108:111], v[200:203], a[108:111], v[108:111]
    ds_read_b128 v[200:203], v1 offset:2048
    s_waitcnt lgkmcnt(5)
    v_mfma_f32_16x16x32_bf16 v[124:127], v[204:207], a[108:111], v[124:127]
    v_add_f32 v172, v172, v188
    v_add_f32 v173, v173, v189
    v_mfma_f32_16x16x32_bf16 v[120:123], v[204:207], a[104:107], v[120:123]
    buffer_load_dwordx4 a[88:91], v6, s[4:7], s91 offen offset:2048 sc1
    v_mfma_f32_16x16x32_bf16 v[116:119], v[204:207], a[100:103], v[116:119]
    v_add_f32 v174, v174, v190
    v_add_f32 v175, v175, v191
    v_mfma_f32_16x16x32_bf16 v[112:115], v[204:207], a[96:99], v[112:115]
    ds_read_b128 v[204:207], v1 offset:3072
    s_waitcnt lgkmcnt(5)
    v_mfma_f32_16x16x32_bf16 v[128:131], a[96:99], v[208:211], v[128:131]
    s_add_u32 m0, s57, 28672
    s_add_u32 s63, s100, 14684160
    v_mfma_f32_16x16x32_bf16 v[132:135], a[100:103], v[208:211], v[132:135]
    buffer_load_dwordx4 v10, s[4:7], s63 offen offset:0 lds
    v_mfma_f32_16x16x32_bf16 v[136:139], a[104:107], v[208:211], v[136:139]
    v_add_f32 v160, v160, v168
    v_add_f32 v161, v161, v169
    v_mfma_f32_16x16x32_bf16 v[140:143], a[108:111], v[208:211], v[140:143]
    ds_read_b128 v[208:211], v1 offset:4096
    s_waitcnt lgkmcnt(5)
    v_mfma_f32_16x16x32_bf16 v[156:159], a[108:111], v[212:215], v[156:159]
    v_add_f32 v162, v162, v170
    v_add_f32 v163, v163, v171
    v_mfma_f32_16x16x32_bf16 v[152:155], a[104:107], v[212:215], v[152:155]
    buffer_load_dwordx4 a[92:95], v7, s[4:7], s91 offen offset:2048 sc1
    v_mfma_f32_16x16x32_bf16 v[148:151], a[100:103], v[212:215], v[148:151]
    v_add_f32 v164, v164, v172
    v_add_f32 v165, v165, v173
    v_mfma_f32_16x16x32_bf16 v[144:147], a[96:99], v[212:215], v[144:147]
    ds_read_b128 v[212:215], v1 offset:5120
    s_waitcnt vmcnt(11)
    s_waitcnt lgkmcnt(5)
    v_mfma_f32_16x16x32_bf16 v[64:67], v[192:195], a[48:51], v[64:67]
    v_add_f32 v166, v166, v174
    v_add_f32 v167, v167, v175
    v_mfma_f32_16x16x32_bf16 v[68:71], v[192:195], a[52:55], v[68:71]
    buffer_load_dwordx4 a[96:99], v4, s[4:7], s91 offen offset:3072 sc1
    v_mfma_f32_16x16x32_bf16 v[72:75], v[192:195], a[56:59], v[72:75]
    v_add_f32 v160, v160, v164
    v_add_f32 v161, v161, v165
    v_mfma_f32_16x16x32_bf16 v[76:79], v[192:195], a[60:63], v[76:79]
    ds_read_b128 v[192:195], v1 offset:6144
    s_waitcnt lgkmcnt(5)
    v_mfma_f32_16x16x32_bf16 v[92:95], v[196:199], a[60:63], v[92:95]
    v_add_f32 v162, v162, v166
    v_add_f32 v163, v163, v167
    v_mfma_f32_16x16x32_bf16 v[88:91], v[196:199], a[56:59], v[88:91]
    buffer_load_dwordx4 a[100:103], v5, s[4:7], s91 offen offset:3072 sc1
    v_mfma_f32_16x16x32_bf16 v[84:87], v[196:199], a[52:55], v[84:87]
    s_nop 0
    v_mfma_f32_16x16x32_bf16 v[80:83], v[196:199], a[48:51], v[80:83]
    ds_read_b128 v[196:199], v1 offset:7168
    s_waitcnt lgkmcnt(5)
    v_mfma_f32_16x16x32_bf16 v[96:99], v[200:203], a[48:51], v[96:99]
    v_permlane32_swap_b32 v160, v162
    v_mfma_f32_16x16x32_bf16 v[100:103], v[200:203], a[52:55], v[100:103]
    buffer_load_dwordx4 v10, s[4:7], s63 offen offset:1024 lds
    v_mfma_f32_16x16x32_bf16 v[104:107], v[200:203], a[56:59], v[104:107]
    v_permlane32_swap_b32 v161, v163
    v_mfma_f32_16x16x32_bf16 v[108:111], v[200:203], a[60:63], v[108:111]
    ds_read_b128 v[200:203], v1 offset:8192
    s_waitcnt lgkmcnt(5)
    v_mfma_f32_16x16x32_bf16 v[124:127], v[204:207], a[60:63], v[124:127]
    v_add_f32 v160, v160, v162
    v_add_f32 v161, v161, v163
    v_mfma_f32_16x16x32_bf16 v[120:123], v[204:207], a[56:59], v[120:123]
    buffer_load_dwordx4 a[104:107], v6, s[4:7], s91 offen offset:3072 sc1
    v_mfma_f32_16x16x32_bf16 v[116:119], v[204:207], a[52:55], v[116:119]
    v_mul_f32 v163, 0xba800000, v160
    v_mul_f32 v161, 0x3a800000, v161
    v_mfma_f32_16x16x32_bf16 v[112:115], v[204:207], a[48:51], v[112:115]
    ds_read_b128 v[204:207], v1 offset:9216
    s_waitcnt lgkmcnt(5)
    v_mfma_f32_16x16x32_bf16 v[128:131], a[48:51], v[208:211], v[128:131]
    v_fma_f32 v161, -v163, v163, v161
    v_max_f32 v161, 0, v161
    v_mfma_f32_16x16x32_bf16 v[132:135], a[52:55], v[208:211], v[132:135]
    buffer_load_dwordx4 a[108:111], v7, s[4:7], s91 offen offset:3072 sc1
    v_mfma_f32_16x16x32_bf16 v[136:139], a[56:59], v[208:211], v[136:139]
    v_add_f32 v161, 0x3727c5ac, v161
    v_mfma_f32_16x16x32_bf16 v[140:143], a[60:63], v[208:211], v[140:143]
    ds_read_b128 v[208:211], v1 offset:10240
    s_waitcnt lgkmcnt(5)
    v_mfma_f32_16x16x32_bf16 v[156:159], a[60:63], v[212:215], v[156:159]
    v_rsq_f32 v162, v161
    v_mfma_f32_16x16x32_bf16 v[152:155], a[56:59], v[212:215], v[152:155]
    ds_write2_b32 v58, v162, v163 offset0:0 offset1:64
    v_mfma_f32_16x16x32_bf16 v[148:151], a[52:55], v[212:215], v[148:151]
    ds_read2_b32 v[160:161], v59 offset0:0 offset1:64
    v_mfma_f32_16x16x32_bf16 v[144:147], a[48:51], v[212:215], v[144:147]
    ds_read_b128 v[212:215], v1 offset:11264
    s_waitcnt vmcnt(11)
    s_waitcnt lgkmcnt(7)
    v_mfma_f32_16x16x32_bf16 v[64:67], v[192:195], a[64:67], v[64:67]
    ds_read2_b32 v[162:163], v59 offset0:16 offset1:80
    v_mfma_f32_16x16x32_bf16 v[68:71], v[192:195], a[68:71], v[68:71]
    buffer_load_dwordx4 a[48:51], v4, s[4:7], s92 offen offset:0 sc1
    v_mfma_f32_16x16x32_bf16 v[72:75], v[192:195], a[72:75], v[72:75]
    ds_read2_b32 v[164:165], v59 offset0:32 offset1:96
    v_mfma_f32_16x16x32_bf16 v[76:79], v[192:195], a[76:79], v[76:79]
    ds_read_b128 v[192:195], v1 offset:12288
    s_waitcnt lgkmcnt(9)
    v_mfma_f32_16x16x32_bf16 v[92:95], v[196:199], a[76:79], v[92:95]
    s_add_u32 m0, s57, 49152
    s_add_u32 s63, s101, 14680064
    v_mfma_f32_16x16x32_bf16 v[88:91], v[196:199], a[72:75], v[88:91]
    buffer_load_dwordx4 v10, s[4:7], s63 offen offset:0 lds
    v_mfma_f32_16x16x32_bf16 v[84:87], v[196:199], a[68:71], v[84:87]
    ds_read2_b32 v[166:167], v59 offset0:48 offset1:112
    v_mfma_f32_16x16x32_bf16 v[80:83], v[196:199], a[64:67], v[80:83]
    ds_read_b128 v[196:199], v1 offset:13312
    s_waitcnt lgkmcnt(10)
    v_mfma_f32_16x16x32_bf16 v[96:99], v[200:203], a[64:67], v[96:99]
    ds_read_b128 v[224:227], v51 offset:0
    v_mfma_f32_16x16x32_bf16 v[100:103], v[200:203], a[68:71], v[100:103]
    buffer_load_dwordx4 a[52:55], v5, s[4:7], s92 offen offset:0 sc1
    v_mfma_f32_16x16x32_bf16 v[104:107], v[200:203], a[72:75], v[104:107]
    ds_read_b128 v[228:231], v51 offset:64
    v_mfma_f32_16x16x32_bf16 v[108:111], v[200:203], a[76:79], v[108:111]
    ds_read_b128 v[200:203], v1 offset:14336
    s_waitcnt lgkmcnt(12)
    v_mfma_f32_16x16x32_bf16 v[124:127], v[204:207], a[76:79], v[124:127]
    ds_read_b128 v[232:235], v51 offset:128
    v_mfma_f32_16x16x32_bf16 v[120:123], v[204:207], a[72:75], v[120:123]
    buffer_load_dwordx4 a[56:59], v6, s[4:7], s92 offen offset:0 sc1
    v_mfma_f32_16x16x32_bf16 v[116:119], v[204:207], a[68:71], v[116:119]
    ds_read_b128 v[236:239], v51 offset:192
    v_mfma_f32_16x16x32_bf16 v[112:115], v[204:207], a[64:67], v[112:115]
    ds_read_b128 v[204:207], v1 offset:15360
    s_waitcnt lgkmcnt(14)
    v_mfma_f32_16x16x32_bf16 v[128:131], a[64:67], v[208:211], v[128:131]
    ds_read_b128 v[240:243], v51 offset:256
    v_mfma_f32_16x16x32_bf16 v[132:135], a[68:71], v[208:211], v[132:135]
    buffer_load_dwordx4 v10, s[4:7], s63 offen offset:1024 lds
    v_mfma_f32_16x16x32_bf16 v[136:139], a[72:75], v[208:211], v[136:139]
    ds_read_b128 v[244:247], v51 offset:320
    v_mfma_f32_16x16x32_bf16 v[140:143], a[76:79], v[208:211], v[140:143]
    ds_read_b128 v[208:211], v1 offset:16384
    s_waitcnt lgkmcnt(14)
    v_mfma_f32_16x16x32_bf16 v[156:159], a[76:79], v[212:215], v[156:159]
    ds_read_b128 v[248:251], v51 offset:384
    v_mfma_f32_16x16x32_bf16 v[152:155], a[72:75], v[212:215], v[152:155]
    buffer_load_dwordx4 a[60:63], v7, s[4:7], s92 offen offset:0 sc1
    v_mfma_f32_16x16x32_bf16 v[148:151], a[68:71], v[212:215], v[148:151]
    ds_read_b128 v[252:255], v51 offset:448
    v_mfma_f32_16x16x32_bf16 v[144:147], a[64:67], v[212:215], v[144:147]
    ds_read_b128 v[212:215], v1 offset:17408
    s_waitcnt vmcnt(11)
    s_waitcnt lgkmcnt(14)
    v_mfma_f32_16x16x32_bf16 v[64:67], v[192:195], a[80:83], v[64:67]
    ds_read_b128 v[168:171], v56 offset:448
    v_mfma_f32_16x16x32_bf16 v[68:71], v[192:195], a[84:87], v[68:71]
    buffer_load_dwordx4 a[64:67], v4, s[4:7], s92 offen offset:1024 sc1
    v_mfma_f32_16x16x32_bf16 v[72:75], v[192:195], a[88:91], v[72:75]
    ds_read_b128 v[172:175], v56 offset:512
    v_mfma_f32_16x16x32_bf16 v[76:79], v[192:195], a[92:95], v[76:79]
    ds_read_b128 v[192:195], v1 offset:18432
    s_waitcnt lgkmcnt(15)
    v_mfma_f32_16x16x32_bf16 v[92:95], v[196:199], a[92:95], v[92:95]
    ds_read_b128 v[176:179], v56 offset:576
    v_mfma_f32_16x16x32_bf16 v[88:91], v[196:199], a[88:91], v[88:91]
    buffer_load_dwordx4 a[68:71], v5, s[4:7], s92 offen offset:1024 sc1
    v_mfma_f32_16x16x32_bf16 v[84:87], v[196:199], a[84:87], v[84:87]
    ds_read_b128 v[180:183], v56 offset:640
    v_mfma_f32_16x16x32_bf16 v[80:83], v[196:199], a[80:83], v[80:83]
    ds_read_b128 v[196:199], v1 offset:19456
    s_waitcnt lgkmcnt(15)
    v_mfma_f32_16x16x32_bf16 v[96:99], v[200:203], a[80:83], v[96:99]
    ds_read2_b32 v[184:185], v53 offset0:160 offset1:176
    v_mfma_f32_16x16x32_bf16 v[100:103], v[200:203], a[84:87], v[100:103]
    buffer_load_dwordx4 v10, s[4:7], s63 offen offset:2048 lds
    v_mfma_f32_16x16x32_bf16 v[104:107], v[200:203], a[88:91], v[104:107]
    v_mfma_f32_16x16x32_bf16 v[108:111], v[200:203], a[92:95], v[108:111]
    ds_read_b128 v[200:203], v1 offset:20480
    s_waitcnt lgkmcnt(14)
    v_mfma_f32_16x16x32_bf16 v[124:127], v[204:207], a[92:95], v[124:127]
    v_mfma_f32_16x16x32_bf16 v[120:123], v[204:207], a[88:91], v[120:123]
    buffer_load_dwordx4 a[72:75], v6, s[4:7], s92 offen offset:1024 sc1
    v_mfma_f32_16x16x32_bf16 v[116:119], v[204:207], a[84:87], v[116:119]
    v_mfma_f32_16x16x32_bf16 v[112:115], v[204:207], a[80:83], v[112:115]
    ds_read_b128 v[204:207], v1 offset:21504
    s_waitcnt lgkmcnt(12)
    v_mfma_f32_16x16x32_bf16 v[128:131], a[80:83], v[208:211], v[128:131]
    v_mfma_f32_16x16x32_bf16 v[132:135], a[84:87], v[208:211], v[132:135]
    buffer_load_dwordx4 a[76:79], v7, s[4:7], s92 offen offset:1024 sc1
    v_mfma_f32_16x16x32_bf16 v[136:139], a[88:91], v[208:211], v[136:139]
    v_mfma_f32_16x16x32_bf16 v[140:143], a[92:95], v[208:211], v[140:143]
    ds_read_b128 v[208:211], v1 offset:22528
    s_waitcnt lgkmcnt(10)
    v_mfma_f32_16x16x32_bf16 v[156:159], a[92:95], v[212:215], v[156:159]
    v_mfma_f32_16x16x32_bf16 v[152:155], a[88:91], v[212:215], v[152:155]
    v_mfma_f32_16x16x32_bf16 v[148:151], a[84:87], v[212:215], v[148:151]
    v_mfma_f32_16x16x32_bf16 v[144:147], a[80:83], v[212:215], v[144:147]
    ds_read_b128 v[212:215], v1 offset:23552
    s_waitcnt vmcnt(11)
    s_barrier
    s_waitcnt lgkmcnt(8)
    v_mfma_f32_16x16x32_bf16 v[64:67], v[192:195], a[96:99], v[64:67]
    v_mfma_f32_16x16x32_bf16 v[68:71], v[192:195], a[100:103], v[68:71]
    buffer_load_dwordx4 a[80:83], v6, s[4:7], s92 offen offset:2048 sc1
    v_mfma_f32_16x16x32_bf16 v[72:75], v[192:195], a[104:107], v[72:75]
    v_mfma_f32_16x16x32_bf16 v[76:79], v[192:195], a[108:111], v[76:79]
    ds_read_b128 v[192:195], v1 offset:24576
    s_waitcnt lgkmcnt(6)
    v_mfma_f32_16x16x32_bf16 v[92:95], v[196:199], a[108:111], v[92:95]
    v_mfma_f32_16x16x32_bf16 v[88:91], v[196:199], a[104:107], v[88:91]
    buffer_load_dwordx4 v10, s[4:7], s63 offen offset:3072 lds
    v_mfma_f32_16x16x32_bf16 v[84:87], v[196:199], a[100:103], v[84:87]
    v_mfma_f32_16x16x32_bf16 v[80:83], v[196:199], a[96:99], v[80:83]
    ds_read_b128 v[196:199], v1 offset:25600
    s_waitcnt lgkmcnt(5)
    v_mfma_f32_16x16x32_bf16 v[96:99], v[200:203], a[96:99], v[96:99]
    v_fmac_f32 v156, v185, v252
    v_fmac_f32 v157, v185, v253
    v_mfma_f32_16x16x32_bf16 v[100:103], v[200:203], a[100:103], v[100:103]
    buffer_load_dwordx4 a[84:87], v7, s[4:7], s92 offen offset:2048 sc1
    v_mfma_f32_16x16x32_bf16 v[104:107], v[200:203], a[104:107], v[104:107]
    v_fmac_f32 v158, v185, v254
    v_fmac_f32 v159, v185, v255
    v_mfma_f32_16x16x32_bf16 v[108:111], v[200:203], a[108:111], v[108:111]
    ds_read_b128 v[200:203], v1 offset:26624
    s_waitcnt lgkmcnt(5)
    v_mfma_f32_16x16x32_bf16 v[124:127], v[204:207], a[108:111], v[124:127]
    v_fmac_f32 v76, v168, v167
    v_fmac_f32 v77, v169, v167
    v_mfma_f32_16x16x32_bf16 v[120:123], v[204:207], a[104:107], v[120:123]
    buffer_load_dwordx4 a[88:91], v6, s[4:7], s92 offen offset:3072 sc1
    v_mfma_f32_16x16x32_bf16 v[116:119], v[204:207], a[100:103], v[116:119]
    v_fmac_f32 v78, v170, v167
    v_fmac_f32 v79, v171, v167
    v_mfma_f32_16x16x32_bf16 v[112:115], v[204:207], a[96:99], v[112:115]
    ds_read_b128 v[204:207], v1 offset:27648
    s_waitcnt lgkmcnt(5)
    v_mfma_f32_16x16x32_bf16 v[128:131], a[96:99], v[208:211], v[128:131]
    s_add_u32 m0, s57, 53248
    s_add_u32 s63, s101, 14684160
    v_mfma_f32_16x16x32_bf16 v[132:135], a[100:103], v[208:211], v[132:135]
    buffer_load_dwordx4 v10, s[4:7], s63 offen offset:0 lds
    v_mfma_f32_16x16x32_bf16 v[136:139], a[104:107], v[208:211], v[136:139]
    v_fmac_f32 v92, v172, v167
    v_fmac_f32 v93, v173, v167
    v_mfma_f32_16x16x32_bf16 v[140:143], a[108:111], v[208:211], v[140:143]
    ds_read_b128 v[208:211], v1 offset:28672
    s_waitcnt lgkmcnt(5)
    v_mfma_f32_16x16x32_bf16 v[156:159], a[108:111], v[212:215], v[156:159]
    v_fmac_f32 v108, v176, v167
    v_fmac_f32 v109, v177, v167
    v_mfma_f32_16x16x32_bf16 v[152:155], a[104:107], v[212:215], v[152:155]
    buffer_load_dwordx4 a[92:95], v7, s[4:7], s92 offen offset:3072 sc1
    v_mfma_f32_16x16x32_bf16 v[148:151], a[100:103], v[212:215], v[148:151]
    v_fmac_f32 v110, v178, v167
    v_fmac_f32 v111, v179, v167
    v_mfma_f32_16x16x32_bf16 v[144:147], a[96:99], v[212:215], v[144:147]
    ds_read_b128 v[212:215], v1 offset:29696
    s_waitcnt vmcnt(11)
    s_waitcnt lgkmcnt(5)
    v_mfma_f32_16x16x32_bf16 v[64:67], v[192:195], a[48:51], v[64:67]
    v_fmac_f32 v124, v180, v167
    v_fmac_f32 v125, v181, v167
    v_mfma_f32_16x16x32_bf16 v[68:71], v[192:195], a[52:55], v[68:71]
    buffer_load_dwordx4 a[96:99], v6, s[4:7], s93 offen offset:0 sc1
    v_mfma_f32_16x16x32_bf16 v[72:75], v[192:195], a[56:59], v[72:75]
    v_fmac_f32 v126, v182, v167
    v_fmac_f32 v127, v183, v167
    v_mfma_f32_16x16x32_bf16 v[76:79], v[192:195], a[60:63], v[76:79]
    ds_read_b128 v[192:195], v1 offset:30720
    s_waitcnt lgkmcnt(5)
    v_mfma_f32_16x16x32_bf16 v[92:95], v[196:199], a[60:63], v[92:95]
    v_fmac_f32 v140, v184, v252
    v_fmac_f32 v141, v184, v253
    v_mfma_f32_16x16x32_bf16 v[88:91], v[196:199], a[56:59], v[88:91]
    buffer_load_dwordx4 a[100:103], v7, s[4:7], s93 offen offset:0 sc1
    v_mfma_f32_16x16x32_bf16 v[84:87], v[196:199], a[52:55], v[84:87]
    v_fmac_f32 v142, v184, v254
    v_fmac_f32 v143, v184, v255
    v_mfma_f32_16x16x32_bf16 v[80:83], v[196:199], a[48:51], v[80:83]
    ds_read_b128 v[196:199], v1 offset:31744
    s_waitcnt lgkmcnt(5)
    v_mfma_f32_16x16x32_bf16 v[96:99], v[200:203], a[48:51], v[96:99]
    v_fmac_f32 v152, v185, v248
    v_fmac_f32 v153, v185, v249
    v_mfma_f32_16x16x32_bf16 v[100:103], v[200:203], a[52:55], v[100:103]
    buffer_load_dwordx4 v10, s[4:7], s63 offen offset:1024 lds
    v_mfma_f32_16x16x32_bf16 v[104:107], v[200:203], a[56:59], v[104:107]
    v_fmac_f32 v154, v185, v250
    v_fmac_f32 v155, v185, v251
    v_mfma_f32_16x16x32_bf16 v[108:111], v[200:203], a[60:63], v[108:111]
    ds_read_b128 v[200:203], v1 offset:32768
    s_waitcnt lgkmcnt(5)
    v_mfma_f32_16x16x32_bf16 v[124:127], v[204:207], a[60:63], v[124:127]
    v_fmac_f32 v72, v168, v165
    v_fmac_f32 v73, v169, v165
    v_mfma_f32_16x16x32_bf16 v[120:123], v[204:207], a[56:59], v[120:123]
    buffer_load_dwordx4 a[104:107], v6, s[4:7], s93 offen offset:1024 sc1
    v_mfma_f32_16x16x32_bf16 v[116:119], v[204:207], a[52:55], v[116:119]
    s_add_u32 s20, s48, L_epi1-L_pc
    s_addc_u32 s21, s49, 0
    global_load_dword v52, v35, s[20:21]
    v_mfma_f32_16x16x32_bf16 v[112:115], v[204:207], a[48:51], v[112:115]
    ds_read_b128 v[204:207], v1 offset:33792
    s_waitcnt lgkmcnt(5)
    v_mfma_f32_16x16x32_bf16 v[128:131], a[48:51], v[208:211], v[128:131]
    v_fmac_f32 v94, v174, v167
    v_fmac_f32 v95, v175, v167
    v_mfma_f32_16x16x32_bf16 v[132:135], a[52:55], v[208:211], v[132:135]
    buffer_load_dwordx4 a[108:111], v7, s[4:7], s93 offen offset:1024 sc1
    v_mfma_f32_16x16x32_bf16 v[136:139], a[56:59], v[208:211], v[136:139]
    v_fmac_f32 v88, v172, v165
    v_fmac_f32 v89, v173, v165
    v_mfma_f32_16x16x32_bf16 v[140:143], a[60:63], v[208:211], v[140:143]
    ds_read_b128 v[208:211], v1 offset:34816
    s_waitcnt lgkmcnt(5)
    v_mfma_f32_16x16x32_bf16 v[156:159], a[60:63], v[212:215], v[156:159]
    v_fmac_f32 v104, v176, v165
    v_fmac_f32 v105, v177, v165
    v_mfma_f32_16x16x32_bf16 v[152:155], a[56:59], v[212:215], v[152:155]
    v_fmac_f32 v106, v178, v165
    v_fmac_f32 v107, v179, v165
    v_mfma_f32_16x16x32_bf16 v[148:151], a[52:55], v[212:215], v[148:151]
    v_fmac_f32 v100, v176, v163
    v_fmac_f32 v101, v177, v163
    v_mfma_f32_16x16x32_bf16 v[144:147], a[48:51], v[212:215], v[144:147]
    ds_read_b128 v[212:215], v1 offset:35840
    s_waitcnt vmcnt(12)
    s_waitcnt lgkmcnt(5)
    v_mfma_f32_16x16x32_bf16 v[64:67], v[192:195], a[64:67], v[64:67]
    v_fmac_f32 v120, v180, v165
    v_fmac_f32 v121, v181, v165
    v_mfma_f32_16x16x32_bf16 v[68:71], v[192:195], a[68:71], v[68:71]
    buffer_load_dwordx4 a[48:51], v6, s[4:7], s93 offen offset:2048 sc1
    v_mfma_f32_16x16x32_bf16 v[72:75], v[192:195], a[72:75], v[72:75]
    v_fmac_f32 v122, v182, v165
    v_fmac_f32 v123, v183, v165
    v_mfma_f32_16x16x32_bf16 v[76:79], v[192:195], a[76:79], v[76:79]
    ds_read_b128 v[192:195], v1 offset:36864
    s_waitcnt lgkmcnt(5)
    v_mfma_f32_16x16x32_bf16 v[92:95], v[196:199], a[76:79], v[92:95]
    s_add_u32 m0, s57, 73728
    s_mov_b32 s63, 23126016
    v_mfma_f32_16x16x32_bf16 v[88:91], v[196:199], a[72:75], v[88:91]
    buffer_load_dwordx4 v11, s[4:7], s63 offen offset:0 lds
    v_mfma_f32_16x16x32_bf16 v[84:87], v[196:199], a[68:71], v[84:87]
    v_fmac_f32 v136, v184, v248
    v_fmac_f32 v137, v184, v249
    v_mfma_f32_16x16x32_bf16 v[80:83], v[196:199], a[64:67], v[80:83]
    ds_read_b128 v[196:199], v1 offset:37888
    s_waitcnt lgkmcnt(5)
    v_mfma_f32_16x16x32_bf16 v[96:99], v[200:203], a[64:67], v[96:99]
    v_fmac_f32 v148, v185, v244
    v_fmac_f32 v149, v185, v245
    v_mfma_f32_16x16x32_bf16 v[100:103], v[200:203], a[68:71], v[100:103]
    buffer_load_dwordx4 a[52:55], v7, s[4:7], s93 offen offset:2048 sc1
    v_mfma_f32_16x16x32_bf16 v[104:107], v[200:203], a[72:75], v[104:107]
    v_fmac_f32 v150, v185, v246
    v_fmac_f32 v151, v185, v247
    v_mfma_f32_16x16x32_bf16 v[108:111], v[200:203], a[76:79], v[108:111]
    ds_read_b128 v[200:203], v1 offset:38912
    s_waitcnt lgkmcnt(5)
    v_mfma_f32_16x16x32_bf16 v[124:127], v[204:207], a[76:79], v[124:127]
    v_fmac_f32 v74, v170, v165
    v_fmac_f32 v75, v171, v165
    v_mfma_f32_16x16x32_bf16 v[120:123], v[204:207], a[72:75], v[120:123]
    buffer_load_dwordx4 a[56:59], v6, s[4:7], s93 offen offset:3072 sc1
    v_mfma_f32_16x16x32_bf16 v[116:119], v[204:207], a[68:71], v[116:119]
    v_fmac_f32 v68, v168, v163
    v_fmac_f32 v69, v169, v163
    v_mfma_f32_16x16x32_bf16 v[112:115], v[204:207], a[64:67], v[112:115]
    ds_read_b128 v[204:207], v1 offset:39936
    s_waitcnt lgkmcnt(5)
    v_mfma_f32_16x16x32_bf16 v[128:131], a[64:67], v[208:211], v[128:131]
    v_fmac_f32 v90, v174, v165
    v_fmac_f32 v91, v175, v165
    v_mfma_f32_16x16x32_bf16 v[132:135], a[68:71], v[208:211], v[132:135]
    buffer_load_dwordx4 v11, s[4:7], s63 offen offset:1024 lds
    v_mfma_f32_16x16x32_bf16 v[136:139], a[72:75], v[208:211], v[136:139]
    v_fmac_f32 v84, v172, v163
    v_fmac_f32 v85, v173, v163
    v_mfma_f32_16x16x32_bf16 v[140:143], a[76:79], v[208:211], v[140:143]
    ds_read_b128 v[208:211], v1 offset:40960
    s_waitcnt lgkmcnt(5)
    v_mfma_f32_16x16x32_bf16 v[156:159], a[76:79], v[212:215], v[156:159]
    v_fmac_f32 v102, v178, v163
    v_fmac_f32 v103, v179, v163
    v_mfma_f32_16x16x32_bf16 v[152:155], a[72:75], v[212:215], v[152:155]
    buffer_load_dwordx4 a[60:63], v7, s[4:7], s93 offen offset:3072 sc1
    v_mfma_f32_16x16x32_bf16 v[148:151], a[68:71], v[212:215], v[148:151]
    v_fmac_f32 v96, v176, v161
    v_fmac_f32 v97, v177, v161
    v_mfma_f32_16x16x32_bf16 v[144:147], a[64:67], v[212:215], v[144:147]
    ds_read_b128 v[212:215], v1 offset:41984
    s_waitcnt vmcnt(15)
    s_waitcnt lgkmcnt(5)
    v_mfma_f32_16x16x32_bf16 v[72:75], v[192:195], a[80:83], v[72:75]
    buffer_load_dwordx4 a[64:67], v4, s[4:7], s92 offen offset:2048 sc1
    v_mfma_f32_16x16x32_bf16 v[76:79], v[192:195], a[84:87], v[76:79]
    ds_read_b128 v[192:195], v1 offset:43008
    v_fmac_f32 v116, v180, v163
    v_fmac_f32 v117, v181, v163
    s_waitcnt lgkmcnt(5)
    v_mfma_f32_16x16x32_bf16 v[92:95], v[196:199], a[84:87], v[92:95]
    v_fmac_f32 v138, v184, v250
    v_fmac_f32 v139, v184, v251
    v_mfma_f32_16x16x32_bf16 v[88:91], v[196:199], a[80:83], v[88:91]
    ds_read_b128 v[196:199], v1 offset:44032
    v_fmac_f32 v132, v184, v244
    v_fmac_f32 v133, v184, v245
    s_waitcnt lgkmcnt(5)
    v_mfma_f32_16x16x32_bf16 v[104:107], v[200:203], a[80:83], v[104:107]
    buffer_load_dwordx4 v11, s[4:7], s63 offen offset:2048 lds
    v_mfma_f32_16x16x32_bf16 v[108:111], v[200:203], a[84:87], v[108:111]
    ds_read_b128 v[200:203], v1 offset:45056
    v_fmac_f32 v144, v185, v240
    v_fmac_f32 v145, v185, v241
    s_waitcnt lgkmcnt(5)
    v_mfma_f32_16x16x32_bf16 v[124:127], v[204:207], a[84:87], v[124:127]
    s_add_u32 s20, s48, L_ool-L_pc
    s_addc_u32 s21, s49, 0
    global_load_dword v52, v35, s[20:21]
    v_mfma_f32_16x16x32_bf16 v[120:123], v[204:207], a[80:83], v[120:123]
    ds_read_b128 v[204:207], v1 offset:46080
    v_fmac_f32 v70, v170, v163
    v_fmac_f32 v71, v171, v163
    s_waitcnt lgkmcnt(5)
    v_mfma_f32_16x16x32_bf16 v[136:139], a[80:83], v[208:211], v[136:139]
    buffer_load_dwordx4 a[68:71], v5, s[4:7], s92 offen offset:2048 sc1
    v_mfma_f32_16x16x32_bf16 v[140:143], a[84:87], v[208:211], v[140:143]
    ds_read_b128 v[208:211], v1 offset:47104
    v_fmac_f32 v86, v174, v163
    v_fmac_f32 v87, v175, v163
    s_waitcnt lgkmcnt(5)
    v_mfma_f32_16x16x32_bf16 v[156:159], a[84:87], v[212:215], v[156:159]
    v_fmac_f32 v98, v178, v161
    v_fmac_f32 v99, v179, v161
    v_mfma_f32_16x16x32_bf16 v[152:155], a[80:83], v[212:215], v[152:155]
    ds_read_b128 v[212:215], v1 offset:48128
    v_mul_f32 v220, 0x3e8293ee, v160
    v_mul_f32 v221, 0x3e8293ee, v162
    s_waitcnt vmcnt(16)
    s_waitcnt vmcnt(13)
    s_barrier
    s_waitcnt lgkmcnt(5)
    v_mfma_f32_16x16x32_bf16 v[72:75], v[192:195], a[88:91], v[72:75]
    buffer_load_dwordx4 a[72:75], v4, s[4:7], s92 offen offset:3072 sc1
    v_mfma_f32_16x16x32_bf16 v[76:79], v[192:195], a[92:95], v[76:79]
    ds_read_b128 v[192:195], v1 offset:49152
    v_fmac_f32 v118, v182, v163
    v_fmac_f32 v119, v183, v163
    s_waitcnt lgkmcnt(5)
    v_mfma_f32_16x16x32_bf16 v[92:95], v[196:199], a[92:95], v[92:95]
    v_fmac_f32 v134, v184, v246
    v_fmac_f32 v135, v184, v247
    v_mfma_f32_16x16x32_bf16 v[88:91], v[196:199], a[88:91], v[88:91]
    ds_read_b128 v[196:199], v1 offset:50176
    v_fmac_f32 v128, v184, v240
    v_fmac_f32 v129, v184, v241
    s_waitcnt lgkmcnt(5)
    v_mfma_f32_16x16x32_bf16 v[104:107], v[200:203], a[88:91], v[104:107]
    buffer_load_dwordx4 v11, s[4:7], s63 offen offset:3072 lds
    v_mfma_f32_16x16x32_bf16 v[108:111], v[200:203], a[92:95], v[108:111]
    ds_read_b128 v[200:203], v1 offset:51200
    v_fmac_f32 v146, v185, v242
    v_fmac_f32 v147, v185, v243
    s_waitcnt lgkmcnt(5)
    v_mfma_f32_16x16x32_bf16 v[124:127], v[204:207], a[92:95], v[124:127]
    v_fmac_f32 v64, v168, v161
    v_fmac_f32 v65, v169, v161
    v_mfma_f32_16x16x32_bf16 v[120:123], v[204:207], a[88:91], v[120:123]
    ds_read_b128 v[204:207], v1 offset:52224
    v_fmac_f32 v66, v170, v161
    v_fmac_f32 v67, v171, v161
    s_waitcnt lgkmcnt(5)
    v_mfma_f32_16x16x32_bf16 v[136:139], a[88:91], v[208:211], v[136:139]
    buffer_load_dwordx4 a[76:79], v5, s[4:7], s92 offen offset:3072 sc1
    v_mfma_f32_16x16x32_bf16 v[140:143], a[92:95], v[208:211], v[140:143]
    ds_read_b128 v[208:211], v1 offset:53248
    v_fmac_f32 v80, v172, v161
    v_fmac_f32 v81, v173, v161
    s_waitcnt lgkmcnt(5)
    v_mfma_f32_16x16x32_bf16 v[156:159], a[92:95], v[212:215], v[156:159]
    v_fmac_f32 v82, v174, v161
    v_fmac_f32 v83, v175, v161
    v_mfma_f32_16x16x32_bf16 v[152:155], a[88:91], v[212:215], v[152:155]
    ds_read_b128 v[212:215], v1 offset:54272
    v_fmac_f32 v112, v180, v161
    v_fmac_f32 v113, v181, v161
    s_waitcnt lgkmcnt(5)
    v_mfma_f32_16x16x32_bf16 v[72:75], v[192:195], a[96:99], v[72:75]
    buffer_load_dwordx4 a[80:83], v4, s[4:7], s93 offen offset:0 sc1
    v_mfma_f32_16x16x32_bf16 v[76:79], v[192:195], a[100:103], v[76:79]
    ds_read_b128 v[192:195], v1 offset:55296
    v_fmac_f32 v114, v182, v161
    v_fmac_f32 v115, v183, v161
    s_waitcnt lgkmcnt(5)
    v_mfma_f32_16x16x32_bf16 v[92:95], v[196:199], a[100:103], v[92:95]
    v_fmac_f32 v130, v184, v242
    v_fmac_f32 v131, v184, v243
    v_mfma_f32_16x16x32_bf16 v[88:91], v[196:199], a[96:99], v[88:91]
    ds_read_b128 v[196:199], v1 offset:56320
    v_mul_f32 v222, 0x3e8293ee, v164
    v_mul_f32 v223, 0x3e8293ee, v166
    s_waitcnt lgkmcnt(5)
    v_mfma_f32_16x16x32_bf16 v[104:107], v[200:203], a[96:99], v[104:107]
    s_add_u32 m0, s57, 77824
    s_mov_b32 s63, 23130112
    buffer_load_dwordx4 v11, s[4:7], s63 offen offset:0 lds
    v_mfma_f32_16x16x32_bf16 v[108:111], v[200:203], a[100:103], v[108:111]
    ds_read_b128 v[200:203], v1 offset:57344
    s_waitcnt lgkmcnt(5)
    v_mfma_f32_16x16x32_bf16 v[124:127], v[204:207], a[100:103], v[124:127]
    s_mov_b32 s20, 29360128
    buffer_load_dword v52, v50, s[4:7], s20 offen sc1
    v_mfma_f32_16x16x32_bf16 v[120:123], v[204:207], a[96:99], v[120:123]
    ds_read_b128 v[204:207], v1 offset:58368
    s_waitcnt lgkmcnt(5)
    v_mfma_f32_16x16x32_bf16 v[136:139], a[96:99], v[208:211], v[136:139]
    buffer_load_dwordx4 a[84:87], v5, s[4:7], s93 offen offset:0 sc1
    v_mfma_f32_16x16x32_bf16 v[140:143], a[100:103], v[208:211], v[140:143]
    ds_read_b128 v[208:211], v1 offset:59392
    s_waitcnt lgkmcnt(5)
    v_mfma_f32_16x16x32_bf16 v[156:159], a[100:103], v[212:215], v[156:159]
    v_mfma_f32_16x16x32_bf16 v[152:155], a[96:99], v[212:215], v[152:155]
    ds_read_b128 v[212:215], v1 offset:60416
    s_waitcnt vmcnt(17)
    s_waitcnt lgkmcnt(5)
    v_mfma_f32_16x16x32_bf16 v[72:75], v[192:195], a[104:107], v[72:75]
    buffer_load_dwordx4 a[88:91], v4, s[4:7], s93 offen offset:1024 sc1
    v_mfma_f32_16x16x32_bf16 v[76:79], v[192:195], a[108:111], v[76:79]
    ds_read_b128 v[192:195], v1 offset:61440
    s_waitcnt lgkmcnt(5)
    v_mfma_f32_16x16x32_bf16 v[92:95], v[196:199], a[108:111], v[92:95]
    v_mfma_f32_16x16x32_bf16 v[88:91], v[196:199], a[104:107], v[88:91]
    ds_read_b128 v[196:199], v1 offset:62464
    s_waitcnt lgkmcnt(5)
    v_mfma_f32_16x16x32_bf16 v[104:107], v[200:203], a[104:107], v[104:107]
    buffer_load_dwordx4 v11, s[4:7], s63 offen offset:1024 lds
    v_mfma_f32_16x16x32_bf16 v[108:111], v[200:203], a[108:111], v[108:111]
    ds_read_b128 v[200:203], v1 offset:63488
    s_waitcnt lgkmcnt(5)
    v_mfma_f32_16x16x32_bf16 v[124:127], v[204:207], a[108:111], v[124:127]
    v_mfma_f32_16x16x32_bf16 v[120:123], v[204:207], a[104:107], v[120:123]
    ds_read_b128 v[204:207], v1 offset:64512
    s_waitcnt lgkmcnt(5)
    v_mfma_f32_16x16x32_bf16 v[136:139], a[104:107], v[208:211], v[136:139]
    buffer_load_dwordx4 a[92:95], v5, s[4:7], s93 offen offset:1024 sc1
    v_mfma_f32_16x16x32_bf16 v[140:143], a[108:111], v[208:211], v[140:143]
    ds_read_b128 v[208:211], v2 offset:0
    s_waitcnt lgkmcnt(5)
    v_mfma_f32_16x16x32_bf16 v[156:159], a[108:111], v[212:215], v[156:159]
    v_mfma_f32_16x16x32_bf16 v[152:155], a[104:107], v[212:215], v[152:155]
    ds_read_b128 v[212:215], v2 offset:1024
    s_waitcnt vmcnt(17)
    s_waitcnt lgkmcnt(5)
    v_mfma_f32_16x16x32_bf16 v[72:75], v[192:195], a[48:51], v[72:75]
    buffer_load_dwordx4 a[96:99], v4, s[4:7], s93 offen offset:2048 sc1
    v_mfma_f32_16x16x32_bf16 v[76:79], v[192:195], a[52:55], v[76:79]
    ds_read_b128 v[192:195], v2 offset:2048
    s_waitcnt lgkmcnt(5)
    v_mfma_f32_16x16x32_bf16 v[92:95], v[196:199], a[52:55], v[92:95]
    v_mfma_f32_16x16x32_bf16 v[88:91], v[196:199], a[48:51], v[88:91]
    ds_read_b128 v[196:199], v2 offset:3072
    s_waitcnt lgkmcnt(5)
    v_mfma_f32_16x16x32_bf16 v[104:107], v[200:203], a[48:51], v[104:107]
    s_add_u32 m0, s57, 98304
    s_mov_b32 s63, 23150592
    buffer_load_dwordx4 v11, s[4:7], s63 offen offset:0 lds
    v_mfma_f32_16x16x32_bf16 v[108:111], v[200:203], a[52:55], v[108:111]
    ds_read_b128 v[200:203], v2 offset:4096
    s_waitcnt lgkmcnt(5)
    v_mfma_f32_16x16x32_bf16 v[124:127], v[204:207], a[52:55], v[124:127]
    v_mfma_f32_16x16x32_bf16 v[120:123], v[204:207], a[48:51], v[120:123]
    ds_read_b128 v[204:207], v2 offset:5120
    s_waitcnt lgkmcnt(5)
    v_mfma_f32_16x16x32_bf16 v[136:139], a[48:51], v[208:211], v[136:139]
    buffer_load_dwordx4 a[100:103], v5, s[4:7], s93 offen offset:2048 sc1
    v_mfma_f32_16x16x32_bf16 v[140:143], a[52:55], v[208:211], v[140:143]
    ds_read_b128 v[208:211], v2 offset:6144
    s_waitcnt lgkmcnt(5)
    v_mfma_f32_16x16x32_bf16 v[156:159], a[52:55], v[212:215], v[156:159]
    v_mfma_f32_16x16x32_bf16 v[152:155], a[48:51], v[212:215], v[152:155]
    ds_read_b128 v[212:215], v2 offset:7168
    s_waitcnt vmcnt(17)
    s_waitcnt lgkmcnt(5)
    v_mfma_f32_16x16x32_bf16 v[72:75], v[192:195], a[56:59], v[72:75]
    buffer_load_dwordx4 a[104:107], v4, s[4:7], s93 offen offset:3072 sc1
    v_mfma_f32_16x16x32_bf16 v[76:79], v[192:195], a[60:63], v[76:79]
    ds_read_b128 v[192:195], v1 offset:36864
    s_waitcnt lgkmcnt(5)
    v_mfma_f32_16x16x32_bf16 v[92:95], v[196:199], a[60:63], v[92:95]
    v_mfma_f32_16x16x32_bf16 v[88:91], v[196:199], a[56:59], v[88:91]
    ds_read_b128 v[196:199], v1 offset:37888
    s_waitcnt lgkmcnt(5)
    v_mfma_f32_16x16x32_bf16 v[104:107], v[200:203], a[56:59], v[104:107]
    buffer_load_dwordx4 v11, s[4:7], s63 offen offset:1024 lds
    v_mfma_f32_16x16x32_bf16 v[108:111], v[200:203], a[60:63], v[108:111]
    ds_read_b128 v[200:203], v1 offset:38912
    s_waitcnt lgkmcnt(5)
    v_mfma_f32_16x16x32_bf16 v[124:127], v[204:207], a[60:63], v[124:127]
    v_mfma_f32_16x16x32_bf16 v[120:123], v[204:207], a[56:59], v[120:123]
    ds_read_b128 v[204:207], v1 offset:39936
    s_waitcnt lgkmcnt(5)
    v_mfma_f32_16x16x32_bf16 v[136:139], a[56:59], v[208:211], v[136:139]
    buffer_load_dwordx4 a[108:111], v5, s[4:7], s93 offen offset:3072 sc1
    v_mfma_f32_16x16x32_bf16 v[140:143], a[60:63], v[208:211], v[140:143]
    ds_read_b128 v[208:211], v1 offset:40960
    s_waitcnt lgkmcnt(5)
    v_mfma_f32_16x16x32_bf16 v[156:159], a[60:63], v[212:215], v[156:159]
    v_mfma_f32_16x16x32_bf16 v[152:155], a[56:59], v[212:215], v[152:155]
    ds_read_b128 v[212:215], v1 offset:41984
    s_waitcnt vmcnt(16)
    s_waitcnt lgkmcnt(5)
    v_mfma_f32_16x16x32_bf16 v[64:67], v[192:195], a[64:67], v[64:67]
    buffer_load_dwordx4 v11, s[4:7], s63 offen offset:2048 lds
    v_mfma_f32_16x16x32_bf16 v[68:71], v[192:195], a[68:71], v[68:71]
    ds_read_b128 v[192:195], v1 offset:43008
    v_mul_f32 v108, v108, v166
    v_mul_f32 v109, v109, v166
    s_waitcnt lgkmcnt(5)
    v_mfma_f32_16x16x32_bf16 v[84:87], v[196:199], a[68:71], v[84:87]
    v_mul_f32 v110, v110, v166
    v_mul_f32 v111, v111, v166
    v_mfma_f32_16x16x32_bf16 v[80:83], v[196:199], a[64:67], v[80:83]
    ds_read_b128 v[196:199], v1 offset:44032
    v_mul_f32 v124, v124, v166
    v_mul_f32 v125, v125, v166
    s_waitcnt lgkmcnt(5)
    v_mfma_f32_16x16x32_bf16 v[96:99], v[200:203], a[64:67], v[96:99]
    buffer_load_dwordx4 v11, s[4:7], s63 offen offset:3072 lds
    v_mfma_f32_16x16x32_bf16 v[100:103], v[200:203], a[68:71], v[100:103]
    ds_read_b128 v[200:203], v1 offset:45056
    v_mul_f32 v126, v126, v166
    v_mul_f32 v127, v127, v166
    s_waitcnt lgkmcnt(5)
    v_mfma_f32_16x16x32_bf16 v[116:119], v[204:207], a[68:71], v[116:119]
    v_cvt_pk_bf16_f32 v108, v108, v109
    v_cvt_pk_bf16_f32 v109, v110, v111
    v_mfma_f32_16x16x32_bf16 v[112:115], v[204:207], a[64:67], v[112:115]
    ds_read_b128 v[204:207], v1 offset:46080
    v_cvt_pk_bf16_f32 v110, v124, v125
    v_cvt_pk_bf16_f32 v111, v126, v127
    s_waitcnt lgkmcnt(5)
    v_mfma_f32_16x16x32_bf16 v[128:131], a[64:67], v[208:211], v[128:131]
    s_add_u32 m0, s57, 102400
    s_mov_b32 s63, 23154688
    buffer_load_dwordx4 v11, s[4:7], s63 offen offset:0 lds
    v_mfma_f32_16x16x32_bf16 v[132:135], a[68:71], v[208:211], v[132:135]
    ds_read_b128 v[208:211], v1 offset:47104
    buffer_store_dwordx4 v[108:111], v1, s[4:7], s16 offen sc1
    s_waitcnt lgkmcnt(5)
    v_mfma_f32_16x16x32_bf16 v[148:151], a[68:71], v[212:215], v[148:151]
    v_mul_f32 v140, v140, v236
    v_mul_f32 v141, v141, v237
    v_mfma_f32_16x16x32_bf16 v[144:147], a[64:67], v[212:215], v[144:147]
    ds_read_b128 v[212:215], v1 offset:48128
    v_mul_f32 v142, v142, v238
    v_mul_f32 v143, v143, v239
    s_waitcnt vmcnt(17)
    s_waitcnt lgkmcnt(5)
    v_mfma_f32_16x16x32_bf16 v[64:67], v[192:195], a[72:75], v[64:67]
    buffer_load_dwordx4 v11, s[4:7], s63 offen offset:1024 lds
    v_mfma_f32_16x16x32_bf16 v[68:71], v[192:195], a[76:79], v[68:71]
    ds_read_b128 v[192:195], v1 offset:49152
    v_mul_f32 v156, v156, v236
    v_mul_f32 v157, v157, v237
    s_waitcnt lgkmcnt(5)
    v_mfma_f32_16x16x32_bf16 v[84:87], v[196:199], a[76:79], v[84:87]
    v_mul_f32 v158, v158, v238
    v_mul_f32 v159, v159, v239
    v_mfma_f32_16x16x32_bf16 v[80:83], v[196:199], a[72:75], v[80:83]
    ds_read_b128 v[196:199], v1 offset:50176
    v_cvt_pk_bf16_f32 v248, v140, v141
    v_cvt_pk_bf16_f32 v249, v142, v143
    s_waitcnt lgkmcnt(5)
    v_mfma_f32_16x16x32_bf16 v[96:99], v[200:203], a[72:75], v[96:99]
    s_add_u32 m0, s57, 122880
    s_mov_b32 s63, 23175168
    buffer_load_dwordx4 v11, s[4:7], s63 offen offset:0 lds
    v_mfma_f32_16x16x32_bf16 v[100:103], v[200:203], a[76:79], v[100:103]
    ds_read_b128 v[200:203], v1 offset:51200
    v_cvt_pk_bf16_f32 v250, v156, v157
    v_cvt_pk_bf16_f32 v251, v158, v159
    s_waitcnt lgkmcnt(5)
    v_mfma_f32_16x16x32_bf16 v[116:119], v[204:207], a[76:79], v[116:119]
    buffer_store_dwordx4 v[248:251], v1, s[4:7], s16 offen offset:1024 sc1
    v_mfma_f32_16x16x32_bf16 v[112:115], v[204:207], a[72:75], v[112:115]
    ds_read_b128 v[204:207], v1 offset:52224
    ds_write_b128 v55, v[108:111] offset:1024
    s_waitcnt lgkmcnt(6)
    v_mfma_f32_16x16x32_bf16 v[128:131], a[72:75], v[208:211], v[128:131]
    buffer_load_dwordx4 v11, s[4:7], s63 offen offset:1024 lds
    v_mfma_f32_16x16x32_bf16 v[132:135], a[76:79], v[208:211], v[132:135]
    ds_read_b128 v[208:211], v1 offset:53248
    v_cvt_pk_bf16_f32 v176, v140, v141
    v_cvt_pk_bf16_f32 v177, v142, v143
    s_waitcnt lgkmcnt(6)
    v_mfma_f32_16x16x32_bf16 v[148:151], a[76:79], v[212:215], v[148:151]
    v_cvt_pk_bf16_f32 v186, v156, v157
    v_cvt_pk_bf16_f32 v187, v158, v159
    v_mfma_f32_16x16x32_bf16 v[144:147], a[72:75], v[212:215], v[144:147]
    ds_read_b128 v[212:215], v1 offset:54272
    ds_write_b128 v55, v[248:251] offset:8192
    s_waitcnt vmcnt(17)
    s_waitcnt lgkmcnt(7)
    v_mfma_f32_16x16x32_bf16 v[64:67], v[192:195], a[80:83], v[64:67]
    buffer_load_dwordx4 v11, s[4:7], s63 offen offset:2048 lds
    v_mfma_f32_16x16x32_bf16 v[68:71], v[192:195], a[84:87], v[68:71]
    ds_read_b128 v[192:195], v1 offset:55296
    v_mul_f32 v104, v104, v164
    v_mul_f32 v105, v105, v164
    s_waitcnt lgkmcnt(7)
    v_mfma_f32_16x16x32_bf16 v[84:87], v[196:199], a[84:87], v[84:87]
    v_mul_f32 v106, v106, v164
    v_mul_f32 v107, v107, v164
    v_mfma_f32_16x16x32_bf16 v[80:83], v[196:199], a[80:83], v[80:83]
    ds_read_b128 v[196:199], v1 offset:56320
    v_mul_f32 v120, v120, v164
    v_mul_f32 v121, v121, v164
    s_waitcnt lgkmcnt(7)
    v_mfma_f32_16x16x32_bf16 v[96:99], v[200:203], a[80:83], v[96:99]
    buffer_load_dwordx4 v11, s[4:7], s63 offen offset:3072 lds
    v_mfma_f32_16x16x32_bf16 v[100:103], v[200:203], a[84:87], v[100:103]
    ds_read_b128 v[200:203], v1 offset:57344
    v_mul_f32 v122, v122, v164
    v_mul_f32 v123, v123, v164
    s_waitcnt lgkmcnt(7)
    v_mfma_f32_16x16x32_bf16 v[116:119], v[204:207], a[84:87], v[116:119]
    v_cvt_pk_bf16_f32 v104, v104, v105
    v_cvt_pk_bf16_f32 v105, v106, v107
    v_mfma_f32_16x16x32_bf16 v[112:115], v[204:207], a[80:83], v[112:115]
    ds_read_b128 v[204:207], v1 offset:58368
    v_cvt_pk_bf16_f32 v106, v120, v121
    v_cvt_pk_bf16_f32 v107, v122, v123
    s_waitcnt lgkmcnt(6)
    v_mfma_f32_16x16x32_bf16 v[128:131], a[80:83], v[208:211], v[128:131]
    s_add_u32 m0, s57, 126976
    s_mov_b32 s63, 23179264
    buffer_load_dwordx4 v11, s[4:7], s63 offen offset:0 lds
    v_mfma_f32_16x16x32_bf16 v[132:135], a[84:87], v[208:211], v[132:135]
    ds_read_b128 v[208:211], v1 offset:59392
    v_cvt_pk_bf16_f32 v76, v76, v77
    v_cvt_pk_bf16_f32 v77, v78, v79
    s_waitcnt lgkmcnt(6)
    v_mfma_f32_16x16x32_bf16 v[148:151], a[84:87], v[212:215], v[148:151]
    v_cvt_pk_bf16_f32 v78, v92, v93
    v_cvt_pk_bf16_f32 v79, v94, v95
    v_mfma_f32_16x16x32_bf16 v[144:147], a[80:83], v[212:215], v[144:147]
    ds_read_b128 v[212:215], v1 offset:60416
    v_mfma_f32_16x16x32_bf16 v[124:127], v[108:111], v[76:79], 0
    s_waitcnt vmcnt(17)
    s_waitcnt lgkmcnt(5)
    v_mfma_f32_16x16x32_bf16 v[64:67], v[192:195], a[88:91], v[64:67]
    buffer_load_dwordx4 v11, s[4:7], s63 offen offset:1024 lds
    v_mfma_f32_16x16x32_bf16 v[68:71], v[192:195], a[92:95], v[68:71]
    ds_read_b128 v[192:195], v1 offset:61440
    v_mfma_f32_16x16x32_bf16 v[92:95], v[104:107], v[76:79], 0
    s_waitcnt lgkmcnt(5)
    v_mfma_f32_16x16x32_bf16 v[84:87], v[196:199], a[92:95], v[84:87]
    v_mul_f32 v136, v136, v232
    v_mul_f32 v137, v137, v233
    v_mfma_f32_16x16x32_bf16 v[80:83], v[196:199], a[88:91], v[80:83]
    ds_read_b128 v[196:199], v1 offset:62464
    v_mul_f32 v138, v138, v234
    v_mul_f32 v139, v139, v235
    s_waitcnt lgkmcnt(5)
    v_mfma_f32_16x16x32_bf16 v[96:99], v[200:203], a[88:91], v[96:99]
    s_add_u32 m0, s57, 0
    s_mov_b32 s63, 23068672
    buffer_load_dwordx4 v11, s[4:7], s63 offen offset:0 lds
    v_mfma_f32_16x16x32_bf16 v[100:103], v[200:203], a[92:95], v[100:103]
    ds_read_b128 v[200:203], v1 offset:63488
    v_mul_f32 v152, v152, v232
    v_mul_f32 v153, v153, v233
    s_waitcnt lgkmcnt(5)
    v_mfma_f32_16x16x32_bf16 v[116:119], v[204:207], a[92:95], v[116:119]
    v_mul_f32 v154, v154, v234
    v_mul_f32 v155, v155, v235
    v_mfma_f32_16x16x32_bf16 v[112:115], v[204:207], a[88:91], v[112:115]
    ds_read_b128 v[204:207], v1 offset:64512
    v_cvt_pk_bf16_f32 v174, v136, v137
    v_cvt_pk_bf16_f32 v175, v138, v139
    s_waitcnt lgkmcnt(5)
    v_mfma_f32_16x16x32_bf16 v[128:131], a[88:91], v[208:211], v[128:131]
    v_cvt_pk_bf16_f32 v184, v152, v153
    v_cvt_pk_bf16_f32 v185, v154, v155
    v_mfma_f32_16x16x32_bf16 v[132:135], a[92:95], v[208:211], v[132:135]
    ds_read_b128 v[208:211], v2 offset:0
    s_barrier
    s_waitcnt lgkmcnt(5)
    v_mfma_f32_16x16x32_bf16 v[148:151], a[92:95], v[212:215], v[148:151]
    ds_read_b128 v[188:191], v55
    v_mfma_f32_16x16x32_bf16 v[144:147], a[88:91], v[212:215], v[144:147]
    ds_read_b128 v[212:215], v2 offset:1024
    ds_read_b64 v[168:169], v55 offset:7168
    s_waitcnt vmcnt(16)
    s_waitcnt lgkmcnt(7)
    v_mfma_f32_16x16x32_bf16 v[64:67], v[192:195], a[96:99], v[64:67]
    buffer_load_dwordx4 v11, s[4:7], s63 offen offset:1024 lds
    v_mfma_f32_16x16x32_bf16 v[68:71], v[192:195], a[100:103], v[68:71]
    ds_read_b128 v[192:195], v2 offset:2048
    ds_read_b64 v[178:179], v55 offset:7176
    s_waitcnt lgkmcnt(8)
    v_mfma_f32_16x16x32_bf16 v[84:87], v[196:199], a[100:103], v[84:87]
    v_cndmask_b32 v124, v124, v125, s[36:37]
    v_cndmask_b32 v126, v126, v127, s[36:37]
    v_mfma_f32_16x16x32_bf16 v[80:83], v[196:199], a[96:99], v[80:83]
    ds_read_b128 v[196:199], v2 offset:3072
    v_cndmask_b32 v92, v92, v93, s[36:37]
    v_cndmask_b32 v94, v94, v95, s[36:37]
    s_waitcnt lgkmcnt(8)
    v_mfma_f32_16x16x32_bf16 v[96:99], v[200:203], a[96:99], v[96:99]
    buffer_load_dwordx4 v11, s[4:7], s63 offen offset:2048 lds
    v_mfma_f32_16x16x32_bf16 v[100:103], v[200:203], a[100:103], v[100:103]
    ds_read_b128 v[200:203], v2 offset:4096
    v_cndmask_b32 v156, v92, v124, s[44:45]
    v_cndmask_b32 v157, v94, v126, s[46:47]
    s_waitcnt lgkmcnt(8)
    v_mfma_f32_16x16x32_bf16 v[116:119], v[204:207], a[100:103], v[116:119]
    v_max_f32 v158, v156, v157
    v_mfma_f32_16x16x32_bf16 v[112:115], v[204:207], a[96:99], v[112:115]
    ds_read_b128 v[204:207], v2 offset:5120
    v_mov_b32 v159, v158
    s_waitcnt lgkmcnt(8)
    v_mfma_f32_16x16x32_bf16 v[128:131], a[96:99], v[208:211], v[128:131]
    v_cvt_pk_bf16_f32 v72, v72, v73
    v_cvt_pk_bf16_f32 v73, v74, v75
    v_mfma_f32_16x16x32_bf16 v[132:135], a[100:103], v[208:211], v[132:135]
    ds_read_b128 v[208:211], v2 offset:6144
    v_permlane32_swap_b32 v158, v159
    s_waitcnt lgkmcnt(7)
    v_mfma_f32_16x16x32_bf16 v[148:151], a[100:103], v[212:215], v[148:151]
    v_max_f32 v158, v158, v159
    v_mov_b32 v159, v158
    v_mfma_f32_16x16x32_bf16 v[144:147], a[96:99], v[212:215], v[144:147]
    ds_read_b128 v[212:215], v2 offset:7168
    v_cvt_pk_bf16_f32 v74, v88, v89
    v_cvt_pk_bf16_f32 v75, v90, v91
    s_waitcnt vmcnt(15)
    s_waitcnt lgkmcnt(6)
    v_mfma_f32_16x16x32_bf16 v[64:67], v[192:195], a[104:107], v[64:67]
    buffer_load_dwordx4 v11, s[4:7], s63 offen offset:3072 lds
    v_mfma_f32_16x16x32_bf16 v[68:71], v[192:195], a[108:111], v[68:71]
    v_permlane16_swap_b32 v158, v159
    s_waitcnt lgkmcnt(4)
    v_mfma_f32_16x16x32_bf16 v[84:87], v[196:199], a[108:111], v[84:87]
    v_max_f32 v158, v158, v159
    v_mfma_f32_16x16x32_bf16 v[80:83], v[196:199], a[104:107], v[80:83]
    v_mfma_f32_16x16x32_bf16 v[120:123], v[104:107], v[72:75], 0
    s_waitcnt lgkmcnt(3)
    v_mfma_f32_16x16x32_bf16 v[96:99], v[200:203], a[104:107], v[96:99]
    s_add_u32 m0, s57, 4096
    s_mov_b32 s63, 23072768
    buffer_load_dwordx4 v11, s[4:7], s63 offen offset:0 lds
    v_mfma_f32_16x16x32_bf16 v[100:103], v[200:203], a[108:111], v[100:103]
    v_sub_f32 v156, v156, v158
    v_sub_f32 v157, v157, v158
    s_waitcnt lgkmcnt(2)
    v_mfma_f32_16x16x32_bf16 v[116:119], v[204:207], a[108:111], v[116:119]
    v_mul_f32 v156, v156, v223
    v_mul_f32 v157, v157, v223
    v_mfma_f32_16x16x32_bf16 v[112:115], v[204:207], a[104:107], v[112:115]
    v_exp_f32 v156, v156
    s_waitcnt lgkmcnt(1)
    v_mfma_f32_16x16x32_bf16 v[128:131], a[104:107], v[208:211], v[128:131]
    v_exp_f32 v157, v157
    v_mfma_f32_16x16x32_bf16 v[132:135], a[108:111], v[208:211], v[132:135]
    v_cvt_pk_bf16_f32 v156, v156, v156
    v_cvt_pk_bf16_f32 v157, v157, v157
    s_waitcnt lgkmcnt(0)
    v_mfma_f32_16x16x32_bf16 v[148:151], a[108:111], v[212:215], v[148:151]
    v_and_b32 v140, v156, v44
    v_and_b32 v141, v157, v45
    v_mfma_f32_16x16x32_bf16 v[144:147], a[104:107], v[212:215], v[144:147]
    v_and_b32 v142, v156, v46
    v_and_b32 v143, v157, v47
L_epi1:
    s_waitcnt lgkmcnt(0)
    buffer_load_dwordx4 v11, s[4:7], s63 offen offset:1024 lds
    v_mov_b32 v217, 0xff61b1e6
    v_mfma_f32_16x16x32_bf16 v[156:159], v[40:43], v[140:143], 0
    buffer_load_dwordx4 v[240:243], v1, s[4:7], s28 offen sc1
    buffer_load_dwordx4 v[244:247], v1, s[4:7], s28 offen offset:1024 sc1
    v_mfma_f32_16x16x32_bf16 v[92:95], v[174:177], v[140:143], 0
    v_mfma_f32_16x16x32_bf16 v[124:127], v[184:187], v[140:143], 0
    s_nop 3
    v_rcp_f32 v156, v156
    s_nop 1
    v_mul_f32 v92, v92, v156
    v_mul_f32 v93, v93, v156
    v_mul_f32 v94, v94, v156
    v_mul_f32 v95, v95, v156
    v_mul_f32 v124, v124, v156
    v_mul_f32 v125, v125, v156
    s_add_u32 m0, s57, 24576
    s_mov_b32 s63, 23093248
    buffer_load_dwordx4 v11, s[4:7], s63 offen offset:0 lds
    v_mul_f32 v126, v126, v156
    v_mul_f32 v127, v127, v156
    v_cvt_pk_bf16_f32 v236, v92, v93
    v_cvt_pk_bf16_f32 v237, v94, v95
    v_cvt_pk_bf16_f32 v238, v124, v125
    v_cvt_pk_bf16_f32 v239, v126, v127
    s_cmp_lg_u32 s15, 0
    s_cbranch_scc1 L_slow_27
    buffer_store_dwordx4 v[236:239], v7, s[4:7], s34 offen
L_done_28:
    v_pk_mul_f32 v[100:101], v[100:101], v[162:163] op_sel:[0,0] op_sel_hi:[1,0]
    v_pk_mul_f32 v[102:103], v[102:103], v[162:163] op_sel:[0,0] op_sel_hi:[1,0]
    v_pk_mul_f32 v[116:117], v[116:117], v[162:163] op_sel:[0,0] op_sel_hi:[1,0]
    v_pk_mul_f32 v[118:119], v[118:119], v[162:163] op_sel:[0,0] op_sel_hi:[1,0]
    v_pk_mul_f32 v[96:97], v[96:97], v[160:161] op_sel:[0,0] op_sel_hi:[1,0]
    v_pk_mul_f32 v[98:99], v[98:99], v[160:161] op_sel:[0,0] op_sel_hi:[1,0]
    v_pk_mul_f32 v[112:113], v[112:113], v[160:161] op_sel:[0,0] op_sel_hi:[1,0]
    v_pk_mul_f32 v[114:115], v[114:115], v[160:161] op_sel:[0,0] op_sel_hi:[1,0]
    v_pk_mul_f32 v[132:133], v[132:133], v[228:229]
    v_pk_mul_f32 v[134:135], v[134:135], v[230:231]
    v_pk_mul_f32 v[148:149], v[148:149], v[228:229]
    v_pk_mul_f32 v[150:151], v[150:151], v[230:231]
    v_pk_mul_f32 v[128:129], v[128:129], v[224:225]
    v_pk_mul_f32 v[130:131], v[130:131], v[226:227]
    buffer_load_dwordx4 v11, s[4:7], s63 offen offset:1024 lds
    v_pk_mul_f32 v[144:145], v[144:145], v[224:225]
    v_pk_mul_f32 v[146:147], v[146:147], v[226:227]
    v_cvt_pk_bf16_f32 v100, v100, v101
    v_cvt_pk_bf16_f32 v101, v102, v103
    v_cvt_pk_bf16_f32 v102, v116, v117
    v_cvt_pk_bf16_f32 v103, v118, v119
    v_cvt_pk_bf16_f32 v68, v68, v69
    v_cvt_pk_bf16_f32 v69, v70, v71
    v_cvt_pk_bf16_f32 v70, v84, v85
    v_cvt_pk_bf16_f32 v71, v86, v87
    v_mfma_f32_16x16x32_bf16 v[88:91], v[100:103], v[72:75], 0
    v_cvt_pk_bf16_f32 v96, v96, v97
    v_cvt_pk_bf16_f32 v97, v98, v99
    v_mfma_f32_16x16x32_bf16 v[116:119], v[100:103], v[68:71], 0
    v_cvt_pk_bf16_f32 v98, v112, v113
    v_cvt_pk_bf16_f32 v99, v114, v115
    v_cvt_pk_bf16_f32 v64, v64, v65
    buffer_load_dwordx4 v11, s[4:7], s63 offen offset:2048 lds
    v_cvt_pk_bf16_f32 v65, v66, v67
    v_cvt_pk_bf16_f32 v66, v80, v81
    v_cvt_pk_bf16_f32 v67, v82, v83
    v_mfma_f32_16x16x32_bf16 v[84:87], v[96:99], v[68:71], 0
    v_cvt_pk_bf16_f32 v172, v132, v133
    v_cvt_pk_bf16_f32 v173, v134, v135
    v_mfma_f32_16x16x32_bf16 v[112:115], v[96:99], v[64:67], 0
    v_cvt_pk_bf16_f32 v182, v148, v149
    v_cvt_pk_bf16_f32 v183, v150, v151
    v_cvt_pk_bf16_f32 v170, v128, v129
    v_cvt_pk_bf16_f32 v171, v130, v131
    v_cvt_pk_bf16_f32 v180, v144, v145
    v_cvt_pk_bf16_f32 v181, v146, v147
    v_cndmask_b32 v120, v120, v121, s[36:37]
    v_cndmask_b32 v122, v122, v123, s[36:37]
    v_cndmask_b32 v88, v88, v89, s[36:37]
    v_cndmask_b32 v90, v90, v91, s[36:37]
    buffer_load_dwordx4 v11, s[4:7], s63 offen offset:3072 lds
    v_cndmask_b32 v152, v88, v120, s[44:45]
    v_cndmask_b32 v153, v90, v122, s[46:47]
    v_max_f32 v154, v152, v153
    s_waitcnt lgkmcnt(0)
    s_cmp_lg_u32 s12, 0
    s_cbranch_scc1 L_halod1
    s_waitcnt vmcnt(5)
    v_max_u32 v218, v240, v244
    v_cmp_eq_u32 vcc, -1, v218
    s_cbranch_vccz L_halow1
    s_mov_b32 s61, 1048576
L_spin_29:
    buffer_load_dwordx4 v[240:243], v1, s[4:7], s28 offen sc1
    buffer_load_dwordx4 v[244:247], v1, s[4:7], s28 offen offset:1024 sc1
    s_sub_u32 s61, s61, 1
    s_waitcnt vmcnt(0)
    v_max_u32 v218, v240, v244
    v_cmp_eq_u32 vcc, -1, v218
    s_cbranch_scc1 L_spind_30
    s_cbranch_vccnz L_spin_29
L_spind_30:
L_halow1:
    v_mov_b32 v188, v240
    v_mov_b32 v168, v244
    v_mov_b32 v189, v241
    v_mov_b32 v169, v245
    v_mov_b32 v190, v242
    v_mov_b32 v178, v246
    v_mov_b32 v191, v243
    v_mov_b32 v179, v247
L_halod1:
    s_nop 1
    v_mfma_f32_16x16x32_bf16 v[80:83], v[188:191], v[64:67], 0
    s_add_u32 s16, s16, 0x80000
    s_add_u32 s28, s28, 0x80000
    v_cndmask_b32 v116, v116, v117, s[36:37]
    v_cndmask_b32 v118, v118, v119, s[36:37]
    v_cndmask_b32 v84, v84, v85, s[36:37]
    v_cndmask_b32 v86, v86, v87, s[36:37]
    v_cndmask_b32 v148, v84, v116, s[44:45]
    v_cndmask_b32 v149, v86, v118, s[46:47]
    v_max_f32 v150, v148, v149
    v_cndmask_b32 v112, v112, v113, s[36:37]
    v_cndmask_b32 v114, v114, v115, s[36:37]
    v_cndmask_b32 v80, v80, v81, s[36:37]
    v_cndmask_b32 v82, v82, v83, s[36:37]
    v_cndmask_b32 v80, v80, v217, s[50:51]
    v_cndmask_b32 v82, v82, v217, s[50:51]
    v_cndmask_b32 v144, v80, v112, s[44:45]
    v_cndmask_b32 v145, v82, v114, s[46:47]
    v_max_f32 v146, v144, v145
    s_nop 1
    v_permlane32_swap_b32 v146, v150
    s_add_u32 m0, s57, 28672
    s_mov_b32 s63, 23097344
    buffer_load_dwordx4 v11, s[4:7], s63 offen offset:0 lds
    v_permlane32_swap_b32 v154, v158
    v_max_f32 v146, v146, v150
    v_max_f32 v154, v154, v158
    s_nop 1
    v_permlane16_swap_b32 v146, v154
    v_max_f32 v150, v146, v154
    v_max_f32 v154, v146, v154
    s_nop 1
    v_permlane16_swap_b32 v150, v154
    v_mov_b32 v146, v150
    v_mov_b32 v158, v154
    s_nop 0
    v_permlane32_swap_b32 v146, v150
    v_permlane32_swap_b32 v154, v158
    v_sub_f32 v152, v152, v154
    v_sub_f32 v153, v153, v154
    v_sub_f32 v148, v148, v150
    v_sub_f32 v149, v149, v150
    v_sub_f32 v144, v144, v146
    v_sub_f32 v145, v145, v146
    v_mul_f32 v152, v152, v222
    buffer_load_dwordx4 v11, s[4:7], s63 offen offset:1024 lds
    v_mul_f32 v153, v153, v222
    v_mul_f32 v148, v148, v221
    v_mul_f32 v149, v149, v221
    v_mul_f32 v144, v144, v220
    v_mul_f32 v145, v145, v220
    v_exp_f32 v152, v152
    v_exp_f32 v153, v153
    v_exp_f32 v148, v148
    v_exp_f32 v149, v149
    v_exp_f32 v144, v144
    v_exp_f32 v145, v145
    v_cvt_pk_bf16_f32 v152, v152, v152
    v_cvt_pk_bf16_f32 v153, v153, v153
    v_cvt_pk_bf16_f32 v148, v148, v148
    v_cvt_pk_bf16_f32 v149, v149, v149
    v_cvt_pk_bf16_f32 v144, v144, v144
    v_cvt_pk_bf16_f32 v145, v145, v145
    s_add_u32 m0, s2, 49152
    s_sub_u32 s63, 23117824, s0
    buffer_load_dwordx4 v11, s[4:7], s63 offen offset:0 lds
    v_and_b32 v136, v152, v44
    v_and_b32 v137, v153, v45
    v_and_b32 v138, v152, v46
    v_and_b32 v139, v153, v47
    v_and_b32 v132, v148, v44
    v_and_b32 v133, v149, v45
    v_and_b32 v134, v148, v46
    v_and_b32 v135, v149, v47
    v_and_b32 v128, v144, v44
    v_and_b32 v129, v145, v45
    v_and_b32 v130, v144, v46
    v_and_b32 v131, v145, v47
    buffer_load_dwordx4 v11, s[4:7], s63 offen offset:1024 lds
    v_mfma_f32_16x16x32_bf16 v[152:155], v[40:43], v[136:139], 0
    v_mfma_f32_16x16x32_bf16 v[88:91], v[172:175], v[136:139], 0
    v_mfma_f32_16x16x32_bf16 v[120:123], v[182:185], v[136:139], 0
    v_mfma_f32_16x16x32_bf16 v[148:151], v[40:43], v[132:135], 0
    v_mfma_f32_16x16x32_bf16 v[84:87], v[170:173], v[132:135], 0
    v_mfma_f32_16x16x32_bf16 v[116:119], v[180:183], v[132:135], 0
    v_mfma_f32_16x16x32_bf16 v[144:147], v[40:43], v[128:131], 0
    v_mfma_f32_16x16x32_bf16 v[80:83], v[168:171], v[128:131], 0
    v_mfma_f32_16x16x32_bf16 v[112:115], v[178:181], v[128:131], 0
    v_rcp_f32 v152, v152
    s_nop 0
    v_pk_mul_f32 v[88:89], v[88:89], v[152:153] op_sel:[0,0] op_sel_hi:[1,0]
    v_pk_mul_f32 v[90:91], v[90:91], v[152:153] op_sel:[0,0] op_sel_hi:[1,0]
    v_pk_mul_f32 v[120:121], v[120:121], v[152:153] op_sel:[0,0] op_sel_hi:[1,0]
    v_pk_mul_f32 v[122:123], v[122:123], v[152:153] op_sel:[0,0] op_sel_hi:[1,0]
    v_cvt_pk_bf16_f32 v232, v88, v89
    v_cvt_pk_bf16_f32 v233, v90, v91
    v_cvt_pk_bf16_f32 v234, v120, v121
    v_cvt_pk_bf16_f32 v235, v122, v123
    s_cmp_lg_u32 s15, 0
    s_cbranch_scc1 L_slow_31
    buffer_store_dwordx4 v[232:235], v6, s[4:7], s34 offen
L_done_32:
    v_rcp_f32 v148, v148
    s_nop 0
    v_pk_mul_f32 v[84:85], v[84:85], v[148:149] op_sel:[0,0] op_sel_hi:[1,0]
    v_pk_mul_f32 v[86:87], v[86:87], v[148:149] op_sel:[0,0] op_sel_hi:[1,0]
    v_pk_mul_f32 v[116:117], v[116:117], v[148:149] op_sel:[0,0] op_sel_hi:[1,0]
    v_pk_mul_f32 v[118:119], v[118:119], v[148:149] op_sel:[0,0] op_sel_hi:[1,0]
    v_cvt_pk_bf16_f32 v228, v84, v85
    v_cvt_pk_bf16_f32 v229, v86, v87
    v_cvt_pk_bf16_f32 v230, v116, v117
    v_cvt_pk_bf16_f32 v231, v118, v119
    s_cmp_lg_u32 s15, 0
    s_cbranch_scc1 L_slow_33
    buffer_store_dwordx4 v[228:231], v5, s[4:7], s34 offen
L_done_34:
    v_rcp_f32 v144, v144
    s_nop 0
    v_pk_mul_f32 v[80:81], v[80:81], v[144:145] op_sel:[0,0] op_sel_hi:[1,0]
    v_pk_mul_f32 v[82:83], v[82:83], v[144:145] op_sel:[0,0] op_sel_hi:[1,0]
    v_pk_mul_f32 v[112:113], v[112:113], v[144:145] op_sel:[0,0] op_sel_hi:[1,0]
    v_pk_mul_f32 v[114:115], v[114:115], v[144:145] op_sel:[0,0] op_sel_hi:[1,0]
    v_cvt_pk_bf16_f32 v224, v80, v81
    v_cvt_pk_bf16_f32 v225, v82, v83
    v_cvt_pk_bf16_f32 v226, v112, v113
    v_cvt_pk_bf16_f32 v227, v114, v115
    s_cmp_lg_u32 s15, 0
    s_cbranch_scc1 L_slow_35
    buffer_store_dwordx4 v[224:227], v4, s[4:7], s34 offen
L_done_36:
    v_mov_b32 v63, 2
    v_lshlrev_b32 v64, 16, v16
    v_and_b32 v65, 0xffff0000, v16
    v_lshlrev_b32 v66, 16, v17
    buffer_load_dword v216, v12, s[4:7], s30 offen sc1
    v_and_b32 v67, 0xffff0000, v17
    v_lshlrev_b32 v72, 16, v18
    v_and_b32 v73, 0xffff0000, v18
    v_lshlrev_b32 v74, 16, v19
    v_and_b32 v75, 0xffff0000, v19
    v_lshlrev_b32 v80, 16, v20
    v_and_b32 v81, 0xffff0000, v20
    v_lshlrev_b32 v82, 16, v21
    v_and_b32 v83, 0xffff0000, v21
    v_lshlrev_b32 v88, 16, v22
    v_and_b32 v89, 0xffff0000, v22
    v_lshlrev_b32 v90, 16, v23
    v_and_b32 v91, 0xffff0000, v23
    v_lshlrev_b32 v68, 16, v24
    v_and_b32 v69, 0xffff0000, v24
    v_lshlrev_b32 v70, 16, v25
    v_and_b32 v71, 0xffff0000, v25
    v_lshlrev_b32 v76, 16, v26
    v_and_b32 v77, 0xffff0000, v26
    v_lshlrev_b32 v78, 16, v27
    v_and_b32 v79, 0xffff0000, v27
    v_lshlrev_b32 v84, 16, v28
    v_and_b32 v85, 0xffff0000, v28
    v_lshlrev_b32 v86, 16, v29
    v_and_b32 v87, 0xffff0000, v29
    v_lshlrev_b32 v92, 16, v30
    v_and_b32 v93, 0xffff0000, v30
    v_lshlrev_b32 v94, 16, v31
    v_and_b32 v95, 0xffff0000, v31
    s_mov_b64 exec, 1
    s_waitcnt vmcnt(1)
    s_cmp_lg_u32 s15, 0
    s_cbranch_scc1 L_slow_38
    buffer_store_dword v63, off, s[4:7], s31
L_done_39:
    s_mov_b64 exec, -1
    s_waitcnt vmcnt(1)
    s_mov_b64 exec, s[82:83]
    v_cmp_gt_u32 vcc, 2, v216
    s_mov_b64 exec, -1
    s_cbranch_vccz L_hd_37
    s_mov_b32 s61, 1048576
L_spin_40:
    buffer_load_dword v216, v12, s[4:7], s30 offen sc1
    s_sub_u32 s61, s61, 1
    s_waitcnt vmcnt(0)
    s_mov_b64 exec, 63
    v_cmp_gt_u32 vcc, 2, v216
    s_mov_b64 exec, -1
    s_cbranch_scc1 L_spind_41
    s_cbranch_vccnz L_spin_40
L_spind_41:
L_hd_37:
    s_mov_b32 s62, 29360128
    buffer_load_dwordx4 a[80:83], v8, s[4:7], s62 offen offset:0 sc1
    buffer_load_dwordx4 a[84:87], v9, s[4:7], s62 offen offset:0 sc1
    buffer_load_dwordx4 a[88:91], v8, s[4:7], s62 offen offset:1024 sc1
    buffer_load_dword v216, v12, s[4:7], s30 offen sc1
    buffer_load_dwordx4 a[92:95], v9, s[4:7], s62 offen offset:1024 sc1
    buffer_load_dwordx4 a[96:99], v8, s[4:7], s62 offen offset:2048 sc1
    buffer_load_dwordx4 a[100:103], v9, s[4:7], s62 offen offset:2048 sc1
    buffer_load_dwordx4 a[104:107], v8, s[4:7], s62 offen offset:3072 sc1
    buffer_load_dwordx4 a[108:111], v9, s[4:7], s62 offen offset:3072 sc1
    s_mov_b32 s62, 29364224
    buffer_load_dwordx4 a[112:115], v8, s[4:7], s62 offen offset:0 sc1
    buffer_load_dwordx4 a[116:119], v9, s[4:7], s62 offen offset:0 sc1
    buffer_load_dwordx4 a[120:123], v8, s[4:7], s62 offen offset:1024 sc1
    buffer_load_dwordx4 a[124:127], v9, s[4:7], s62 offen offset:1024 sc1
    s_barrier
    ds_read_b128 a[48:51], v1 offset:0
    ds_read_b128 a[52:55], v1 offset:1024
    ds_read_b128 a[56:59], v1 offset:2048
    ds_read_b128 a[60:63], v1 offset:3072
    ds_read_b128 a[64:67], v1 offset:4096
    ds_read_b128 a[68:71], v1 offset:5120
    ds_read_b128 a[72:75], v1 offset:6144
    ds_read_b128 a[76:79], v1 offset:7168
    s_waitcnt vmcnt(9)
    v_cmp_gt_u32 vcc, 2, v216
    s_cbranch_vccnz L_p2_42
L_p2_42_r:
    s_waitcnt lgkmcnt(7)
    v_mfma_f32_16x16x32_bf16 v[64:67], a[48:51], a[80:83], v[64:67]
    buffer_load_dwordx4 a[128:131], v8, s[4:7], s62 offen offset:2048 sc1
    v_mfma_f32_16x16x32_bf16 v[68:71], a[48:51], a[84:87], v[68:71]
    ds_read_b128 a[48:51], v1 offset:8192
    s_waitcnt lgkmcnt(7)
    v_mfma_f32_16x16x32_bf16 v[76:79], a[52:55], a[84:87], v[76:79]
    v_mfma_f32_16x16x32_bf16 v[72:75], a[52:55], a[80:83], v[72:75]
    ds_read_b128 a[52:55], v1 offset:9216
    s_waitcnt lgkmcnt(7)
    v_mfma_f32_16x16x32_bf16 v[80:83], a[56:59], a[80:83], v[80:83]
    buffer_load_dwordx4 a[132:135], v9, s[4:7], s62 offen offset:2048 sc1
    v_mfma_f32_16x16x32_bf16 v[84:87], a[56:59], a[84:87], v[84:87]
    ds_read_b128 a[56:59], v1 offset:10240
    s_waitcnt lgkmcnt(7)
    v_mfma_f32_16x16x32_bf16 v[92:95], a[60:63], a[84:87], v[92:95]
    v_mfma_f32_16x16x32_bf16 v[88:91], a[60:63], a[80:83], v[88:91]
    ds_read_b128 a[60:63], v1 offset:11264
    s_waitcnt vmcnt(10)
    s_waitcnt lgkmcnt(7)
    v_mfma_f32_16x16x32_bf16 v[64:67], a[64:67], a[88:91], v[64:67]
    buffer_load_dwordx4 a[80:83], v8, s[4:7], s62 offen offset:3072 sc1
    v_mfma_f32_16x16x32_bf16 v[68:71], a[64:67], a[92:95], v[68:71]
    ds_read_b128 a[64:67], v1 offset:12288
    s_waitcnt lgkmcnt(7)
    v_mfma_f32_16x16x32_bf16 v[76:79], a[68:71], a[92:95], v[76:79]
    v_mfma_f32_16x16x32_bf16 v[72:75], a[68:71], a[88:91], v[72:75]
    ds_read_b128 a[68:71], v1 offset:13312
    s_waitcnt lgkmcnt(7)
    v_mfma_f32_16x16x32_bf16 v[80:83], a[72:75], a[88:91], v[80:83]
    buffer_load_dwordx4 a[84:87], v9, s[4:7], s62 offen offset:3072 sc1
    v_mfma_f32_16x16x32_bf16 v[84:87], a[72:75], a[92:95], v[84:87]
    ds_read_b128 a[72:75], v1 offset:14336
    s_waitcnt lgkmcnt(7)
    v_mfma_f32_16x16x32_bf16 v[92:95], a[76:79], a[92:95], v[92:95]
    v_mfma_f32_16x16x32_bf16 v[88:91], a[76:79], a[88:91], v[88:91]
    ds_read_b128 a[76:79], v1 offset:15360
    s_waitcnt vmcnt(10)
    s_waitcnt lgkmcnt(7)
    v_mfma_f32_16x16x32_bf16 v[64:67], a[48:51], a[96:99], v[64:67]
    s_mov_b32 s62, 29368320
    buffer_load_dwordx4 a[88:91], v8, s[4:7], s62 offen offset:0 sc1
    v_mfma_f32_16x16x32_bf16 v[68:71], a[48:51], a[100:103], v[68:71]
    ds_read_b128 a[48:51], v1 offset:16384
    s_waitcnt lgkmcnt(7)
    v_mfma_f32_16x16x32_bf16 v[76:79], a[52:55], a[100:103], v[76:79]
    v_mfma_f32_16x16x32_bf16 v[72:75], a[52:55], a[96:99], v[72:75]
    ds_read_b128 a[52:55], v1 offset:17408
    s_waitcnt lgkmcnt(7)
    v_mfma_f32_16x16x32_bf16 v[80:83], a[56:59], a[96:99], v[80:83]
    buffer_load_dwordx4 a[92:95], v9, s[4:7], s62 offen offset:0 sc1
    v_mfma_f32_16x16x32_bf16 v[84:87], a[56:59], a[100:103], v[84:87]
    ds_read_b128 a[56:59], v1 offset:18432
    s_waitcnt lgkmcnt(7)
    v_mfma_f32_16x16x32_bf16 v[92:95], a[60:63], a[100:103], v[92:95]
    v_mfma_f32_16x16x32_bf16 v[88:91], a[60:63], a[96:99], v[88:91]
    ds_read_b128 a[60:63], v1 offset:19456
    s_waitcnt vmcnt(10)
    s_waitcnt lgkmcnt(7)
    v_mfma_f32_16x16x32_bf16 v[64:67], a[64:67], a[104:107], v[64:67]
    buffer_load_dwordx4 a[96:99], v8, s[4:7], s62 offen offset:1024 sc1
    v_mfma_f32_16x16x32_bf16 v[68:71], a[64:67], a[108:111], v[68:71]
    ds_read_b128 a[64:67], v1 offset:20480
    s_waitcnt lgkmcnt(7)
    v_mfma_f32_16x16x32_bf16 v[76:79], a[68:71], a[108:111], v[76:79]
    v_mfma_f32_16x16x32_bf16 v[72:75], a[68:71], a[104:107], v[72:75]
    ds_read_b128 a[68:71], v1 offset:21504
    s_waitcnt lgkmcnt(7)
    v_mfma_f32_16x16x32_bf16 v[80:83], a[72:75], a[104:107], v[80:83]
    buffer_load_dwordx4 a[100:103], v9, s[4:7], s62 offen offset:1024 sc1
    v_mfma_f32_16x16x32_bf16 v[84:87], a[72:75], a[108:111], v[84:87]
    ds_read_b128 a[72:75], v1 offset:22528
    s_waitcnt lgkmcnt(7)
    v_mfma_f32_16x16x32_bf16 v[92:95], a[76:79], a[108:111], v[92:95]
    v_mfma_f32_16x16x32_bf16 v[88:91], a[76:79], a[104:107], v[88:91]
    ds_read_b128 a[76:79], v1 offset:23552
    s_waitcnt vmcnt(10)
    s_waitcnt lgkmcnt(7)
    v_mfma_f32_16x16x32_bf16 v[64:67], a[48:51], a[112:115], v[64:67]
    buffer_load_dwordx4 a[104:107], v8, s[4:7], s62 offen offset:2048 sc1
    v_mfma_f32_16x16x32_bf16 v[68:71], a[48:51], a[116:119], v[68:71]
    ds_read_b128 a[48:51], v1 offset:24576
    s_waitcnt lgkmcnt(7)
    v_mfma_f32_16x16x32_bf16 v[76:79], a[52:55], a[116:119], v[76:79]
    v_mfma_f32_16x16x32_bf16 v[72:75], a[52:55], a[112:115], v[72:75]
    ds_read_b128 a[52:55], v1 offset:25600
    s_waitcnt lgkmcnt(7)
    v_mfma_f32_16x16x32_bf16 v[80:83], a[56:59], a[112:115], v[80:83]
    buffer_load_dwordx4 a[108:111], v9, s[4:7], s62 offen offset:2048 sc1
    v_mfma_f32_16x16x32_bf16 v[84:87], a[56:59], a[116:119], v[84:87]
    ds_read_b128 a[56:59], v1 offset:26624
    s_waitcnt lgkmcnt(7)
    v_mfma_f32_16x16x32_bf16 v[92:95], a[60:63], a[116:119], v[92:95]
    v_mfma_f32_16x16x32_bf16 v[88:91], a[60:63], a[112:115], v[88:91]
    ds_read_b128 a[60:63], v1 offset:27648
    s_waitcnt vmcnt(10)
    s_waitcnt lgkmcnt(7)
    v_mfma_f32_16x16x32_bf16 v[64:67], a[64:67], a[120:123], v[64:67]
    buffer_load_dwordx4 a[112:115], v8, s[4:7], s62 offen offset:3072 sc1
    v_mfma_f32_16x16x32_bf16 v[68:71], a[64:67], a[124:127], v[68:71]
    ds_read_b128 a[64:67], v1 offset:28672
    s_waitcnt lgkmcnt(7)
    v_mfma_f32_16x16x32_bf16 v[76:79], a[68:71], a[124:127], v[76:79]
    v_mfma_f32_16x16x32_bf16 v[72:75], a[68:71], a[120:123], v[72:75]
    ds_read_b128 a[68:71], v1 offset:29696
    s_waitcnt lgkmcnt(7)
    v_mfma_f32_16x16x32_bf16 v[80:83], a[72:75], a[120:123], v[80:83]
    buffer_load_dwordx4 a[116:119], v9, s[4:7], s62 offen offset:3072 sc1
    v_mfma_f32_16x16x32_bf16 v[84:87], a[72:75], a[124:127], v[84:87]
    ds_read_b128 a[72:75], v1 offset:30720
    s_waitcnt lgkmcnt(7)
    v_mfma_f32_16x16x32_bf16 v[92:95], a[76:79], a[124:127], v[92:95]
    v_mfma_f32_16x16x32_bf16 v[88:91], a[76:79], a[120:123], v[88:91]
    ds_read_b128 a[76:79], v1 offset:31744
    s_waitcnt vmcnt(10)
    s_waitcnt lgkmcnt(7)
    v_mfma_f32_16x16x32_bf16 v[64:67], a[48:51], a[128:131], v[64:67]
    s_mov_b32 s62, 29372416
    buffer_load_dwordx4 a[120:123], v8, s[4:7], s62 offen offset:0 sc1
    v_mfma_f32_16x16x32_bf16 v[68:71], a[48:51], a[132:135], v[68:71]
    ds_read_b128 a[48:51], v1 offset:32768
    s_waitcnt lgkmcnt(7)
    v_mfma_f32_16x16x32_bf16 v[76:79], a[52:55], a[132:135], v[76:79]
    v_mfma_f32_16x16x32_bf16 v[72:75], a[52:55], a[128:131], v[72:75]
    ds_read_b128 a[52:55], v1 offset:33792
    s_waitcnt lgkmcnt(7)
    v_mfma_f32_16x16x32_bf16 v[80:83], a[56:59], a[128:131], v[80:83]
    buffer_load_dwordx4 a[124:127], v9, s[4:7], s62 offen offset:0 sc1
    v_mfma_f32_16x16x32_bf16 v[84:87], a[56:59], a[132:135], v[84:87]
    ds_read_b128 a[56:59], v1 offset:34816
    s_waitcnt lgkmcnt(7)
    v_mfma_f32_16x16x32_bf16 v[92:95], a[60:63], a[132:135], v[92:95]
    v_mfma_f32_16x16x32_bf16 v[88:91], a[60:63], a[128:131], v[88:91]
    ds_read_b128 a[60:63], v1 offset:35840
    s_waitcnt vmcnt(10)
    s_waitcnt lgkmcnt(7)
    v_mfma_f32_16x16x32_bf16 v[64:67], a[64:67], a[80:83], v[64:67]
    buffer_load_dwordx4 a[128:131], v8, s[4:7], s62 offen offset:1024 sc1
    v_mfma_f32_16x16x32_bf16 v[68:71], a[64:67], a[84:87], v[68:71]
    ds_read_b128 a[64:67], v1 offset:36864
    s_waitcnt lgkmcnt(7)
    v_mfma_f32_16x16x32_bf16 v[76:79], a[68:71], a[84:87], v[76:79]
    v_mfma_f32_16x16x32_bf16 v[72:75], a[68:71], a[80:83], v[72:75]
    ds_read_b128 a[68:71], v1 offset:37888
    s_waitcnt lgkmcnt(7)
    v_mfma_f32_16x16x32_bf16 v[80:83], a[72:75], a[80:83], v[80:83]
    buffer_load_dwordx4 a[132:135], v9, s[4:7], s62 offen offset:1024 sc1
    v_mfma_f32_16x16x32_bf16 v[84:87], a[72:75], a[84:87], v[84:87]
    ds_read_b128 a[72:75], v1 offset:38912
    s_waitcnt lgkmcnt(7)
    v_mfma_f32_16x16x32_bf16 v[92:95], a[76:79], a[84:87], v[92:95]
    v_mfma_f32_16x16x32_bf16 v[88:91], a[76:79], a[80:83], v[88:91]
    ds_read_b128 a[76:79], v1 offset:39936
    s_waitcnt vmcnt(10)
    s_waitcnt lgkmcnt(7)
    v_mfma_f32_16x16x32_bf16 v[64:67], a[48:51], a[88:91], v[64:67]
    buffer_load_dwordx4 a[80:83], v8, s[4:7], s62 offen offset:2048 sc1
    v_mfma_f32_16x16x32_bf16 v[68:71], a[48:51], a[92:95], v[68:71]
    ds_read_b128 a[48:51], v1 offset:40960
    s_waitcnt lgkmcnt(7)
    v_mfma_f32_16x16x32_bf16 v[76:79], a[52:55], a[92:95], v[76:79]
    v_mfma_f32_16x16x32_bf16 v[72:75], a[52:55], a[88:91], v[72:75]
    ds_read_b128 a[52:55], v1 offset:41984
    s_waitcnt lgkmcnt(7)
    v_mfma_f32_16x16x32_bf16 v[80:83], a[56:59], a[88:91], v[80:83]
    buffer_load_dwordx4 a[84:87], v9, s[4:7], s62 offen offset:2048 sc1
    v_mfma_f32_16x16x32_bf16 v[84:87], a[56:59], a[92:95], v[84:87]
    ds_read_b128 a[56:59], v1 offset:43008
    s_waitcnt lgkmcnt(7)
    v_mfma_f32_16x16x32_bf16 v[92:95], a[60:63], a[92:95], v[92:95]
    v_mfma_f32_16x16x32_bf16 v[88:91], a[60:63], a[88:91], v[88:91]
    ds_read_b128 a[60:63], v1 offset:44032
    s_waitcnt vmcnt(10)
    s_waitcnt lgkmcnt(7)
    v_mfma_f32_16x16x32_bf16 v[64:67], a[64:67], a[96:99], v[64:67]
    buffer_load_dwordx4 a[88:91], v8, s[4:7], s62 offen offset:3072 sc1
    v_mfma_f32_16x16x32_bf16 v[68:71], a[64:67], a[100:103], v[68:71]
    ds_read_b128 a[64:67], v1 offset:45056
    s_waitcnt lgkmcnt(7)
    v_mfma_f32_16x16x32_bf16 v[76:79], a[68:71], a[100:103], v[76:79]
    v_mfma_f32_16x16x32_bf16 v[72:75], a[68:71], a[96:99], v[72:75]
    ds_read_b128 a[68:71], v1 offset:46080
    s_waitcnt lgkmcnt(7)
    v_mfma_f32_16x16x32_bf16 v[80:83], a[72:75], a[96:99], v[80:83]
    buffer_load_dwordx4 a[92:95], v9, s[4:7], s62 offen offset:3072 sc1
    v_mfma_f32_16x16x32_bf16 v[84:87], a[72:75], a[100:103], v[84:87]
    ds_read_b128 a[72:75], v1 offset:47104
    s_waitcnt lgkmcnt(7)
    v_mfma_f32_16x16x32_bf16 v[92:95], a[76:79], a[100:103], v[92:95]
    v_mfma_f32_16x16x32_bf16 v[88:91], a[76:79], a[96:99], v[88:91]
    ds_read_b128 a[76:79], v1 offset:48128
    s_waitcnt vmcnt(10)
    s_waitcnt lgkmcnt(7)
    v_mfma_f32_16x16x32_bf16 v[64:67], a[48:51], a[104:107], v[64:67]
    s_mov_b32 s62, 29376512
    buffer_load_dwordx4 a[96:99], v8, s[4:7], s62 offen offset:0 sc1
    v_mfma_f32_16x16x32_bf16 v[68:71], a[48:51], a[108:111], v[68:71]
    ds_read_b128 a[48:51], v1 offset:49152
    s_waitcnt lgkmcnt(7)
    v_mfma_f32_16x16x32_bf16 v[76:79], a[52:55], a[108:111], v[76:79]
    v_mfma_f32_16x16x32_bf16 v[72:75], a[52:55], a[104:107], v[72:75]
    ds_read_b128 a[52:55], v1 offset:50176
    s_waitcnt lgkmcnt(7)
    v_mfma_f32_16x16x32_bf16 v[80:83], a[56:59], a[104:107], v[80:83]
    buffer_load_dwordx4 a[100:103], v9, s[4:7], s62 offen offset:0 sc1
    v_mfma_f32_16x16x32_bf16 v[84:87], a[56:59], a[108:111], v[84:87]
    ds_read_b128 a[56:59], v1 offset:51200
    s_waitcnt lgkmcnt(7)
    v_mfma_f32_16x16x32_bf16 v[92:95], a[60:63], a[108:111], v[92:95]
    v_mfma_f32_16x16x32_bf16 v[88:91], a[60:63], a[104:107], v[88:91]
    ds_read_b128 a[60:63], v1 offset:52224
    s_waitcnt vmcnt(10)
    s_waitcnt lgkmcnt(7)
    v_mfma_f32_16x16x32_bf16 v[64:67], a[64:67], a[112:115], v[64:67]
    buffer_load_dwordx4 a[104:107], v8, s[4:7], s62 offen offset:1024 sc1
    v_mfma_f32_16x16x32_bf16 v[68:71], a[64:67], a[116:119], v[68:71]
    ds_read_b128 a[64:67], v1 offset:53248
    s_waitcnt lgkmcnt(7)
    v_mfma_f32_16x16x32_bf16 v[76:79], a[68:71], a[116:119], v[76:79]
    v_mfma_f32_16x16x32_bf16 v[72:75], a[68:71], a[112:115], v[72:75]
    ds_read_b128 a[68:71], v1 offset:54272
    s_waitcnt lgkmcnt(7)
    v_mfma_f32_16x16x32_bf16 v[80:83], a[72:75], a[112:115], v[80:83]
    buffer_load_dwordx4 a[108:111], v9, s[4:7], s62 offen offset:1024 sc1
    v_mfma_f32_16x16x32_bf16 v[84:87], a[72:75], a[116:119], v[84:87]
    ds_read_b128 a[72:75], v1 offset:55296
    s_waitcnt lgkmcnt(7)
    v_mfma_f32_16x16x32_bf16 v[92:95], a[76:79], a[116:119], v[92:95]
    v_mfma_f32_16x16x32_bf16 v[88:91], a[76:79], a[112:115], v[88:91]
    ds_read_b128 a[76:79], v1 offset:56320
    s_waitcnt vmcnt(10)
    s_waitcnt lgkmcnt(7)
    v_mfma_f32_16x16x32_bf16 v[64:67], a[48:51], a[120:123], v[64:67]
    buffer_load_dwordx4 a[112:115], v8, s[4:7], s62 offen offset:2048 sc1
    v_mfma_f32_16x16x32_bf16 v[68:71], a[48:51], a[124:127], v[68:71]
    ds_read_b128 a[48:51], v2 offset:8192
    s_waitcnt lgkmcnt(7)
    v_mfma_f32_16x16x32_bf16 v[76:79], a[52:55], a[124:127], v[76:79]
    v_mfma_f32_16x16x32_bf16 v[72:75], a[52:55], a[120:123], v[72:75]
    ds_read_b128 a[52:55], v2 offset:9216
    s_waitcnt lgkmcnt(7)
    v_mfma_f32_16x16x32_bf16 v[80:83], a[56:59], a[120:123], v[80:83]
    buffer_load_dwordx4 a[116:119], v9, s[4:7], s62 offen offset:2048 sc1
    v_mfma_f32_16x16x32_bf16 v[84:87], a[56:59], a[124:127], v[84:87]
    ds_read_b128 a[56:59], v2 offset:10240
    s_waitcnt lgkmcnt(7)
    v_mfma_f32_16x16x32_bf16 v[92:95], a[60:63], a[124:127], v[92:95]
    v_mfma_f32_16x16x32_bf16 v[88:91], a[60:63], a[120:123], v[88:91]
    ds_read_b128 a[60:63], v2 offset:11264
    s_waitcnt vmcnt(10)
    s_waitcnt lgkmcnt(7)
    v_mfma_f32_16x16x32_bf16 v[64:67], a[64:67], a[128:131], v[64:67]
    buffer_load_dwordx4 a[120:123], v8, s[4:7], s62 offen offset:3072 sc1
    v_mfma_f32_16x16x32_bf16 v[68:71], a[64:67], a[132:135], v[68:71]
    ds_read_b128 a[64:67], v2 offset:12288
    s_waitcnt lgkmcnt(7)
    v_mfma_f32_16x16x32_bf16 v[76:79], a[68:71], a[132:135], v[76:79]
    v_mfma_f32_16x16x32_bf16 v[72:75], a[68:71], a[128:131], v[72:75]
    ds_read_b128 a[68:71], v2 offset:13312
    s_waitcnt lgkmcnt(7)
    v_mfma_f32_16x16x32_bf16 v[80:83], a[72:75], a[128:131], v[80:83]
    buffer_load_dwordx4 a[124:127], v9, s[4:7], s62 offen offset:3072 sc1
    v_mfma_f32_16x16x32_bf16 v[84:87], a[72:75], a[132:135], v[84:87]
    ds_read_b128 a[72:75], v2 offset:14336
    s_waitcnt lgkmcnt(7)
    v_mfma_f32_16x16x32_bf16 v[92:95], a[76:79], a[132:135], v[92:95]
    v_mfma_f32_16x16x32_bf16 v[88:91], a[76:79], a[128:131], v[88:91]
    ds_read_b128 a[76:79], v2 offset:15360
    s_waitcnt vmcnt(10)
    s_waitcnt lgkmcnt(7)
    v_mfma_f32_16x16x32_bf16 v[64:67], a[48:51], a[80:83], v[64:67]
    s_mov_b32 s62, 29380608
    buffer_load_dwordx4 a[128:131], v8, s[4:7], s62 offen offset:0 sc1
    v_mfma_f32_16x16x32_bf16 v[68:71], a[48:51], a[84:87], v[68:71]
    ds_read_b128 a[48:51], v2 offset:16384
    s_waitcnt lgkmcnt(7)
    v_mfma_f32_16x16x32_bf16 v[76:79], a[52:55], a[84:87], v[76:79]
    v_mfma_f32_16x16x32_bf16 v[72:75], a[52:55], a[80:83], v[72:75]
    ds_read_b128 a[52:55], v2 offset:17408
    buffer_load_dword v52, v50, s[4:7], s86 offen sc1
    s_waitcnt lgkmcnt(7)
    v_mfma_f32_16x16x32_bf16 v[80:83], a[56:59], a[80:83], v[80:83]
    buffer_load_dwordx4 a[132:135], v9, s[4:7], s62 offen offset:0 sc1
    v_mfma_f32_16x16x32_bf16 v[84:87], a[56:59], a[84:87], v[84:87]
    ds_read_b128 a[56:59], v2 offset:18432
    s_waitcnt lgkmcnt(7)
    v_mfma_f32_16x16x32_bf16 v[92:95], a[60:63], a[84:87], v[92:95]
    v_mfma_f32_16x16x32_bf16 v[88:91], a[60:63], a[80:83], v[88:91]
    ds_read_b128 a[60:63], v2 offset:19456
    s_waitcnt vmcnt(11)
    s_barrier
    s_waitcnt lgkmcnt(7)
    v_mfma_f32_16x16x32_bf16 v[64:67], a[64:67], a[88:91], v[64:67]
    buffer_load_dwordx4 a[80:83], v8, s[4:7], s62 offen offset:1024 sc1
    v_mfma_f32_16x16x32_bf16 v[68:71], a[64:67], a[92:95], v[68:71]
    ds_read_b128 a[64:67], v2 offset:20480
    s_waitcnt lgkmcnt(7)
    v_mfma_f32_16x16x32_bf16 v[76:79], a[68:71], a[92:95], v[76:79]
    v_mfma_f32_16x16x32_bf16 v[72:75], a[68:71], a[88:91], v[72:75]
    ds_read_b128 a[68:71], v2 offset:21504
    s_waitcnt lgkmcnt(7)
    v_mfma_f32_16x16x32_bf16 v[80:83], a[72:75], a[88:91], v[80:83]
    buffer_load_dwordx4 a[84:87], v9, s[4:7], s62 offen offset:1024 sc1
    v_mfma_f32_16x16x32_bf16 v[84:87], a[72:75], a[92:95], v[84:87]
    ds_read_b128 a[72:75], v2 offset:22528
    s_waitcnt lgkmcnt(7)
    v_mfma_f32_16x16x32_bf16 v[92:95], a[76:79], a[92:95], v[92:95]
    v_mfma_f32_16x16x32_bf16 v[88:91], a[76:79], a[88:91], v[88:91]
    ds_read_b128 a[76:79], v2 offset:23552
    s_waitcnt vmcnt(11)
    s_waitcnt lgkmcnt(7)
    v_mfma_f32_16x16x32_bf16 v[64:67], a[48:51], a[96:99], v[64:67]
    buffer_load_dwordx4 a[88:91], v8, s[4:7], s62 offen offset:2048 sc1
    v_mfma_f32_16x16x32_bf16 v[68:71], a[48:51], a[100:103], v[68:71]
    ds_read_b128 a[48:51], v2 offset:24576
    s_waitcnt lgkmcnt(7)
    v_mfma_f32_16x16x32_bf16 v[76:79], a[52:55], a[100:103], v[76:79]
    v_mfma_f32_16x16x32_bf16 v[72:75], a[52:55], a[96:99], v[72:75]
    ds_read_b128 a[52:55], v2 offset:25600
    s_waitcnt lgkmcnt(7)
    v_mfma_f32_16x16x32_bf16 v[80:83], a[56:59], a[96:99], v[80:83]
    buffer_load_dwordx4 a[92:95], v9, s[4:7], s62 offen offset:2048 sc1
    v_mfma_f32_16x16x32_bf16 v[84:87], a[56:59], a[100:103], v[84:87]
    ds_read_b128 a[56:59], v2 offset:26624
    s_waitcnt lgkmcnt(7)
    v_mfma_f32_16x16x32_bf16 v[92:95], a[60:63], a[100:103], v[92:95]
    v_mfma_f32_16x16x32_bf16 v[88:91], a[60:63], a[96:99], v[88:91]
    ds_read_b128 a[60:63], v2 offset:27648
    s_waitcnt vmcnt(11)
    s_waitcnt lgkmcnt(7)
    v_mfma_f32_16x16x32_bf16 v[64:67], a[64:67], a[104:107], v[64:67]
    buffer_load_dwordx4 a[96:99], v8, s[4:7], s62 offen offset:3072 sc1
    v_mfma_f32_16x16x32_bf16 v[68:71], a[64:67], a[108:111], v[68:71]
    ds_read_b128 a[64:67], v2 offset:28672
    s_waitcnt lgkmcnt(7)
    v_mfma_f32_16x16x32_bf16 v[76:79], a[68:71], a[108:111], v[76:79]
    v_mfma_f32_16x16x32_bf16 v[72:75], a[68:71], a[104:107], v[72:75]
    ds_read_b128 a[68:71], v2 offset:29696
    s_waitcnt lgkmcnt(7)
    v_mfma_f32_16x16x32_bf16 v[80:83], a[72:75], a[104:107], v[80:83]
    buffer_load_dwordx4 a[100:103], v9, s[4:7], s62 offen offset:3072 sc1
    v_mfma_f32_16x16x32_bf16 v[84:87], a[72:75], a[108:111], v[84:87]
    ds_read_b128 a[72:75], v2 offset:30720
    s_waitcnt lgkmcnt(7)
    v_mfma_f32_16x16x32_bf16 v[92:95], a[76:79], a[108:111], v[92:95]
    v_mfma_f32_16x16x32_bf16 v[88:91], a[76:79], a[104:107], v[88:91]
    ds_read_b128 a[76:79], v2 offset:31744
    s_waitcnt vmcnt(11)
    s_waitcnt lgkmcnt(7)
    v_mfma_f32_16x16x32_bf16 v[64:67], a[48:51], a[112:115], v[64:67]
    s_mov_b32 s62, 29384704
    buffer_load_dwordx4 a[104:107], v8, s[4:7], s62 offen offset:0 sc1
    v_mfma_f32_16x16x32_bf16 v[68:71], a[48:51], a[116:119], v[68:71]
    ds_read_b128 a[48:51], v2 offset:32768
    s_waitcnt lgkmcnt(7)
    v_mfma_f32_16x16x32_bf16 v[76:79], a[52:55], a[116:119], v[76:79]
    v_mfma_f32_16x16x32_bf16 v[72:75], a[52:55], a[112:115], v[72:75]
    ds_read_b128 a[52:55], v2 offset:33792
    s_add_u32 s20, s48, L_layer2-L_pc
    s_addc_u32 s21, s49, 0
    global_load_dword v52, v35, s[20:21]
    s_waitcnt lgkmcnt(7)
    v_mfma_f32_16x16x32_bf16 v[80:83], a[56:59], a[112:115], v[80:83]
    buffer_load_dwordx4 a[108:111], v9, s[4:7], s62 offen offset:0 sc1
    v_mfma_f32_16x16x32_bf16 v[84:87], a[56:59], a[116:119], v[84:87]
    ds_read_b128 a[56:59], v2 offset:34816
    s_waitcnt lgkmcnt(7)
    v_mfma_f32_16x16x32_bf16 v[92:95], a[60:63], a[116:119], v[92:95]
    v_mfma_f32_16x16x32_bf16 v[88:91], a[60:63], a[112:115], v[88:91]
    ds_read_b128 a[60:63], v2 offset:35840
    s_waitcnt vmcnt(12)
    s_waitcnt lgkmcnt(7)
    v_mfma_f32_16x16x32_bf16 v[64:67], a[64:67], a[120:123], v[64:67]
    buffer_load_dwordx4 a[112:115], v8, s[4:7], s62 offen offset:1024 sc1
    v_mfma_f32_16x16x32_bf16 v[68:71], a[64:67], a[124:127], v[68:71]
    ds_read_b128 a[64:67], v2 offset:36864
    s_waitcnt lgkmcnt(7)
    v_mfma_f32_16x16x32_bf16 v[76:79], a[68:71], a[124:127], v[76:79]
    v_mfma_f32_16x16x32_bf16 v[72:75], a[68:71], a[120:123], v[72:75]
    ds_read_b128 a[68:71], v2 offset:37888
    s_waitcnt lgkmcnt(7)
    v_mfma_f32_16x16x32_bf16 v[80:83], a[72:75], a[120:123], v[80:83]
    buffer_load_dwordx4 a[116:119], v9, s[4:7], s62 offen offset:1024 sc1
    v_mfma_f32_16x16x32_bf16 v[84:87], a[72:75], a[124:127], v[84:87]
    ds_read_b128 a[72:75], v2 offset:38912
    s_waitcnt lgkmcnt(7)
    v_mfma_f32_16x16x32_bf16 v[92:95], a[76:79], a[124:127], v[92:95]
    v_mfma_f32_16x16x32_bf16 v[88:91], a[76:79], a[120:123], v[88:91]
    ds_read_b128 a[76:79], v2 offset:39936
    s_waitcnt vmcnt(11)
    s_waitcnt lgkmcnt(7)
    v_mfma_f32_16x16x32_bf16 v[64:67], a[48:51], a[128:131], v[64:67]
    buffer_load_dwordx4 a[120:123], v8, s[4:7], s62 offen offset:2048 sc1
    v_mfma_f32_16x16x32_bf16 v[68:71], a[48:51], a[132:135], v[68:71]
    ds_read_b128 a[48:51], v2 offset:40960
    s_waitcnt lgkmcnt(7)
    v_mfma_f32_16x16x32_bf16 v[76:79], a[52:55], a[132:135], v[76:79]
    v_mfma_f32_16x16x32_bf16 v[72:75], a[52:55], a[128:131], v[72:75]
    ds_read_b128 a[52:55], v2 offset:41984
    s_waitcnt lgkmcnt(7)
    v_mfma_f32_16x16x32_bf16 v[80:83], a[56:59], a[128:131], v[80:83]
    buffer_load_dwordx4 a[124:127], v9, s[4:7], s62 offen offset:2048 sc1
    v_mfma_f32_16x16x32_bf16 v[84:87], a[56:59], a[132:135], v[84:87]
    ds_read_b128 a[56:59], v2 offset:43008
    s_waitcnt lgkmcnt(7)
    v_mfma_f32_16x16x32_bf16 v[92:95], a[60:63], a[132:135], v[92:95]
    v_mfma_f32_16x16x32_bf16 v[88:91], a[60:63], a[128:131], v[88:91]
    ds_read_b128 a[60:63], v2 offset:44032
    s_waitcnt vmcnt(11)
    s_waitcnt lgkmcnt(7)
    v_mfma_f32_16x16x32_bf16 v[64:67], a[64:67], a[80:83], v[64:67]
    buffer_load_dwordx4 a[128:131], v8, s[4:7], s62 offen offset:3072 sc1
    v_mfma_f32_16x16x32_bf16 v[68:71], a[64:67], a[84:87], v[68:71]
    ds_read_b128 a[64:67], v2 offset:45056
    s_waitcnt lgkmcnt(7)
    v_mfma_f32_16x16x32_bf16 v[76:79], a[68:71], a[84:87], v[76:79]
    v_mfma_f32_16x16x32_bf16 v[72:75], a[68:71], a[80:83], v[72:75]
    ds_read_b128 a[68:71], v2 offset:46080
    s_waitcnt lgkmcnt(7)
    v_mfma_f32_16x16x32_bf16 v[80:83], a[72:75], a[80:83], v[80:83]
    buffer_load_dwordx4 a[132:135], v9, s[4:7], s62 offen offset:3072 sc1
    v_mfma_f32_16x16x32_bf16 v[84:87], a[72:75], a[84:87], v[84:87]
    ds_read_b128 a[72:75], v2 offset:47104
    s_waitcnt lgkmcnt(7)
    v_mfma_f32_16x16x32_bf16 v[92:95], a[76:79], a[84:87], v[92:95]
    v_mfma_f32_16x16x32_bf16 v[88:91], a[76:79], a[80:83], v[88:91]
    ds_read_b128 a[76:79], v2 offset:48128
    s_waitcnt vmcnt(11)
    s_waitcnt lgkmcnt(7)
    v_mfma_f32_16x16x32_bf16 v[64:67], a[48:51], a[88:91], v[64:67]
    s_mov_b32 s62, 29388800
    buffer_load_dwordx4 a[80:83], v8, s[4:7], s62 offen offset:0 sc1
    v_mfma_f32_16x16x32_bf16 v[68:71], a[48:51], a[92:95], v[68:71]
    ds_read_b128 a[48:51], v2 offset:49152
    s_waitcnt lgkmcnt(7)
    v_mfma_f32_16x16x32_bf16 v[76:79], a[52:55], a[92:95], v[76:79]
    v_mfma_f32_16x16x32_bf16 v[72:75], a[52:55], a[88:91], v[72:75]
    ds_read_b128 a[52:55], v2 offset:50176
    s_waitcnt lgkmcnt(7)
    v_mfma_f32_16x16x32_bf16 v[80:83], a[56:59], a[88:91], v[80:83]
    buffer_load_dwordx4 a[84:87], v9, s[4:7], s62 offen offset:0 sc1
    v_mfma_f32_16x16x32_bf16 v[84:87], a[56:59], a[92:95], v[84:87]
    ds_read_b128 a[56:59], v2 offset:51200
    s_waitcnt lgkmcnt(7)
    v_mfma_f32_16x16x32_bf16 v[92:95], a[60:63], a[92:95], v[92:95]
    v_mfma_f32_16x16x32_bf16 v[88:91], a[60:63], a[88:91], v[88:91]
    ds_read_b128 a[60:63], v2 offset:52224
    s_waitcnt vmcnt(11)
    s_waitcnt lgkmcnt(7)
    v_mfma_f32_16x16x32_bf16 v[64:67], a[64:67], a[96:99], v[64:67]
    buffer_load_dwordx4 a[88:91], v8, s[4:7], s62 offen offset:1024 sc1
    v_mfma_f32_16x16x32_bf16 v[68:71], a[64:67], a[100:103], v[68:71]
    ds_read_b128 a[64:67], v2 offset:53248
    s_waitcnt lgkmcnt(7)
    v_mfma_f32_16x16x32_bf16 v[76:79], a[68:71], a[100:103], v[76:79]
    v_mfma_f32_16x16x32_bf16 v[72:75], a[68:71], a[96:99], v[72:75]
    ds_read_b128 a[68:71], v2 offset:54272
    s_waitcnt lgkmcnt(7)
    v_mfma_f32_16x16x32_bf16 v[80:83], a[72:75], a[96:99], v[80:83]
    buffer_load_dwordx4 a[92:95], v8, s[4:7], s62 offen offset:2048 sc1
    v_mfma_f32_16x16x32_bf16 v[84:87], a[72:75], a[100:103], v[84:87]
    ds_read_b128 a[72:75], v2 offset:55296
    s_waitcnt lgkmcnt(7)
    v_mfma_f32_16x16x32_bf16 v[92:95], a[76:79], a[100:103], v[92:95]
    v_mfma_f32_16x16x32_bf16 v[88:91], a[76:79], a[96:99], v[88:91]
    ds_read_b128 a[76:79], v2 offset:56320
    s_waitcnt vmcnt(10)
    s_waitcnt lgkmcnt(7)
    v_mfma_f32_16x16x32_bf16 v[64:67], a[48:51], a[104:107], v[64:67]
    buffer_load_dwordx4 a[96:99], v8, s[4:7], s62 offen offset:3072 sc1
    v_mfma_f32_16x16x32_bf16 v[68:71], a[48:51], a[108:111], v[68:71]
    ds_read_b128 a[48:51], v2 offset:57344
    s_waitcnt lgkmcnt(7)
    v_mfma_f32_16x16x32_bf16 v[76:79], a[52:55], a[108:111], v[76:79]
    v_mfma_f32_16x16x32_bf16 v[72:75], a[52:55], a[104:107], v[72:75]
    ds_read_b128 a[52:55], v2 offset:58368
    s_waitcnt lgkmcnt(7)
    v_mfma_f32_16x16x32_bf16 v[80:83], a[56:59], a[104:107], v[80:83]
    buffer_load_dwordx4 a[100:103], v9, s[4:7], s62 offen offset:1024 sc1
    v_mfma_f32_16x16x32_bf16 v[84:87], a[56:59], a[108:111], v[84:87]
    ds_read_b128 a[56:59], v2 offset:59392
    s_waitcnt lgkmcnt(7)
    v_mfma_f32_16x16x32_bf16 v[92:95], a[60:63], a[108:111], v[92:95]
    v_mfma_f32_16x16x32_bf16 v[88:91], a[60:63], a[104:107], v[88:91]
    ds_read_b128 a[60:63], v2 offset:60416
    s_waitcnt vmcnt(10)
    s_waitcnt lgkmcnt(7)
    v_mfma_f32_16x16x32_bf16 v[64:67], a[64:67], a[112:115], v[64:67]
    buffer_load_dwordx4 a[104:107], v9, s[4:7], s62 offen offset:2048 sc1
    v_mfma_f32_16x16x32_bf16 v[68:71], a[64:67], a[116:119], v[68:71]
    ds_read_b128 a[64:67], v2 offset:61440
    s_waitcnt lgkmcnt(7)
    v_mfma_f32_16x16x32_bf16 v[76:79], a[68:71], a[116:119], v[76:79]
    v_mfma_f32_16x16x32_bf16 v[72:75], a[68:71], a[112:115], v[72:75]
    ds_read_b128 a[68:71], v2 offset:62464
    s_waitcnt lgkmcnt(7)
    v_mfma_f32_16x16x32_bf16 v[80:83], a[72:75], a[112:115], v[80:83]
    buffer_load_dwordx4 a[108:111], v9, s[4:7], s62 offen offset:3072 sc1
    v_mfma_f32_16x16x32_bf16 v[84:87], a[72:75], a[116:119], v[84:87]
    ds_read_b128 a[72:75], v2 offset:63488
    s_waitcnt lgkmcnt(7)
    v_mfma_f32_16x16x32_bf16 v[92:95], a[76:79], a[116:119], v[92:95]
    v_mfma_f32_16x16x32_bf16 v[88:91], a[76:79], a[112:115], v[88:91]
    ds_read_b128 a[76:79], v2 offset:64512
    s_waitcnt vmcnt(10)
    s_waitcnt lgkmcnt(7)
    v_mfma_f32_16x16x32_bf16 v[64:67], a[48:51], a[120:123], v[64:67]
    s_add_u32 m0, s57, 49152
    s_add_u32 s63, s95, 8388608
    buffer_load_dwordx4 v10, s[4:7], s63 offen offset:0 lds
    v_mfma_f32_16x16x32_bf16 v[68:71], a[48:51], a[124:127], v[68:71]
    ds_read_b128 a[48:51], v3 offset:0
    s_waitcnt lgkmcnt(7)
    v_mfma_f32_16x16x32_bf16 v[76:79], a[52:55], a[124:127], v[76:79]
    v_mfma_f32_16x16x32_bf16 v[72:75], a[52:55], a[120:123], v[72:75]
    ds_read_b128 a[52:55], v3 offset:1024
    s_waitcnt lgkmcnt(7)
    v_mfma_f32_16x16x32_bf16 v[80:83], a[56:59], a[120:123], v[80:83]
    buffer_load_dwordx4 v10, s[4:7], s63 offen offset:1024 lds
    v_mfma_f32_16x16x32_bf16 v[84:87], a[56:59], a[124:127], v[84:87]
    ds_read_b128 a[56:59], v3 offset:2048
    s_waitcnt lgkmcnt(7)
    v_mfma_f32_16x16x32_bf16 v[92:95], a[60:63], a[124:127], v[92:95]
    v_mfma_f32_16x16x32_bf16 v[88:91], a[60:63], a[120:123], v[88:91]
    ds_read_b128 a[60:63], v3 offset:3072
    s_waitcnt vmcnt(10)
    s_barrier
    s_waitcnt lgkmcnt(7)
    v_mfma_f32_16x16x32_bf16 v[64:67], a[64:67], a[128:131], v[64:67]
    buffer_load_dwordx4 v10, s[4:7], s63 offen offset:2048 lds
    v_mfma_f32_16x16x32_bf16 v[68:71], a[64:67], a[132:135], v[68:71]
    ds_read_b128 a[64:67], v3 offset:4096
    s_waitcnt lgkmcnt(7)
    v_mfma_f32_16x16x32_bf16 v[76:79], a[68:71], a[132:135], v[76:79]
    v_mfma_f32_16x16x32_bf16 v[72:75], a[68:71], a[128:131], v[72:75]
    ds_read_b128 a[68:71], v3 offset:5120
    s_waitcnt lgkmcnt(7)
    v_mfma_f32_16x16x32_bf16 v[80:83], a[72:75], a[128:131], v[80:83]
    buffer_load_dwordx4 v10, s[4:7], s63 offen offset:3072 lds
    v_mfma_f32_16x16x32_bf16 v[84:87], a[72:75], a[132:135], v[84:87]
    ds_read_b128 a[72:75], v3 offset:6144
    s_waitcnt lgkmcnt(7)
    v_mfma_f32_16x16x32_bf16 v[92:95], a[76:79], a[132:135], v[92:95]
    v_mfma_f32_16x16x32_bf16 v[88:91], a[76:79], a[128:131], v[88:91]
    ds_read_b128 a[76:79], v3 offset:7168
    s_waitcnt vmcnt(10)
    s_waitcnt lgkmcnt(7)
    v_mfma_f32_16x16x32_bf16 v[64:67], a[48:51], a[80:83], v[64:67]
    s_add_u32 m0, s57, 53248
    s_add_u32 s63, s95, 8392704
    buffer_load_dwordx4 v10, s[4:7], s63 offen offset:0 lds
    v_mfma_f32_16x16x32_bf16 v[68:71], a[48:51], a[84:87], v[68:71]
    ds_read_b128 a[48:51], v3 offset:8192
    s_waitcnt lgkmcnt(7)
    v_mfma_f32_16x16x32_bf16 v[76:79], a[52:55], a[84:87], v[76:79]
    v_mfma_f32_16x16x32_bf16 v[72:75], a[52:55], a[80:83], v[72:75]
    ds_read_b128 a[52:55], v3 offset:9216
    s_waitcnt lgkmcnt(7)
    v_mfma_f32_16x16x32_bf16 v[80:83], a[56:59], a[80:83], v[80:83]
    buffer_load_dwordx4 v10, s[4:7], s63 offen offset:1024 lds
    v_mfma_f32_16x16x32_bf16 v[84:87], a[56:59], a[84:87], v[84:87]
    ds_read_b128 a[56:59], v3 offset:10240
    s_waitcnt lgkmcnt(7)
    v_mfma_f32_16x16x32_bf16 v[92:95], a[60:63], a[84:87], v[92:95]
    v_mfma_f32_16x16x32_bf16 v[88:91], a[60:63], a[80:83], v[88:91]
    ds_read_b128 a[60:63], v3 offset:11264
    s_waitcnt vmcnt(11)
    s_waitcnt lgkmcnt(7)
    v_mfma_f32_16x16x32_bf16 v[64:67], a[64:67], a[88:91], v[64:67]
    ds_read_b128 a[64:67], v3 offset:12288
    s_waitcnt lgkmcnt(7)
    v_mfma_f32_16x16x32_bf16 v[72:75], a[68:71], a[88:91], v[72:75]
    ds_read_b128 a[68:71], v3 offset:13312
    s_waitcnt lgkmcnt(7)
    v_mfma_f32_16x16x32_bf16 v[80:83], a[72:75], a[88:91], v[80:83]
    ds_read_b128 a[72:75], v3 offset:14336
    s_waitcnt lgkmcnt(7)
    v_mfma_f32_16x16x32_bf16 v[88:91], a[76:79], a[88:91], v[88:91]
    ds_read_b128 a[76:79], v3 offset:15360
    s_waitcnt vmcnt(10)
    s_waitcnt lgkmcnt(7)
    v_mfma_f32_16x16x32_bf16 v[64:67], a[48:51], a[92:95], v[64:67]
    ds_read_b128 a[48:51], v3 offset:4096
    s_waitcnt lgkmcnt(7)
    v_mfma_f32_16x16x32_bf16 v[72:75], a[52:55], a[92:95], v[72:75]
    ds_read_b128 a[52:55], v3 offset:5120
    s_waitcnt lgkmcnt(7)
    v_mfma_f32_16x16x32_bf16 v[80:83], a[56:59], a[92:95], v[80:83]
    ds_read_b128 a[56:59], v3 offset:6144
    s_waitcnt lgkmcnt(7)
    v_mfma_f32_16x16x32_bf16 v[88:91], a[60:63], a[92:95], v[88:91]
    ds_read_b128 a[60:63], v3 offset:7168
    s_waitcnt vmcnt(9)
    s_waitcnt lgkmcnt(7)
    v_mfma_f32_16x16x32_bf16 v[64:67], a[64:67], a[96:99], v[64:67]
    ds_read_b128 a[64:67], v3 offset:8192
    s_waitcnt lgkmcnt(7)
    v_mfma_f32_16x16x32_bf16 v[72:75], a[68:71], a[96:99], v[72:75]
    ds_read_b128 a[68:71], v3 offset:9216
    s_waitcnt lgkmcnt(7)
    v_mfma_f32_16x16x32_bf16 v[80:83], a[72:75], a[96:99], v[80:83]
    ds_read_b128 a[72:75], v3 offset:10240
    s_waitcnt lgkmcnt(7)
    v_mfma_f32_16x16x32_bf16 v[88:91], a[76:79], a[96:99], v[88:91]
    ds_read_b128 a[76:79], v3 offset:11264
    s_waitcnt vmcnt(8)
    s_waitcnt lgkmcnt(7)
    v_mfma_f32_16x16x32_bf16 v[68:71], a[48:51], a[100:103], v[68:71]
    ds_read_b128 a[48:51], v3 offset:12288
    s_waitcnt lgkmcnt(7)
    v_mfma_f32_16x16x32_bf16 v[76:79], a[52:55], a[100:103], v[76:79]
    v_cvt_pk_bf16_f32 v16, v64, v65
    v_cvt_pk_bf16_f32 v17, v66, v67
    ds_read_b128 a[52:55], v3 offset:13312
    s_waitcnt lgkmcnt(7)
    v_mfma_f32_16x16x32_bf16 v[84:87], a[56:59], a[100:103], v[84:87]
    v_cvt_pk_bf16_f32 v18, v72, v73
    v_cvt_pk_bf16_f32 v19, v74, v75
    ds_read_b128 a[56:59], v3 offset:14336
    s_waitcnt lgkmcnt(7)
    v_mfma_f32_16x16x32_bf16 v[92:95], a[60:63], a[100:103], v[92:95]
    v_cvt_pk_bf16_f32 v20, v80, v81
    v_cvt_pk_bf16_f32 v21, v82, v83
    ds_read_b128 a[60:63], v3 offset:15360
    s_waitcnt vmcnt(7)
    s_waitcnt lgkmcnt(7)
    v_mfma_f32_16x16x32_bf16 v[68:71], a[64:67], a[104:107], v[68:71]
    v_cvt_pk_bf16_f32 v22, v88, v89
    v_cvt_pk_bf16_f32 v23, v90, v91
    s_waitcnt lgkmcnt(6)
    v_mfma_f32_16x16x32_bf16 v[76:79], a[68:71], a[104:107], v[76:79]
    v_mfma_f32_16x16x32_bf16 v[164:167], v[16:19], v[16:19], 0
    s_waitcnt lgkmcnt(5)
    v_mfma_f32_16x16x32_bf16 v[84:87], a[72:75], a[104:107], v[84:87]
    s_cmp_lg_u32 s15, 0
    s_cbranch_scc1 L_slow_43
    buffer_store_dwordx4 v[16:19], v8, s[4:7], s35 offen offset:0
L_done_44:
    s_waitcnt lgkmcnt(4)
    v_mfma_f32_16x16x32_bf16 v[92:95], a[76:79], a[104:107], v[92:95]
    v_mfma_f32_16x16x32_bf16 v[160:163], v[40:43], v[16:19], 0
    s_waitcnt vmcnt(7)
    s_waitcnt lgkmcnt(3)
    v_mfma_f32_16x16x32_bf16 v[68:71], a[48:51], a[108:111], v[68:71]
    v_mfma_f32_16x16x32_bf16 v[164:167], v[20:23], v[20:23], v[164:167]
    s_waitcnt lgkmcnt(2)
    v_mfma_f32_16x16x32_bf16 v[76:79], a[52:55], a[108:111], v[76:79]
    s_cmp_lg_u32 s15, 0
    s_cbranch_scc1 L_slow_45
    buffer_store_dwordx4 v[20:23], v8, s[4:7], s35 offen offset:1024
L_done_46:
    s_waitcnt lgkmcnt(1)
    v_mfma_f32_16x16x32_bf16 v[84:87], a[56:59], a[108:111], v[84:87]
    v_mfma_f32_16x16x32_bf16 v[160:163], v[40:43], v[20:23], v[160:163]
    s_waitcnt lgkmcnt(0)
    v_mfma_f32_16x16x32_bf16 v[92:95], a[60:63], a[108:111], v[92:95]
    s_cmp_lg_u32 s15, 0
    s_cbranch_scc1 L_slow_47
    v_cndmask_b32 v164, v164, v165, s[36:37]
    v_cndmask_b32 v166, v166, v167, s[36:37]
    s_nop 1
    v_cndmask_b32 v161, v164, v166, s[38:39]
    s_mov_b64 exec, s[40:41]
    buffer_store_dwordx2 v[160:161], v14, s[4:7], s56 offen offset:0
    s_mov_b64 exec, -1
L_done_48:
    v_cvt_pk_bf16_f32 v24, v68, v69
    v_cvt_pk_bf16_f32 v25, v70, v71
    v_cvt_pk_bf16_f32 v26, v76, v77
    v_cvt_pk_bf16_f32 v27, v78, v79
    v_cvt_pk_bf16_f32 v28, v84, v85
    v_cvt_pk_bf16_f32 v29, v86, v87
    v_cvt_pk_bf16_f32 v30, v92, v93
    v_cvt_pk_bf16_f32 v31, v94, v95
    s_cmp_lg_u32 s15, 0
    s_cbranch_scc1 L_slow_49
    v_mfma_f32_16x16x32_bf16 v[172:175], v[24:27], v[24:27], 0
    buffer_store_dwordx4 v[24:27], v9, s[4:7], s35 offen offset:0
    v_mfma_f32_16x16x32_bf16 v[168:171], v[40:43], v[24:27], 0
    v_mfma_f32_16x16x32_bf16 v[172:175], v[28:31], v[28:31], v[172:175]
    buffer_store_dwordx4 v[28:31], v9, s[4:7], s35 offen offset:1024
    v_mfma_f32_16x16x32_bf16 v[168:171], v[40:43], v[28:31], v[168:171]
    s_nop 5
    v_cndmask_b32 v172, v172, v173, s[36:37]
    v_cndmask_b32 v174, v174, v175, s[36:37]
    v_cndmask_b32 v169, v172, v174, s[38:39]
    s_mov_b64 exec, s[40:41]
    buffer_store_dwordx2 v[168:169], v14, s[4:7], s56 offen offset:128
    s_mov_b64 exec, -1
L_done_50:
    ds_write_b128 v0, a[0:3] offset:24576
    ds_write_b128 v0, a[4:7] offset:25600
    ds_write_b128 v0, a[8:11] offset:26624
    ds_write_b128 v0, a[12:15] offset:27648
    buffer_load_dword v216, v12, s[4:7], s32 offen sc1
    ds_write_b128 v0, a[16:19] offset:28672
    ds_write_b128 v0, a[20:23] offset:29696
    ds_write_b128 v34, a[192:195] offset:0
    ds_write_b128 v34, a[196:199] offset:1024
    ds_write_b128 v34, a[200:203] offset:2048
    ds_write_b128 v34, a[204:207] offset:3072
    ds_write_b128 v34, a[208:211] offset:4096
    ds_write_b128 v34, a[212:215] offset:5120
    s_mov_b64 exec, 1
    s_waitcnt vmcnt(1)
    s_cmp_lg_u32 s15, 0
    s_cbranch_scc1 L_slow_52
    buffer_store_dword v63, off, s[4:7], s33
L_done_53:
    s_mov_b64 exec, -1
    ds_write_b128 v34, a[144:147] offset:24576
    ds_write_b128 v34, a[148:151] offset:25600
    ds_write_b128 v34, a[152:155] offset:26624
    ds_write_b128 v34, a[156:159] offset:27648
    ds_write_b128 v34, a[160:163] offset:28672
    ds_write_b128 v34, a[164:167] offset:29696
    s_waitcnt vmcnt(1)
    s_mov_b64 exec, s[66:67]
    v_cmp_gt_u32 vcc, 2, v216
    s_mov_b64 exec, -1
    s_cbranch_vccz L_hd_51
    s_mov_b32 s61, 1048576
L_spin_54:
    buffer_load_dword v216, v12, s[4:7], s32 offen sc1
    s_sub_u32 s61, s61, 1
    s_waitcnt vmcnt(0)
    s_mov_b64 exec, s[68:69]
    v_cmp_gt_u32 vcc, 2, v216
    s_mov_b64 exec, -1
    s_cbranch_scc1 L_spind_55
    s_cbranch_vccnz L_spin_54
L_spind_55:
L_hd_51:
L_layer2:
    buffer_load_dwordx4 a[48:51], v4, s[4:7], s86 offen offset:0 sc1
    buffer_load_dwordx4 a[52:55], v5, s[4:7], s86 offen offset:0 sc1
    buffer_load_dwordx4 a[56:59], v6, s[4:7], s86 offen offset:0 sc1
    buffer_load_dwordx4 a[60:63], v7, s[4:7], s86 offen offset:0 sc1
    buffer_load_dwordx4 a[64:67], v4, s[4:7], s86 offen offset:1024 sc1
    buffer_load_dwordx4 a[68:71], v5, s[4:7], s86 offen offset:1024 sc1
    buffer_load_dwordx4 a[72:75], v6, s[4:7], s86 offen offset:1024 sc1
    buffer_load_dwordx4 a[76:79], v7, s[4:7], s86 offen offset:1024 sc1
    buffer_load_dwordx4 a[80:83], v4, s[4:7], s86 offen offset:2048 sc1
    buffer_load_dwordx4 a[84:87], v5, s[4:7], s86 offen offset:2048 sc1
    buffer_load_dwordx4 a[88:91], v6, s[4:7], s86 offen offset:2048 sc1
    buffer_load_dwordx4 a[92:95], v7, s[4:7], s86 offen offset:2048 sc1
    buffer_load_dword v216, v12, s[4:7], s32 offen sc1
    s_waitcnt lgkmcnt(0)
    s_barrier
    ds_read_b128 v[192:195], v1 offset:24576
    ds_read_b128 v[196:199], v1 offset:25600
    ds_read_b128 v[200:203], v1 offset:26624
    ds_read_b128 v[204:207], v1 offset:27648
    ds_read_b128 v[208:211], v1 offset:28672
    ds_read_b128 v[212:215], v1 offset:29696
    s_waitcnt vmcnt(9)
    s_waitcnt lgkmcnt(5)
    v_mfma_f32_16x16x32_bf16 v[64:67], v[192:195], a[48:51], 0
    v_mfma_f32_16x16x32_bf16 v[68:71], v[192:195], a[52:55], 0
    buffer_load_dwordx4 a[96:99], v4, s[4:7], s86 offen offset:3072 sc1
    v_mfma_f32_16x16x32_bf16 v[72:75], v[192:195], a[56:59], 0
    v_mfma_f32_16x16x32_bf16 v[76:79], v[192:195], a[60:63], 0
    ds_read_b128 v[192:195], v1 offset:30720
    s_waitcnt lgkmcnt(5)
    v_mfma_f32_16x16x32_bf16 v[92:95], v[196:199], a[60:63], 0
    v_mfma_f32_16x16x32_bf16 v[88:91], v[196:199], a[56:59], 0
    buffer_load_dwordx4 a[100:103], v5, s[4:7], s86 offen offset:3072 sc1
    v_mfma_f32_16x16x32_bf16 v[84:87], v[196:199], a[52:55], 0
    v_mfma_f32_16x16x32_bf16 v[80:83], v[196:199], a[48:51], 0
    ds_read_b128 v[196:199], v1 offset:31744
    s_waitcnt lgkmcnt(5)
    v_mfma_f32_16x16x32_bf16 v[96:99], v[200:203], a[48:51], 0
    v_mfma_f32_16x16x32_bf16 v[100:103], v[200:203], a[52:55], 0
    buffer_load_dwordx4 a[104:107], v6, s[4:7], s86 offen offset:3072 sc1
    v_mfma_f32_16x16x32_bf16 v[104:107], v[200:203], a[56:59], 0
    v_mfma_f32_16x16x32_bf16 v[108:111], v[200:203], a[60:63], 0
    ds_read_b128 v[200:203], v1 offset:32768
    s_waitcnt lgkmcnt(5)
    v_mfma_f32_16x16x32_bf16 v[124:127], v[204:207], a[60:63], 0
    v_mfma_f32_16x16x32_bf16 v[120:123], v[204:207], a[56:59], 0
    buffer_load_dwordx4 a[108:111], v7, s[4:7], s86 offen offset:3072 sc1
    v_mfma_f32_16x16x32_bf16 v[116:119], v[204:207], a[52:55], 0
    v_mfma_f32_16x16x32_bf16 v[112:115], v[204:207], a[48:51], 0
    ds_read_b128 v[204:207], v1 offset:33792
    s_waitcnt lgkmcnt(5)
    v_mfma_f32_16x16x32_bf16 v[128:131], v[208:211], a[48:51], 0
    v_mfma_f32_16x16x32_bf16 v[132:135], v[208:211], a[52:55], 0
    v_mfma_f32_16x16x32_bf16 v[136:139], v[208:211], a[56:59], 0
    v_mfma_f32_16x16x32_bf16 v[140:143], v[208:211], a[60:63], 0
    ds_read_b128 v[208:211], v1 offset:34816
    s_waitcnt lgkmcnt(5)
    v_mfma_f32_16x16x32_bf16 v[156:159], v[212:215], a[60:63], 0
    v_mfma_f32_16x16x32_bf16 v[152:155], v[212:215], a[56:59], 0
    v_mfma_f32_16x16x32_bf16 v[148:151], v[212:215], a[52:55], 0
    v_mfma_f32_16x16x32_bf16 v[144:147], v[212:215], a[48:51], 0
    ds_read_b128 v[212:215], v1 offset:35840
    s_waitcnt vmcnt(9)
    s_waitcnt vmcnt(4)
    v_cmp_gt_u32 vcc, 2, v216
    s_cbranch_vccnz L_p2_56
L_p2_56_r:
    s_waitcnt lgkmcnt(5)
    v_mfma_f32_16x16x32_bf16 v[64:67], v[192:195], a[64:67], v[64:67]
    v_mfma_f32_16x16x32_bf16 v[68:71], v[192:195], a[68:71], v[68:71]
    buffer_load_dwordx4 a[112:115], v4, s[4:7], s87 offen offset:0 sc1
    v_mfma_f32_16x16x32_bf16 v[72:75], v[192:195], a[72:75], v[72:75]
    v_mfma_f32_16x16x32_bf16 v[76:79], v[192:195], a[76:79], v[76:79]
    ds_read_b128 v[192:195], v1 offset:36864
    s_waitcnt lgkmcnt(5)
    v_mfma_f32_16x16x32_bf16 v[92:95], v[196:199], a[76:79], v[92:95]
    s_mov_b32 s19, 1048576
    v_mfma_f32_16x16x32_bf16 v[88:91], v[196:199], a[72:75], v[88:91]
    buffer_load_dwordx4 v[160:163], v13, s[4:7], s19 offen sc1
    v_mfma_f32_16x16x32_bf16 v[84:87], v[196:199], a[68:71], v[84:87]
    v_mfma_f32_16x16x32_bf16 v[80:83], v[196:199], a[64:67], v[80:83]
    ds_read_b128 v[196:199], v1 offset:37888
    s_waitcnt lgkmcnt(5)
    v_mfma_f32_16x16x32_bf16 v[96:99], v[200:203], a[64:67], v[96:99]
    v_mfma_f32_16x16x32_bf16 v[100:103], v[200:203], a[68:71], v[100:103]
    buffer_load_dwordx4 a[116:119], v5, s[4:7], s87 offen offset:0 sc1
    v_mfma_f32_16x16x32_bf16 v[104:107], v[200:203], a[72:75], v[104:107]
    v_mfma_f32_16x16x32_bf16 v[108:111], v[200:203], a[76:79], v[108:111]
    ds_read_b128 v[200:203], v1 offset:38912
    s_waitcnt lgkmcnt(5)
    v_mfma_f32_16x16x32_bf16 v[124:127], v[204:207], a[76:79], v[124:127]
    v_mfma_f32_16x16x32_bf16 v[120:123], v[204:207], a[72:75], v[120:123]
    buffer_load_dwordx4 a[120:123], v6, s[4:7], s87 offen offset:0 sc1
    v_mfma_f32_16x16x32_bf16 v[116:119], v[204:207], a[68:71], v[116:119]
    v_mfma_f32_16x16x32_bf16 v[112:115], v[204:207], a[64:67], v[112:115]
    ds_read_b128 v[204:207], v1 offset:39936
    s_waitcnt lgkmcnt(5)
    v_mfma_f32_16x16x32_bf16 v[128:131], v[208:211], a[64:67], v[128:131]
    s_mov_b32 s19, 1064960
    v_mfma_f32_16x16x32_bf16 v[132:135], v[208:211], a[68:71], v[132:135]
    buffer_load_dwordx4 v[164:167], v13, s[4:7], s19 offen sc1
    v_mfma_f32_16x16x32_bf16 v[136:139], v[208:211], a[72:75], v[136:139]
    v_mfma_f32_16x16x32_bf16 v[140:143], v[208:211], a[76:79], v[140:143]
    ds_read_b128 v[208:211], v1 offset:40960
    s_waitcnt lgkmcnt(5)
    v_mfma_f32_16x16x32_bf16 v[156:159], v[212:215], a[76:79], v[156:159]
    v_mfma_f32_16x16x32_bf16 v[152:155], v[212:215], a[72:75], v[152:155]
    buffer_load_dwordx4 a[124:127], v7, s[4:7], s87 offen offset:0 sc1
    v_mfma_f32_16x16x32_bf16 v[148:151], v[212:215], a[68:71], v[148:151]
    v_mfma_f32_16x16x32_bf16 v[144:147], v[212:215], a[64:67], v[144:147]
    ds_read_b128 v[212:215], v1 offset:41984
    s_waitcnt lgkmcnt(5)
    v_mfma_f32_16x16x32_bf16 v[64:67], v[192:195], a[80:83], v[64:67]
    v_mfma_f32_16x16x32_bf16 v[68:71], v[192:195], a[84:87], v[68:71]
    buffer_load_dwordx4 a[128:131], v4, s[4:7], s87 offen offset:1024 sc1
    v_mfma_f32_16x16x32_bf16 v[72:75], v[192:195], a[88:91], v[72:75]
    v_mfma_f32_16x16x32_bf16 v[76:79], v[192:195], a[92:95], v[76:79]
    ds_read_b128 v[192:195], v1 offset:43008
    s_waitcnt lgkmcnt(5)
    v_mfma_f32_16x16x32_bf16 v[92:95], v[196:199], a[92:95], v[92:95]
    s_add_u32 m0, s57, 122880
    s_add_u32 s63, s98, 8388608
    v_mfma_f32_16x16x32_bf16 v[88:91], v[196:199], a[88:91], v[88:91]
    buffer_load_dwordx4 v10, s[4:7], s63 offen offset:0 lds
    v_mfma_f32_16x16x32_bf16 v[84:87], v[196:199], a[84:87], v[84:87]
    v_mfma_f32_16x16x32_bf16 v[80:83], v[196:199], a[80:83], v[80:83]
    ds_read_b128 v[196:199], v1 offset:44032
    s_waitcnt lgkmcnt(5)
    v_mfma_f32_16x16x32_bf16 v[96:99], v[200:203], a[80:83], v[96:99]
    v_mfma_f32_16x16x32_bf16 v[100:103], v[200:203], a[84:87], v[100:103]
    buffer_load_dwordx4 a[132:135], v5, s[4:7], s87 offen offset:1024 sc1
    v_mfma_f32_16x16x32_bf16 v[104:107], v[200:203], a[88:91], v[104:107]
    v_mfma_f32_16x16x32_bf16 v[108:111], v[200:203], a[92:95], v[108:111]
    ds_read_b128 v[200:203], v1 offset:45056
    s_waitcnt lgkmcnt(5)
    v_mfma_f32_16x16x32_bf16 v[124:127], v[204:207], a[92:95], v[124:127]
    v_mfma_f32_16x16x32_bf16 v[120:123], v[204:207], a[88:91], v[120:123]
    buffer_load_dwordx4 a[136:139], v6, s[4:7], s87 offen offset:1024 sc1
    v_mfma_f32_16x16x32_bf16 v[116:119], v[204:207], a[84:87], v[116:119]
    v_mfma_f32_16x16x32_bf16 v[112:115], v[204:207], a[80:83], v[112:115]
    ds_read_b128 v[204:207], v1 offset:46080
    s_waitcnt lgkmcnt(5)
    v_mfma_f32_16x16x32_bf16 v[128:131], v[208:211], a[80:83], v[128:131]
    s_mov_b32 s19, 1081344
    v_mfma_f32_16x16x32_bf16 v[132:135], v[208:211], a[84:87], v[132:135]
    buffer_load_dwordx4 v[168:171], v13, s[4:7], s19 offen sc1
    v_mfma_f32_16x16x32_bf16 v[136:139], v[208:211], a[88:91], v[136:139]
    v_mfma_f32_16x16x32_bf16 v[140:143], v[208:211], a[92:95], v[140:143]
    ds_read_b128 v[208:211], v1 offset:47104
    s_waitcnt lgkmcnt(5)
    v_mfma_f32_16x16x32_bf16 v[156:159], v[212:215], a[92:95], v[156:159]
    v_mfma_f32_16x16x32_bf16 v[152:155], v[212:215], a[88:91], v[152:155]
    buffer_load_dwordx4 a[140:143], v7, s[4:7], s87 offen offset:1024 sc1
    v_mfma_f32_16x16x32_bf16 v[148:151], v[212:215], a[84:87], v[148:151]
    v_mfma_f32_16x16x32_bf16 v[144:147], v[212:215], a[80:83], v[144:147]
    ds_read_b128 v[212:215], v1 offset:48128
    s_waitcnt vmcnt(12)
    s_barrier
    s_waitcnt lgkmcnt(5)
    v_mfma_f32_16x16x32_bf16 v[64:67], v[192:195], a[96:99], v[64:67]
    v_mfma_f32_16x16x32_bf16 v[68:71], v[192:195], a[100:103], v[68:71]
    buffer_load_dwordx4 a[0:3], v4, s[4:7], s87 offen offset:2048 sc1
    v_mfma_f32_16x16x32_bf16 v[72:75], v[192:195], a[104:107], v[72:75]
    v_mfma_f32_16x16x32_bf16 v[76:79], v[192:195], a[108:111], v[76:79]
    ds_read_b128 v[192:195], v1 offset:49152
    s_waitcnt lgkmcnt(5)
    v_mfma_f32_16x16x32_bf16 v[92:95], v[196:199], a[108:111], v[92:95]
    v_mfma_f32_16x16x32_bf16 v[88:91], v[196:199], a[104:107], v[88:91]
    buffer_load_dwordx4 v10, s[4:7], s63 offen offset:1024 lds
    v_mfma_f32_16x16x32_bf16 v[84:87], v[196:199], a[100:103], v[84:87]
    v_mfma_f32_16x16x32_bf16 v[80:83], v[196:199], a[96:99], v[80:83]
    ds_read_b128 v[196:199], v1 offset:50176
    s_waitcnt lgkmcnt(5)
    v_mfma_f32_16x16x32_bf16 v[96:99], v[200:203], a[96:99], v[96:99]
    v_mfma_f32_16x16x32_bf16 v[100:103], v[200:203], a[100:103], v[100:103]
    buffer_load_dwordx4 a[4:7], v5, s[4:7], s87 offen offset:2048 sc1
    v_mfma_f32_16x16x32_bf16 v[104:107], v[200:203], a[104:107], v[104:107]
    v_mfma_f32_16x16x32_bf16 v[108:111], v[200:203], a[108:111], v[108:111]
    ds_read_b128 v[200:203], v1 offset:51200
    s_waitcnt lgkmcnt(5)
    v_mfma_f32_16x16x32_bf16 v[124:127], v[204:207], a[108:111], v[124:127]
    v_mfma_f32_16x16x32_bf16 v[120:123], v[204:207], a[104:107], v[120:123]
    buffer_load_dwordx4 a[8:11], v6, s[4:7], s87 offen offset:2048 sc1
    v_mfma_f32_16x16x32_bf16 v[116:119], v[204:207], a[100:103], v[116:119]
    v_mfma_f32_16x16x32_bf16 v[112:115], v[204:207], a[96:99], v[112:115]
    ds_read_b128 v[204:207], v1 offset:52224
    s_waitcnt lgkmcnt(5)
    v_mfma_f32_16x16x32_bf16 v[128:131], v[208:211], a[96:99], v[128:131]
    s_mov_b32 s19, 1097728
    v_mfma_f32_16x16x32_bf16 v[132:135], v[208:211], a[100:103], v[132:135]
    buffer_load_dwordx4 v[172:175], v13, s[4:7], s19 offen sc1
    v_mfma_f32_16x16x32_bf16 v[136:139], v[208:211], a[104:107], v[136:139]
    v_mfma_f32_16x16x32_bf16 v[140:143], v[208:211], a[108:111], v[140:143]
    ds_read_b128 v[208:211], v1 offset:53248
    s_waitcnt lgkmcnt(5)
    v_mfma_f32_16x16x32_bf16 v[156:159], v[212:215], a[108:111], v[156:159]
    v_mfma_f32_16x16x32_bf16 v[152:155], v[212:215], a[104:107], v[152:155]
    buffer_load_dwordx4 a[12:15], v7, s[4:7], s87 offen offset:2048 sc1
    v_mfma_f32_16x16x32_bf16 v[148:151], v[212:215], a[100:103], v[148:151]
    v_mfma_f32_16x16x32_bf16 v[144:147], v[212:215], a[96:99], v[144:147]
    ds_read_b128 v[212:215], v1 offset:54272
    s_waitcnt vmcnt(12)
    s_waitcnt lgkmcnt(5)
    v_mfma_f32_16x16x32_bf16 v[64:67], v[192:195], a[112:115], v[64:67]
    v_mfma_f32_16x16x32_bf16 v[68:71], v[192:195], a[116:119], v[68:71]
    buffer_load_dwordx4 a[16:19], v4, s[4:7], s87 offen offset:3072 sc1
    v_mfma_f32_16x16x32_bf16 v[72:75], v[192:195], a[120:123], v[72:75]
    v_mfma_f32_16x16x32_bf16 v[76:79], v[192:195], a[124:127], v[76:79]
    ds_read_b128 v[192:195], v1 offset:55296
    s_waitcnt lgkmcnt(5)
    v_mfma_f32_16x16x32_bf16 v[92:95], v[196:199], a[124:127], v[92:95]
    v_mfma_f32_16x16x32_bf16 v[88:91], v[196:199], a[120:123], v[88:91]
    buffer_load_dwordx4 v10, s[4:7], s63 offen offset:2048 lds
    v_mfma_f32_16x16x32_bf16 v[84:87], v[196:199], a[116:119], v[84:87]
    v_mfma_f32_16x16x32_bf16 v[80:83], v[196:199], a[112:115], v[80:83]
    ds_read_b128 v[196:199], v1 offset:56320
    s_waitcnt lgkmcnt(5)
    v_mfma_f32_16x16x32_bf16 v[96:99], v[200:203], a[112:115], v[96:99]
    v_mfma_f32_16x16x32_bf16 v[100:103], v[200:203], a[116:119], v[100:103]
    buffer_load_dwordx4 a[20:23], v5, s[4:7], s87 offen offset:3072 sc1
    v_mfma_f32_16x16x32_bf16 v[104:107], v[200:203], a[120:123], v[104:107]
    v_mfma_f32_16x16x32_bf16 v[108:111], v[200:203], a[124:127], v[108:111]
    ds_read_b128 v[200:203], v1 offset:57344
    s_waitcnt lgkmcnt(5)
    v_mfma_f32_16x16x32_bf16 v[124:127], v[204:207], a[124:127], v[124:127]
    v_mfma_f32_16x16x32_bf16 v[120:123], v[204:207], a[120:123], v[120:123]
    buffer_load_dwordx4 a[192:195], v6, s[4:7], s87 offen offset:3072 sc1
    v_mfma_f32_16x16x32_bf16 v[116:119], v[204:207], a[116:119], v[116:119]
    v_mfma_f32_16x16x32_bf16 v[112:115], v[204:207], a[112:115], v[112:115]
    ds_read_b128 v[204:207], v1 offset:58368
    s_waitcnt lgkmcnt(5)
    v_mfma_f32_16x16x32_bf16 v[128:131], v[208:211], a[112:115], v[128:131]
    s_mov_b32 s19, 1114112
    v_mfma_f32_16x16x32_bf16 v[132:135], v[208:211], a[116:119], v[132:135]
    buffer_load_dwordx4 v[176:179], v13, s[4:7], s19 offen sc1
    v_mfma_f32_16x16x32_bf16 v[136:139], v[208:211], a[120:123], v[136:139]
    v_mfma_f32_16x16x32_bf16 v[140:143], v[208:211], a[124:127], v[140:143]
    ds_read_b128 v[208:211], v1 offset:59392
    s_waitcnt lgkmcnt(5)
    v_mfma_f32_16x16x32_bf16 v[156:159], v[212:215], a[124:127], v[156:159]
    v_mfma_f32_16x16x32_bf16 v[152:155], v[212:215], a[120:123], v[152:155]
    buffer_load_dwordx4 a[196:199], v7, s[4:7], s87 offen offset:3072 sc1
    v_mfma_f32_16x16x32_bf16 v[148:151], v[212:215], a[116:119], v[148:151]
    v_mfma_f32_16x16x32_bf16 v[144:147], v[212:215], a[112:115], v[144:147]
    ds_read_b128 v[212:215], v1 offset:60416
    s_waitcnt vmcnt(12)
    s_waitcnt lgkmcnt(5)
    v_mfma_f32_16x16x32_bf16 v[64:67], v[192:195], a[128:131], v[64:67]
    v_mfma_f32_16x16x32_bf16 v[68:71], v[192:195], a[132:135], v[68:71]
    buffer_load_dwordx4 a[48:51], v4, s[4:7], s88 offen offset:0 sc1
    v_mfma_f32_16x16x32_bf16 v[72:75], v[192:195], a[136:139], v[72:75]
    v_mfma_f32_16x16x32_bf16 v[76:79], v[192:195], a[140:143], v[76:79]
    ds_read_b128 v[192:195], v1 offset:61440
    s_waitcnt lgkmcnt(5)
    v_mfma_f32_16x16x32_bf16 v[92:95], v[196:199], a[140:143], v[92:95]
    v_mfma_f32_16x16x32_bf16 v[88:91], v[196:199], a[136:139], v[88:91]
    buffer_load_dwordx4 v10, s[4:7], s63 offen offset:3072 lds
    v_mfma_f32_16x16x32_bf16 v[84:87], v[196:199], a[132:135], v[84:87]
    v_mfma_f32_16x16x32_bf16 v[80:83], v[196:199], a[128:131], v[80:83]
    ds_read_b128 v[196:199], v1 offset:62464
    s_waitcnt lgkmcnt(5)
    v_mfma_f32_16x16x32_bf16 v[96:99], v[200:203], a[128:131], v[96:99]
    v_mfma_f32_16x16x32_bf16 v[100:103], v[200:203], a[132:135], v[100:103]
    buffer_load_dwordx4 a[52:55], v5, s[4:7], s88 offen offset:0 sc1
    v_mfma_f32_16x16x32_bf16 v[104:107], v[200:203], a[136:139], v[104:107]
    v_mfma_f32_16x16x32_bf16 v[108:111], v[200:203], a[140:143], v[108:111]
    ds_read_b128 v[200:203], v1 offset:63488
    s_waitcnt lgkmcnt(5)
    v_mfma_f32_16x16x32_bf16 v[124:127], v[204:207], a[140:143], v[124:127]
    v_mfma_f32_16x16x32_bf16 v[120:123], v[204:207], a[136:139], v[120:123]
    buffer_load_dwordx4 a[56:59], v6, s[4:7], s88 offen offset:0 sc1
    v_mfma_f32_16x16x32_bf16 v[116:119], v[204:207], a[132:135], v[116:119]
    v_mfma_f32_16x16x32_bf16 v[112:115], v[204:207], a[128:131], v[112:115]
    ds_read_b128 v[204:207], v1 offset:64512
    s_waitcnt lgkmcnt(5)
    v_mfma_f32_16x16x32_bf16 v[128:131], v[208:211], a[128:131], v[128:131]
    s_mov_b32 s19, 1130496
    v_mfma_f32_16x16x32_bf16 v[132:135], v[208:211], a[132:135], v[132:135]
    buffer_load_dwordx4 v[180:183], v13, s[4:7], s19 offen sc1
    v_mfma_f32_16x16x32_bf16 v[136:139], v[208:211], a[136:139], v[136:139]
    v_mfma_f32_16x16x32_bf16 v[140:143], v[208:211], a[140:143], v[140:143]
    ds_read_b128 v[208:211], v2 offset:0
    s_waitcnt lgkmcnt(5)
    v_mfma_f32_16x16x32_bf16 v[156:159], v[212:215], a[140:143], v[156:159]
    v_mfma_f32_16x16x32_bf16 v[152:155], v[212:215], a[136:139], v[152:155]
    buffer_load_dwordx4 a[60:63], v7, s[4:7], s88 offen offset:0 sc1
    v_mfma_f32_16x16x32_bf16 v[148:151], v[212:215], a[132:135], v[148:151]
    v_mfma_f32_16x16x32_bf16 v[144:147], v[212:215], a[128:131], v[144:147]
    ds_read_b128 v[212:215], v2 offset:1024
    s_waitcnt vmcnt(12)
    s_waitcnt lgkmcnt(5)
    v_mfma_f32_16x16x32_bf16 v[64:67], v[192:195], a[0:3], v[64:67]
    v_mfma_f32_16x16x32_bf16 v[68:71], v[192:195], a[4:7], v[68:71]
    buffer_load_dwordx4 a[64:67], v4, s[4:7], s88 offen offset:1024 sc1
    v_mfma_f32_16x16x32_bf16 v[72:75], v[192:195], a[8:11], v[72:75]
    v_mfma_f32_16x16x32_bf16 v[76:79], v[192:195], a[12:15], v[76:79]
    ds_read_b128 v[192:195], v2 offset:2048
    s_waitcnt lgkmcnt(5)
    v_mfma_f32_16x16x32_bf16 v[92:95], v[196:199], a[12:15], v[92:95]
    s_add_u32 m0, s57, 126976
    s_add_u32 s63, s98, 8392704
    v_mfma_f32_16x16x32_bf16 v[88:91], v[196:199], a[8:11], v[88:91]
    buffer_load_dwordx4 v10, s[4:7], s63 offen offset:0 lds
    v_mfma_f32_16x16x32_bf16 v[84:87], v[196:199], a[4:7], v[84:87]
    v_mfma_f32_16x16x32_bf16 v[80:83], v[196:199], a[0:3], v[80:83]
    ds_read_b128 v[196:199], v2 offset:3072
    s_waitcnt lgkmcnt(5)
    v_mfma_f32_16x16x32_bf16 v[96:99], v[200:203], a[0:3], v[96:99]
    v_mfma_f32_16x16x32_bf16 v[100:103], v[200:203], a[4:7], v[100:103]
    buffer_load_dwordx4 a[68:71], v5, s[4:7], s88 offen offset:1024 sc1
    v_mfma_f32_16x16x32_bf16 v[104:107], v[200:203], a[8:11], v[104:107]
    v_mfma_f32_16x16x32_bf16 v[108:111], v[200:203], a[12:15], v[108:111]
    ds_read_b128 v[200:203], v2 offset:4096
    s_waitcnt lgkmcnt(5)
    v_mfma_f32_16x16x32_bf16 v[124:127], v[204:207], a[12:15], v[124:127]
    v_mfma_f32_16x16x32_bf16 v[120:123], v[204:207], a[8:11], v[120:123]
    buffer_load_dwordx4 a[72:75], v6, s[4:7], s88 offen offset:1024 sc1
    v_mfma_f32_16x16x32_bf16 v[116:119], v[204:207], a[4:7], v[116:119]
    v_mfma_f32_16x16x32_bf16 v[112:115], v[204:207], a[0:3], v[112:115]
    ds_read_b128 v[204:207], v2 offset:5120
    s_waitcnt lgkmcnt(5)
    v_mfma_f32_16x16x32_bf16 v[128:131], v[208:211], a[0:3], v[128:131]
    s_mov_b32 s19, 1146880
    v_mfma_f32_16x16x32_bf16 v[132:135], v[208:211], a[4:7], v[132:135]
    buffer_load_dwordx4 v[184:187], v13, s[4:7], s19 offen sc1
    v_mfma_f32_16x16x32_bf16 v[136:139], v[208:211], a[8:11], v[136:139]
    v_mfma_f32_16x16x32_bf16 v[140:143], v[208:211], a[12:15], v[140:143]
    ds_read_b128 v[208:211], v2 offset:6144
    s_waitcnt lgkmcnt(5)
    v_mfma_f32_16x16x32_bf16 v[156:159], v[212:215], a[12:15], v[156:159]
    v_mfma_f32_16x16x32_bf16 v[152:155], v[212:215], a[8:11], v[152:155]
    buffer_load_dwordx4 a[76:79], v7, s[4:7], s88 offen offset:1024 sc1
    v_mfma_f32_16x16x32_bf16 v[148:151], v[212:215], a[4:7], v[148:151]
    v_mfma_f32_16x16x32_bf16 v[144:147], v[212:215], a[0:3], v[144:147]
    ds_read_b128 v[212:215], v2 offset:7168
    s_waitcnt vmcnt(12)
    s_barrier
    s_waitcnt lgkmcnt(5)
    v_mfma_f32_16x16x32_bf16 v[64:67], v[192:195], a[16:19], v[64:67]
    v_mfma_f32_16x16x32_bf16 v[68:71], v[192:195], a[20:23], v[68:71]
    buffer_load_dwordx4 a[80:83], v4, s[4:7], s88 offen offset:2048 sc1
    v_mfma_f32_16x16x32_bf16 v[72:75], v[192:195], a[192:195], v[72:75]
    v_mfma_f32_16x16x32_bf16 v[76:79], v[192:195], a[196:199], v[76:79]
    ds_read_b128 v[192:195], v2 offset:8192
    s_waitcnt lgkmcnt(5)
    v_mfma_f32_16x16x32_bf16 v[92:95], v[196:199], a[196:199], v[92:95]
    v_mfma_f32_16x16x32_bf16 v[88:91], v[196:199], a[192:195], v[88:91]
    buffer_load_dwordx4 v10, s[4:7], s63 offen offset:1024 lds
    v_mfma_f32_16x16x32_bf16 v[84:87], v[196:199], a[20:23], v[84:87]
    v_mfma_f32_16x16x32_bf16 v[80:83], v[196:199], a[16:19], v[80:83]
    ds_read_b128 v[196:199], v2 offset:9216
    s_waitcnt lgkmcnt(5)
    v_mfma_f32_16x16x32_bf16 v[96:99], v[200:203], a[16:19], v[96:99]
    v_mfma_f32_16x16x32_bf16 v[100:103], v[200:203], a[20:23], v[100:103]
    buffer_load_dwordx4 a[84:87], v5, s[4:7], s88 offen offset:2048 sc1
    v_mfma_f32_16x16x32_bf16 v[104:107], v[200:203], a[192:195], v[104:107]
    v_mfma_f32_16x16x32_bf16 v[108:111], v[200:203], a[196:199], v[108:111]
    ds_read_b128 v[200:203], v2 offset:10240
    s_waitcnt lgkmcnt(5)
    v_mfma_f32_16x16x32_bf16 v[124:127], v[204:207], a[196:199], v[124:127]
    v_mfma_f32_16x16x32_bf16 v[120:123], v[204:207], a[192:195], v[120:123]
    buffer_load_dwordx4 a[88:91], v6, s[4:7], s88 offen offset:2048 sc1
    v_mfma_f32_16x16x32_bf16 v[116:119], v[204:207], a[20:23], v[116:119]
    v_mfma_f32_16x16x32_bf16 v[112:115], v[204:207], a[16:19], v[112:115]
    ds_read_b128 v[204:207], v2 offset:11264
    s_waitcnt lgkmcnt(5)
    v_mfma_f32_16x16x32_bf16 v[128:131], v[208:211], a[16:19], v[128:131]
    s_mov_b32 s19, 1163264
    v_mfma_f32_16x16x32_bf16 v[132:135], v[208:211], a[20:23], v[132:135]
    buffer_load_dwordx4 v[188:191], v13, s[4:7], s19 offen sc1
    v_mfma_f32_16x16x32_bf16 v[136:139], v[208:211], a[192:195], v[136:139]
    v_mfma_f32_16x16x32_bf16 v[140:143], v[208:211], a[196:199], v[140:143]
    ds_read_b128 v[208:211], v2 offset:12288
    s_waitcnt lgkmcnt(5)
    v_mfma_f32_16x16x32_bf16 v[156:159], v[212:215], a[196:199], v[156:159]
    v_mfma_f32_16x16x32_bf16 v[152:155], v[212:215], a[192:195], v[152:155]
    buffer_load_dwordx4 a[92:95], v7, s[4:7], s88 offen offset:2048 sc1
    v_mfma_f32_16x16x32_bf16 v[148:151], v[212:215], a[20:23], v[148:151]
    v_mfma_f32_16x16x32_bf16 v[144:147], v[212:215], a[16:19], v[144:147]
    ds_read_b128 v[212:215], v2 offset:13312
    s_waitcnt vmcnt(12)
    s_waitcnt lgkmcnt(5)
    v_mfma_f32_16x16x32_bf16 v[64:67], v[192:195], a[48:51], v[64:67]
    v_mfma_f32_16x16x32_bf16 v[68:71], v[192:195], a[52:55], v[68:71]
    buffer_load_dwordx4 a[96:99], v4, s[4:7], s88 offen offset:3072 sc1
    v_mfma_f32_16x16x32_bf16 v[72:75], v[192:195], a[56:59], v[72:75]
    v_mfma_f32_16x16x32_bf16 v[76:79], v[192:195], a[60:63], v[76:79]
    ds_read_b128 v[192:195], v2 offset:14336
    s_waitcnt lgkmcnt(5)
    v_mfma_f32_16x16x32_bf16 v[92:95], v[196:199], a[60:63], v[92:95]
    v_mfma_f32_16x16x32_bf16 v[88:91], v[196:199], a[56:59], v[88:91]
    buffer_load_dwordx4 a[100:103], v5, s[4:7], s88 offen offset:3072 sc1
    v_mfma_f32_16x16x32_bf16 v[84:87], v[196:199], a[52:55], v[84:87]
    v_mfma_f32_16x16x32_bf16 v[80:83], v[196:199], a[48:51], v[80:83]
    ds_read_b128 v[196:199], v2 offset:15360
    s_waitcnt lgkmcnt(5)
    v_mfma_f32_16x16x32_bf16 v[96:99], v[200:203], a[48:51], v[96:99]
    s_add_u32 m0, s57, 0
    s_add_u32 s63, s99, 8388608
    v_mfma_f32_16x16x32_bf16 v[100:103], v[200:203], a[52:55], v[100:103]
    buffer_load_dwordx4 v10, s[4:7], s63 offen offset:0 lds
    v_mfma_f32_16x16x32_bf16 v[104:107], v[200:203], a[56:59], v[104:107]
    v_mfma_f32_16x16x32_bf16 v[108:111], v[200:203], a[60:63], v[108:111]
    ds_read_b128 v[200:203], v2 offset:16384
    s_waitcnt lgkmcnt(5)
    v_mfma_f32_16x16x32_bf16 v[124:127], v[204:207], a[60:63], v[124:127]
    v_mfma_f32_16x16x32_bf16 v[120:123], v[204:207], a[56:59], v[120:123]
    buffer_load_dwordx4 a[104:107], v6, s[4:7], s88 offen offset:3072 sc1
    v_mfma_f32_16x16x32_bf16 v[116:119], v[204:207], a[52:55], v[116:119]
    v_mfma_f32_16x16x32_bf16 v[112:115], v[204:207], a[48:51], v[112:115]
    ds_read_b128 v[204:207], v2 offset:17408
    s_waitcnt lgkmcnt(5)
    v_mfma_f32_16x16x32_bf16 v[128:131], v[208:211], a[48:51], v[128:131]
    v_mfma_f32_16x16x32_bf16 v[132:135], v[208:211], a[52:55], v[132:135]
    buffer_load_dwordx4 a[108:111], v7, s[4:7], s88 offen offset:3072 sc1
    v_mfma_f32_16x16x32_bf16 v[136:139], v[208:211], a[56:59], v[136:139]
    v_mfma_f32_16x16x32_bf16 v[140:143], v[208:211], a[60:63], v[140:143]
    ds_read_b128 v[208:211], v2 offset:18432
    s_waitcnt lgkmcnt(5)
    v_mfma_f32_16x16x32_bf16 v[156:159], v[212:215], a[60:63], v[156:159]
    v_mfma_f32_16x16x32_bf16 v[152:155], v[212:215], a[56:59], v[152:155]
    v_mfma_f32_16x16x32_bf16 v[148:151], v[212:215], a[52:55], v[148:151]
    v_mfma_f32_16x16x32_bf16 v[144:147], v[212:215], a[48:51], v[144:147]
    ds_read_b128 v[212:215], v2 offset:19456
    s_waitcnt vmcnt(11)
    s_waitcnt lgkmcnt(5)
    v_mfma_f32_16x16x32_bf16 v[64:67], v[192:195], a[64:67], v[64:67]
    v_mfma_f32_16x16x32_bf16 v[68:71], v[192:195], a[68:71], v[68:71]
    buffer_load_dwordx4 a[112:115], v4, s[4:7], s89 offen offset:0 sc1
    v_mfma_f32_16x16x32_bf16 v[72:75], v[192:195], a[72:75], v[72:75]
    v_mfma_f32_16x16x32_bf16 v[76:79], v[192:195], a[76:79], v[76:79]
    ds_read_b128 v[192:195], v2 offset:20480
    s_waitcnt lgkmcnt(5)
    v_mfma_f32_16x16x32_bf16 v[92:95], v[196:199], a[76:79], v[92:95]
    v_mfma_f32_16x16x32_bf16 v[88:91], v[196:199], a[72:75], v[88:91]
    buffer_load_dwordx4 a[116:119], v5, s[4:7], s89 offen offset:0 sc1
    v_mfma_f32_16x16x32_bf16 v[84:87], v[196:199], a[68:71], v[84:87]
    v_mfma_f32_16x16x32_bf16 v[80:83], v[196:199], a[64:67], v[80:83]
    ds_read_b128 v[196:199], v2 offset:21504
    s_waitcnt lgkmcnt(5)
    v_mfma_f32_16x16x32_bf16 v[96:99], v[200:203], a[64:67], v[96:99]
    v_mfma_f32_16x16x32_bf16 v[100:103], v[200:203], a[68:71], v[100:103]
    buffer_load_dwordx4 v10, s[4:7], s63 offen offset:1024 lds
    v_mfma_f32_16x16x32_bf16 v[104:107], v[200:203], a[72:75], v[104:107]
    v_mfma_f32_16x16x32_bf16 v[108:111], v[200:203], a[76:79], v[108:111]
    ds_read_b128 v[200:203], v2 offset:22528
    s_waitcnt lgkmcnt(5)
    v_mfma_f32_16x16x32_bf16 v[124:127], v[204:207], a[76:79], v[124:127]
    v_mfma_f32_16x16x32_bf16 v[120:123], v[204:207], a[72:75], v[120:123]
    buffer_load_dwordx4 a[120:123], v6, s[4:7], s89 offen offset:0 sc1
    v_mfma_f32_16x16x32_bf16 v[116:119], v[204:207], a[68:71], v[116:119]
    v_mfma_f32_16x16x32_bf16 v[112:115], v[204:207], a[64:67], v[112:115]
    ds_read_b128 v[204:207], v2 offset:23552
    s_waitcnt lgkmcnt(5)
    v_mfma_f32_16x16x32_bf16 v[128:131], v[208:211], a[64:67], v[128:131]
    v_mfma_f32_16x16x32_bf16 v[132:135], v[208:211], a[68:71], v[132:135]
    buffer_load_dwordx4 a[124:127], v7, s[4:7], s89 offen offset:0 sc1
    v_mfma_f32_16x16x32_bf16 v[136:139], v[208:211], a[72:75], v[136:139]
    v_mfma_f32_16x16x32_bf16 v[140:143], v[208:211], a[76:79], v[140:143]
    ds_read_b128 v[208:211], v2 offset:24576
    s_waitcnt lgkmcnt(5)
    v_mfma_f32_16x16x32_bf16 v[156:159], v[212:215], a[76:79], v[156:159]
    v_mfma_f32_16x16x32_bf16 v[152:155], v[212:215], a[72:75], v[152:155]
    v_mfma_f32_16x16x32_bf16 v[148:151], v[212:215], a[68:71], v[148:151]
    v_mfma_f32_16x16x32_bf16 v[144:147], v[212:215], a[64:67], v[144:147]
    ds_read_b128 v[212:215], v2 offset:25600
    s_waitcnt vmcnt(10)
    s_waitcnt lgkmcnt(5)
    v_mfma_f32_16x16x32_bf16 v[64:67], v[192:195], a[80:83], v[64:67]
    v_add_f32 v160, v160, v176
    v_add_f32 v161, v161, v177
    v_mfma_f32_16x16x32_bf16 v[68:71], v[192:195], a[84:87], v[68:71]
    buffer_load_dwordx4 a[128:131], v4, s[4:7], s89 offen offset:1024 sc1
    v_mfma_f32_16x16x32_bf16 v[72:75], v[192:195], a[88:91], v[72:75]
    v_add_f32 v162, v162, v178
    v_add_f32 v163, v163, v179
    v_mfma_f32_16x16x32_bf16 v[76:79], v[192:195], a[92:95], v[76:79]
    ds_read_b128 v[192:195], v2 offset:26624
    s_waitcnt lgkmcnt(5)
    v_mfma_f32_16x16x32_bf16 v[92:95], v[196:199], a[92:95], v[92:95]
    v_add_f32 v164, v164, v180
    v_add_f32 v165, v165, v181
    v_mfma_f32_16x16x32_bf16 v[88:91], v[196:199], a[88:91], v[88:91]
    buffer_load_dwordx4 a[132:135], v5, s[4:7], s89 offen offset:1024 sc1
    v_mfma_f32_16x16x32_bf16 v[84:87], v[196:199], a[84:87], v[84:87]
    v_add_f32 v166, v166, v182
    v_add_f32 v167, v167, v183
    v_mfma_f32_16x16x32_bf16 v[80:83], v[196:199], a[80:83], v[80:83]
    ds_read_b128 v[196:199], v2 offset:27648
    s_waitcnt lgkmcnt(5)
    v_mfma_f32_16x16x32_bf16 v[96:99], v[200:203], a[80:83], v[96:99]
    v_add_f32 v168, v168, v184
    v_add_f32 v169, v169, v185
    v_mfma_f32_16x16x32_bf16 v[100:103], v[200:203], a[84:87], v[100:103]
    buffer_load_dwordx4 v10, s[4:7], s63 offen offset:2048 lds
    v_mfma_f32_16x16x32_bf16 v[104:107], v[200:203], a[88:91], v[104:107]
    v_add_f32 v170, v170, v186
    v_add_f32 v171, v171, v187
    v_mfma_f32_16x16x32_bf16 v[108:111], v[200:203], a[92:95], v[108:111]
    ds_read_b128 v[200:203], v2 offset:28672
    s_waitcnt lgkmcnt(5)
    v_mfma_f32_16x16x32_bf16 v[124:127], v[204:207], a[92:95], v[124:127]
    v_add_f32 v172, v172, v188
    v_add_f32 v173, v173, v189
    v_mfma_f32_16x16x32_bf16 v[120:123], v[204:207], a[88:91], v[120:123]
    buffer_load_dwordx4 a[136:139], v6, s[4:7], s89 offen offset:1024 sc1
    v_mfma_f32_16x16x32_bf16 v[116:119], v[204:207], a[84:87], v[116:119]
    v_add_f32 v174, v174, v190
    v_add_f32 v175, v175, v191
    v_mfma_f32_16x16x32_bf16 v[112:115], v[204:207], a[80:83], v[112:115]
    ds_read_b128 v[204:207], v2 offset:29696
    s_waitcnt lgkmcnt(5)
    v_mfma_f32_16x16x32_bf16 v[128:131], v[208:211], a[80:83], v[128:131]
    v_add_f32 v160, v160, v168
    v_add_f32 v161, v161, v169
    v_mfma_f32_16x16x32_bf16 v[132:135], v[208:211], a[84:87], v[132:135]
    buffer_load_dwordx4 a[140:143], v7, s[4:7], s89 offen offset:1024 sc1
    v_mfma_f32_16x16x32_bf16 v[136:139], v[208:211], a[88:91], v[136:139]
    v_add_f32 v162, v162, v170
    v_add_f32 v163, v163, v171
    v_mfma_f32_16x16x32_bf16 v[140:143], v[208:211], a[92:95], v[140:143]
    ds_read_b128 v[208:211], v2 offset:30720
    s_waitcnt lgkmcnt(5)
    v_mfma_f32_16x16x32_bf16 v[156:159], v[212:215], a[92:95], v[156:159]
    v_add_f32 v164, v164, v172
    v_add_f32 v165, v165, v173
    v_mfma_f32_16x16x32_bf16 v[152:155], v[212:215], a[88:91], v[152:155]
    v_add_f32 v166, v166, v174
    v_add_f32 v167, v167, v175
    v_mfma_f32_16x16x32_bf16 v[148:151], v[212:215], a[84:87], v[148:151]
    v_add_f32 v160, v160, v164
    v_add_f32 v161, v161, v165
    v_mfma_f32_16x16x32_bf16 v[144:147], v[212:215], a[80:83], v[144:147]
    ds_read_b128 v[212:215], v2 offset:31744
    s_waitcnt vmcnt(10)
    s_barrier
    s_waitcnt lgkmcnt(5)
    v_mfma_f32_16x16x32_bf16 v[64:67], v[192:195], a[96:99], v[64:67]
    v_add_f32 v162, v162, v166
    v_add_f32 v163, v163, v167
    v_mfma_f32_16x16x32_bf16 v[68:71], v[192:195], a[100:103], v[68:71]
    buffer_load_dwordx4 a[0:3], v4, s[4:7], s89 offen offset:2048 sc1
    v_mfma_f32_16x16x32_bf16 v[72:75], v[192:195], a[104:107], v[72:75]
    s_nop 0
    v_mfma_f32_16x16x32_bf16 v[76:79], v[192:195], a[108:111], v[76:79]
    ds_read_b128 v[192:195], v2 offset:32768
    s_waitcnt lgkmcnt(5)
    v_mfma_f32_16x16x32_bf16 v[92:95], v[196:199], a[108:111], v[92:95]
    v_permlane32_swap_b32 v160, v162
    v_mfma_f32_16x16x32_bf16 v[88:91], v[196:199], a[104:107], v[88:91]
    buffer_load_dwordx4 v10, s[4:7], s63 offen offset:3072 lds
    v_mfma_f32_16x16x32_bf16 v[84:87], v[196:199], a[100:103], v[84:87]
    v_permlane32_swap_b32 v161, v163
    v_mfma_f32_16x16x32_bf16 v[80:83], v[196:199], a[96:99], v[80:83]
    ds_read_b128 v[196:199], v2 offset:33792
    s_waitcnt lgkmcnt(5)
    v_mfma_f32_16x16x32_bf16 v[96:99], v[200:203], a[96:99], v[96:99]
    v_add_f32 v160, v160, v162
    v_add_f32 v161, v161, v163
    v_mfma_f32_16x16x32_bf16 v[100:103], v[200:203], a[100:103], v[100:103]
    buffer_load_dwordx4 a[4:7], v5, s[4:7], s89 offen offset:2048 sc1
    v_mfma_f32_16x16x32_bf16 v[104:107], v[200:203], a[104:107], v[104:107]
    v_mul_f32 v163, 0xba800000, v160
    v_mul_f32 v161, 0x3a800000, v161
    v_mfma_f32_16x16x32_bf16 v[108:111], v[200:203], a[108:111], v[108:111]
    ds_read_b128 v[200:203], v2 offset:34816
    s_waitcnt lgkmcnt(5)
    v_mfma_f32_16x16x32_bf16 v[124:127], v[204:207], a[108:111], v[124:127]
    v_fma_f32 v161, -v163, v163, v161
    v_max_f32 v161, 0, v161
    v_mfma_f32_16x16x32_bf16 v[120:123], v[204:207], a[104:107], v[120:123]
    buffer_load_dwordx4 a[8:11], v6, s[4:7], s89 offen offset:2048 sc1
    v_mfma_f32_16x16x32_bf16 v[116:119], v[204:207], a[100:103], v[116:119]
    v_add_f32 v161, 0x3727c5ac, v161
    v_mfma_f32_16x16x32_bf16 v[112:115], v[204:207], a[96:99], v[112:115]
    ds_read_b128 v[204:207], v2 offset:35840
    s_waitcnt lgkmcnt(5)
    v_mfma_f32_16x16x32_bf16 v[128:131], v[208:211], a[96:99], v[128:131]
    s_add_u32 m0, s57, 4096
    s_add_u32 s63, s99, 8392704
    v_mfma_f32_16x16x32_bf16 v[132:135], v[208:211], a[100:103], v[132:135]
    buffer_load_dwordx4 v10, s[4:7], s63 offen offset:0 lds
    v_mfma_f32_16x16x32_bf16 v[136:139], v[208:211], a[104:107], v[136:139]
    v_rsq_f32 v162, v161
    v_mfma_f32_16x16x32_bf16 v[140:143], v[208:211], a[108:111], v[140:143]
    ds_read_b128 v[208:211], v2 offset:36864
    s_waitcnt lgkmcnt(5)
    v_mfma_f32_16x16x32_bf16 v[156:159], v[212:215], a[108:111], v[156:159]
    ds_write2_b32 v58, v162, v163 offset0:0 offset1:64
    v_mfma_f32_16x16x32_bf16 v[152:155], v[212:215], a[104:107], v[152:155]
    buffer_load_dwordx4 a[12:15], v7, s[4:7], s89 offen offset:2048 sc1
    v_mfma_f32_16x16x32_bf16 v[148:151], v[212:215], a[100:103], v[148:151]
    ds_read2_b32 v[160:161], v59 offset0:0 offset1:64
    v_mfma_f32_16x16x32_bf16 v[144:147], v[212:215], a[96:99], v[144:147]
    ds_read_b128 v[212:215], v2 offset:37888
    s_waitcnt vmcnt(11)
    s_waitcnt lgkmcnt(7)
    v_mfma_f32_16x16x32_bf16 v[64:67], v[192:195], a[112:115], v[64:67]
    ds_read2_b32 v[162:163], v59 offset0:16 offset1:80
    v_mfma_f32_16x16x32_bf16 v[68:71], v[192:195], a[116:119], v[68:71]
    buffer_load_dwordx4 a[16:19], v4, s[4:7], s89 offen offset:3072 sc1
    v_mfma_f32_16x16x32_bf16 v[72:75], v[192:195], a[120:123], v[72:75]
    ds_read2_b32 v[164:165], v59 offset0:32 offset1:96
    v_mfma_f32_16x16x32_bf16 v[76:79], v[192:195], a[124:127], v[76:79]
    ds_read_b128 v[192:195], v2 offset:38912
    s_waitcnt lgkmcnt(9)
    v_mfma_f32_16x16x32_bf16 v[92:95], v[196:199], a[124:127], v[92:95]
    ds_read2_b32 v[166:167], v59 offset0:48 offset1:112
    v_mfma_f32_16x16x32_bf16 v[88:91], v[196:199], a[120:123], v[88:91]
    buffer_load_dwordx4 a[20:23], v5, s[4:7], s89 offen offset:3072 sc1
    v_mfma_f32_16x16x32_bf16 v[84:87], v[196:199], a[116:119], v[84:87]
    ds_read_b128 v[168:171], v56 offset:64
    v_mfma_f32_16x16x32_bf16 v[80:83], v[196:199], a[112:115], v[80:83]
    ds_read_b128 v[196:199], v2 offset:39936
    s_waitcnt lgkmcnt(11)
    v_mfma_f32_16x16x32_bf16 v[96:99], v[200:203], a[112:115], v[96:99]
    ds_read_b128 v[172:175], v56 offset:128
    v_mfma_f32_16x16x32_bf16 v[100:103], v[200:203], a[116:119], v[100:103]
    buffer_load_dwordx4 v10, s[4:7], s63 offen offset:1024 lds
    v_mfma_f32_16x16x32_bf16 v[104:107], v[200:203], a[120:123], v[104:107]
    ds_read_b128 v[176:179], v56 offset:192
    v_mfma_f32_16x16x32_bf16 v[108:111], v[200:203], a[124:127], v[108:111]
    ds_read_b128 v[200:203], v2 offset:40960
    s_waitcnt lgkmcnt(13)
    v_mfma_f32_16x16x32_bf16 v[124:127], v[204:207], a[124:127], v[124:127]
    ds_read_b128 v[180:183], v56 offset:256
    v_mfma_f32_16x16x32_bf16 v[120:123], v[204:207], a[120:123], v[120:123]
    buffer_load_dwordx4 a[192:195], v6, s[4:7], s89 offen offset:3072 sc1
    v_mfma_f32_16x16x32_bf16 v[116:119], v[204:207], a[116:119], v[116:119]
    ds_read_b128 v[184:187], v56 offset:320
    v_mfma_f32_16x16x32_bf16 v[112:115], v[204:207], a[112:115], v[112:115]
    ds_read_b128 v[204:207], v2 offset:41984
    s_waitcnt lgkmcnt(15)
    v_mfma_f32_16x16x32_bf16 v[128:131], v[208:211], a[112:115], v[128:131]
    ds_read_b128 v[188:191], v56 offset:384
    v_mfma_f32_16x16x32_bf16 v[132:135], v[208:211], a[116:119], v[132:135]
    buffer_load_dwordx4 a[196:199], v7, s[4:7], s89 offen offset:3072 sc1
    v_mfma_f32_16x16x32_bf16 v[136:139], v[208:211], a[120:123], v[136:139]
    v_mfma_f32_16x16x32_bf16 v[140:143], v[208:211], a[124:127], v[140:143]
    ds_read_b128 v[208:211], v2 offset:43008
    s_waitcnt lgkmcnt(14)
    v_mfma_f32_16x16x32_bf16 v[156:159], v[212:215], a[124:127], v[156:159]
    v_mfma_f32_16x16x32_bf16 v[152:155], v[212:215], a[120:123], v[152:155]
    v_mfma_f32_16x16x32_bf16 v[148:151], v[212:215], a[116:119], v[148:151]
    v_mfma_f32_16x16x32_bf16 v[144:147], v[212:215], a[112:115], v[144:147]
    ds_read_b128 v[212:215], v2 offset:44032
    s_waitcnt vmcnt(11)
    s_waitcnt lgkmcnt(12)
    v_mfma_f32_16x16x32_bf16 v[64:67], v[192:195], a[128:131], v[64:67]
    v_mfma_f32_16x16x32_bf16 v[68:71], v[192:195], a[132:135], v[68:71]
    buffer_load_dwordx4 a[48:51], v4, s[4:7], s90 offen offset:0 sc1
    v_mfma_f32_16x16x32_bf16 v[72:75], v[192:195], a[136:139], v[72:75]
    v_mfma_f32_16x16x32_bf16 v[76:79], v[192:195], a[140:143], v[76:79]
    ds_read_b128 v[192:195], v2 offset:45056
    s_waitcnt lgkmcnt(10)
    v_mfma_f32_16x16x32_bf16 v[92:95], v[196:199], a[140:143], v[92:95]
    v_mfma_f32_16x16x32_bf16 v[88:91], v[196:199], a[136:139], v[88:91]
    buffer_load_dwordx4 a[52:55], v5, s[4:7], s90 offen offset:0 sc1
    v_mfma_f32_16x16x32_bf16 v[84:87], v[196:199], a[132:135], v[84:87]
    v_mfma_f32_16x16x32_bf16 v[80:83], v[196:199], a[128:131], v[80:83]
    ds_read_b128 v[196:199], v2 offset:46080
    s_waitcnt lgkmcnt(8)
    v_mfma_f32_16x16x32_bf16 v[96:99], v[200:203], a[128:131], v[96:99]
    s_add_u32 m0, s57, 24576
    s_add_u32 s63, s100, 8388608
    v_mfma_f32_16x16x32_bf16 v[100:103], v[200:203], a[132:135], v[100:103]
    buffer_load_dwordx4 v10, s[4:7], s63 offen offset:0 lds
    v_mfma_f32_16x16x32_bf16 v[104:107], v[200:203], a[136:139], v[104:107]
    v_mfma_f32_16x16x32_bf16 v[108:111], v[200:203], a[140:143], v[108:111]
    ds_read_b128 v[200:203], v2 offset:47104
    s_waitcnt lgkmcnt(6)
    v_mfma_f32_16x16x32_bf16 v[124:127], v[204:207], a[140:143], v[124:127]
    v_mfma_f32_16x16x32_bf16 v[120:123], v[204:207], a[136:139], v[120:123]
    buffer_load_dwordx4 a[56:59], v6, s[4:7], s90 offen offset:0 sc1
    v_mfma_f32_16x16x32_bf16 v[116:119], v[204:207], a[132:135], v[116:119]
    v_mfma_f32_16x16x32_bf16 v[112:115], v[204:207], a[128:131], v[112:115]
    ds_read_b128 v[204:207], v2 offset:48128
    s_waitcnt lgkmcnt(5)
    v_mfma_f32_16x16x32_bf16 v[128:131], v[208:211], a[128:131], v[128:131]
    v_fmac_f32 v92, v172, v167
    v_fmac_f32 v93, v173, v167
    v_mfma_f32_16x16x32_bf16 v[132:135], v[208:211], a[132:135], v[132:135]
    buffer_load_dwordx4 a[60:63], v7, s[4:7], s90 offen offset:0 sc1
    v_mfma_f32_16x16x32_bf16 v[136:139], v[208:211], a[136:139], v[136:139]
    v_fmac_f32 v94, v174, v167
    v_fmac_f32 v95, v175, v167
    v_mfma_f32_16x16x32_bf16 v[140:143], v[208:211], a[140:143], v[140:143]
    ds_read_b128 v[208:211], v2 offset:49152
    s_waitcnt lgkmcnt(5)
    v_mfma_f32_16x16x32_bf16 v[156:159], v[212:215], a[140:143], v[156:159]
    v_fmac_f32 v108, v176, v167
    v_fmac_f32 v109, v177, v167
    v_mfma_f32_16x16x32_bf16 v[152:155], v[212:215], a[136:139], v[152:155]
    v_fmac_f32 v110, v178, v167
    v_fmac_f32 v111, v179, v167
    v_mfma_f32_16x16x32_bf16 v[148:151], v[212:215], a[132:135], v[148:151]
    v_fmac_f32 v104, v176, v165
    v_fmac_f32 v105, v177, v165
    v_mfma_f32_16x16x32_bf16 v[144:147], v[212:215], a[128:131], v[144:147]
    ds_read_b128 v[212:215], v2 offset:50176
    s_waitcnt vmcnt(10)
    s_waitcnt lgkmcnt(5)
    v_mfma_f32_16x16x32_bf16 v[64:67], v[192:195], a[0:3], v[64:67]
    v_fmac_f32 v124, v180, v167
    v_fmac_f32 v125, v181, v167
    v_mfma_f32_16x16x32_bf16 v[68:71], v[192:195], a[4:7], v[68:71]
    buffer_load_dwordx4 a[64:67], v4, s[4:7], s90 offen offset:1024 sc1
    v_mfma_f32_16x16x32_bf16 v[72:75], v[192:195], a[8:11], v[72:75]
    v_fmac_f32 v126, v182, v167
    v_fmac_f32 v127, v183, v167
    v_mfma_f32_16x16x32_bf16 v[76:79], v[192:195], a[12:15], v[76:79]
    ds_read_b128 v[192:195], v2 offset:51200
    s_waitcnt lgkmcnt(5)
    v_mfma_f32_16x16x32_bf16 v[92:95], v[196:199], a[12:15], v[92:95]
    v_fmac_f32 v140, v184, v167
    v_fmac_f32 v141, v185, v167
    v_mfma_f32_16x16x32_bf16 v[88:91], v[196:199], a[8:11], v[88:91]
    buffer_load_dwordx4 a[68:71], v5, s[4:7], s90 offen offset:1024 sc1
    v_mfma_f32_16x16x32_bf16 v[84:87], v[196:199], a[4:7], v[84:87]
    v_fmac_f32 v142, v186, v167
    v_fmac_f32 v143, v187, v167
    v_mfma_f32_16x16x32_bf16 v[80:83], v[196:199], a[0:3], v[80:83]
    ds_read_b128 v[196:199], v2 offset:52224
    s_waitcnt lgkmcnt(5)
    v_mfma_f32_16x16x32_bf16 v[96:99], v[200:203], a[0:3], v[96:99]
    v_fmac_f32 v156, v188, v167
    v_fmac_f32 v157, v189, v167
    v_mfma_f32_16x16x32_bf16 v[100:103], v[200:203], a[4:7], v[100:103]
    buffer_load_dwordx4 v10, s[4:7], s63 offen offset:1024 lds
    v_mfma_f32_16x16x32_bf16 v[104:107], v[200:203], a[8:11], v[104:107]
    v_fmac_f32 v158, v190, v167
    v_fmac_f32 v159, v191, v167
    v_mfma_f32_16x16x32_bf16 v[108:111], v[200:203], a[12:15], v[108:111]
    ds_read_b128 v[200:203], v2 offset:53248
    s_waitcnt lgkmcnt(5)
    v_mfma_f32_16x16x32_bf16 v[124:127], v[204:207], a[12:15], v[124:127]
    v_fmac_f32 v76, v168, v167
    v_fmac_f32 v77, v169, v167
    v_mfma_f32_16x16x32_bf16 v[120:123], v[204:207], a[8:11], v[120:123]
    buffer_load_dwordx4 a[72:75], v6, s[4:7], s90 offen offset:1024 sc1
    v_mfma_f32_16x16x32_bf16 v[116:119], v[204:207], a[4:7], v[116:119]
    v_fmac_f32 v78, v170, v167
    v_fmac_f32 v79, v171, v167
    v_mfma_f32_16x16x32_bf16 v[112:115], v[204:207], a[0:3], v[112:115]
    ds_read_b128 v[204:207], v2 offset:54272
    s_waitcnt lgkmcnt(5)
    v_mfma_f32_16x16x32_bf16 v[128:131], v[208:211], a[0:3], v[128:131]
    v_fmac_f32 v88, v172, v165
    v_fmac_f32 v89, v173, v165
    v_mfma_f32_16x16x32_bf16 v[132:135], v[208:211], a[4:7], v[132:135]
    buffer_load_dwordx4 a[76:79], v7, s[4:7], s90 offen offset:1024 sc1
    v_mfma_f32_16x16x32_bf16 v[136:139], v[208:211], a[8:11], v[136:139]
    v_fmac_f32 v90, v174, v165
    v_fmac_f32 v91, v175, v165
    v_mfma_f32_16x16x32_bf16 v[140:143], v[208:211], a[12:15], v[140:143]
    ds_read_b128 v[208:211], v2 offset:55296
    s_waitcnt lgkmcnt(5)
    v_mfma_f32_16x16x32_bf16 v[156:159], v[212:215], a[12:15], v[156:159]
    v_fmac_f32 v106, v178, v165
    v_fmac_f32 v107, v179, v165
    v_mfma_f32_16x16x32_bf16 v[152:155], v[212:215], a[8:11], v[152:155]
    v_fmac_f32 v100, v176, v163
    v_fmac_f32 v101, v177, v163
    v_mfma_f32_16x16x32_bf16 v[148:151], v[212:215], a[4:7], v[148:151]
    v_fmac_f32 v102, v178, v163
    v_fmac_f32 v103, v179, v163
    v_mfma_f32_16x16x32_bf16 v[144:147], v[212:215], a[0:3], v[144:147]
    ds_read_b128 v[212:215], v2 offset:56320
    s_waitcnt vmcnt(10)
    s_barrier
    s_waitcnt lgkmcnt(5)
    v_mfma_f32_16x16x32_bf16 v[64:67], v[192:195], a[16:19], v[64:67]
    v_fmac_f32 v120, v180, v165
    v_fmac_f32 v121, v181, v165
    v_mfma_f32_16x16x32_bf16 v[68:71], v[192:195], a[20:23], v[68:71]
    buffer_load_dwordx4 a[80:83], v4, s[4:7], s90 offen offset:2048 sc1
    v_mfma_f32_16x16x32_bf16 v[72:75], v[192:195], a[192:195], v[72:75]
    v_fmac_f32 v122, v182, v165
    v_fmac_f32 v123, v183, v165
    v_mfma_f32_16x16x32_bf16 v[76:79], v[192:195], a[196:199], v[76:79]
    ds_read_b128 v[192:195], v2 offset:57344
    s_waitcnt lgkmcnt(5)
    v_mfma_f32_16x16x32_bf16 v[92:95], v[196:199], a[196:199], v[92:95]
    v_fmac_f32 v136, v184, v165
    v_fmac_f32 v137, v185, v165
    v_mfma_f32_16x16x32_bf16 v[88:91], v[196:199], a[192:195], v[88:91]
    buffer_load_dwordx4 a[84:87], v5, s[4:7], s90 offen offset:2048 sc1
    v_mfma_f32_16x16x32_bf16 v[84:87], v[196:199], a[20:23], v[84:87]
    v_fmac_f32 v138, v186, v165
    v_fmac_f32 v139, v187, v165
    v_mfma_f32_16x16x32_bf16 v[80:83], v[196:199], a[16:19], v[80:83]
    ds_read_b128 v[196:199], v2 offset:58368
    s_waitcnt lgkmcnt(5)
    v_mfma_f32_16x16x32_bf16 v[96:99], v[200:203], a[16:19], v[96:99]
    v_fmac_f32 v152, v188, v165
    v_fmac_f32 v153, v189, v165
    v_mfma_f32_16x16x32_bf16 v[100:103], v[200:203], a[20:23], v[100:103]
    buffer_load_dwordx4 v10, s[4:7], s63 offen offset:2048 lds
    v_mfma_f32_16x16x32_bf16 v[104:107], v[200:203], a[192:195], v[104:107]
    v_fmac_f32 v154, v190, v165
    v_fmac_f32 v155, v191, v165
    v_mfma_f32_16x16x32_bf16 v[108:111], v[200:203], a[196:199], v[108:111]
    ds_read_b128 v[200:203], v2 offset:59392
    s_waitcnt lgkmcnt(5)
    v_mfma_f32_16x16x32_bf16 v[124:127], v[204:207], a[196:199], v[124:127]
    v_fmac_f32 v72, v168, v165
    v_fmac_f32 v73, v169, v165
    v_mfma_f32_16x16x32_bf16 v[120:123], v[204:207], a[192:195], v[120:123]
    buffer_load_dwordx4 a[88:91], v6, s[4:7], s90 offen offset:2048 sc1
    v_mfma_f32_16x16x32_bf16 v[116:119], v[204:207], a[20:23], v[116:119]
    v_fmac_f32 v74, v170, v165
    v_fmac_f32 v75, v171, v165
    v_mfma_f32_16x16x32_bf16 v[112:115], v[204:207], a[16:19], v[112:115]
    ds_read_b128 v[204:207], v2 offset:60416
    s_waitcnt lgkmcnt(5)
    v_mfma_f32_16x16x32_bf16 v[128:131], v[208:211], a[16:19], v[128:131]
    v_fmac_f32 v84, v172, v163
    v_fmac_f32 v85, v173, v163
    v_mfma_f32_16x16x32_bf16 v[132:135], v[208:211], a[20:23], v[132:135]
    buffer_load_dwordx4 a[92:95], v7, s[4:7], s90 offen offset:2048 sc1
    v_mfma_f32_16x16x32_bf16 v[136:139], v[208:211], a[192:195], v[136:139]
    v_fmac_f32 v86, v174, v163
    v_fmac_f32 v87, v175, v163
    v_mfma_f32_16x16x32_bf16 v[140:143], v[208:211], a[196:199], v[140:143]
    ds_read_b128 v[208:211], v2 offset:61440
    s_waitcnt lgkmcnt(5)
    v_mfma_f32_16x16x32_bf16 v[156:159], v[212:215], a[196:199], v[156:159]
    v_fmac_f32 v96, v176, v161
    v_fmac_f32 v97, v177, v161
    v_mfma_f32_16x16x32_bf16 v[152:155], v[212:215], a[192:195], v[152:155]
    v_fmac_f32 v98, v178, v161
    v_fmac_f32 v99, v179, v161
    v_mfma_f32_16x16x32_bf16 v[148:151], v[212:215], a[20:23], v[148:151]
    v_mul_f32 v220, 0x3fb8aa3b, v160
    v_mul_f32 v221, 0x3fb8aa3b, v162
    v_mfma_f32_16x16x32_bf16 v[144:147], v[212:215], a[16:19], v[144:147]
    ds_read_b128 v[212:215], v2 offset:62464
    s_waitcnt vmcnt(10)
    s_waitcnt lgkmcnt(5)
    v_mfma_f32_16x16x32_bf16 v[64:67], v[192:195], a[48:51], v[64:67]
    v_fmac_f32 v116, v180, v163
    v_fmac_f32 v117, v181, v163
    v_mfma_f32_16x16x32_bf16 v[68:71], v[192:195], a[52:55], v[68:71]
    buffer_load_dwordx4 a[96:99], v4, s[4:7], s90 offen offset:3072 sc1
    v_mfma_f32_16x16x32_bf16 v[72:75], v[192:195], a[56:59], v[72:75]
    v_fmac_f32 v118, v182, v163
    v_fmac_f32 v119, v183, v163
    v_mfma_f32_16x16x32_bf16 v[76:79], v[192:195], a[60:63], v[76:79]
    ds_read_b128 v[192:195], v2 offset:63488
    s_waitcnt lgkmcnt(5)
    v_mfma_f32_16x16x32_bf16 v[92:95], v[196:199], a[60:63], v[92:95]
    v_fmac_f32 v132, v184, v163
    v_fmac_f32 v133, v185, v163
    v_mfma_f32_16x16x32_bf16 v[88:91], v[196:199], a[56:59], v[88:91]
    buffer_load_dwordx4 a[100:103], v5, s[4:7], s90 offen offset:3072 sc1
    v_mfma_f32_16x16x32_bf16 v[84:87], v[196:199], a[52:55], v[84:87]
    v_fmac_f32 v134, v186, v163
    v_fmac_f32 v135, v187, v163
    v_mfma_f32_16x16x32_bf16 v[80:83], v[196:199], a[48:51], v[80:83]
    ds_read_b128 v[196:199], v2 offset:64512
    s_waitcnt lgkmcnt(5)
    v_mfma_f32_16x16x32_bf16 v[96:99], v[200:203], a[48:51], v[96:99]
    v_fmac_f32 v148, v188, v163
    v_fmac_f32 v149, v189, v163
    v_mfma_f32_16x16x32_bf16 v[100:103], v[200:203], a[52:55], v[100:103]
    buffer_load_dwordx4 v10, s[4:7], s63 offen offset:3072 lds
    v_mfma_f32_16x16x32_bf16 v[104:107], v[200:203], a[56:59], v[104:107]
    v_fmac_f32 v150, v190, v163
    v_fmac_f32 v151, v191, v163
    v_mfma_f32_16x16x32_bf16 v[108:111], v[200:203], a[60:63], v[108:111]
    ds_read_b128 v[200:203], v3 offset:0
    s_waitcnt lgkmcnt(5)
    v_mfma_f32_16x16x32_bf16 v[124:127], v[204:207], a[60:63], v[124:127]
    v_fmac_f32 v68, v168, v163
    v_fmac_f32 v69, v169, v163
    v_mfma_f32_16x16x32_bf16 v[120:123], v[204:207], a[56:59], v[120:123]
    buffer_load_dwordx4 a[104:107], v6, s[4:7], s90 offen offset:3072 sc1
    v_mfma_f32_16x16x32_bf16 v[116:119], v[204:207], a[52:55], v[116:119]
    v_fmac_f32 v70, v170, v163
    v_fmac_f32 v71, v171, v163
    v_mfma_f32_16x16x32_bf16 v[112:115], v[204:207], a[48:51], v[112:115]
    ds_read_b128 v[204:207], v3 offset:1024
    s_waitcnt lgkmcnt(5)
    v_mfma_f32_16x16x32_bf16 v[128:131], v[208:211], a[48:51], v[128:131]
    v_fmac_f32 v80, v172, v161
    v_fmac_f32 v81, v173, v161
    v_mfma_f32_16x16x32_bf16 v[132:135], v[208:211], a[52:55], v[132:135]
    buffer_load_dwordx4 a[108:111], v7, s[4:7], s90 offen offset:3072 sc1
    v_mfma_f32_16x16x32_bf16 v[136:139], v[208:211], a[56:59], v[136:139]
    v_fmac_f32 v82, v174, v161
    v_fmac_f32 v83, v175, v161
    v_mfma_f32_16x16x32_bf16 v[140:143], v[208:211], a[60:63], v[140:143]
    ds_read_b128 v[208:211], v3 offset:2048
    s_waitcnt lgkmcnt(5)
    v_mfma_f32_16x16x32_bf16 v[156:159], v[212:215], a[60:63], v[156:159]
    v_mul_f32 v222, 0x3fb8aa3b, v164
    v_mul_f32 v223, 0x3fb8aa3b, v166
    v_mfma_f32_16x16x32_bf16 v[152:155], v[212:215], a[56:59], v[152:155]
    v_mfma_f32_16x16x32_bf16 v[148:151], v[212:215], a[52:55], v[148:151]
    v_mfma_f32_16x16x32_bf16 v[144:147], v[212:215], a[48:51], v[144:147]
    ds_read_b128 v[212:215], v3 offset:3072
    s_waitcnt vmcnt(10)
    s_waitcnt lgkmcnt(5)
    v_mfma_f32_16x16x32_bf16 v[64:67], v[192:195], a[64:67], v[64:67]
    v_fmac_f32 v112, v180, v161
    v_fmac_f32 v113, v181, v161
    v_mfma_f32_16x16x32_bf16 v[68:71], v[192:195], a[68:71], v[68:71]
    buffer_load_dwordx4 a[112:115], v4, s[4:7], s91 offen offset:0 sc1
    v_mfma_f32_16x16x32_bf16 v[72:75], v[192:195], a[72:75], v[72:75]
    v_fmac_f32 v114, v182, v161
    v_fmac_f32 v115, v183, v161
    v_mfma_f32_16x16x32_bf16 v[76:79], v[192:195], a[76:79], v[76:79]
    ds_read_b128 v[192:195], v3 offset:4096
    s_waitcnt lgkmcnt(5)
    v_mfma_f32_16x16x32_bf16 v[92:95], v[196:199], a[76:79], v[92:95]
    v_fmac_f32 v128, v184, v161
    v_fmac_f32 v129, v185, v161
    v_mfma_f32_16x16x32_bf16 v[88:91], v[196:199], a[72:75], v[88:91]
    buffer_load_dwordx4 a[116:119], v5, s[4:7], s91 offen offset:0 sc1
    v_mfma_f32_16x16x32_bf16 v[84:87], v[196:199], a[68:71], v[84:87]
    v_fmac_f32 v130, v186, v161
    v_fmac_f32 v131, v187, v161
    v_mfma_f32_16x16x32_bf16 v[80:83], v[196:199], a[64:67], v[80:83]
    ds_read_b128 v[196:199], v3 offset:5120
    s_waitcnt lgkmcnt(5)
    v_mfma_f32_16x16x32_bf16 v[96:99], v[200:203], a[64:67], v[96:99]
    s_add_u32 m0, s57, 28672
    s_add_u32 s63, s100, 8392704
    v_mfma_f32_16x16x32_bf16 v[100:103], v[200:203], a[68:71], v[100:103]
    buffer_load_dwordx4 v10, s[4:7], s63 offen offset:0 lds
    v_mfma_f32_16x16x32_bf16 v[104:107], v[200:203], a[72:75], v[104:107]
    v_fmac_f32 v144, v188, v161
    v_fmac_f32 v145, v189, v161
    v_mfma_f32_16x16x32_bf16 v[108:111], v[200:203], a[76:79], v[108:111]
    ds_read_b128 v[200:203], v3 offset:6144
    s_waitcnt lgkmcnt(5)
    v_mfma_f32_16x16x32_bf16 v[124:127], v[204:207], a[76:79], v[124:127]
    v_fmac_f32 v64, v168, v161
    v_fmac_f32 v65, v169, v161
    v_mfma_f32_16x16x32_bf16 v[120:123], v[204:207], a[72:75], v[120:123]
    buffer_load_dwordx4 a[120:123], v6, s[4:7], s91 offen offset:0 sc1
    v_mfma_f32_16x16x32_bf16 v[116:119], v[204:207], a[68:71], v[116:119]
    v_fmac_f32 v66, v170, v161
    v_fmac_f32 v67, v171, v161
    v_mfma_f32_16x16x32_bf16 v[112:115], v[204:207], a[64:67], v[112:115]
    ds_read_b128 v[204:207], v3 offset:7168
    s_waitcnt lgkmcnt(5)
    v_mfma_f32_16x16x32_bf16 v[128:131], v[208:211], a[64:67], v[128:131]
    v_mfma_f32_16x16x32_bf16 v[132:135], v[208:211], a[68:71], v[132:135]
    buffer_load_dwordx4 a[124:127], v7, s[4:7], s91 offen offset:0 sc1
    v_mfma_f32_16x16x32_bf16 v[136:139], v[208:211], a[72:75], v[136:139]
    v_mfma_f32_16x16x32_bf16 v[140:143], v[208:211], a[76:79], v[140:143]
    ds_read_b128 v[208:211], v3 offset:8192
    s_waitcnt lgkmcnt(5)
    v_mfma_f32_16x16x32_bf16 v[156:159], v[212:215], a[76:79], v[156:159]
    v_mfma_f32_16x16x32_bf16 v[152:155], v[212:215], a[72:75], v[152:155]
    v_mfma_f32_16x16x32_bf16 v[148:151], v[212:215], a[68:71], v[148:151]
    v_mfma_f32_16x16x32_bf16 v[144:147], v[212:215], a[64:67], v[144:147]
    ds_read_b128 v[212:215], v3 offset:9216
    s_waitcnt vmcnt(10)
    s_waitcnt lgkmcnt(5)
    v_mfma_f32_16x16x32_bf16 v[64:67], v[192:195], a[80:83], v[64:67]
    v_mfma_f32_16x16x32_bf16 v[68:71], v[192:195], a[84:87], v[68:71]
    buffer_load_dwordx4 a[128:131], v4, s[4:7], s91 offen offset:1024 sc1
    v_mfma_f32_16x16x32_bf16 v[72:75], v[192:195], a[88:91], v[72:75]
    v_mfma_f32_16x16x32_bf16 v[76:79], v[192:195], a[92:95], v[76:79]
    ds_read_b128 v[192:195], v3 offset:10240
    s_waitcnt lgkmcnt(5)
    v_mfma_f32_16x16x32_bf16 v[92:95], v[196:199], a[92:95], v[92:95]
    v_mfma_f32_16x16x32_bf16 v[88:91], v[196:199], a[88:91], v[88:91]
    buffer_load_dwordx4 a[132:135], v5, s[4:7], s91 offen offset:1024 sc1
    v_mfma_f32_16x16x32_bf16 v[84:87], v[196:199], a[84:87], v[84:87]
    v_mfma_f32_16x16x32_bf16 v[80:83], v[196:199], a[80:83], v[80:83]
    ds_read_b128 v[196:199], v3 offset:11264
    s_waitcnt lgkmcnt(5)
    v_mfma_f32_16x16x32_bf16 v[96:99], v[200:203], a[80:83], v[96:99]
    v_fmac_f32 v146, v190, v161
    v_fmac_f32 v147, v191, v161
    v_mfma_f32_16x16x32_bf16 v[100:103], v[200:203], a[84:87], v[100:103]
    buffer_load_dwordx4 v10, s[4:7], s63 offen offset:1024 lds
    v_mfma_f32_16x16x32_bf16 v[104:107], v[200:203], a[88:91], v[104:107]
    v_mfma_f32_16x16x32_bf16 v[108:111], v[200:203], a[92:95], v[108:111]
    ds_read_b128 v[200:203], v3 offset:12288
    s_waitcnt lgkmcnt(5)
    v_mfma_f32_16x16x32_bf16 v[124:127], v[204:207], a[92:95], v[124:127]
    v_mfma_f32_16x16x32_bf16 v[120:123], v[204:207], a[88:91], v[120:123]
    buffer_load_dwordx4 a[136:139], v6, s[4:7], s91 offen offset:1024 sc1
    v_mfma_f32_16x16x32_bf16 v[116:119], v[204:207], a[84:87], v[116:119]
    v_mfma_f32_16x16x32_bf16 v[112:115], v[204:207], a[80:83], v[112:115]
    ds_read_b128 v[204:207], v3 offset:13312
    s_waitcnt lgkmcnt(5)
    v_mfma_f32_16x16x32_bf16 v[128:131], v[208:211], a[80:83], v[128:131]
    v_mfma_f32_16x16x32_bf16 v[132:135], v[208:211], a[84:87], v[132:135]
    buffer_load_dwordx4 a[140:143], v7, s[4:7], s91 offen offset:1024 sc1
    v_mfma_f32_16x16x32_bf16 v[136:139], v[208:211], a[88:91], v[136:139]
    v_mfma_f32_16x16x32_bf16 v[140:143], v[208:211], a[92:95], v[140:143]
    ds_read_b128 v[208:211], v3 offset:14336
    s_waitcnt lgkmcnt(5)
    v_mfma_f32_16x16x32_bf16 v[156:159], v[212:215], a[92:95], v[156:159]
    v_mfma_f32_16x16x32_bf16 v[152:155], v[212:215], a[88:91], v[152:155]
    v_mfma_f32_16x16x32_bf16 v[148:151], v[212:215], a[84:87], v[148:151]
    v_mfma_f32_16x16x32_bf16 v[144:147], v[212:215], a[80:83], v[144:147]
    ds_read_b128 v[212:215], v3 offset:15360
    s_waitcnt vmcnt(10)
    s_barrier
    s_waitcnt lgkmcnt(5)
    v_mfma_f32_16x16x32_bf16 v[64:67], v[192:195], a[96:99], v[64:67]
    v_mfma_f32_16x16x32_bf16 v[68:71], v[192:195], a[100:103], v[68:71]
    buffer_load_dwordx4 a[0:3], v4, s[4:7], s91 offen offset:2048 sc1
    v_mfma_f32_16x16x32_bf16 v[72:75], v[192:195], a[104:107], v[72:75]
    v_mfma_f32_16x16x32_bf16 v[76:79], v[192:195], a[108:111], v[76:79]
    ds_read_b128 v[192:195], v1 offset:0
    s_waitcnt lgkmcnt(5)
    v_mfma_f32_16x16x32_bf16 v[92:95], v[196:199], a[108:111], v[92:95]
    v_mfma_f32_16x16x32_bf16 v[88:91], v[196:199], a[104:107], v[88:91]
    buffer_load_dwordx4 a[4:7], v5, s[4:7], s91 offen offset:2048 sc1
    v_mfma_f32_16x16x32_bf16 v[84:87], v[196:199], a[100:103], v[84:87]
    v_mfma_f32_16x16x32_bf16 v[80:83], v[196:199], a[96:99], v[80:83]
    ds_read_b128 v[196:199], v1 offset:1024
    s_waitcnt lgkmcnt(5)
    v_mfma_f32_16x16x32_bf16 v[96:99], v[200:203], a[96:99], v[96:99]
    s_add_u32 m0, s57, 49152
    s_add_u32 s63, s101, 8388608
    v_mfma_f32_16x16x32_bf16 v[100:103], v[200:203], a[100:103], v[100:103]
    buffer_load_dwordx4 v10, s[4:7], s63 offen offset:0 lds
    v_mfma_f32_16x16x32_bf16 v[104:107], v[200:203], a[104:107], v[104:107]
    v_mfma_f32_16x16x32_bf16 v[108:111], v[200:203], a[108:111], v[108:111]
    ds_read_b128 v[200:203], v1 offset:2048
    s_waitcnt lgkmcnt(5)
    v_mfma_f32_16x16x32_bf16 v[124:127], v[204:207], a[108:111], v[124:127]
    v_mfma_f32_16x16x32_bf16 v[120:123], v[204:207], a[104:107], v[120:123]
    buffer_load_dwordx4 a[8:11], v6, s[4:7], s91 offen offset:2048 sc1
    v_mfma_f32_16x16x32_bf16 v[116:119], v[204:207], a[100:103], v[116:119]
    v_mfma_f32_16x16x32_bf16 v[112:115], v[204:207], a[96:99], v[112:115]
    ds_read_b128 v[204:207], v1 offset:3072
    s_waitcnt lgkmcnt(5)
    v_mfma_f32_16x16x32_bf16 v[128:131], v[208:211], a[96:99], v[128:131]
    v_mfma_f32_16x16x32_bf16 v[132:135], v[208:211], a[100:103], v[132:135]
    buffer_load_dwordx4 a[12:15], v7, s[4:7], s91 offen offset:2048 sc1
    v_mfma_f32_16x16x32_bf16 v[136:139], v[208:211], a[104:107], v[136:139]
    v_mfma_f32_16x16x32_bf16 v[140:143], v[208:211], a[108:111], v[140:143]
    ds_read_b128 v[208:211], v1 offset:4096
    s_waitcnt lgkmcnt(5)
    v_mfma_f32_16x16x32_bf16 v[156:159], v[212:215], a[108:111], v[156:159]
    v_mfma_f32_16x16x32_bf16 v[152:155], v[212:215], a[104:107], v[152:155]
    v_mfma_f32_16x16x32_bf16 v[148:151], v[212:215], a[100:103], v[148:151]
    v_mfma_f32_16x16x32_bf16 v[144:147], v[212:215], a[96:99], v[144:147]
    ds_read_b128 v[212:215], v1 offset:5120
    s_waitcnt vmcnt(10)
    s_waitcnt lgkmcnt(5)
    v_mfma_f32_16x16x32_bf16 v[64:67], v[192:195], a[112:115], v[64:67]
    v_mfma_f32_16x16x32_bf16 v[68:71], v[192:195], a[116:119], v[68:71]
    buffer_load_dwordx4 a[16:19], v4, s[4:7], s91 offen offset:3072 sc1
    v_mfma_f32_16x16x32_bf16 v[72:75], v[192:195], a[120:123], v[72:75]
    v_mfma_f32_16x16x32_bf16 v[76:79], v[192:195], a[124:127], v[76:79]
    ds_read_b128 v[192:195], v1 offset:6144
    s_waitcnt lgkmcnt(5)
    v_mfma_f32_16x16x32_bf16 v[92:95], v[196:199], a[124:127], v[92:95]
    v_mfma_f32_16x16x32_bf16 v[88:91], v[196:199], a[120:123], v[88:91]
    buffer_load_dwordx4 a[20:23], v5, s[4:7], s91 offen offset:3072 sc1
    v_mfma_f32_16x16x32_bf16 v[84:87], v[196:199], a[116:119], v[84:87]
    v_mfma_f32_16x16x32_bf16 v[80:83], v[196:199], a[112:115], v[80:83]
    ds_read_b128 v[196:199], v1 offset:7168
    s_waitcnt lgkmcnt(5)
    v_mfma_f32_16x16x32_bf16 v[96:99], v[200:203], a[112:115], v[96:99]
    v_mfma_f32_16x16x32_bf16 v[100:103], v[200:203], a[116:119], v[100:103]
    buffer_load_dwordx4 v10, s[4:7], s63 offen offset:1024 lds
    v_mfma_f32_16x16x32_bf16 v[104:107], v[200:203], a[120:123], v[104:107]
    v_mfma_f32_16x16x32_bf16 v[108:111], v[200:203], a[124:127], v[108:111]
    ds_read_b128 v[200:203], v1 offset:8192
    s_waitcnt lgkmcnt(5)
    v_mfma_f32_16x16x32_bf16 v[124:127], v[204:207], a[124:127], v[124:127]
    v_mfma_f32_16x16x32_bf16 v[120:123], v[204:207], a[120:123], v[120:123]
    buffer_load_dwordx4 a[192:195], v6, s[4:7], s91 offen offset:3072 sc1
    v_mfma_f32_16x16x32_bf16 v[116:119], v[204:207], a[116:119], v[116:119]
    v_mfma_f32_16x16x32_bf16 v[112:115], v[204:207], a[112:115], v[112:115]
    ds_read_b128 v[204:207], v1 offset:9216
    s_waitcnt lgkmcnt(5)
    v_mfma_f32_16x16x32_bf16 v[128:131], v[208:211], a[112:115], v[128:131]
    v_mfma_f32_16x16x32_bf16 v[132:135], v[208:211], a[116:119], v[132:135]
    buffer_load_dwordx4 a[196:199], v7, s[4:7], s91 offen offset:3072 sc1
    v_mfma_f32_16x16x32_bf16 v[136:139], v[208:211], a[120:123], v[136:139]
    v_mfma_f32_16x16x32_bf16 v[140:143], v[208:211], a[124:127], v[140:143]
    ds_read_b128 v[208:211], v1 offset:10240
    s_waitcnt lgkmcnt(5)
    v_mfma_f32_16x16x32_bf16 v[156:159], v[212:215], a[124:127], v[156:159]
    v_mfma_f32_16x16x32_bf16 v[152:155], v[212:215], a[120:123], v[152:155]
    v_mfma_f32_16x16x32_bf16 v[148:151], v[212:215], a[116:119], v[148:151]
    v_mfma_f32_16x16x32_bf16 v[144:147], v[212:215], a[112:115], v[144:147]
    ds_read_b128 v[212:215], v1 offset:11264
    s_waitcnt vmcnt(10)
    s_waitcnt lgkmcnt(5)
    v_mfma_f32_16x16x32_bf16 v[64:67], v[192:195], a[128:131], v[64:67]
    v_mfma_f32_16x16x32_bf16 v[68:71], v[192:195], a[132:135], v[68:71]
    buffer_load_dwordx4 a[48:51], v4, s[4:7], s92 offen offset:0 sc1
    v_mfma_f32_16x16x32_bf16 v[72:75], v[192:195], a[136:139], v[72:75]
    v_mfma_f32_16x16x32_bf16 v[76:79], v[192:195], a[140:143], v[76:79]
    ds_read_b128 v[192:195], v1 offset:12288
    s_waitcnt lgkmcnt(5)
    v_mfma_f32_16x16x32_bf16 v[92:95], v[196:199], a[140:143], v[92:95]
    v_mfma_f32_16x16x32_bf16 v[88:91], v[196:199], a[136:139], v[88:91]
    buffer_load_dwordx4 v10, s[4:7], s63 offen offset:2048 lds
    v_mfma_f32_16x16x32_bf16 v[84:87], v[196:199], a[132:135], v[84:87]
    v_mfma_f32_16x16x32_bf16 v[80:83], v[196:199], a[128:131], v[80:83]
    ds_read_b128 v[196:199], v1 offset:13312
    s_waitcnt lgkmcnt(5)
    v_mfma_f32_16x16x32_bf16 v[96:99], v[200:203], a[128:131], v[96:99]
    v_mfma_f32_16x16x32_bf16 v[100:103], v[200:203], a[132:135], v[100:103]
    buffer_load_dwordx4 a[52:55], v5, s[4:7], s92 offen offset:0 sc1
    v_mfma_f32_16x16x32_bf16 v[104:107], v[200:203], a[136:139], v[104:107]
    v_mfma_f32_16x16x32_bf16 v[108:111], v[200:203], a[140:143], v[108:111]
    ds_read_b128 v[200:203], v1 offset:14336
    s_waitcnt lgkmcnt(5)
    v_mfma_f32_16x16x32_bf16 v[124:127], v[204:207], a[140:143], v[124:127]
    v_mfma_f32_16x16x32_bf16 v[120:123], v[204:207], a[136:139], v[120:123]
    buffer_load_dwordx4 a[56:59], v6, s[4:7], s92 offen offset:0 sc1
    v_mfma_f32_16x16x32_bf16 v[116:119], v[204:207], a[132:135], v[116:119]
    v_mfma_f32_16x16x32_bf16 v[112:115], v[204:207], a[128:131], v[112:115]
    ds_read_b128 v[204:207], v1 offset:15360
    s_waitcnt lgkmcnt(5)
    v_mfma_f32_16x16x32_bf16 v[128:131], v[208:211], a[128:131], v[128:131]
    v_mfma_f32_16x16x32_bf16 v[132:135], v[208:211], a[132:135], v[132:135]
    buffer_load_dwordx4 v10, s[4:7], s63 offen offset:3072 lds
    v_mfma_f32_16x16x32_bf16 v[136:139], v[208:211], a[136:139], v[136:139]
    v_mfma_f32_16x16x32_bf16 v[140:143], v[208:211], a[140:143], v[140:143]
    ds_read_b128 v[208:211], v1 offset:16384
    s_waitcnt lgkmcnt(5)
    v_mfma_f32_16x16x32_bf16 v[156:159], v[212:215], a[140:143], v[156:159]
    v_mfma_f32_16x16x32_bf16 v[152:155], v[212:215], a[136:139], v[152:155]
    buffer_load_dwordx4 a[60:63], v7, s[4:7], s92 offen offset:0 sc1
    v_mfma_f32_16x16x32_bf16 v[148:151], v[212:215], a[132:135], v[148:151]
    v_mfma_f32_16x16x32_bf16 v[144:147], v[212:215], a[128:131], v[144:147]
    ds_read_b128 v[212:215], v1 offset:17408
    s_waitcnt vmcnt(11)
    s_waitcnt lgkmcnt(5)
    v_mfma_f32_16x16x32_bf16 v[64:67], v[192:195], a[0:3], v[64:67]
    v_mfma_f32_16x16x32_bf16 v[68:71], v[192:195], a[4:7], v[68:71]
    buffer_load_dwordx4 a[64:67], v4, s[4:7], s92 offen offset:1024 sc1
    v_mfma_f32_16x16x32_bf16 v[72:75], v[192:195], a[8:11], v[72:75]
    v_mfma_f32_16x16x32_bf16 v[76:79], v[192:195], a[12:15], v[76:79]
    ds_read_b128 v[192:195], v1 offset:18432
    s_waitcnt lgkmcnt(5)
    v_mfma_f32_16x16x32_bf16 v[92:95], v[196:199], a[12:15], v[92:95]
    v_mfma_f32_16x16x32_bf16 v[88:91], v[196:199], a[8:11], v[88:91]
    buffer_load_dwordx4 a[68:71], v5, s[4:7], s92 offen offset:1024 sc1
    v_mfma_f32_16x16x32_bf16 v[84:87], v[196:199], a[4:7], v[84:87]
    v_mfma_f32_16x16x32_bf16 v[80:83], v[196:199], a[0:3], v[80:83]
    ds_read_b128 v[196:199], v1 offset:19456
    s_waitcnt lgkmcnt(5)
    v_mfma_f32_16x16x32_bf16 v[96:99], v[200:203], a[0:3], v[96:99]
    s_add_u32 m0, s57, 53248
    s_add_u32 s63, s101, 8392704
    v_mfma_f32_16x16x32_bf16 v[100:103], v[200:203], a[4:7], v[100:103]
    buffer_load_dwordx4 v10, s[4:7], s63 offen offset:0 lds
    v_mfma_f32_16x16x32_bf16 v[104:107], v[200:203], a[8:11], v[104:107]
    v_mfma_f32_16x16x32_bf16 v[108:111], v[200:203], a[12:15], v[108:111]
    ds_read_b128 v[200:203], v1 offset:20480
    s_waitcnt lgkmcnt(5)
    v_mfma_f32_16x16x32_bf16 v[124:127], v[204:207], a[12:15], v[124:127]
    v_mfma_f32_16x16x32_bf16 v[120:123], v[204:207], a[8:11], v[120:123]
    buffer_load_dwordx4 a[72:75], v6, s[4:7], s92 offen offset:1024 sc1
    v_mfma_f32_16x16x32_bf16 v[116:119], v[204:207], a[4:7], v[116:119]
    v_mfma_f32_16x16x32_bf16 v[112:115], v[204:207], a[0:3], v[112:115]
    ds_read_b128 v[204:207], v1 offset:21504
    s_waitcnt lgkmcnt(5)
    v_mfma_f32_16x16x32_bf16 v[128:131], v[208:211], a[0:3], v[128:131]
    v_mfma_f32_16x16x32_bf16 v[132:135], v[208:211], a[4:7], v[132:135]
    buffer_load_dwordx4 a[76:79], v7, s[4:7], s92 offen offset:1024 sc1
    v_mfma_f32_16x16x32_bf16 v[136:139], v[208:211], a[8:11], v[136:139]
    v_mfma_f32_16x16x32_bf16 v[140:143], v[208:211], a[12:15], v[140:143]
    ds_read_b128 v[208:211], v1 offset:22528
    s_waitcnt lgkmcnt(5)
    v_mfma_f32_16x16x32_bf16 v[156:159], v[212:215], a[12:15], v[156:159]
    v_mfma_f32_16x16x32_bf16 v[152:155], v[212:215], a[8:11], v[152:155]
    v_mfma_f32_16x16x32_bf16 v[148:151], v[212:215], a[4:7], v[148:151]
    v_mfma_f32_16x16x32_bf16 v[144:147], v[212:215], a[0:3], v[144:147]
    ds_read_b128 v[212:215], v1 offset:23552
    s_waitcnt vmcnt(11)
    s_barrier
    s_waitcnt lgkmcnt(5)
    v_mfma_f32_16x16x32_bf16 v[64:67], v[192:195], a[16:19], v[64:67]
    v_mfma_f32_16x16x32_bf16 v[68:71], v[192:195], a[20:23], v[68:71]
    buffer_load_dwordx4 a[80:83], v4, s[4:7], s92 offen offset:2048 sc1
    v_mfma_f32_16x16x32_bf16 v[72:75], v[192:195], a[192:195], v[72:75]
    v_mfma_f32_16x16x32_bf16 v[76:79], v[192:195], a[196:199], v[76:79]
    ds_read_b128 v[192:195], v1 offset:24576
    s_waitcnt lgkmcnt(5)
    v_mfma_f32_16x16x32_bf16 v[92:95], v[196:199], a[196:199], v[92:95]
    v_mfma_f32_16x16x32_bf16 v[88:91], v[196:199], a[192:195], v[88:91]
    buffer_load_dwordx4 a[84:87], v5, s[4:7], s92 offen offset:2048 sc1
    v_mfma_f32_16x16x32_bf16 v[84:87], v[196:199], a[20:23], v[84:87]
    v_mfma_f32_16x16x32_bf16 v[80:83], v[196:199], a[16:19], v[80:83]
    ds_read_b128 v[196:199], v1 offset:25600
    s_waitcnt lgkmcnt(5)
    v_mfma_f32_16x16x32_bf16 v[96:99], v[200:203], a[16:19], v[96:99]
    v_mfma_f32_16x16x32_bf16 v[100:103], v[200:203], a[20:23], v[100:103]
    buffer_load_dwordx4 v10, s[4:7], s63 offen offset:1024 lds
    v_mfma_f32_16x16x32_bf16 v[104:107], v[200:203], a[192:195], v[104:107]
    v_mfma_f32_16x16x32_bf16 v[108:111], v[200:203], a[196:199], v[108:111]
    ds_read_b128 v[200:203], v1 offset:26624
    s_waitcnt lgkmcnt(5)
    v_mfma_f32_16x16x32_bf16 v[124:127], v[204:207], a[196:199], v[124:127]
    v_mfma_f32_16x16x32_bf16 v[120:123], v[204:207], a[192:195], v[120:123]
    buffer_load_dwordx4 a[88:91], v6, s[4:7], s92 offen offset:2048 sc1
    v_mfma_f32_16x16x32_bf16 v[116:119], v[204:207], a[20:23], v[116:119]
    v_mfma_f32_16x16x32_bf16 v[112:115], v[204:207], a[16:19], v[112:115]
    ds_read_b128 v[204:207], v1 offset:27648
    s_waitcnt lgkmcnt(5)
    v_mfma_f32_16x16x32_bf16 v[128:131], v[208:211], a[16:19], v[128:131]
    v_mfma_f32_16x16x32_bf16 v[132:135], v[208:211], a[20:23], v[132:135]
    buffer_load_dwordx4 a[92:95], v7, s[4:7], s92 offen offset:2048 sc1
    v_mfma_f32_16x16x32_bf16 v[136:139], v[208:211], a[192:195], v[136:139]
    v_mfma_f32_16x16x32_bf16 v[140:143], v[208:211], a[196:199], v[140:143]
    ds_read_b128 v[208:211], v1 offset:28672
    s_waitcnt lgkmcnt(5)
    v_mfma_f32_16x16x32_bf16 v[156:159], v[212:215], a[196:199], v[156:159]
    v_mfma_f32_16x16x32_bf16 v[152:155], v[212:215], a[192:195], v[152:155]
    v_mfma_f32_16x16x32_bf16 v[148:151], v[212:215], a[20:23], v[148:151]
    v_mfma_f32_16x16x32_bf16 v[144:147], v[212:215], a[16:19], v[144:147]
    ds_read_b128 v[212:215], v1 offset:29696
    s_waitcnt vmcnt(10)
    s_waitcnt lgkmcnt(3)
    v_mfma_f32_16x16x32_bf16 v[96:99], v[200:203], a[48:51], v[96:99]
    v_mfma_f32_16x16x32_bf16 v[100:103], v[200:203], a[52:55], v[100:103]
    buffer_load_dwordx4 a[96:99], v4, s[4:7], s92 offen offset:3072 sc1
    v_mfma_f32_16x16x32_bf16 v[104:107], v[200:203], a[56:59], v[104:107]
    ds_read_b128 a[200:203], v1 offset:30720
    v_mfma_f32_16x16x32_bf16 v[108:111], v[200:203], a[60:63], v[108:111]
    ds_read_b128 v[200:203], v1 offset:32768
    s_waitcnt lgkmcnt(4)
    v_mfma_f32_16x16x32_bf16 v[124:127], v[204:207], a[60:63], v[124:127]
    v_mfma_f32_16x16x32_bf16 v[120:123], v[204:207], a[56:59], v[120:123]
    buffer_load_dwordx4 a[100:103], v5, s[4:7], s92 offen offset:3072 sc1
    v_mfma_f32_16x16x32_bf16 v[116:119], v[204:207], a[52:55], v[116:119]
    ds_read_b128 a[204:207], v1 offset:31744
    v_mfma_f32_16x16x32_bf16 v[112:115], v[204:207], a[48:51], v[112:115]
    ds_read_b128 v[204:207], v1 offset:33792
    s_waitcnt lgkmcnt(5)
    v_mfma_f32_16x16x32_bf16 v[128:131], v[208:211], a[48:51], v[128:131]
    v_mfma_f32_16x16x32_bf16 v[132:135], v[208:211], a[52:55], v[132:135]
    buffer_load_dwordx4 a[104:107], v6, s[4:7], s92 offen offset:3072 sc1
    v_mfma_f32_16x16x32_bf16 v[136:139], v[208:211], a[56:59], v[136:139]
    v_mfma_f32_16x16x32_bf16 v[140:143], v[208:211], a[60:63], v[140:143]
    ds_read_b128 v[208:211], v1 offset:34816
    s_waitcnt lgkmcnt(5)
    v_mfma_f32_16x16x32_bf16 v[156:159], v[212:215], a[60:63], v[156:159]
    v_mfma_f32_16x16x32_bf16 v[152:155], v[212:215], a[56:59], v[152:155]
    buffer_load_dwordx4 a[108:111], v7, s[4:7], s92 offen offset:3072 sc1
    v_mfma_f32_16x16x32_bf16 v[148:151], v[212:215], a[52:55], v[148:151]
    s_add_u32 s20, s48, L_epi2-L_pc
    s_addc_u32 s21, s49, 0
    global_load_dword v52, v35, s[20:21]
    v_mfma_f32_16x16x32_bf16 v[144:147], v[212:215], a[48:51], v[144:147]
    ds_read_b128 v[212:215], v1 offset:35840
    s_waitcnt vmcnt(10)
    s_waitcnt lgkmcnt(4)
    v_mfma_f32_16x16x32_bf16 v[96:99], v[200:203], a[64:67], v[96:99]
    v_mfma_f32_16x16x32_bf16 v[100:103], v[200:203], a[68:71], v[100:103]
    buffer_load_dwordx4 a[112:115], v4, s[4:7], s93 offen offset:0 sc1
    v_mfma_f32_16x16x32_bf16 v[104:107], v[200:203], a[72:75], v[104:107]
    ds_read_b128 a[208:211], v1 offset:36864
    v_mfma_f32_16x16x32_bf16 v[108:111], v[200:203], a[76:79], v[108:111]
    ds_read_b128 v[200:203], v1 offset:38912
    s_waitcnt lgkmcnt(4)
    v_mfma_f32_16x16x32_bf16 v[124:127], v[204:207], a[76:79], v[124:127]
    v_mfma_f32_16x16x32_bf16 v[120:123], v[204:207], a[72:75], v[120:123]
    buffer_load_dwordx4 a[116:119], v5, s[4:7], s93 offen offset:0 sc1
    v_mfma_f32_16x16x32_bf16 v[116:119], v[204:207], a[68:71], v[116:119]
    ds_read_b128 a[212:215], v1 offset:37888
    v_mfma_f32_16x16x32_bf16 v[112:115], v[204:207], a[64:67], v[112:115]
    ds_read_b128 v[204:207], v1 offset:39936
    s_waitcnt lgkmcnt(5)
    v_mfma_f32_16x16x32_bf16 v[128:131], v[208:211], a[64:67], v[128:131]
    v_mfma_f32_16x16x32_bf16 v[132:135], v[208:211], a[68:71], v[132:135]
    buffer_load_dwordx4 a[120:123], v6, s[4:7], s93 offen offset:0 sc1
    v_mfma_f32_16x16x32_bf16 v[136:139], v[208:211], a[72:75], v[136:139]
    v_mfma_f32_16x16x32_bf16 v[140:143], v[208:211], a[76:79], v[140:143]
    ds_read_b128 v[208:211], v1 offset:40960
    s_waitcnt lgkmcnt(5)
    v_mfma_f32_16x16x32_bf16 v[156:159], v[212:215], a[76:79], v[156:159]
    v_mfma_f32_16x16x32_bf16 v[152:155], v[212:215], a[72:75], v[152:155]
    buffer_load_dwordx4 a[124:127], v7, s[4:7], s93 offen offset:0 sc1
    v_mfma_f32_16x16x32_bf16 v[148:151], v[212:215], a[68:71], v[148:151]
    v_mfma_f32_16x16x32_bf16 v[144:147], v[212:215], a[64:67], v[144:147]
    ds_read_b128 v[212:215], v1 offset:41984
    s_waitcnt vmcnt(9)
    s_waitcnt lgkmcnt(4)
    v_mfma_f32_16x16x32_bf16 v[96:99], v[200:203], a[80:83], v[96:99]
    v_mfma_f32_16x16x32_bf16 v[100:103], v[200:203], a[84:87], v[100:103]
    buffer_load_dwordx4 a[128:131], v4, s[4:7], s93 offen offset:1024 sc1
    v_mfma_f32_16x16x32_bf16 v[104:107], v[200:203], a[88:91], v[104:107]
    ds_read_b128 a[144:147], v1 offset:43008
    v_mfma_f32_16x16x32_bf16 v[108:111], v[200:203], a[92:95], v[108:111]
    ds_read_b128 v[200:203], v1 offset:45056
    s_waitcnt lgkmcnt(4)
    v_mfma_f32_16x16x32_bf16 v[124:127], v[204:207], a[92:95], v[124:127]
    v_mfma_f32_16x16x32_bf16 v[120:123], v[204:207], a[88:91], v[120:123]
    buffer_load_dwordx4 a[132:135], v5, s[4:7], s93 offen offset:1024 sc1
    v_mfma_f32_16x16x32_bf16 v[116:119], v[204:207], a[84:87], v[116:119]
    ds_read_b128 a[148:151], v1 offset:44032
    v_mfma_f32_16x16x32_bf16 v[112:115], v[204:207], a[80:83], v[112:115]
    ds_read_b128 v[204:207], v1 offset:46080
    s_waitcnt lgkmcnt(5)
    v_mfma_f32_16x16x32_bf16 v[128:131], v[208:211], a[80:83], v[128:131]
    v_mfma_f32_16x16x32_bf16 v[132:135], v[208:211], a[84:87], v[132:135]
    buffer_load_dwordx4 a[136:139], v6, s[4:7], s93 offen offset:1024 sc1
    v_mfma_f32_16x16x32_bf16 v[136:139], v[208:211], a[88:91], v[136:139]
    v_mfma_f32_16x16x32_bf16 v[140:143], v[208:211], a[92:95], v[140:143]
    ds_read_b128 v[208:211], v1 offset:47104
    s_waitcnt lgkmcnt(5)
    v_mfma_f32_16x16x32_bf16 v[156:159], v[212:215], a[92:95], v[156:159]
    v_mfma_f32_16x16x32_bf16 v[152:155], v[212:215], a[88:91], v[152:155]
    buffer_load_dwordx4 a[140:143], v7, s[4:7], s93 offen offset:1024 sc1
    v_mfma_f32_16x16x32_bf16 v[148:151], v[212:215], a[84:87], v[148:151]
    s_add_u32 s20, s48, L_ool-L_pc
    s_addc_u32 s21, s49, 0
    global_load_dword v52, v35, s[20:21]
    v_mfma_f32_16x16x32_bf16 v[144:147], v[212:215], a[80:83], v[144:147]
    ds_read_b128 v[212:215], v1 offset:48128
    s_waitcnt vmcnt(10)
    s_barrier
    s_waitcnt lgkmcnt(4)
    v_mfma_f32_16x16x32_bf16 v[96:99], v[200:203], a[96:99], v[96:99]
    v_mfma_f32_16x16x32_bf16 v[100:103], v[200:203], a[100:103], v[100:103]
    buffer_load_dwordx4 a[0:3], v4, s[4:7], s93 offen offset:2048 sc1
    v_mfma_f32_16x16x32_bf16 v[104:107], v[200:203], a[104:107], v[104:107]
    ds_read_b128 a[152:155], v1 offset:49152
    v_mfma_f32_16x16x32_bf16 v[108:111], v[200:203], a[108:111], v[108:111]
    ds_read_b128 v[200:203], v1 offset:51200
    s_waitcnt lgkmcnt(4)
    v_mfma_f32_16x16x32_bf16 v[124:127], v[204:207], a[108:111], v[124:127]
    v_mfma_f32_16x16x32_bf16 v[120:123], v[204:207], a[104:107], v[120:123]
    buffer_load_dwordx4 a[4:7], v5, s[4:7], s93 offen offset:2048 sc1
    v_mfma_f32_16x16x32_bf16 v[116:119], v[204:207], a[100:103], v[116:119]
    ds_read_b128 a[156:159], v1 offset:50176
    v_mfma_f32_16x16x32_bf16 v[112:115], v[204:207], a[96:99], v[112:115]
    ds_read_b128 v[204:207], v1 offset:52224
    s_waitcnt lgkmcnt(5)
    v_mfma_f32_16x16x32_bf16 v[128:131], v[208:211], a[96:99], v[128:131]
    v_mfma_f32_16x16x32_bf16 v[132:135], v[208:211], a[100:103], v[132:135]
    buffer_load_dwordx4 a[8:11], v6, s[4:7], s93 offen offset:2048 sc1
    v_mfma_f32_16x16x32_bf16 v[136:139], v[208:211], a[104:107], v[136:139]
    v_mfma_f32_16x16x32_bf16 v[140:143], v[208:211], a[108:111], v[140:143]
    ds_read_b128 v[208:211], v1 offset:53248
    s_waitcnt lgkmcnt(5)
    v_mfma_f32_16x16x32_bf16 v[156:159], v[212:215], a[108:111], v[156:159]
    v_mfma_f32_16x16x32_bf16 v[152:155], v[212:215], a[104:107], v[152:155]
    buffer_load_dwordx4 a[12:15], v7, s[4:7], s93 offen offset:2048 sc1
    v_mfma_f32_16x16x32_bf16 v[148:151], v[212:215], a[100:103], v[148:151]
    v_mfma_f32_16x16x32_bf16 v[144:147], v[212:215], a[96:99], v[144:147]
    ds_read_b128 v[212:215], v1 offset:54272
    s_waitcnt vmcnt(9)
    s_waitcnt lgkmcnt(4)
    v_mfma_f32_16x16x32_bf16 v[96:99], v[200:203], a[112:115], v[96:99]
    v_mfma_f32_16x16x32_bf16 v[100:103], v[200:203], a[116:119], v[100:103]
    buffer_load_dwordx4 a[16:19], v4, s[4:7], s93 offen offset:3072 sc1
    v_mfma_f32_16x16x32_bf16 v[104:107], v[200:203], a[120:123], v[104:107]
    ds_read_b128 a[160:163], v1 offset:55296
    v_mfma_f32_16x16x32_bf16 v[108:111], v[200:203], a[124:127], v[108:111]
    ds_read_b128 v[200:203], v1 offset:57344
    s_waitcnt lgkmcnt(4)
    v_mfma_f32_16x16x32_bf16 v[124:127], v[204:207], a[124:127], v[124:127]
    v_mfma_f32_16x16x32_bf16 v[120:123], v[204:207], a[120:123], v[120:123]
    buffer_load_dwordx4 a[20:23], v5, s[4:7], s93 offen offset:3072 sc1
    v_mfma_f32_16x16x32_bf16 v[116:119], v[204:207], a[116:119], v[116:119]
    ds_read_b128 a[164:167], v1 offset:56320
    v_mfma_f32_16x16x32_bf16 v[112:115], v[204:207], a[112:115], v[112:115]
    ds_read_b128 v[204:207], v1 offset:58368
    s_waitcnt lgkmcnt(5)
    v_mfma_f32_16x16x32_bf16 v[128:131], v[208:211], a[112:115], v[128:131]
    v_mfma_f32_16x16x32_bf16 v[132:135], v[208:211], a[116:119], v[132:135]
    buffer_load_dwordx4 a[192:195], v6, s[4:7], s93 offen offset:3072 sc1
    v_mfma_f32_16x16x32_bf16 v[136:139], v[208:211], a[120:123], v[136:139]
    v_mfma_f32_16x16x32_bf16 v[140:143], v[208:211], a[124:127], v[140:143]
    ds_read_b128 v[208:211], v1 offset:59392
    s_waitcnt lgkmcnt(5)
    v_mfma_f32_16x16x32_bf16 v[156:159], v[212:215], a[124:127], v[156:159]
    v_mfma_f32_16x16x32_bf16 v[152:155], v[212:215], a[120:123], v[152:155]
    buffer_load_dwordx4 a[196:199], v7, s[4:7], s93 offen offset:3072 sc1
    v_mfma_f32_16x16x32_bf16 v[148:151], v[212:215], a[116:119], v[148:151]
    v_mfma_f32_16x16x32_bf16 v[144:147], v[212:215], a[112:115], v[144:147]
    ds_read_b128 v[212:215], v1 offset:60416
    s_waitcnt vmcnt(9)
    s_waitcnt lgkmcnt(4)
    v_mfma_f32_16x16x32_bf16 v[96:99], v[200:203], a[128:131], v[96:99]
    s_add_u32 m0, s57, 73728
    s_mov_b32 s63, 21028864
    v_mfma_f32_16x16x32_bf16 v[100:103], v[200:203], a[132:135], v[100:103]
    buffer_load_dwordx4 v11, s[4:7], s63 offen offset:0 lds
    v_mfma_f32_16x16x32_bf16 v[104:107], v[200:203], a[136:139], v[104:107]
    ds_read_b128 a[240:243], v1 offset:61440
    v_mfma_f32_16x16x32_bf16 v[108:111], v[200:203], a[140:143], v[108:111]
    ds_read_b128 v[200:203], v1 offset:63488
    s_waitcnt lgkmcnt(4)
    v_mfma_f32_16x16x32_bf16 v[124:127], v[204:207], a[140:143], v[124:127]
    v_mfma_f32_16x16x32_bf16 v[120:123], v[204:207], a[136:139], v[120:123]
    buffer_load_dwordx4 v11, s[4:7], s63 offen offset:1024 lds
    v_mfma_f32_16x16x32_bf16 v[116:119], v[204:207], a[132:135], v[116:119]
    ds_read_b128 a[244:247], v1 offset:62464
    v_mfma_f32_16x16x32_bf16 v[112:115], v[204:207], a[128:131], v[112:115]
    ds_read_b128 v[204:207], v1 offset:64512
    s_waitcnt lgkmcnt(5)
    v_mfma_f32_16x16x32_bf16 v[128:131], v[208:211], a[128:131], v[128:131]
    v_mfma_f32_16x16x32_bf16 v[132:135], v[208:211], a[132:135], v[132:135]
    buffer_load_dwordx4 v11, s[4:7], s63 offen offset:2048 lds
    v_mfma_f32_16x16x32_bf16 v[136:139], v[208:211], a[136:139], v[136:139]
    v_mfma_f32_16x16x32_bf16 v[140:143], v[208:211], a[140:143], v[140:143]
    ds_read_b128 v[208:211], v2 offset:0
    s_waitcnt lgkmcnt(5)
    v_mfma_f32_16x16x32_bf16 v[156:159], v[212:215], a[140:143], v[156:159]
    v_mfma_f32_16x16x32_bf16 v[152:155], v[212:215], a[136:139], v[152:155]
    v_mfma_f32_16x16x32_bf16 v[148:151], v[212:215], a[132:135], v[148:151]
    v_mfma_f32_16x16x32_bf16 v[144:147], v[212:215], a[128:131], v[144:147]
    ds_read_b128 v[212:215], v2 offset:1024
    s_waitcnt vmcnt(7)
    s_waitcnt lgkmcnt(4)
    v_mfma_f32_16x16x32_bf16 v[96:99], v[200:203], a[0:3], v[96:99]
    v_mfma_f32_16x16x32_bf16 v[100:103], v[200:203], a[4:7], v[100:103]
    buffer_load_dwordx4 v11, s[4:7], s63 offen offset:3072 lds
    v_mfma_f32_16x16x32_bf16 v[104:107], v[200:203], a[8:11], v[104:107]
    ds_read_b128 a[248:251], v2 offset:2048
    v_mfma_f32_16x16x32_bf16 v[108:111], v[200:203], a[12:15], v[108:111]
    ds_read_b128 v[200:203], v2 offset:4096
    s_waitcnt lgkmcnt(4)
    v_mfma_f32_16x16x32_bf16 v[124:127], v[204:207], a[12:15], v[124:127]
    s_add_u32 m0, s57, 77824
    s_mov_b32 s63, 21032960
    v_mfma_f32_16x16x32_bf16 v[120:123], v[204:207], a[8:11], v[120:123]
    buffer_load_dwordx4 v11, s[4:7], s63 offen offset:0 lds
    v_mfma_f32_16x16x32_bf16 v[116:119], v[204:207], a[4:7], v[116:119]
    ds_read_b128 a[252:255], v2 offset:3072
    v_mfma_f32_16x16x32_bf16 v[112:115], v[204:207], a[0:3], v[112:115]
    ds_read_b128 v[204:207], v2 offset:5120
    s_waitcnt lgkmcnt(5)
    v_mfma_f32_16x16x32_bf16 v[128:131], v[208:211], a[0:3], v[128:131]
    v_mfma_f32_16x16x32_bf16 v[132:135], v[208:211], a[4:7], v[132:135]
    v_mfma_f32_16x16x32_bf16 v[136:139], v[208:211], a[8:11], v[136:139]
    v_mfma_f32_16x16x32_bf16 v[140:143], v[208:211], a[12:15], v[140:143]
    ds_read_b128 v[208:211], v2 offset:6144
    s_waitcnt lgkmcnt(5)
    v_mfma_f32_16x16x32_bf16 v[156:159], v[212:215], a[12:15], v[156:159]
    v_mfma_f32_16x16x32_bf16 v[152:155], v[212:215], a[8:11], v[152:155]
    v_mfma_f32_16x16x32_bf16 v[148:151], v[212:215], a[4:7], v[148:151]
    v_mfma_f32_16x16x32_bf16 v[144:147], v[212:215], a[0:3], v[144:147]
    ds_read_b128 v[212:215], v2 offset:7168
    s_waitcnt vmcnt(5)
    s_waitcnt lgkmcnt(4)
    v_mfma_f32_16x16x32_bf16 v[96:99], v[200:203], a[16:19], v[96:99]
    v_mfma_f32_16x16x32_bf16 v[100:103], v[200:203], a[20:23], v[100:103]
    buffer_load_dwordx4 v11, s[4:7], s63 offen offset:1024 lds
    v_mfma_f32_16x16x32_bf16 v[104:107], v[200:203], a[192:195], v[104:107]
    v_mfma_f32_16x16x32_bf16 v[108:111], v[200:203], a[196:199], v[108:111]
    s_waitcnt lgkmcnt(2)
    v_mfma_f32_16x16x32_bf16 v[124:127], v[204:207], a[196:199], v[124:127]
    s_add_u32 m0, s57, 98304
    s_mov_b32 s63, 21053440
    v_mfma_f32_16x16x32_bf16 v[120:123], v[204:207], a[192:195], v[120:123]
    buffer_load_dwordx4 v11, s[4:7], s63 offen offset:0 lds
    v_mfma_f32_16x16x32_bf16 v[116:119], v[204:207], a[20:23], v[116:119]
    v_mfma_f32_16x16x32_bf16 v[112:115], v[204:207], a[16:19], v[112:115]
    s_waitcnt lgkmcnt(1)
    v_mfma_f32_16x16x32_bf16 v[128:131], v[208:211], a[16:19], v[128:131]
    v_mfma_f32_16x16x32_bf16 v[132:135], v[208:211], a[20:23], v[132:135]
    v_mfma_f32_16x16x32_bf16 v[136:139], v[208:211], a[192:195], v[136:139]
    v_mfma_f32_16x16x32_bf16 v[140:143], v[208:211], a[196:199], v[140:143]
    s_waitcnt lgkmcnt(0)
    v_mfma_f32_16x16x32_bf16 v[156:159], v[212:215], a[196:199], v[156:159]
    v_mfma_f32_16x16x32_bf16 v[152:155], v[212:215], a[192:195], v[152:155]
    v_mfma_f32_16x16x32_bf16 v[148:151], v[212:215], a[20:23], v[148:151]
    v_mfma_f32_16x16x32_bf16 v[144:147], v[212:215], a[16:19], v[144:147]
L_epi2:
    s_waitcnt lgkmcnt(0)
    s_barrier
    buffer_load_dwordx4 v11, s[4:7], s63 offen offset:1024 lds
    v_max3_f32 v171, v108, v109, v110
    v_max3_f32 v171, v171, v111, v124
    v_max3_f32 v171, v171, v125, v126
    v_max_f32 v171, v171, v127
    v_min3_f32 v175, v108, v109, v110
    v_min3_f32 v175, v175, v111, v124
    v_min3_f32 v175, v175, v125, v126
    v_min_f32 v175, v175, v127
    v_max3_f32 v170, v104, v105, v106
    v_max3_f32 v170, v170, v107, v120
    v_max3_f32 v170, v170, v121, v122
    v_max_f32 v170, v170, v123
    v_min3_f32 v174, v104, v105, v106
    v_min3_f32 v174, v174, v107, v120
    v_min3_f32 v174, v174, v121, v122
    v_min_f32 v174, v174, v123
    v_max3_f32 v169, v100, v101, v102
    v_max3_f32 v169, v169, v103, v116
    v_max3_f32 v169, v169, v117, v118
    v_max_f32 v169, v169, v119
    v_min3_f32 v173, v100, v101, v102
    v_min3_f32 v173, v173, v103, v116
    v_min3_f32 v173, v173, v117, v118
    v_min_f32 v173, v173, v119
    v_max3_f32 v168, v96, v97, v98
    v_max3_f32 v168, v168, v99, v112
    v_max3_f32 v168, v168, v113, v114
    v_max_f32 v168, v168, v115
    v_min3_f32 v172, v96, v97, v98
    v_min3_f32 v172, v172, v99, v112
    v_min3_f32 v172, v172, v113, v114
    v_min_f32 v172, v172, v115
    v_pk_mul_f32 v[128:129], v[128:129], v[160:161] op_sel:[0,0] op_sel_hi:[1,0]
    v_pk_mul_f32 v[130:131], v[130:131], v[160:161] op_sel:[0,0] op_sel_hi:[1,0]
    v_pk_mul_f32 v[144:145], v[144:145], v[160:161] op_sel:[0,0] op_sel_hi:[1,0]
    v_pk_mul_f32 v[146:147], v[146:147], v[160:161] op_sel:[0,0] op_sel_hi:[1,0]
    v_cvt_pk_bf16_f32 v128, v128, v129
    v_cvt_pk_bf16_f32 v129, v130, v131
    buffer_load_dwordx4 v11, s[4:7], s63 offen offset:2048 lds
    v_cvt_pk_bf16_f32 v130, v144, v145
    v_cvt_pk_bf16_f32 v131, v146, v147
    ds_write2st64_b64 v48, v[128:129], v[130:131] offset0:112 offset1:113
    v_pk_mul_f32 v[132:133], v[132:133], v[162:163] op_sel:[0,0] op_sel_hi:[1,0]
    v_pk_mul_f32 v[134:135], v[134:135], v[162:163] op_sel:[0,0] op_sel_hi:[1,0]
    v_pk_mul_f32 v[148:149], v[148:149], v[162:163] op_sel:[0,0] op_sel_hi:[1,0]
    v_pk_mul_f32 v[150:151], v[150:151], v[162:163] op_sel:[0,0] op_sel_hi:[1,0]
    v_cvt_pk_bf16_f32 v132, v132, v133
    v_cvt_pk_bf16_f32 v133, v134, v135
    v_cvt_pk_bf16_f32 v134, v148, v149
    v_cvt_pk_bf16_f32 v135, v150, v151
    ds_write2st64_b64 v48, v[132:133], v[134:135] offset0:114 offset1:115
    v_pk_mul_f32 v[136:137], v[136:137], v[164:165] op_sel:[0,0] op_sel_hi:[1,0]
    v_pk_mul_f32 v[138:139], v[138:139], v[164:165] op_sel:[0,0] op_sel_hi:[1,0]
    v_pk_mul_f32 v[152:153], v[152:153], v[164:165] op_sel:[0,0] op_sel_hi:[1,0]
    v_pk_mul_f32 v[154:155], v[154:155], v[164:165] op_sel:[0,0] op_sel_hi:[1,0]
    v_cvt_pk_bf16_f32 v136, v136, v137
    v_cvt_pk_bf16_f32 v137, v138, v139
    v_cvt_pk_bf16_f32 v138, v152, v153
    v_cvt_pk_bf16_f32 v139, v154, v155
    ds_write2st64_b64 v48, v[136:137], v[138:139] offset0:116 offset1:117
    v_pk_mul_f32 v[140:141], v[140:141], v[166:167] op_sel:[0,0] op_sel_hi:[1,0]
    v_pk_mul_f32 v[142:143], v[142:143], v[166:167] op_sel:[0,0] op_sel_hi:[1,0]
    v_pk_mul_f32 v[156:157], v[156:157], v[166:167] op_sel:[0,0] op_sel_hi:[1,0]
    v_pk_mul_f32 v[158:159], v[158:159], v[166:167] op_sel:[0,0] op_sel_hi:[1,0]
    v_cvt_pk_bf16_f32 v140, v140, v141
    v_cvt_pk_bf16_f32 v141, v142, v143
    v_cvt_pk_bf16_f32 v142, v156, v157
    v_cvt_pk_bf16_f32 v143, v158, v159
    ds_write2st64_b64 v48, v[140:141], v[142:143] offset0:118 offset1:119
    v_permlane32_swap_b32 v168, v169
    v_permlane32_swap_b32 v170, v171
    v_permlane32_swap_b32 v172, v173
    v_permlane32_swap_b32 v174, v175
    buffer_load_dwordx4 v11, s[4:7], s63 offen offset:3072 lds
    v_max_f32 v168, v168, v169
    v_max_f32 v170, v170, v171
    v_min_f32 v172, v172, v173
    v_min_f32 v174, v174, v175
    v_permlane16_swap_b32 v168, v170
    s_nop 0
    v_permlane16_swap_b32 v172, v174
    v_max_f32 v169, v168, v170
    v_max_f32 v170, v168, v170
    v_min_f32 v173, v172, v174
    v_min_f32 v174, v172, v174
    v_permlane16_swap_b32 v169, v170
    s_nop 0
    v_permlane16_swap_b32 v173, v174
    v_mov_b32 v168, v169
    v_mov_b32 v171, v170
    v_mov_b32 v172, v173
    v_mov_b32 v175, v174
    v_permlane32_swap_b32 v168, v169
    v_permlane32_swap_b32 v170, v171
    v_permlane32_swap_b32 v172, v173
    v_permlane32_swap_b32 v174, v175
    v_mul_f32 v168, -v168, v220
    v_mul_f32 v172, v172, v220
    v_mul_f32 v169, -v169, v221
    v_mul_f32 v173, v173, v221
    v_mul_f32 v170, -v170, v222
    v_mul_f32 v174, v174, v222
    v_mul_f32 v171, -v171, v223
    v_mul_f32 v175, v175, v223
    v_pk_fma_f32 v[224:225], v[96:97], v[220:221], v[168:169] op_sel:[0,0,0] op_sel_hi:[1,0,0]
    v_pk_fma_f32 v[96:97], v[96:97], v[220:221], v[172:173] op_sel:[0,0,0] op_sel_hi:[1,0,0] neg_lo:[1,0,0] neg_hi:[1,0,0]
    s_add_u32 m0, s57, 102400
    s_mov_b32 s63, 21057536
    buffer_load_dwordx4 v11, s[4:7], s63 offen offset:0 lds
    v_pk_fma_f32 v[226:227], v[98:99], v[220:221], v[168:169] op_sel:[0,0,0] op_sel_hi:[1,0,0]
    v_pk_fma_f32 v[98:99], v[98:99], v[220:221], v[172:173] op_sel:[0,0,0] op_sel_hi:[1,0,0] neg_lo:[1,0,0] neg_hi:[1,0,0]
    v_pk_fma_f32 v[228:229], v[112:113], v[220:221], v[168:169] op_sel:[0,0,0] op_sel_hi:[1,0,0]
    v_pk_fma_f32 v[112:113], v[112:113], v[220:221], v[172:173] op_sel:[0,0,0] op_sel_hi:[1,0,0] neg_lo:[1,0,0] neg_hi:[1,0,0]
    v_pk_fma_f32 v[230:231], v[114:115], v[220:221], v[168:169] op_sel:[0,0,0] op_sel_hi:[1,0,0]
    v_pk_fma_f32 v[114:115], v[114:115], v[220:221], v[172:173] op_sel:[0,0,0] op_sel_hi:[1,0,0] neg_lo:[1,0,0] neg_hi:[1,0,0]
    v_pk_fma_f32 v[232:233], v[100:101], v[220:221], v[168:169] op_sel:[0,1,1] op_sel_hi:[1,1,1]
    v_pk_fma_f32 v[100:101], v[100:101], v[220:221], v[172:173] op_sel:[0,1,1] op_sel_hi:[1,1,1] neg_lo:[1,0,0] neg_hi:[1,0,0]
    v_pk_fma_f32 v[234:235], v[102:103], v[220:221], v[168:169] op_sel:[0,1,1] op_sel_hi:[1,1,1]
    v_pk_fma_f32 v[102:103], v[102:103], v[220:221], v[172:173] op_sel:[0,1,1] op_sel_hi:[1,1,1] neg_lo:[1,0,0] neg_hi:[1,0,0]
    v_pk_fma_f32 v[236:237], v[116:117], v[220:221], v[168:169] op_sel:[0,1,1] op_sel_hi:[1,1,1]
    v_pk_fma_f32 v[116:117], v[116:117], v[220:221], v[172:173] op_sel:[0,1,1] op_sel_hi:[1,1,1] neg_lo:[1,0,0] neg_hi:[1,0,0]
    v_pk_fma_f32 v[238:239], v[118:119], v[220:221], v[168:169] op_sel:[0,1,1] op_sel_hi:[1,1,1]
    v_pk_fma_f32 v[118:119], v[118:119], v[220:221], v[172:173] op_sel:[0,1,1] op_sel_hi:[1,1,1] neg_lo:[1,0,0] neg_hi:[1,0,0]
    v_pk_fma_f32 v[240:241], v[104:105], v[222:223], v[170:171] op_sel:[0,0,0] op_sel_hi:[1,0,0]
    v_pk_fma_f32 v[104:105], v[104:105], v[222:223], v[174:175] op_sel:[0,0,0] op_sel_hi:[1,0,0] neg_lo:[1,0,0] neg_hi:[1,0,0]
    v_pk_fma_f32 v[242:243], v[106:107], v[222:223], v[170:171] op_sel:[0,0,0] op_sel_hi:[1,0,0]
    v_pk_fma_f32 v[106:107], v[106:107], v[222:223], v[174:175] op_sel:[0,0,0] op_sel_hi:[1,0,0] neg_lo:[1,0,0] neg_hi:[1,0,0]
    v_pk_fma_f32 v[244:245], v[120:121], v[222:223], v[170:171] op_sel:[0,0,0] op_sel_hi:[1,0,0]
    v_pk_fma_f32 v[120:121], v[120:121], v[222:223], v[174:175] op_sel:[0,0,0] op_sel_hi:[1,0,0] neg_lo:[1,0,0] neg_hi:[1,0,0]
    v_pk_fma_f32 v[246:247], v[122:123], v[222:223], v[170:171] op_sel:[0,0,0] op_sel_hi:[1,0,0]
    v_pk_fma_f32 v[122:123], v[122:123], v[222:223], v[174:175] op_sel:[0,0,0] op_sel_hi:[1,0,0] neg_lo:[1,0,0] neg_hi:[1,0,0]
    v_pk_fma_f32 v[248:249], v[108:109], v[222:223], v[170:171] op_sel:[0,1,1] op_sel_hi:[1,1,1]
    v_pk_fma_f32 v[108:109], v[108:109], v[222:223], v[174:175] op_sel:[0,1,1] op_sel_hi:[1,1,1] neg_lo:[1,0,0] neg_hi:[1,0,0]
    v_pk_fma_f32 v[250:251], v[110:111], v[222:223], v[170:171] op_sel:[0,1,1] op_sel_hi:[1,1,1]
    v_pk_fma_f32 v[110:111], v[110:111], v[222:223], v[174:175] op_sel:[0,1,1] op_sel_hi:[1,1,1] neg_lo:[1,0,0] neg_hi:[1,0,0]
    v_pk_fma_f32 v[252:253], v[124:125], v[222:223], v[170:171] op_sel:[0,1,1] op_sel_hi:[1,1,1]
    v_pk_fma_f32 v[124:125], v[124:125], v[222:223], v[174:175] op_sel:[0,1,1] op_sel_hi:[1,1,1] neg_lo:[1,0,0] neg_hi:[1,0,0]
    v_pk_fma_f32 v[254:255], v[126:127], v[222:223], v[170:171] op_sel:[0,1,1] op_sel_hi:[1,1,1]
    v_pk_fma_f32 v[126:127], v[126:127], v[222:223], v[174:175] op_sel:[0,1,1] op_sel_hi:[1,1,1] neg_lo:[1,0,0] neg_hi:[1,0,0]
    v_exp_f32 v224, v224
    v_exp_f32 v225, v225
    v_exp_f32 v226, v226
    v_exp_f32 v227, v227
    buffer_load_dwordx4 v11, s[4:7], s63 offen offset:1024 lds
    v_exp_f32 v228, v228
    v_exp_f32 v229, v229
    v_exp_f32 v230, v230
    v_exp_f32 v231, v231
    v_exp_f32 v96, v96
    v_exp_f32 v97, v97
    v_exp_f32 v98, v98
    v_exp_f32 v99, v99
    v_exp_f32 v112, v112
    v_exp_f32 v113, v113
    v_exp_f32 v114, v114
    v_exp_f32 v115, v115
    v_cvt_pk_bf16_f32 v200, v224, v225
    v_cvt_pk_bf16_f32 v201, v226, v227
    v_cvt_pk_bf16_f32 v202, v228, v229
    v_cvt_pk_bf16_f32 v203, v230, v231
    v_cvt_pk_bf16_f32 v144, v96, v97
    v_cvt_pk_bf16_f32 v145, v98, v99
    v_cvt_pk_bf16_f32 v146, v112, v113
    v_cvt_pk_bf16_f32 v147, v114, v115
    v_mfma_f32_16x16x32_bf16 v[168:171], v[40:43], v[200:203], 0
    s_nop 0
    v_mfma_f32_16x16x32_bf16 v[172:175], v[40:43], v[144:147], 0
    s_add_u32 m0, s57, 122880
    s_mov_b32 s63, 21078016
    buffer_load_dwordx4 v11, s[4:7], s63 offen offset:0 lds
    v_exp_f32 v232, v232
    v_exp_f32 v233, v233
    v_exp_f32 v234, v234
    v_exp_f32 v235, v235
    v_exp_f32 v236, v236
    v_exp_f32 v237, v237
    v_exp_f32 v238, v238
    v_exp_f32 v239, v239
    v_exp_f32 v100, v100
    v_exp_f32 v101, v101
    v_exp_f32 v102, v102
    v_exp_f32 v103, v103
    v_exp_f32 v116, v116
    v_exp_f32 v117, v117
    v_exp_f32 v118, v118
    v_exp_f32 v119, v119
    v_rcp_f32 v184, v168
    v_rcp_f32 v185, v172
    s_nop 0
    v_pk_mul_f32 v[224:225], v[224:225], v[184:185] op_sel:[0,0] op_sel_hi:[1,0]
    v_pk_mul_f32 v[226:227], v[226:227], v[184:185] op_sel:[0,0] op_sel_hi:[1,0]
    buffer_load_dwordx4 v11, s[4:7], s63 offen offset:1024 lds
    v_pk_mul_f32 v[228:229], v[228:229], v[184:185] op_sel:[0,0] op_sel_hi:[1,0]
    v_pk_mul_f32 v[230:231], v[230:231], v[184:185] op_sel:[0,0] op_sel_hi:[1,0]
    v_cvt_pk_bf16_f32 v200, v224, v225
    v_cvt_pk_bf16_f32 v201, v226, v227
    v_cvt_pk_bf16_f32 v202, v228, v229
    v_cvt_pk_bf16_f32 v203, v230, v231
    ds_write2st64_b64 v48, v[200:201], v[202:203] offset0:48 offset1:49
    v_pk_mul_f32 v[96:97], v[96:97], v[184:185] op_sel:[0,1] op_sel_hi:[1,1]
    v_pk_mul_f32 v[98:99], v[98:99], v[184:185] op_sel:[0,1] op_sel_hi:[1,1]
    v_pk_mul_f32 v[112:113], v[112:113], v[184:185] op_sel:[0,1] op_sel_hi:[1,1]
    v_pk_mul_f32 v[114:115], v[114:115], v[184:185] op_sel:[0,1] op_sel_hi:[1,1]
    v_cvt_pk_bf16_f32 v144, v96, v97
    v_cvt_pk_bf16_f32 v145, v98, v99
    v_cvt_pk_bf16_f32 v146, v112, v113
    v_cvt_pk_bf16_f32 v147, v114, v115
    ds_write2st64_b64 v48, v[144:145], v[146:147] offset0:80 offset1:81
    v_cvt_pk_bf16_f32 v204, v232, v233
    v_cvt_pk_bf16_f32 v205, v234, v235
    v_cvt_pk_bf16_f32 v206, v236, v237
    v_cvt_pk_bf16_f32 v207, v238, v239
    v_cvt_pk_bf16_f32 v148, v100, v101
    v_cvt_pk_bf16_f32 v149, v102, v103
    v_cvt_pk_bf16_f32 v150, v116, v117
    v_cvt_pk_bf16_f32 v151, v118, v119
    v_mfma_f32_16x16x32_bf16 v[176:179], v[40:43], v[204:207], 0
    s_nop 0
    v_mfma_f32_16x16x32_bf16 v[180:183], v[40:43], v[148:151], 0
    v_exp_f32 v240, v240
    v_exp_f32 v241, v241
    v_exp_f32 v242, v242
    buffer_load_dwordx4 v11, s[4:7], s63 offen offset:2048 lds
    v_exp_f32 v243, v243
    v_exp_f32 v244, v244
    v_exp_f32 v245, v245
    v_exp_f32 v246, v246
    v_exp_f32 v247, v247
    v_exp_f32 v104, v104
    v_exp_f32 v105, v105
    v_exp_f32 v106, v106
    v_exp_f32 v107, v107
    v_exp_f32 v120, v120
    v_exp_f32 v121, v121
    v_exp_f32 v122, v122
    v_exp_f32 v123, v123
    v_rcp_f32 v186, v176
    v_rcp_f32 v187, v180
    s_nop 0
    v_pk_mul_f32 v[232:233], v[232:233], v[186:187] op_sel:[0,0] op_sel_hi:[1,0]
    v_pk_mul_f32 v[234:235], v[234:235], v[186:187] op_sel:[0,0] op_sel_hi:[1,0]
    v_pk_mul_f32 v[236:237], v[236:237], v[186:187] op_sel:[0,0] op_sel_hi:[1,0]
    v_pk_mul_f32 v[238:239], v[238:239], v[186:187] op_sel:[0,0] op_sel_hi:[1,0]
    v_cvt_pk_bf16_f32 v204, v232, v233
    v_cvt_pk_bf16_f32 v205, v234, v235
    v_cvt_pk_bf16_f32 v206, v236, v237
    v_cvt_pk_bf16_f32 v207, v238, v239
    ds_write2st64_b64 v48, v[204:205], v[206:207] offset0:50 offset1:51
    buffer_load_dwordx4 v11, s[4:7], s63 offen offset:3072 lds
    v_pk_mul_f32 v[100:101], v[100:101], v[186:187] op_sel:[0,1] op_sel_hi:[1,1]
    v_pk_mul_f32 v[102:103], v[102:103], v[186:187] op_sel:[0,1] op_sel_hi:[1,1]
    v_pk_mul_f32 v[116:117], v[116:117], v[186:187] op_sel:[0,1] op_sel_hi:[1,1]
    v_pk_mul_f32 v[118:119], v[118:119], v[186:187] op_sel:[0,1] op_sel_hi:[1,1]
    v_cvt_pk_bf16_f32 v148, v100, v101
    v_cvt_pk_bf16_f32 v149, v102, v103
    v_cvt_pk_bf16_f32 v150, v116, v117
    v_cvt_pk_bf16_f32 v151, v118, v119
    ds_write2st64_b64 v48, v[148:149], v[150:151] offset0:82 offset1:83
    v_cvt_pk_bf16_f32 v208, v240, v241
    v_cvt_pk_bf16_f32 v209, v242, v243
    v_cvt_pk_bf16_f32 v210, v244, v245
    v_cvt_pk_bf16_f32 v211, v246, v247
    v_cvt_pk_bf16_f32 v152, v104, v105
    v_cvt_pk_bf16_f32 v153, v106, v107
    v_cvt_pk_bf16_f32 v154, v120, v121
    v_cvt_pk_bf16_f32 v155, v122, v123
    v_mfma_f32_16x16x32_bf16 v[168:171], v[40:43], v[208:211], 0
    s_nop 0
    v_mfma_f32_16x16x32_bf16 v[172:175], v[40:43], v[152:155], 0
    v_exp_f32 v248, v248
    v_exp_f32 v249, v249
    v_exp_f32 v250, v250
    v_exp_f32 v251, v251
    v_exp_f32 v252, v252
    v_exp_f32 v253, v253
    v_exp_f32 v254, v254
    s_add_u32 m0, s57, 126976
    s_mov_b32 s63, 21082112
    buffer_load_dwordx4 v11, s[4:7], s63 offen offset:0 lds
    v_exp_f32 v255, v255
    v_exp_f32 v108, v108
    v_exp_f32 v109, v109
    v_exp_f32 v110, v110
    v_exp_f32 v111, v111
    v_exp_f32 v124, v124
    v_exp_f32 v125, v125
    v_exp_f32 v126, v126
    v_exp_f32 v127, v127
    v_cvt_pk_bf16_f32 v212, v248, v249
    v_cvt_pk_bf16_f32 v213, v250, v251
    v_cvt_pk_bf16_f32 v214, v252, v253
    v_cvt_pk_bf16_f32 v215, v254, v255
    v_cvt_pk_bf16_f32 v156, v108, v109
    v_cvt_pk_bf16_f32 v157, v110, v111
    v_cvt_pk_bf16_f32 v158, v124, v125
    v_cvt_pk_bf16_f32 v159, v126, v127
    v_mfma_f32_16x16x32_bf16 v[176:179], v[40:43], v[212:215], 0
    s_nop 0
    v_mfma_f32_16x16x32_bf16 v[180:183], v[40:43], v[156:159], 0
    v_rcp_f32 v188, v168
    v_rcp_f32 v189, v172
    buffer_load_dwordx4 v11, s[4:7], s63 offen offset:1024 lds
    v_pk_mul_f32 v[240:241], v[240:241], v[188:189] op_sel:[0,0] op_sel_hi:[1,0]
    v_pk_mul_f32 v[242:243], v[242:243], v[188:189] op_sel:[0,0] op_sel_hi:[1,0]
    v_pk_mul_f32 v[244:245], v[244:245], v[188:189] op_sel:[0,0] op_sel_hi:[1,0]
    v_pk_mul_f32 v[246:247], v[246:247], v[188:189] op_sel:[0,0] op_sel_hi:[1,0]
    v_cvt_pk_bf16_f32 v208, v240, v241
    v_cvt_pk_bf16_f32 v209, v242, v243
    v_cvt_pk_bf16_f32 v210, v244, v245
    v_cvt_pk_bf16_f32 v211, v246, v247
    ds_write2st64_b64 v48, v[208:209], v[210:211] offset0:52 offset1:53
    v_pk_mul_f32 v[104:105], v[104:105], v[188:189] op_sel:[0,1] op_sel_hi:[1,1]
    v_pk_mul_f32 v[106:107], v[106:107], v[188:189] op_sel:[0,1] op_sel_hi:[1,1]
    v_pk_mul_f32 v[120:121], v[120:121], v[188:189] op_sel:[0,1] op_sel_hi:[1,1]
    v_pk_mul_f32 v[122:123], v[122:123], v[188:189] op_sel:[0,1] op_sel_hi:[1,1]
    v_cvt_pk_bf16_f32 v152, v104, v105
    v_cvt_pk_bf16_f32 v153, v106, v107
    v_cvt_pk_bf16_f32 v154, v120, v121
    v_cvt_pk_bf16_f32 v155, v122, v123
    ds_write2st64_b64 v48, v[152:153], v[154:155] offset0:84 offset1:85
    v_rcp_f32 v190, v176
    v_rcp_f32 v191, v180
    s_nop 0
    v_pk_mul_f32 v[248:249], v[248:249], v[190:191] op_sel:[0,0] op_sel_hi:[1,0]
    v_pk_mul_f32 v[250:251], v[250:251], v[190:191] op_sel:[0,0] op_sel_hi:[1,0]
    v_pk_mul_f32 v[252:253], v[252:253], v[190:191] op_sel:[0,0] op_sel_hi:[1,0]
    v_pk_mul_f32 v[254:255], v[254:255], v[190:191] op_sel:[0,0] op_sel_hi:[1,0]
    v_cvt_pk_bf16_f32 v212, v248, v249
    v_cvt_pk_bf16_f32 v213, v250, v251
    v_cvt_pk_bf16_f32 v214, v252, v253
    v_cvt_pk_bf16_f32 v215, v254, v255
    ds_write2st64_b64 v48, v[212:213], v[214:215] offset0:54 offset1:55
    v_pk_mul_f32 v[108:109], v[108:109], v[190:191] op_sel:[0,1] op_sel_hi:[1,1]
    v_pk_mul_f32 v[110:111], v[110:111], v[190:191] op_sel:[0,1] op_sel_hi:[1,1]
    v_pk_mul_f32 v[124:125], v[124:125], v[190:191] op_sel:[0,1] op_sel_hi:[1,1]
    v_pk_mul_f32 v[126:127], v[126:127], v[190:191] op_sel:[0,1] op_sel_hi:[1,1]
    v_cvt_pk_bf16_f32 v156, v108, v109
    v_cvt_pk_bf16_f32 v157, v110, v111
    v_cvt_pk_bf16_f32 v158, v124, v125
    s_add_u32 m0, s57, 0
    s_mov_b32 s63, 20971520
    buffer_load_dwordx4 v11, s[4:7], s63 offen offset:0 lds
    v_cvt_pk_bf16_f32 v159, v126, v127
    ds_write2st64_b64 v48, v[156:157], v[158:159] offset0:86 offset1:87
    buffer_load_dwordx4 v11, s[4:7], s63 offen offset:1024 lds
    buffer_load_dwordx4 v11, s[4:7], s63 offen offset:2048 lds
    buffer_load_dwordx4 v11, s[4:7], s63 offen offset:3072 lds
    s_add_u32 m0, s57, 4096
    s_mov_b32 s63, 20975616
    buffer_load_dwordx4 v11, s[4:7], s63 offen offset:0 lds
    buffer_load_dwordx4 v11, s[4:7], s63 offen offset:1024 lds
    s_add_u32 s21, s58, s86
    s_waitcnt lgkmcnt(0)
    s_barrier
    ds_read_b64_tr_b16 v[96:97], v49 offset:24576
    ds_read_b64_tr_b16 v[104:105], v33 offset:0
    ds_read_b64_tr_b16 v[98:99], v49 offset:25600
    ds_read_b64_tr_b16 v[106:107], v33 offset:1024
    ds_read_b64_tr_b16 v[100:101], v32 offset:24576
    ds_read_b64_tr_b16 v[102:103], v32 offset:25600
    ds_read_b64_tr_b16 v[112:113], v49 offset:26624
    ds_read_b64_tr_b16 v[120:121], v33 offset:2048
    ds_read_b64_tr_b16 v[114:115], v49 offset:27648
    ds_read_b64_tr_b16 v[122:123], v33 offset:3072
    ds_read_b64_tr_b16 v[116:117], v32 offset:26624
    ds_read_b64_tr_b16 v[118:119], v32 offset:27648
    ds_read_b64_tr_b16 v[128:129], v49 offset:28672
    ds_read_b64_tr_b16 v[136:137], v33 offset:4096
    v_mfma_f32_16x16x32_bf16 v[64:67], v[192:195], a[48:51], v[64:67]
    v_mfma_f32_16x16x32_bf16 v[68:71], v[192:195], a[52:55], v[68:71]
    v_mfma_f32_16x16x32_bf16 v[72:75], v[192:195], a[56:59], v[72:75]
    v_mfma_f32_16x16x32_bf16 v[76:79], v[192:195], a[60:63], v[76:79]
    s_waitcnt lgkmcnt(10)
    v_mfma_f32_16x16x32_bf16 v[168:171], v[96:99], v[104:107], 0
    ds_read_b64_tr_b16 v[130:131], v49 offset:29696
    ds_read_b64_tr_b16 v[138:139], v33 offset:5120
    v_mfma_f32_16x16x32_bf16 v[200:203], v[96:99], v[40:43], 0
    ds_read_b64_tr_b16 v[132:133], v32 offset:28672
    ds_read_b64_tr_b16 v[134:135], v32 offset:29696
    s_waitcnt lgkmcnt(12)
    v_mfma_f32_16x16x32_bf16 v[172:175], v[100:103], v[104:107], 0
    ds_read_b64_tr_b16 v[144:145], v49 offset:30720
    ds_read_b64_tr_b16 v[152:153], v33 offset:6144
    s_waitcnt lgkmcnt(10)
    v_mfma_f32_16x16x32_bf16 v[168:171], v[112:115], v[120:123], v[168:171]
    ds_read_b64_tr_b16 v[146:147], v49 offset:31744
    ds_read_b64_tr_b16 v[154:155], v33 offset:7168
    v_mfma_f32_16x16x32_bf16 v[200:203], v[112:115], v[40:43], v[200:203]
    ds_read_b64_tr_b16 v[148:149], v32 offset:30720
    ds_read_b64_tr_b16 v[150:151], v32 offset:31744
    s_waitcnt lgkmcnt(12)
    v_mfma_f32_16x16x32_bf16 v[172:175], v[116:119], v[120:123], v[172:175]
    ds_read_b64_tr_b16 v[96:97], v49 offset:32768
    ds_read_b64_tr_b16 v[104:105], v33 offset:8192
    s_waitcnt lgkmcnt(10)
    v_mfma_f32_16x16x32_bf16 v[168:171], v[128:131], v[136:139], v[168:171]
    ds_read_b64_tr_b16 v[98:99], v49 offset:33792
    ds_read_b64_tr_b16 v[106:107], v33 offset:9216
    v_mfma_f32_16x16x32_bf16 v[200:203], v[128:131], v[40:43], v[200:203]
    ds_read_b64_tr_b16 v[100:101], v32 offset:32768
    ds_read_b64_tr_b16 v[102:103], v32 offset:33792
    s_waitcnt lgkmcnt(12)
    v_mfma_f32_16x16x32_bf16 v[172:175], v[132:135], v[136:139], v[172:175]
    ds_read_b64_tr_b16 v[112:113], v49 offset:34816
    ds_read_b64_tr_b16 v[120:121], v33 offset:10240
    s_waitcnt lgkmcnt(10)
    v_mfma_f32_16x16x32_bf16 v[168:171], v[144:147], v[152:155], v[168:171]
    ds_read_b64_tr_b16 v[114:115], v49 offset:35840
    ds_read_b64_tr_b16 v[122:123], v33 offset:11264
    v_mfma_f32_16x16x32_bf16 v[200:203], v[144:147], v[40:43], v[200:203]
    ds_read_b64_tr_b16 v[116:117], v32 offset:34816
    ds_read_b64_tr_b16 v[118:119], v32 offset:35840
    s_waitcnt lgkmcnt(12)
    v_mfma_f32_16x16x32_bf16 v[172:175], v[148:151], v[152:155], v[172:175]
    ds_read_b64_tr_b16 v[128:129], v49 offset:36864
    ds_read_b64_tr_b16 v[136:137], v33 offset:12288
    s_waitcnt lgkmcnt(10)
    v_mfma_f32_16x16x32_bf16 v[168:171], v[96:99], v[104:107], v[168:171]
    ds_read_b64_tr_b16 v[130:131], v49 offset:37888
    ds_read_b64_tr_b16 v[138:139], v33 offset:13312
    v_mfma_f32_16x16x32_bf16 v[200:203], v[96:99], v[40:43], v[200:203]
    ds_read_b64_tr_b16 v[132:133], v32 offset:36864
    ds_read_b64_tr_b16 v[134:135], v32 offset:37888
    s_waitcnt lgkmcnt(12)
    v_mfma_f32_16x16x32_bf16 v[172:175], v[100:103], v[104:107], v[172:175]
    ds_read_b64_tr_b16 v[144:145], v49 offset:38912
    ds_read_b64_tr_b16 v[152:153], v33 offset:14336
    s_waitcnt lgkmcnt(10)
    v_mfma_f32_16x16x32_bf16 v[168:171], v[112:115], v[120:123], v[168:171]
    ds_read_b64_tr_b16 v[146:147], v49 offset:39936
    ds_read_b64_tr_b16 v[154:155], v33 offset:15360
    v_mfma_f32_16x16x32_bf16 v[200:203], v[112:115], v[40:43], v[200:203]
    ds_read_b64_tr_b16 v[148:149], v32 offset:38912
    ds_read_b64_tr_b16 v[150:151], v32 offset:39936
    s_waitcnt lgkmcnt(12)
    v_mfma_f32_16x16x32_bf16 v[172:175], v[116:119], v[120:123], v[172:175]
    s_waitcnt lgkmcnt(8)
    v_mfma_f32_16x16x32_bf16 v[168:171], v[128:131], v[136:139], v[168:171]
    v_mfma_f32_16x16x32_bf16 v[200:203], v[128:131], v[40:43], v[200:203]
    s_waitcnt lgkmcnt(6)
    v_mfma_f32_16x16x32_bf16 v[172:175], v[132:135], v[136:139], v[172:175]
    s_waitcnt lgkmcnt(2)
    v_mfma_f32_16x16x32_bf16 v[168:171], v[144:147], v[152:155], v[168:171]
    v_mfma_f32_16x16x32_bf16 v[200:203], v[144:147], v[40:43], v[200:203]
    s_waitcnt lgkmcnt(0)
    v_mfma_f32_16x16x32_bf16 v[172:175], v[148:151], v[152:155], v[172:175]
    v_mfma_f32_16x16x32_bf16 v[92:95], v[196:199], a[60:63], v[92:95]
    v_mfma_f32_16x16x32_bf16 v[88:91], v[196:199], a[56:59], v[88:91]
    s_barrier
    v_mfma_f32_16x16x32_bf16 v[84:87], v[196:199], a[52:55], v[84:87]
    v_mfma_f32_16x16x32_bf16 v[80:83], v[196:199], a[48:51], v[80:83]
    v_cvt_pk_bf16_f32 v192, v168, v169
    v_cvt_pk_bf16_f32 v193, v170, v171
    v_mfma_f32_16x16x32_bf16 v[64:67], a[200:203], a[64:67], v[64:67]
    v_cvt_pk_bf16_f32 v194, v172, v173
    v_cvt_pk_bf16_f32 v195, v174, v175
    v_mfma_f32_16x16x32_bf16 v[68:71], a[200:203], a[68:71], v[68:71]
    buffer_store_dwordx4 v[192:195], v1, s[4:7], s21 offen sc1
    v_mfma_f32_16x16x32_bf16 v[72:75], a[200:203], a[72:75], v[72:75]
    s_mov_b64 exec, s[42:43]
    buffer_store_dwordx4 v[200:203], v60, s[4:7], s54 offen sc1
    s_mov_b64 exec, -1
    v_mfma_f32_16x16x32_bf16 v[76:79], a[200:203], a[76:79], v[76:79]
    v_mfma_f32_16x16x32_bf16 v[92:95], a[204:207], a[76:79], v[92:95]
    v_mfma_f32_16x16x32_bf16 v[88:91], a[204:207], a[72:75], v[88:91]
    v_mfma_f32_16x16x32_bf16 v[84:87], a[204:207], a[68:71], v[84:87]
    v_mfma_f32_16x16x32_bf16 v[80:83], a[204:207], a[64:67], v[80:83]
    v_mfma_f32_16x16x32_bf16 v[64:67], a[208:211], a[80:83], v[64:67]
    s_add_u32 m0, s57, 24576
    s_mov_b32 s63, 20996096
    buffer_load_dwordx4 v11, s[4:7], s63 offen offset:0 lds
    v_mfma_f32_16x16x32_bf16 v[68:71], a[208:211], a[84:87], v[68:71]
    v_mfma_f32_16x16x32_bf16 v[72:75], a[208:211], a[88:91], v[72:75]
    v_mfma_f32_16x16x32_bf16 v[76:79], a[208:211], a[92:95], v[76:79]
    v_mfma_f32_16x16x32_bf16 v[92:95], a[212:215], a[92:95], v[92:95]
    v_mfma_f32_16x16x32_bf16 v[88:91], a[212:215], a[88:91], v[88:91]
    v_mfma_f32_16x16x32_bf16 v[84:87], a[212:215], a[84:87], v[84:87]
    buffer_load_dwordx4 v11, s[4:7], s63 offen offset:1024 lds
    v_mfma_f32_16x16x32_bf16 v[80:83], a[212:215], a[80:83], v[80:83]
    v_mfma_f32_16x16x32_bf16 v[64:67], a[144:147], a[96:99], v[64:67]
    v_mfma_f32_16x16x32_bf16 v[68:71], a[144:147], a[100:103], v[68:71]
    v_mfma_f32_16x16x32_bf16 v[72:75], a[144:147], a[104:107], v[72:75]
    v_mfma_f32_16x16x32_bf16 v[76:79], a[144:147], a[108:111], v[76:79]
    v_mfma_f32_16x16x32_bf16 v[92:95], a[148:151], a[108:111], v[92:95]
    buffer_load_dwordx4 v11, s[4:7], s63 offen offset:2048 lds
    v_mfma_f32_16x16x32_bf16 v[88:91], a[148:151], a[104:107], v[88:91]
    v_mfma_f32_16x16x32_bf16 v[84:87], a[148:151], a[100:103], v[84:87]
    v_mfma_f32_16x16x32_bf16 v[80:83], a[148:151], a[96:99], v[80:83]
    v_mfma_f32_16x16x32_bf16 v[64:67], a[152:155], a[112:115], v[64:67]
    v_mfma_f32_16x16x32_bf16 v[68:71], a[152:155], a[116:119], v[68:71]
    v_mfma_f32_16x16x32_bf16 v[72:75], a[152:155], a[120:123], v[72:75]
    buffer_load_dwordx4 v11, s[4:7], s63 offen offset:3072 lds
    v_mfma_f32_16x16x32_bf16 v[76:79], a[152:155], a[124:127], v[76:79]
    v_mfma_f32_16x16x32_bf16 v[92:95], a[156:159], a[124:127], v[92:95]
    v_mfma_f32_16x16x32_bf16 v[88:91], a[156:159], a[120:123], v[88:91]
    v_mfma_f32_16x16x32_bf16 v[84:87], a[156:159], a[116:119], v[84:87]
    v_mfma_f32_16x16x32_bf16 v[80:83], a[156:159], a[112:115], v[80:83]
    v_mfma_f32_16x16x32_bf16 v[64:67], a[160:163], a[128:131], v[64:67]
    s_add_u32 m0, s57, 28672
    s_mov_b32 s63, 21000192
    buffer_load_dwordx4 v11, s[4:7], s63 offen offset:0 lds
    v_mfma_f32_16x16x32_bf16 v[68:71], a[160:163], a[132:135], v[68:71]
    v_mfma_f32_16x16x32_bf16 v[72:75], a[160:163], a[136:139], v[72:75]
    v_mfma_f32_16x16x32_bf16 v[76:79], a[160:163], a[140:143], v[76:79]
    v_mfma_f32_16x16x32_bf16 v[92:95], a[164:167], a[140:143], v[92:95]
    v_mfma_f32_16x16x32_bf16 v[88:91], a[164:167], a[136:139], v[88:91]
    v_mfma_f32_16x16x32_bf16 v[84:87], a[164:167], a[132:135], v[84:87]
    buffer_load_dwordx4 v11, s[4:7], s63 offen offset:1024 lds
    v_mfma_f32_16x16x32_bf16 v[80:83], a[164:167], a[128:131], v[80:83]
    v_mfma_f32_16x16x32_bf16 v[64:67], a[240:243], a[0:3], v[64:67]
    v_mfma_f32_16x16x32_bf16 v[68:71], a[240:243], a[4:7], v[68:71]
    v_mfma_f32_16x16x32_bf16 v[72:75], a[240:243], a[8:11], v[72:75]
    v_mfma_f32_16x16x32_bf16 v[76:79], a[240:243], a[12:15], v[76:79]
    v_mfma_f32_16x16x32_bf16 v[92:95], a[244:247], a[12:15], v[92:95]
    s_add_u32 m0, s2, 49152
    s_sub_u32 s63, 21020672, s0
    buffer_load_dwordx4 v11, s[4:7], s63 offen offset:0 lds
    v_mfma_f32_16x16x32_bf16 v[88:91], a[244:247], a[8:11], v[88:91]
    v_mfma_f32_16x16x32_bf16 v[84:87], a[244:247], a[4:7], v[84:87]
    v_mfma_f32_16x16x32_bf16 v[80:83], a[244:247], a[0:3], v[80:83]
    v_mfma_f32_16x16x32_bf16 v[64:67], a[248:251], a[16:19], v[64:67]
    v_mfma_f32_16x16x32_bf16 v[68:71], a[248:251], a[20:23], v[68:71]
    v_mfma_f32_16x16x32_bf16 v[72:75], a[248:251], a[192:195], v[72:75]
    buffer_load_dwordx4 v11, s[4:7], s63 offen offset:1024 lds
    v_mfma_f32_16x16x32_bf16 v[76:79], a[248:251], a[196:199], v[76:79]
    v_mfma_f32_16x16x32_bf16 v[92:95], a[252:255], a[196:199], v[92:95]
    v_mfma_f32_16x16x32_bf16 v[88:91], a[252:255], a[192:195], v[88:91]
    v_mfma_f32_16x16x32_bf16 v[84:87], a[252:255], a[20:23], v[84:87]
    v_mfma_f32_16x16x32_bf16 v[80:83], a[252:255], a[16:19], v[80:83]
    s_nop 3
    v_max3_f32 v199, v76, v77, v78
    v_max3_f32 v199, v199, v79, v92
    v_max3_f32 v199, v199, v93, v94
    v_max_f32 v199, v199, v95
    v_min3_f32 v203, v76, v77, v78
    v_min3_f32 v203, v203, v79, v92
    v_min3_f32 v203, v203, v93, v94
    v_min_f32 v203, v203, v95
    v_max3_f32 v198, v72, v73, v74
    v_max3_f32 v198, v198, v75, v88
    v_max3_f32 v198, v198, v89, v90
    v_max_f32 v198, v198, v91
    v_min3_f32 v202, v72, v73, v74
    v_min3_f32 v202, v202, v75, v88
    v_min3_f32 v202, v202, v89, v90
    v_min_f32 v202, v202, v91
    v_max3_f32 v197, v68, v69, v70
    v_max3_f32 v197, v197, v71, v84
    v_max3_f32 v197, v197, v85, v86
    v_max_f32 v197, v197, v87
    v_min3_f32 v201, v68, v69, v70
    v_min3_f32 v201, v201, v71, v84
    v_min3_f32 v201, v201, v85, v86
    v_min_f32 v201, v201, v87
    v_max3_f32 v196, v64, v65, v66
    v_max3_f32 v196, v196, v67, v80
    v_max3_f32 v196, v196, v81, v82
    v_max_f32 v196, v196, v83
    v_min3_f32 v200, v64, v65, v66
    v_min3_f32 v200, v200, v67, v80
    v_min3_f32 v200, v200, v81, v82
    v_min_f32 v200, v200, v83
    v_permlane32_swap_b32 v196, v197
    v_permlane32_swap_b32 v198, v199
    v_permlane32_swap_b32 v200, v201
    v_permlane32_swap_b32 v202, v203
    v_max_f32 v196, v196, v197
    v_max_f32 v198, v198, v199
    v_min_f32 v200, v200, v201
    v_min_f32 v202, v202, v203
    v_permlane16_swap_b32 v196, v198
    s_nop 0
    v_permlane16_swap_b32 v200, v202
    v_max_f32 v197, v196, v198
    v_max_f32 v198, v196, v198
    v_min_f32 v201, v200, v202
    v_min_f32 v202, v200, v202
    v_permlane16_swap_b32 v197, v198
    s_nop 0
    v_permlane16_swap_b32 v201, v202
    v_mov_b32 v196, v197
    v_mov_b32 v199, v198
    v_mov_b32 v200, v201
    v_mov_b32 v203, v202
    v_permlane32_swap_b32 v196, v197
    v_permlane32_swap_b32 v198, v199
    v_permlane32_swap_b32 v200, v201
    v_permlane32_swap_b32 v202, v203
    v_mul_f32 v196, -v196, v220
    v_mul_f32 v200, v200, v220
    v_mul_f32 v197, -v197, v221
    v_mul_f32 v201, v201, v221
    v_mul_f32 v198, -v198, v222
    v_mul_f32 v202, v202, v222
    v_mul_f32 v199, -v199, v223
    v_mul_f32 v203, v203, v223
    v_pk_fma_f32 v[224:225], v[64:65], v[220:221], v[196:197] op_sel:[0,0,0] op_sel_hi:[1,0,0]
    v_pk_fma_f32 v[64:65], v[64:65], v[220:221], v[200:201] op_sel:[0,0,0] op_sel_hi:[1,0,0] neg_lo:[1,0,0] neg_hi:[1,0,0]
    v_pk_fma_f32 v[226:227], v[66:67], v[220:221], v[196:197] op_sel:[0,0,0] op_sel_hi:[1,0,0]
    v_pk_fma_f32 v[66:67], v[66:67], v[220:221], v[200:201] op_sel:[0,0,0] op_sel_hi:[1,0,0] neg_lo:[1,0,0] neg_hi:[1,0,0]
    v_pk_fma_f32 v[228:229], v[80:81], v[220:221], v[196:197] op_sel:[0,0,0] op_sel_hi:[1,0,0]
    v_pk_fma_f32 v[80:81], v[80:81], v[220:221], v[200:201] op_sel:[0,0,0] op_sel_hi:[1,0,0] neg_lo:[1,0,0] neg_hi:[1,0,0]
    v_pk_fma_f32 v[230:231], v[82:83], v[220:221], v[196:197] op_sel:[0,0,0] op_sel_hi:[1,0,0]
    v_pk_fma_f32 v[82:83], v[82:83], v[220:221], v[200:201] op_sel:[0,0,0] op_sel_hi:[1,0,0] neg_lo:[1,0,0] neg_hi:[1,0,0]
    v_pk_fma_f32 v[232:233], v[68:69], v[220:221], v[196:197] op_sel:[0,1,1] op_sel_hi:[1,1,1]
    v_pk_fma_f32 v[68:69], v[68:69], v[220:221], v[200:201] op_sel:[0,1,1] op_sel_hi:[1,1,1] neg_lo:[1,0,0] neg_hi:[1,0,0]
    v_pk_fma_f32 v[234:235], v[70:71], v[220:221], v[196:197] op_sel:[0,1,1] op_sel_hi:[1,1,1]
    v_pk_fma_f32 v[70:71], v[70:71], v[220:221], v[200:201] op_sel:[0,1,1] op_sel_hi:[1,1,1] neg_lo:[1,0,0] neg_hi:[1,0,0]
    v_pk_fma_f32 v[236:237], v[84:85], v[220:221], v[196:197] op_sel:[0,1,1] op_sel_hi:[1,1,1]
    v_pk_fma_f32 v[84:85], v[84:85], v[220:221], v[200:201] op_sel:[0,1,1] op_sel_hi:[1,1,1] neg_lo:[1,0,0] neg_hi:[1,0,0]
    v_pk_fma_f32 v[238:239], v[86:87], v[220:221], v[196:197] op_sel:[0,1,1] op_sel_hi:[1,1,1]
    v_pk_fma_f32 v[86:87], v[86:87], v[220:221], v[200:201] op_sel:[0,1,1] op_sel_hi:[1,1,1] neg_lo:[1,0,0] neg_hi:[1,0,0]
    v_pk_fma_f32 v[240:241], v[72:73], v[222:223], v[198:199] op_sel:[0,0,0] op_sel_hi:[1,0,0]
    v_pk_fma_f32 v[72:73], v[72:73], v[222:223], v[202:203] op_sel:[0,0,0] op_sel_hi:[1,0,0] neg_lo:[1,0,0] neg_hi:[1,0,0]
    v_pk_fma_f32 v[242:243], v[74:75], v[222:223], v[198:199] op_sel:[0,0,0] op_sel_hi:[1,0,0]
    v_pk_fma_f32 v[74:75], v[74:75], v[222:223], v[202:203] op_sel:[0,0,0] op_sel_hi:[1,0,0] neg_lo:[1,0,0] neg_hi:[1,0,0]
    v_pk_fma_f32 v[244:245], v[88:89], v[222:223], v[198:199] op_sel:[0,0,0] op_sel_hi:[1,0,0]
    v_pk_fma_f32 v[88:89], v[88:89], v[222:223], v[202:203] op_sel:[0,0,0] op_sel_hi:[1,0,0] neg_lo:[1,0,0] neg_hi:[1,0,0]
    v_pk_fma_f32 v[246:247], v[90:91], v[222:223], v[198:199] op_sel:[0,0,0] op_sel_hi:[1,0,0]
    v_pk_fma_f32 v[90:91], v[90:91], v[222:223], v[202:203] op_sel:[0,0,0] op_sel_hi:[1,0,0] neg_lo:[1,0,0] neg_hi:[1,0,0]
    v_pk_fma_f32 v[248:249], v[76:77], v[222:223], v[198:199] op_sel:[0,1,1] op_sel_hi:[1,1,1]
    v_pk_fma_f32 v[76:77], v[76:77], v[222:223], v[202:203] op_sel:[0,1,1] op_sel_hi:[1,1,1] neg_lo:[1,0,0] neg_hi:[1,0,0]
    v_pk_fma_f32 v[250:251], v[78:79], v[222:223], v[198:199] op_sel:[0,1,1] op_sel_hi:[1,1,1]
    v_pk_fma_f32 v[78:79], v[78:79], v[222:223], v[202:203] op_sel:[0,1,1] op_sel_hi:[1,1,1] neg_lo:[1,0,0] neg_hi:[1,0,0]
    v_pk_fma_f32 v[252:253], v[92:93], v[222:223], v[198:199] op_sel:[0,1,1] op_sel_hi:[1,1,1]
    v_pk_fma_f32 v[92:93], v[92:93], v[222:223], v[202:203] op_sel:[0,1,1] op_sel_hi:[1,1,1] neg_lo:[1,0,0] neg_hi:[1,0,0]
    v_pk_fma_f32 v[254:255], v[94:95], v[222:223], v[198:199] op_sel:[0,1,1] op_sel_hi:[1,1,1]
    v_pk_fma_f32 v[94:95], v[94:95], v[222:223], v[202:203] op_sel:[0,1,1] op_sel_hi:[1,1,1] neg_lo:[1,0,0] neg_hi:[1,0,0]
    v_exp_f32 v224, v224
    v_exp_f32 v225, v225
    v_exp_f32 v226, v226
    v_exp_f32 v227, v227
    v_exp_f32 v228, v228
    v_exp_f32 v229, v229
    v_exp_f32 v230, v230
    v_exp_f32 v231, v231
    v_exp_f32 v64, v64
    v_exp_f32 v65, v65
    v_exp_f32 v66, v66
    v_exp_f32 v67, v67
    v_exp_f32 v80, v80
    v_exp_f32 v81, v81
    v_exp_f32 v82, v82
    v_exp_f32 v83, v83
    v_cvt_pk_bf16_f32 v204, v224, v225
    v_cvt_pk_bf16_f32 v205, v226, v227
    v_cvt_pk_bf16_f32 v206, v228, v229
    v_cvt_pk_bf16_f32 v207, v230, v231
    v_cvt_pk_bf16_f32 v136, v64, v65
    v_cvt_pk_bf16_f32 v137, v66, v67
    v_cvt_pk_bf16_f32 v138, v80, v81
    v_cvt_pk_bf16_f32 v139, v82, v83
    v_mfma_f32_16x16x32_bf16 v[152:155], v[40:43], v[204:207], 0
    s_nop 0
    v_mfma_f32_16x16x32_bf16 v[156:159], v[40:43], v[136:139], 0
    s_add_u32 s19, s58, s87
    buffer_load_dwordx4 v[96:99], v1, s[4:7], s19 offen sc1
    s_add_u32 s19, s58, s88
    buffer_load_dwordx4 v[100:103], v1, s[4:7], s19 offen sc1
    s_add_u32 s19, s58, s89
    buffer_load_dwordx4 v[104:107], v1, s[4:7], s19 offen sc1
    s_add_u32 s19, s58, s90
    buffer_load_dwordx4 v[108:111], v1, s[4:7], s19 offen sc1
    s_add_u32 s19, s58, s91
    buffer_load_dwordx4 v[112:115], v1, s[4:7], s19 offen sc1
    s_add_u32 s19, s58, s92
    buffer_load_dwordx4 v[116:119], v1, s[4:7], s19 offen sc1
    s_add_u32 s19, s58, s93
    buffer_load_dwordx4 v[120:123], v1, s[4:7], s19 offen sc1
    buffer_load_dwordx4 v[192:195], v62, s[4:7], s59 offen sc1
    v_exp_f32 v232, v232
    v_exp_f32 v233, v233
    v_exp_f32 v234, v234
    v_exp_f32 v235, v235
    v_exp_f32 v236, v236
    v_exp_f32 v237, v237
    v_exp_f32 v238, v238
    v_exp_f32 v239, v239
    v_exp_f32 v68, v68
    v_exp_f32 v69, v69
    v_exp_f32 v70, v70
    v_exp_f32 v71, v71
    v_exp_f32 v84, v84
    v_exp_f32 v85, v85
    v_exp_f32 v86, v86
    v_exp_f32 v87, v87
    v_rcp_f32 v184, v152
    v_rcp_f32 v185, v156
    s_nop 0
    v_pk_mul_f32 v[224:225], v[224:225], v[184:185] op_sel:[0,0] op_sel_hi:[1,0]
    v_pk_mul_f32 v[226:227], v[226:227], v[184:185] op_sel:[0,0] op_sel_hi:[1,0]
    v_pk_mul_f32 v[228:229], v[228:229], v[184:185] op_sel:[0,0] op_sel_hi:[1,0]
    v_pk_mul_f32 v[230:231], v[230:231], v[184:185] op_sel:[0,0] op_sel_hi:[1,0]
    v_cvt_pk_bf16_f32 v204, v224, v225
    v_cvt_pk_bf16_f32 v205, v226, v227
    v_cvt_pk_bf16_f32 v206, v228, v229
    v_cvt_pk_bf16_f32 v207, v230, v231
    v_pk_mul_f32 v[64:65], v[64:65], v[184:185] op_sel:[0,1] op_sel_hi:[1,1]
    v_pk_mul_f32 v[66:67], v[66:67], v[184:185] op_sel:[0,1] op_sel_hi:[1,1]
    v_pk_mul_f32 v[80:81], v[80:81], v[184:185] op_sel:[0,1] op_sel_hi:[1,1]
    v_pk_mul_f32 v[82:83], v[82:83], v[184:185] op_sel:[0,1] op_sel_hi:[1,1]
    v_cvt_pk_bf16_f32 v136, v64, v65
    v_cvt_pk_bf16_f32 v137, v66, v67
    v_cvt_pk_bf16_f32 v138, v80, v81
    v_cvt_pk_bf16_f32 v139, v82, v83
    v_cvt_pk_bf16_f32 v208, v232, v233
    v_cvt_pk_bf16_f32 v209, v234, v235
    v_cvt_pk_bf16_f32 v210, v236, v237
    v_cvt_pk_bf16_f32 v211, v238, v239
    v_cvt_pk_bf16_f32 v140, v68, v69
    v_cvt_pk_bf16_f32 v141, v70, v71
    v_cvt_pk_bf16_f32 v142, v84, v85
    v_cvt_pk_bf16_f32 v143, v86, v87
    v_mfma_f32_16x16x32_bf16 v[176:179], v[40:43], v[208:211], 0
    s_nop 0
    v_mfma_f32_16x16x32_bf16 v[180:183], v[40:43], v[140:143], 0
    v_exp_f32 v240, v240
    v_exp_f32 v241, v241
    v_exp_f32 v242, v242
    v_exp_f32 v243, v243
    v_exp_f32 v244, v244
    v_exp_f32 v245, v245
    v_exp_f32 v246, v246
    v_exp_f32 v247, v247
    v_exp_f32 v72, v72
    v_exp_f32 v73, v73
    v_exp_f32 v74, v74
    v_exp_f32 v75, v75
    v_exp_f32 v88, v88
    v_exp_f32 v89, v89
    v_exp_f32 v90, v90
    v_exp_f32 v91, v91
    v_rcp_f32 v186, v176
    v_rcp_f32 v187, v180
    s_nop 0
    v_pk_mul_f32 v[232:233], v[232:233], v[186:187] op_sel:[0,0] op_sel_hi:[1,0]
    v_pk_mul_f32 v[234:235], v[234:235], v[186:187] op_sel:[0,0] op_sel_hi:[1,0]
    v_pk_mul_f32 v[236:237], v[236:237], v[186:187] op_sel:[0,0] op_sel_hi:[1,0]
    v_pk_mul_f32 v[238:239], v[238:239], v[186:187] op_sel:[0,0] op_sel_hi:[1,0]
    v_cvt_pk_bf16_f32 v208, v232, v233
    v_cvt_pk_bf16_f32 v209, v234, v235
    v_cvt_pk_bf16_f32 v210, v236, v237
    v_cvt_pk_bf16_f32 v211, v238, v239
    v_pk_mul_f32 v[68:69], v[68:69], v[186:187] op_sel:[0,1] op_sel_hi:[1,1]
    v_pk_mul_f32 v[70:71], v[70:71], v[186:187] op_sel:[0,1] op_sel_hi:[1,1]
    v_pk_mul_f32 v[84:85], v[84:85], v[186:187] op_sel:[0,1] op_sel_hi:[1,1]
    v_pk_mul_f32 v[86:87], v[86:87], v[186:187] op_sel:[0,1] op_sel_hi:[1,1]
    v_cvt_pk_bf16_f32 v140, v68, v69
    v_cvt_pk_bf16_f32 v141, v70, v71
    v_cvt_pk_bf16_f32 v142, v84, v85
    v_cvt_pk_bf16_f32 v143, v86, v87
    v_cvt_pk_bf16_f32 v212, v240, v241
    v_cvt_pk_bf16_f32 v213, v242, v243
    v_cvt_pk_bf16_f32 v214, v244, v245
    v_cvt_pk_bf16_f32 v215, v246, v247
    v_cvt_pk_bf16_f32 v144, v72, v73
    v_cvt_pk_bf16_f32 v145, v74, v75
    v_cvt_pk_bf16_f32 v146, v88, v89
    v_cvt_pk_bf16_f32 v147, v90, v91
    v_mfma_f32_16x16x32_bf16 v[152:155], v[40:43], v[212:215], 0
    s_nop 0
    v_mfma_f32_16x16x32_bf16 v[156:159], v[40:43], v[144:147], 0
    v_exp_f32 v248, v248
    v_exp_f32 v249, v249
    v_exp_f32 v250, v250
    v_exp_f32 v251, v251
    v_exp_f32 v252, v252
    v_exp_f32 v253, v253
    v_exp_f32 v254, v254
    v_exp_f32 v255, v255
    v_exp_f32 v76, v76
    v_exp_f32 v77, v77
    v_exp_f32 v78, v78
    v_exp_f32 v79, v79
    v_exp_f32 v92, v92
    v_exp_f32 v93, v93
    v_exp_f32 v94, v94
    v_exp_f32 v95, v95
    v_cvt_pk_bf16_f32 v216, v248, v249
    v_cvt_pk_bf16_f32 v217, v250, v251
    v_cvt_pk_bf16_f32 v218, v252, v253
    v_cvt_pk_bf16_f32 v219, v254, v255
    v_cvt_pk_bf16_f32 v148, v76, v77
    v_cvt_pk_bf16_f32 v149, v78, v79
    v_cvt_pk_bf16_f32 v150, v92, v93
    v_cvt_pk_bf16_f32 v151, v94, v95
    v_mfma_f32_16x16x32_bf16 v[176:179], v[40:43], v[216:219], 0
    s_nop 0
    v_mfma_f32_16x16x32_bf16 v[180:183], v[40:43], v[148:151], 0
    s_andn2_b64 s[20:21], s[40:41], s[38:39]
    s_and_b64 s[22:23], s[40:41], s[38:39]
    v_or_b32 v128, v46, v44
    v_and_b32 v128, v128, v40
    v_cndmask_b32 v130, 0, v128, s[20:21]
    v_cndmask_b32 v131, 0, v128, s[22:23]
    v_mov_b32 v128, 0
    v_mov_b32 v129, 0
    v_mov_b32 v132, 0
    v_mov_b32 v133, 0
    v_rcp_f32 v188, v152
    v_rcp_f32 v189, v156
    s_nop 0
    v_pk_mul_f32 v[240:241], v[240:241], v[188:189] op_sel:[0,0] op_sel_hi:[1,0]
    v_pk_mul_f32 v[242:243], v[242:243], v[188:189] op_sel:[0,0] op_sel_hi:[1,0]
    v_pk_mul_f32 v[244:245], v[244:245], v[188:189] op_sel:[0,0] op_sel_hi:[1,0]
    v_pk_mul_f32 v[246:247], v[246:247], v[188:189] op_sel:[0,0] op_sel_hi:[1,0]
    v_cvt_pk_bf16_f32 v212, v240, v241
    v_cvt_pk_bf16_f32 v213, v242, v243
    v_cvt_pk_bf16_f32 v214, v244, v245
    v_cvt_pk_bf16_f32 v215, v246, v247
    v_pk_mul_f32 v[72:73], v[72:73], v[188:189] op_sel:[0,1] op_sel_hi:[1,1]
    v_pk_mul_f32 v[74:75], v[74:75], v[188:189] op_sel:[0,1] op_sel_hi:[1,1]
    v_pk_mul_f32 v[88:89], v[88:89], v[188:189] op_sel:[0,1] op_sel_hi:[1,1]
    v_pk_mul_f32 v[90:91], v[90:91], v[188:189] op_sel:[0,1] op_sel_hi:[1,1]
    v_cvt_pk_bf16_f32 v144, v72, v73
    v_cvt_pk_bf16_f32 v145, v74, v75
    v_cvt_pk_bf16_f32 v146, v88, v89
    v_cvt_pk_bf16_f32 v147, v90, v91
    v_rcp_f32 v190, v176
    v_rcp_f32 v191, v180
    s_nop 0
    v_pk_mul_f32 v[248:249], v[248:249], v[190:191] op_sel:[0,0] op_sel_hi:[1,0]
    v_pk_mul_f32 v[250:251], v[250:251], v[190:191] op_sel:[0,0] op_sel_hi:[1,0]
    v_pk_mul_f32 v[252:253], v[252:253], v[190:191] op_sel:[0,0] op_sel_hi:[1,0]
    v_pk_mul_f32 v[254:255], v[254:255], v[190:191] op_sel:[0,0] op_sel_hi:[1,0]
    v_cvt_pk_bf16_f32 v216, v248, v249
    v_cvt_pk_bf16_f32 v217, v250, v251
    v_cvt_pk_bf16_f32 v218, v252, v253
    v_cvt_pk_bf16_f32 v219, v254, v255
    v_pk_mul_f32 v[76:77], v[76:77], v[190:191] op_sel:[0,1] op_sel_hi:[1,1]
    v_pk_mul_f32 v[78:79], v[78:79], v[190:191] op_sel:[0,1] op_sel_hi:[1,1]
    v_pk_mul_f32 v[92:93], v[92:93], v[190:191] op_sel:[0,1] op_sel_hi:[1,1]
    v_pk_mul_f32 v[94:95], v[94:95], v[190:191] op_sel:[0,1] op_sel_hi:[1,1]
    v_cvt_pk_bf16_f32 v148, v76, v77
    v_cvt_pk_bf16_f32 v149, v78, v79
    v_cvt_pk_bf16_f32 v150, v92, v93
    v_cvt_pk_bf16_f32 v151, v94, v95
    s_mov_b32 s61, 1048576
    s_waitcnt vmcnt(7)
L_kvc2_0:
    v_cmp_eq_u32 vcc, -1, v96
    s_cbranch_vccnz L_kvs2_0
L_kvo2_0:
    v_mfma_f32_16x16x32_bf16 v[168:171], v[130:133], v[96:99], v[168:171]
    v_mfma_f32_16x16x32_bf16 v[172:175], v[128:131], v[96:99], v[172:175]
    s_waitcnt vmcnt(6)
L_kvc2_1:
    v_cmp_eq_u32 vcc, -1, v100
    s_cbranch_vccnz L_kvs2_1
L_kvo2_1:
    v_mfma_f32_16x16x32_bf16 v[168:171], v[130:133], v[100:103], v[168:171]
    v_mfma_f32_16x16x32_bf16 v[172:175], v[128:131], v[100:103], v[172:175]
    s_waitcnt vmcnt(5)
L_kvc2_2:
    v_cmp_eq_u32 vcc, -1, v104
    s_cbranch_vccnz L_kvs2_2
L_kvo2_2:
    v_mfma_f32_16x16x32_bf16 v[168:171], v[130:133], v[104:107], v[168:171]
    v_mfma_f32_16x16x32_bf16 v[172:175], v[128:131], v[104:107], v[172:175]
    s_waitcnt vmcnt(4)
L_kvc2_3:
    v_cmp_eq_u32 vcc, -1, v108
    s_cbranch_vccnz L_kvs2_3
L_kvo2_3:
    v_mfma_f32_16x16x32_bf16 v[168:171], v[130:133], v[108:111], v[168:171]
    v_mfma_f32_16x16x32_bf16 v[172:175], v[128:131], v[108:111], v[172:175]
    s_waitcnt vmcnt(3)
L_kvc2_4:
    v_cmp_eq_u32 vcc, -1, v112
    s_cbranch_vccnz L_kvs2_4
L_kvo2_4:
    v_mfma_f32_16x16x32_bf16 v[168:171], v[130:133], v[112:115], v[168:171]
    v_mfma_f32_16x16x32_bf16 v[172:175], v[128:131], v[112:115], v[172:175]
    s_waitcnt vmcnt(2)
L_kvc2_5:
    v_cmp_eq_u32 vcc, -1, v116
    s_cbranch_vccnz L_kvs2_5
L_kvo2_5:
    v_mfma_f32_16x16x32_bf16 v[168:171], v[130:133], v[116:119], v[168:171]
    v_mfma_f32_16x16x32_bf16 v[172:175], v[128:131], v[116:119], v[172:175]
    s_waitcnt vmcnt(1)
L_kvc2_6:
    v_cmp_eq_u32 vcc, -1, v120
    s_cbranch_vccnz L_kvs2_6
L_kvo2_6:
    v_mfma_f32_16x16x32_bf16 v[168:171], v[130:133], v[120:123], v[168:171]
    v_mfma_f32_16x16x32_bf16 v[172:175], v[128:131], v[120:123], v[172:175]
    s_waitcnt vmcnt(0)
L_kvc2_7:
    v_cmp_eq_u32 vcc, -1, v192
    s_cbranch_vccnz L_kvs2_7
L_kvo2_7:
    v_add_f32_dpp v192, v192, v192 row_ror:4 row_mask:0xf bank_mask:0xf
    v_add_f32_dpp v193, v193, v193 row_ror:4 row_mask:0xf bank_mask:0xf
    v_add_f32_dpp v194, v194, v194 row_ror:4 row_mask:0xf bank_mask:0xf
    v_add_f32_dpp v195, v195, v195 row_ror:4 row_mask:0xf bank_mask:0xf
    v_add_f32_dpp v192, v192, v192 row_ror:2 row_mask:0xf bank_mask:0xf
    v_add_f32_dpp v193, v193, v193 row_ror:2 row_mask:0xf bank_mask:0xf
    v_add_f32_dpp v194, v194, v194 row_ror:2 row_mask:0xf bank_mask:0xf
    v_add_f32_dpp v195, v195, v195 row_ror:2 row_mask:0xf bank_mask:0xf
    v_cvt_pk_bf16_f32 v196, v168, v169
    v_cvt_pk_bf16_f32 v197, v170, v171
    v_cvt_pk_bf16_f32 v198, v172, v173
    v_cvt_pk_bf16_f32 v199, v174, v175
    ds_write_b64 v36, v[196:197]
    ds_write_b64 v37, v[198:199]
    v_add_f32_dpp v192, v192, v192 row_ror:1 row_mask:0xf bank_mask:0xf
    v_add_f32_dpp v193, v193, v193 row_ror:1 row_mask:0xf bank_mask:0xf
    v_add_f32_dpp v194, v194, v194 row_ror:1 row_mask:0xf bank_mask:0xf
    v_add_f32_dpp v195, v195, v195 row_ror:1 row_mask:0xf bank_mask:0xf
    v_cvt_pk_bf16_f32 v192, v192, v193
    v_cvt_pk_bf16_f32 v193, v194, v195
    s_mov_b64 exec, s[42:43]
    ds_write_b64 v57, v[192:193] offset:10240
    s_mov_b64 exec, -1
    s_waitcnt lgkmcnt(0)
    s_barrier
    ds_read_b128 v[184:187], v56 offset:10240
    ds_read_b128 v[188:191], v56 offset:10304
    ds_read_b128 v[168:171], v3 offset:20480
    ds_read_b128 v[172:175], v3 offset:21504
    ds_read_b128 v[176:179], v3 offset:22528
    ds_read_b128 v[180:183], v3 offset:23552
    s_waitcnt lgkmcnt(4)
    v_mfma_f32_16x16x32_bf16 v[64:67], v[184:187], v[204:207], 0
    v_mfma_f32_16x16x32_bf16 v[68:71], v[184:187], v[208:211], 0
    v_mfma_f32_16x16x32_bf16 v[72:75], v[184:187], v[212:215], 0
    v_mfma_f32_16x16x32_bf16 v[76:79], v[184:187], v[216:219], 0
    v_mfma_f32_16x16x32_bf16 v[64:67], v[188:191], v[136:139], v[64:67]
    v_mfma_f32_16x16x32_bf16 v[68:71], v[188:191], v[140:143], v[68:71]
    v_mfma_f32_16x16x32_bf16 v[72:75], v[188:191], v[144:147], v[72:75]
    v_mfma_f32_16x16x32_bf16 v[76:79], v[188:191], v[148:151], v[76:79]
    s_waitcnt lgkmcnt(0)
    v_mfma_f32_16x16x32_bf16 v[96:99], v[168:171], v[204:207], 0
    v_mfma_f32_16x16x32_bf16 v[100:103], v[172:175], v[204:207], 0
    v_mfma_f32_16x16x32_bf16 v[96:99], v[176:179], v[136:139], v[96:99]
    v_mfma_f32_16x16x32_bf16 v[100:103], v[180:183], v[136:139], v[100:103]
    v_mfma_f32_16x16x32_bf16 v[104:107], v[168:171], v[208:211], 0
    v_add_f32 v64, 0x358637bd, v64
    v_rcp_f32 v64, v64
    v_mfma_f32_16x16x32_bf16 v[108:111], v[172:175], v[208:211], 0
    v_add_f32 v68, 0x358637bd, v68
    v_rcp_f32 v68, v68
    v_mfma_f32_16x16x32_bf16 v[104:107], v[176:179], v[140:143], v[104:107]
    v_add_f32 v72, 0x358637bd, v72
    v_rcp_f32 v72, v72
    v_mfma_f32_16x16x32_bf16 v[108:111], v[180:183], v[140:143], v[108:111]
    v_add_f32 v76, 0x358637bd, v76
    v_rcp_f32 v76, v76
    v_mfma_f32_16x16x32_bf16 v[112:115], v[168:171], v[212:215], 0
    v_mul_f32 v96, v96, v64
    v_mul_f32 v97, v97, v64
    v_mul_f32 v98, v98, v64
    v_mfma_f32_16x16x32_bf16 v[116:119], v[172:175], v[212:215], 0
    v_mul_f32 v99, v99, v64
    v_mul_f32 v100, v100, v64
    v_mul_f32 v101, v101, v64
    v_mfma_f32_16x16x32_bf16 v[112:115], v[176:179], v[144:147], v[112:115]
    v_mul_f32 v102, v102, v64
    v_mul_f32 v103, v103, v64
    v_cvt_pk_bf16_f32 v224, v96, v97
    v_mfma_f32_16x16x32_bf16 v[116:119], v[180:183], v[144:147], v[116:119]
    v_cvt_pk_bf16_f32 v225, v98, v99
    v_cvt_pk_bf16_f32 v226, v100, v101
    v_cvt_pk_bf16_f32 v227, v102, v103
    s_cmp_lg_u32 s15, 0
    s_cbranch_scc1 L_slow_57
    buffer_store_dwordx4 v[224:227], v4, s[4:7], s34 offen
L_done_58:
    v_mfma_f32_16x16x32_bf16 v[120:123], v[168:171], v[216:219], 0
    v_mul_f32 v104, v104, v68
    v_mul_f32 v105, v105, v68
    v_mul_f32 v106, v106, v68
    v_mfma_f32_16x16x32_bf16 v[124:127], v[172:175], v[216:219], 0
    v_mul_f32 v107, v107, v68
    v_mul_f32 v108, v108, v68
    v_mul_f32 v109, v109, v68
    v_mfma_f32_16x16x32_bf16 v[120:123], v[176:179], v[148:151], v[120:123]
    v_mul_f32 v110, v110, v68
    v_mul_f32 v111, v111, v68
    v_cvt_pk_bf16_f32 v228, v104, v105
    v_mfma_f32_16x16x32_bf16 v[124:127], v[180:183], v[148:151], v[124:127]
    v_cvt_pk_bf16_f32 v229, v106, v107
    v_cvt_pk_bf16_f32 v230, v108, v109
    v_cvt_pk_bf16_f32 v231, v110, v111
    s_cmp_lg_u32 s15, 0
    s_cbranch_scc1 L_slow_59
    buffer_store_dwordx4 v[228:231], v5, s[4:7], s34 offen
L_done_60:
    v_pk_mul_f32 v[112:113], v[112:113], v[72:73] op_sel:[0,0] op_sel_hi:[1,0]
    v_pk_mul_f32 v[114:115], v[114:115], v[72:73] op_sel:[0,0] op_sel_hi:[1,0]
    v_pk_mul_f32 v[116:117], v[116:117], v[72:73] op_sel:[0,0] op_sel_hi:[1,0]
    v_pk_mul_f32 v[118:119], v[118:119], v[72:73] op_sel:[0,0] op_sel_hi:[1,0]
    v_cvt_pk_bf16_f32 v232, v112, v113
    v_cvt_pk_bf16_f32 v233, v114, v115
    v_cvt_pk_bf16_f32 v234, v116, v117
    v_cvt_pk_bf16_f32 v235, v118, v119
    s_cmp_lg_u32 s15, 0
    s_cbranch_scc1 L_slow_61
    buffer_store_dwordx4 v[232:235], v6, s[4:7], s34 offen
L_done_62:
    v_pk_mul_f32 v[120:121], v[120:121], v[76:77] op_sel:[0,0] op_sel_hi:[1,0]
    v_pk_mul_f32 v[122:123], v[122:123], v[76:77] op_sel:[0,0] op_sel_hi:[1,0]
    v_pk_mul_f32 v[124:125], v[124:125], v[76:77] op_sel:[0,0] op_sel_hi:[1,0]
    v_pk_mul_f32 v[126:127], v[126:127], v[76:77] op_sel:[0,0] op_sel_hi:[1,0]
    v_cvt_pk_bf16_f32 v236, v120, v121
    v_cvt_pk_bf16_f32 v237, v122, v123
    v_cvt_pk_bf16_f32 v238, v124, v125
    v_cvt_pk_bf16_f32 v239, v126, v127
    s_cmp_lg_u32 s15, 0
    s_cbranch_scc1 L_slow_63
    buffer_store_dwordx4 v[236:239], v7, s[4:7], s34 offen
L_done_64:
    v_mov_b32 v63, 3
    v_lshlrev_b32 v64, 16, v16
    v_and_b32 v65, 0xffff0000, v16
    v_lshlrev_b32 v66, 16, v17
    buffer_load_dword v216, v12, s[4:7], s30 offen sc1
    v_and_b32 v67, 0xffff0000, v17
    v_lshlrev_b32 v72, 16, v18
    v_and_b32 v73, 0xffff0000, v18
    v_lshlrev_b32 v74, 16, v19
    v_and_b32 v75, 0xffff0000, v19
    v_lshlrev_b32 v80, 16, v20
    v_and_b32 v81, 0xffff0000, v20
    v_lshlrev_b32 v82, 16, v21
    v_and_b32 v83, 0xffff0000, v21
    v_lshlrev_b32 v88, 16, v22
    v_and_b32 v89, 0xffff0000, v22
    v_lshlrev_b32 v90, 16, v23
    v_and_b32 v91, 0xffff0000, v23
    v_lshlrev_b32 v68, 16, v24
    v_and_b32 v69, 0xffff0000, v24
    v_lshlrev_b32 v70, 16, v25
    v_and_b32 v71, 0xffff0000, v25
    v_lshlrev_b32 v76, 16, v26
    v_and_b32 v77, 0xffff0000, v26
    v_lshlrev_b32 v78, 16, v27
    v_and_b32 v79, 0xffff0000, v27
    v_lshlrev_b32 v84, 16, v28
    v_and_b32 v85, 0xffff0000, v28
    v_lshlrev_b32 v86, 16, v29
    v_and_b32 v87, 0xffff0000, v29
    v_lshlrev_b32 v92, 16, v30
    v_and_b32 v93, 0xffff0000, v30
    v_lshlrev_b32 v94, 16, v31
    v_and_b32 v95, 0xffff0000, v31
    s_mov_b64 exec, 1
    s_waitcnt vmcnt(1)
    s_cmp_lg_u32 s15, 0
    s_cbranch_scc1 L_slow_66
    buffer_store_dword v63, off, s[4:7], s31
L_done_67:
    s_mov_b64 exec, -1
    s_waitcnt vmcnt(1)
    s_mov_b64 exec, s[82:83]
    v_cmp_gt_u32 vcc, 3, v216
    s_mov_b64 exec, -1
    s_cbranch_vccz L_hd_65
    s_mov_b32 s61, 1048576
L_spin_68:
    buffer_load_dword v216, v12, s[4:7], s30 offen sc1
    s_sub_u32 s61, s61, 1
    s_waitcnt vmcnt(0)
    s_mov_b64 exec, 63
    v_cmp_gt_u32 vcc, 3, v216
    s_mov_b64 exec, -1
    s_cbranch_scc1 L_spind_69
    s_cbranch_vccnz L_spin_68
L_spind_69:
L_hd_65:
    s_mov_b32 s62, 29360128
    buffer_load_dwordx4 a[80:83], v8, s[4:7], s62 offen offset:0 sc1
    buffer_load_dwordx4 a[84:87], v9, s[4:7], s62 offen offset:0 sc1
    buffer_load_dwordx4 a[88:91], v8, s[4:7], s62 offen offset:1024 sc1
    buffer_load_dword v216, v12, s[4:7], s30 offen sc1
    buffer_load_dwordx4 a[92:95], v9, s[4:7], s62 offen offset:1024 sc1
    buffer_load_dwordx4 a[96:99], v8, s[4:7], s62 offen offset:2048 sc1
    buffer_load_dwordx4 a[100:103], v9, s[4:7], s62 offen offset:2048 sc1
    buffer_load_dwordx4 a[104:107], v8, s[4:7], s62 offen offset:3072 sc1
    buffer_load_dwordx4 a[108:111], v9, s[4:7], s62 offen offset:3072 sc1
    s_mov_b32 s62, 29364224
    buffer_load_dwordx4 a[112:115], v8, s[4:7], s62 offen offset:0 sc1
    buffer_load_dwordx4 a[116:119], v9, s[4:7], s62 offen offset:0 sc1
    buffer_load_dwordx4 a[120:123], v8, s[4:7], s62 offen offset:1024 sc1
    buffer_load_dwordx4 a[124:127], v9, s[4:7], s62 offen offset:1024 sc1
    ds_read_b128 a[48:51], v1 offset:0
    ds_read_b128 a[52:55], v1 offset:1024
    ds_read_b128 a[56:59], v1 offset:2048
    ds_read_b128 a[60:63], v1 offset:3072
    ds_read_b128 a[64:67], v1 offset:4096
    ds_read_b128 a[68:71], v1 offset:5120
    ds_read_b128 a[72:75], v1 offset:6144
    ds_read_b128 a[76:79], v1 offset:7168
    s_waitcnt vmcnt(9)
    v_cmp_gt_u32 vcc, 3, v216
    s_cbranch_vccnz L_p2_70
L_p2_70_r:
    s_waitcnt lgkmcnt(7)
    v_mfma_f32_16x16x32_bf16 v[64:67], a[48:51], a[80:83], v[64:67]
    buffer_load_dwordx4 a[128:131], v8, s[4:7], s62 offen offset:2048 sc1
    v_mfma_f32_16x16x32_bf16 v[68:71], a[48:51], a[84:87], v[68:71]
    ds_read_b128 a[48:51], v1 offset:8192
    s_waitcnt lgkmcnt(7)
    v_mfma_f32_16x16x32_bf16 v[76:79], a[52:55], a[84:87], v[76:79]
    v_mfma_f32_16x16x32_bf16 v[72:75], a[52:55], a[80:83], v[72:75]
    ds_read_b128 a[52:55], v1 offset:9216
    s_waitcnt lgkmcnt(7)
    v_mfma_f32_16x16x32_bf16 v[80:83], a[56:59], a[80:83], v[80:83]
    buffer_load_dwordx4 a[132:135], v9, s[4:7], s62 offen offset:2048 sc1
    v_mfma_f32_16x16x32_bf16 v[84:87], a[56:59], a[84:87], v[84:87]
    ds_read_b128 a[56:59], v1 offset:10240
    s_waitcnt lgkmcnt(7)
    v_mfma_f32_16x16x32_bf16 v[92:95], a[60:63], a[84:87], v[92:95]
    v_mfma_f32_16x16x32_bf16 v[88:91], a[60:63], a[80:83], v[88:91]
    ds_read_b128 a[60:63], v1 offset:11264
    s_waitcnt vmcnt(10)
    s_waitcnt lgkmcnt(7)
    v_mfma_f32_16x16x32_bf16 v[64:67], a[64:67], a[88:91], v[64:67]
    buffer_load_dwordx4 a[80:83], v8, s[4:7], s62 offen offset:3072 sc1
    v_mfma_f32_16x16x32_bf16 v[68:71], a[64:67], a[92:95], v[68:71]
    ds_read_b128 a[64:67], v1 offset:12288
    s_waitcnt lgkmcnt(7)
    v_mfma_f32_16x16x32_bf16 v[76:79], a[68:71], a[92:95], v[76:79]
    v_mfma_f32_16x16x32_bf16 v[72:75], a[68:71], a[88:91], v[72:75]
    ds_read_b128 a[68:71], v1 offset:13312
    s_waitcnt lgkmcnt(7)
    v_mfma_f32_16x16x32_bf16 v[80:83], a[72:75], a[88:91], v[80:83]
    buffer_load_dwordx4 a[84:87], v9, s[4:7], s62 offen offset:3072 sc1
    v_mfma_f32_16x16x32_bf16 v[84:87], a[72:75], a[92:95], v[84:87]
    ds_read_b128 a[72:75], v1 offset:14336
    s_waitcnt lgkmcnt(7)
    v_mfma_f32_16x16x32_bf16 v[92:95], a[76:79], a[92:95], v[92:95]
    v_mfma_f32_16x16x32_bf16 v[88:91], a[76:79], a[88:91], v[88:91]
    ds_read_b128 a[76:79], v1 offset:15360
    s_waitcnt vmcnt(10)
    s_waitcnt lgkmcnt(7)
    v_mfma_f32_16x16x32_bf16 v[64:67], a[48:51], a[96:99], v[64:67]
    s_mov_b32 s62, 29368320
    buffer_load_dwordx4 a[88:91], v8, s[4:7], s62 offen offset:0 sc1
    v_mfma_f32_16x16x32_bf16 v[68:71], a[48:51], a[100:103], v[68:71]
    ds_read_b128 a[48:51], v1 offset:16384
    s_waitcnt lgkmcnt(7)
    v_mfma_f32_16x16x32_bf16 v[76:79], a[52:55], a[100:103], v[76:79]
    v_mfma_f32_16x16x32_bf16 v[72:75], a[52:55], a[96:99], v[72:75]
    ds_read_b128 a[52:55], v1 offset:17408
    s_waitcnt lgkmcnt(7)
    v_mfma_f32_16x16x32_bf16 v[80:83], a[56:59], a[96:99], v[80:83]
    buffer_load_dwordx4 a[92:95], v9, s[4:7], s62 offen offset:0 sc1
    v_mfma_f32_16x16x32_bf16 v[84:87], a[56:59], a[100:103], v[84:87]
    ds_read_b128 a[56:59], v1 offset:18432
    s_waitcnt lgkmcnt(7)
    v_mfma_f32_16x16x32_bf16 v[92:95], a[60:63], a[100:103], v[92:95]
    v_mfma_f32_16x16x32_bf16 v[88:91], a[60:63], a[96:99], v[88:91]
    ds_read_b128 a[60:63], v1 offset:19456
    s_waitcnt vmcnt(10)
    s_waitcnt lgkmcnt(7)
    v_mfma_f32_16x16x32_bf16 v[64:67], a[64:67], a[104:107], v[64:67]
    buffer_load_dwordx4 a[96:99], v8, s[4:7], s62 offen offset:1024 sc1
    v_mfma_f32_16x16x32_bf16 v[68:71], a[64:67], a[108:111], v[68:71]
    ds_read_b128 a[64:67], v1 offset:20480
    s_waitcnt lgkmcnt(7)
    v_mfma_f32_16x16x32_bf16 v[76:79], a[68:71], a[108:111], v[76:79]
    v_mfma_f32_16x16x32_bf16 v[72:75], a[68:71], a[104:107], v[72:75]
    ds_read_b128 a[68:71], v1 offset:21504
    s_waitcnt lgkmcnt(7)
    v_mfma_f32_16x16x32_bf16 v[80:83], a[72:75], a[104:107], v[80:83]
    buffer_load_dwordx4 a[100:103], v9, s[4:7], s62 offen offset:1024 sc1
    v_mfma_f32_16x16x32_bf16 v[84:87], a[72:75], a[108:111], v[84:87]
    ds_read_b128 a[72:75], v1 offset:22528
    s_waitcnt lgkmcnt(7)
    v_mfma_f32_16x16x32_bf16 v[92:95], a[76:79], a[108:111], v[92:95]
    v_mfma_f32_16x16x32_bf16 v[88:91], a[76:79], a[104:107], v[88:91]
    ds_read_b128 a[76:79], v1 offset:23552
    s_waitcnt vmcnt(10)
    s_waitcnt lgkmcnt(7)
    v_mfma_f32_16x16x32_bf16 v[64:67], a[48:51], a[112:115], v[64:67]
    buffer_load_dwordx4 a[104:107], v8, s[4:7], s62 offen offset:2048 sc1
    v_mfma_f32_16x16x32_bf16 v[68:71], a[48:51], a[116:119], v[68:71]
    ds_read_b128 a[48:51], v1 offset:24576
    s_waitcnt lgkmcnt(7)
    v_mfma_f32_16x16x32_bf16 v[76:79], a[52:55], a[116:119], v[76:79]
    v_mfma_f32_16x16x32_bf16 v[72:75], a[52:55], a[112:115], v[72:75]
    ds_read_b128 a[52:55], v1 offset:25600
    s_waitcnt lgkmcnt(7)
    v_mfma_f32_16x16x32_bf16 v[80:83], a[56:59], a[112:115], v[80:83]
    buffer_load_dwordx4 a[108:111], v9, s[4:7], s62 offen offset:2048 sc1
    v_mfma_f32_16x16x32_bf16 v[84:87], a[56:59], a[116:119], v[84:87]
    ds_read_b128 a[56:59], v1 offset:26624
    s_waitcnt lgkmcnt(7)
    v_mfma_f32_16x16x32_bf16 v[92:95], a[60:63], a[116:119], v[92:95]
    v_mfma_f32_16x16x32_bf16 v[88:91], a[60:63], a[112:115], v[88:91]
    ds_read_b128 a[60:63], v1 offset:27648
    s_waitcnt vmcnt(10)
    s_waitcnt lgkmcnt(7)
    v_mfma_f32_16x16x32_bf16 v[64:67], a[64:67], a[120:123], v[64:67]
    buffer_load_dwordx4 a[112:115], v8, s[4:7], s62 offen offset:3072 sc1
    v_mfma_f32_16x16x32_bf16 v[68:71], a[64:67], a[124:127], v[68:71]
    ds_read_b128 a[64:67], v1 offset:28672
    s_waitcnt lgkmcnt(7)
    v_mfma_f32_16x16x32_bf16 v[76:79], a[68:71], a[124:127], v[76:79]
    v_mfma_f32_16x16x32_bf16 v[72:75], a[68:71], a[120:123], v[72:75]
    ds_read_b128 a[68:71], v1 offset:29696
    s_waitcnt lgkmcnt(7)
    v_mfma_f32_16x16x32_bf16 v[80:83], a[72:75], a[120:123], v[80:83]
    buffer_load_dwordx4 a[116:119], v9, s[4:7], s62 offen offset:3072 sc1
    v_mfma_f32_16x16x32_bf16 v[84:87], a[72:75], a[124:127], v[84:87]
    ds_read_b128 a[72:75], v1 offset:30720
    s_waitcnt lgkmcnt(7)
    v_mfma_f32_16x16x32_bf16 v[92:95], a[76:79], a[124:127], v[92:95]
    v_mfma_f32_16x16x32_bf16 v[88:91], a[76:79], a[120:123], v[88:91]
    ds_read_b128 a[76:79], v1 offset:31744
    s_waitcnt vmcnt(10)
    s_waitcnt lgkmcnt(7)
    v_mfma_f32_16x16x32_bf16 v[64:67], a[48:51], a[128:131], v[64:67]
    s_mov_b32 s62, 29372416
    buffer_load_dwordx4 a[120:123], v8, s[4:7], s62 offen offset:0 sc1
    v_mfma_f32_16x16x32_bf16 v[68:71], a[48:51], a[132:135], v[68:71]
    ds_read_b128 a[48:51], v1 offset:32768
    s_waitcnt lgkmcnt(7)
    v_mfma_f32_16x16x32_bf16 v[76:79], a[52:55], a[132:135], v[76:79]
    v_mfma_f32_16x16x32_bf16 v[72:75], a[52:55], a[128:131], v[72:75]
    ds_read_b128 a[52:55], v1 offset:33792
    s_waitcnt lgkmcnt(7)
    v_mfma_f32_16x16x32_bf16 v[80:83], a[56:59], a[128:131], v[80:83]
    buffer_load_dwordx4 a[124:127], v9, s[4:7], s62 offen offset:0 sc1
    v_mfma_f32_16x16x32_bf16 v[84:87], a[56:59], a[132:135], v[84:87]
    ds_read_b128 a[56:59], v1 offset:34816
    s_waitcnt lgkmcnt(7)
    v_mfma_f32_16x16x32_bf16 v[92:95], a[60:63], a[132:135], v[92:95]
    v_mfma_f32_16x16x32_bf16 v[88:91], a[60:63], a[128:131], v[88:91]
    ds_read_b128 a[60:63], v1 offset:35840
    s_waitcnt vmcnt(10)
    s_waitcnt lgkmcnt(7)
    v_mfma_f32_16x16x32_bf16 v[64:67], a[64:67], a[80:83], v[64:67]
    buffer_load_dwordx4 a[128:131], v8, s[4:7], s62 offen offset:1024 sc1
    v_mfma_f32_16x16x32_bf16 v[68:71], a[64:67], a[84:87], v[68:71]
    ds_read_b128 a[64:67], v1 offset:36864
    s_waitcnt lgkmcnt(7)
    v_mfma_f32_16x16x32_bf16 v[76:79], a[68:71], a[84:87], v[76:79]
    v_mfma_f32_16x16x32_bf16 v[72:75], a[68:71], a[80:83], v[72:75]
    ds_read_b128 a[68:71], v1 offset:37888
    s_waitcnt lgkmcnt(7)
    v_mfma_f32_16x16x32_bf16 v[80:83], a[72:75], a[80:83], v[80:83]
    buffer_load_dwordx4 a[132:135], v9, s[4:7], s62 offen offset:1024 sc1
    v_mfma_f32_16x16x32_bf16 v[84:87], a[72:75], a[84:87], v[84:87]
    ds_read_b128 a[72:75], v1 offset:38912
    s_waitcnt lgkmcnt(7)
    v_mfma_f32_16x16x32_bf16 v[92:95], a[76:79], a[84:87], v[92:95]
    v_mfma_f32_16x16x32_bf16 v[88:91], a[76:79], a[80:83], v[88:91]
    ds_read_b128 a[76:79], v1 offset:39936
    s_waitcnt vmcnt(10)
    s_waitcnt lgkmcnt(7)
    v_mfma_f32_16x16x32_bf16 v[64:67], a[48:51], a[88:91], v[64:67]
    buffer_load_dwordx4 a[80:83], v8, s[4:7], s62 offen offset:2048 sc1
    v_mfma_f32_16x16x32_bf16 v[68:71], a[48:51], a[92:95], v[68:71]
    ds_read_b128 a[48:51], v1 offset:40960
    s_waitcnt lgkmcnt(7)
    v_mfma_f32_16x16x32_bf16 v[76:79], a[52:55], a[92:95], v[76:79]
    v_mfma_f32_16x16x32_bf16 v[72:75], a[52:55], a[88:91], v[72:75]
    ds_read_b128 a[52:55], v1 offset:41984
    s_waitcnt lgkmcnt(7)
    v_mfma_f32_16x16x32_bf16 v[80:83], a[56:59], a[88:91], v[80:83]
    buffer_load_dwordx4 a[84:87], v9, s[4:7], s62 offen offset:2048 sc1
    v_mfma_f32_16x16x32_bf16 v[84:87], a[56:59], a[92:95], v[84:87]
    ds_read_b128 a[56:59], v1 offset:43008
    s_waitcnt lgkmcnt(7)
    v_mfma_f32_16x16x32_bf16 v[92:95], a[60:63], a[92:95], v[92:95]
    v_mfma_f32_16x16x32_bf16 v[88:91], a[60:63], a[88:91], v[88:91]
    ds_read_b128 a[60:63], v1 offset:44032
    s_waitcnt vmcnt(10)
    s_waitcnt lgkmcnt(7)
    v_mfma_f32_16x16x32_bf16 v[64:67], a[64:67], a[96:99], v[64:67]
    buffer_load_dwordx4 a[88:91], v8, s[4:7], s62 offen offset:3072 sc1
    v_mfma_f32_16x16x32_bf16 v[68:71], a[64:67], a[100:103], v[68:71]
    ds_read_b128 a[64:67], v1 offset:45056
    s_waitcnt lgkmcnt(7)
    v_mfma_f32_16x16x32_bf16 v[76:79], a[68:71], a[100:103], v[76:79]
    v_mfma_f32_16x16x32_bf16 v[72:75], a[68:71], a[96:99], v[72:75]
    ds_read_b128 a[68:71], v1 offset:46080
    s_waitcnt lgkmcnt(7)
    v_mfma_f32_16x16x32_bf16 v[80:83], a[72:75], a[96:99], v[80:83]
    buffer_load_dwordx4 a[92:95], v9, s[4:7], s62 offen offset:3072 sc1
    v_mfma_f32_16x16x32_bf16 v[84:87], a[72:75], a[100:103], v[84:87]
    ds_read_b128 a[72:75], v1 offset:47104
    s_waitcnt lgkmcnt(7)
    v_mfma_f32_16x16x32_bf16 v[92:95], a[76:79], a[100:103], v[92:95]
    v_mfma_f32_16x16x32_bf16 v[88:91], a[76:79], a[96:99], v[88:91]
    ds_read_b128 a[76:79], v1 offset:48128
    s_waitcnt vmcnt(10)
    s_waitcnt lgkmcnt(7)
    v_mfma_f32_16x16x32_bf16 v[64:67], a[48:51], a[104:107], v[64:67]
    s_mov_b32 s62, 29376512
    buffer_load_dwordx4 a[96:99], v8, s[4:7], s62 offen offset:0 sc1
    v_mfma_f32_16x16x32_bf16 v[68:71], a[48:51], a[108:111], v[68:71]
    ds_read_b128 a[48:51], v1 offset:49152
    s_waitcnt lgkmcnt(7)
    v_mfma_f32_16x16x32_bf16 v[76:79], a[52:55], a[108:111], v[76:79]
    v_mfma_f32_16x16x32_bf16 v[72:75], a[52:55], a[104:107], v[72:75]
    ds_read_b128 a[52:55], v1 offset:50176
    s_waitcnt lgkmcnt(7)
    v_mfma_f32_16x16x32_bf16 v[80:83], a[56:59], a[104:107], v[80:83]
    buffer_load_dwordx4 a[100:103], v9, s[4:7], s62 offen offset:0 sc1
    v_mfma_f32_16x16x32_bf16 v[84:87], a[56:59], a[108:111], v[84:87]
    ds_read_b128 a[56:59], v1 offset:51200
    s_waitcnt lgkmcnt(7)
    v_mfma_f32_16x16x32_bf16 v[92:95], a[60:63], a[108:111], v[92:95]
    v_mfma_f32_16x16x32_bf16 v[88:91], a[60:63], a[104:107], v[88:91]
    ds_read_b128 a[60:63], v1 offset:52224
    s_waitcnt vmcnt(10)
    s_waitcnt lgkmcnt(7)
    v_mfma_f32_16x16x32_bf16 v[64:67], a[64:67], a[112:115], v[64:67]
    buffer_load_dwordx4 a[104:107], v8, s[4:7], s62 offen offset:1024 sc1
    v_mfma_f32_16x16x32_bf16 v[68:71], a[64:67], a[116:119], v[68:71]
    ds_read_b128 a[64:67], v1 offset:53248
    s_waitcnt lgkmcnt(7)
    v_mfma_f32_16x16x32_bf16 v[76:79], a[68:71], a[116:119], v[76:79]
    v_mfma_f32_16x16x32_bf16 v[72:75], a[68:71], a[112:115], v[72:75]
    ds_read_b128 a[68:71], v1 offset:54272
    s_waitcnt lgkmcnt(7)
    v_mfma_f32_16x16x32_bf16 v[80:83], a[72:75], a[112:115], v[80:83]
    buffer_load_dwordx4 a[108:111], v9, s[4:7], s62 offen offset:1024 sc1
    v_mfma_f32_16x16x32_bf16 v[84:87], a[72:75], a[116:119], v[84:87]
    ds_read_b128 a[72:75], v1 offset:55296
    s_waitcnt lgkmcnt(7)
    v_mfma_f32_16x16x32_bf16 v[92:95], a[76:79], a[116:119], v[92:95]
    v_mfma_f32_16x16x32_bf16 v[88:91], a[76:79], a[112:115], v[88:91]
    ds_read_b128 a[76:79], v1 offset:56320
    s_waitcnt vmcnt(10)
    s_waitcnt lgkmcnt(7)
    v_mfma_f32_16x16x32_bf16 v[64:67], a[48:51], a[120:123], v[64:67]
    buffer_load_dwordx4 a[112:115], v8, s[4:7], s62 offen offset:2048 sc1
    v_mfma_f32_16x16x32_bf16 v[68:71], a[48:51], a[124:127], v[68:71]
    ds_read_b128 a[48:51], v2 offset:8192
    s_waitcnt lgkmcnt(7)
    v_mfma_f32_16x16x32_bf16 v[76:79], a[52:55], a[124:127], v[76:79]
    v_mfma_f32_16x16x32_bf16 v[72:75], a[52:55], a[120:123], v[72:75]
    ds_read_b128 a[52:55], v2 offset:9216
    s_waitcnt lgkmcnt(7)
    v_mfma_f32_16x16x32_bf16 v[80:83], a[56:59], a[120:123], v[80:83]
    buffer_load_dwordx4 a[116:119], v9, s[4:7], s62 offen offset:2048 sc1
    v_mfma_f32_16x16x32_bf16 v[84:87], a[56:59], a[124:127], v[84:87]
    ds_read_b128 a[56:59], v2 offset:10240
    s_waitcnt lgkmcnt(7)
    v_mfma_f32_16x16x32_bf16 v[92:95], a[60:63], a[124:127], v[92:95]
    v_mfma_f32_16x16x32_bf16 v[88:91], a[60:63], a[120:123], v[88:91]
    ds_read_b128 a[60:63], v2 offset:11264
    s_waitcnt vmcnt(10)
    s_waitcnt lgkmcnt(7)
    v_mfma_f32_16x16x32_bf16 v[64:67], a[64:67], a[128:131], v[64:67]
    buffer_load_dwordx4 a[120:123], v8, s[4:7], s62 offen offset:3072 sc1
    v_mfma_f32_16x16x32_bf16 v[68:71], a[64:67], a[132:135], v[68:71]
    ds_read_b128 a[64:67], v2 offset:12288
    s_waitcnt lgkmcnt(7)
    v_mfma_f32_16x16x32_bf16 v[76:79], a[68:71], a[132:135], v[76:79]
    v_mfma_f32_16x16x32_bf16 v[72:75], a[68:71], a[128:131], v[72:75]
    ds_read_b128 a[68:71], v2 offset:13312
    s_waitcnt lgkmcnt(7)
    v_mfma_f32_16x16x32_bf16 v[80:83], a[72:75], a[128:131], v[80:83]
    buffer_load_dwordx4 a[124:127], v9, s[4:7], s62 offen offset:3072 sc1
    v_mfma_f32_16x16x32_bf16 v[84:87], a[72:75], a[132:135], v[84:87]
    ds_read_b128 a[72:75], v2 offset:14336
    s_waitcnt lgkmcnt(7)
    v_mfma_f32_16x16x32_bf16 v[92:95], a[76:79], a[132:135], v[92:95]
    v_mfma_f32_16x16x32_bf16 v[88:91], a[76:79], a[128:131], v[88:91]
    ds_read_b128 a[76:79], v2 offset:15360
    s_waitcnt vmcnt(10)
    s_waitcnt lgkmcnt(7)
    v_mfma_f32_16x16x32_bf16 v[64:67], a[48:51], a[80:83], v[64:67]
    s_mov_b32 s62, 29380608
    buffer_load_dwordx4 a[128:131], v8, s[4:7], s62 offen offset:0 sc1
    v_mfma_f32_16x16x32_bf16 v[68:71], a[48:51], a[84:87], v[68:71]
    ds_read_b128 a[48:51], v2 offset:16384
    s_waitcnt lgkmcnt(7)
    v_mfma_f32_16x16x32_bf16 v[76:79], a[52:55], a[84:87], v[76:79]
    v_mfma_f32_16x16x32_bf16 v[72:75], a[52:55], a[80:83], v[72:75]
    ds_read_b128 a[52:55], v2 offset:17408
    buffer_load_dword v52, v50, s[4:7], s86 offen sc1
    s_waitcnt lgkmcnt(7)
    v_mfma_f32_16x16x32_bf16 v[80:83], a[56:59], a[80:83], v[80:83]
    buffer_load_dwordx4 a[132:135], v9, s[4:7], s62 offen offset:0 sc1
    v_mfma_f32_16x16x32_bf16 v[84:87], a[56:59], a[84:87], v[84:87]
    ds_read_b128 a[56:59], v2 offset:18432
    s_waitcnt lgkmcnt(7)
    v_mfma_f32_16x16x32_bf16 v[92:95], a[60:63], a[84:87], v[92:95]
    v_mfma_f32_16x16x32_bf16 v[88:91], a[60:63], a[80:83], v[88:91]
    ds_read_b128 a[60:63], v2 offset:19456
    s_waitcnt vmcnt(11)
    s_barrier
    s_waitcnt lgkmcnt(7)
    v_mfma_f32_16x16x32_bf16 v[64:67], a[64:67], a[88:91], v[64:67]
    buffer_load_dwordx4 a[80:83], v8, s[4:7], s62 offen offset:1024 sc1
    v_mfma_f32_16x16x32_bf16 v[68:71], a[64:67], a[92:95], v[68:71]
    ds_read_b128 a[64:67], v2 offset:20480
    s_waitcnt lgkmcnt(7)
    v_mfma_f32_16x16x32_bf16 v[76:79], a[68:71], a[92:95], v[76:79]
    v_mfma_f32_16x16x32_bf16 v[72:75], a[68:71], a[88:91], v[72:75]
    ds_read_b128 a[68:71], v2 offset:21504
    s_waitcnt lgkmcnt(7)
    v_mfma_f32_16x16x32_bf16 v[80:83], a[72:75], a[88:91], v[80:83]
    buffer_load_dwordx4 a[84:87], v9, s[4:7], s62 offen offset:1024 sc1
    v_mfma_f32_16x16x32_bf16 v[84:87], a[72:75], a[92:95], v[84:87]
    ds_read_b128 a[72:75], v2 offset:22528
    s_waitcnt lgkmcnt(7)
    v_mfma_f32_16x16x32_bf16 v[92:95], a[76:79], a[92:95], v[92:95]
    v_mfma_f32_16x16x32_bf16 v[88:91], a[76:79], a[88:91], v[88:91]
    ds_read_b128 a[76:79], v2 offset:23552
    s_waitcnt vmcnt(11)
    s_waitcnt lgkmcnt(7)
    v_mfma_f32_16x16x32_bf16 v[64:67], a[48:51], a[96:99], v[64:67]
    buffer_load_dwordx4 a[88:91], v8, s[4:7], s62 offen offset:2048 sc1
    v_mfma_f32_16x16x32_bf16 v[68:71], a[48:51], a[100:103], v[68:71]
    ds_read_b128 a[48:51], v2 offset:24576
    s_waitcnt lgkmcnt(7)
    v_mfma_f32_16x16x32_bf16 v[76:79], a[52:55], a[100:103], v[76:79]
    v_mfma_f32_16x16x32_bf16 v[72:75], a[52:55], a[96:99], v[72:75]
    ds_read_b128 a[52:55], v2 offset:25600
    s_waitcnt lgkmcnt(7)
    v_mfma_f32_16x16x32_bf16 v[80:83], a[56:59], a[96:99], v[80:83]
    buffer_load_dwordx4 a[92:95], v9, s[4:7], s62 offen offset:2048 sc1
    v_mfma_f32_16x16x32_bf16 v[84:87], a[56:59], a[100:103], v[84:87]
    ds_read_b128 a[56:59], v2 offset:26624
    s_waitcnt lgkmcnt(7)
    v_mfma_f32_16x16x32_bf16 v[92:95], a[60:63], a[100:103], v[92:95]
    v_mfma_f32_16x16x32_bf16 v[88:91], a[60:63], a[96:99], v[88:91]
    ds_read_b128 a[60:63], v2 offset:27648
    s_waitcnt vmcnt(11)
    s_waitcnt lgkmcnt(7)
    v_mfma_f32_16x16x32_bf16 v[64:67], a[64:67], a[104:107], v[64:67]
    buffer_load_dwordx4 a[96:99], v8, s[4:7], s62 offen offset:3072 sc1
    v_mfma_f32_16x16x32_bf16 v[68:71], a[64:67], a[108:111], v[68:71]
    ds_read_b128 a[64:67], v2 offset:28672
    s_waitcnt lgkmcnt(7)
    v_mfma_f32_16x16x32_bf16 v[76:79], a[68:71], a[108:111], v[76:79]
    v_mfma_f32_16x16x32_bf16 v[72:75], a[68:71], a[104:107], v[72:75]
    ds_read_b128 a[68:71], v2 offset:29696
    s_waitcnt lgkmcnt(7)
    v_mfma_f32_16x16x32_bf16 v[80:83], a[72:75], a[104:107], v[80:83]
    buffer_load_dwordx4 a[100:103], v9, s[4:7], s62 offen offset:3072 sc1
    v_mfma_f32_16x16x32_bf16 v[84:87], a[72:75], a[108:111], v[84:87]
    ds_read_b128 a[72:75], v2 offset:30720
    s_waitcnt lgkmcnt(7)
    v_mfma_f32_16x16x32_bf16 v[92:95], a[76:79], a[108:111], v[92:95]
    v_mfma_f32_16x16x32_bf16 v[88:91], a[76:79], a[104:107], v[88:91]
    ds_read_b128 a[76:79], v2 offset:31744
    s_waitcnt vmcnt(11)
    s_waitcnt lgkmcnt(7)
    v_mfma_f32_16x16x32_bf16 v[64:67], a[48:51], a[112:115], v[64:67]
    s_mov_b32 s62, 29384704
    buffer_load_dwordx4 a[104:107], v8, s[4:7], s62 offen offset:0 sc1
    v_mfma_f32_16x16x32_bf16 v[68:71], a[48:51], a[116:119], v[68:71]
    ds_read_b128 a[48:51], v2 offset:32768
    s_waitcnt lgkmcnt(7)
    v_mfma_f32_16x16x32_bf16 v[76:79], a[52:55], a[116:119], v[76:79]
    v_mfma_f32_16x16x32_bf16 v[72:75], a[52:55], a[112:115], v[72:75]
    ds_read_b128 a[52:55], v2 offset:33792
    s_add_u32 s20, s48, L_layer3-L_pc
    s_addc_u32 s21, s49, 0
    global_load_dword v52, v35, s[20:21]
    s_waitcnt lgkmcnt(7)
    v_mfma_f32_16x16x32_bf16 v[80:83], a[56:59], a[112:115], v[80:83]
    buffer_load_dwordx4 a[108:111], v9, s[4:7], s62 offen offset:0 sc1
    v_mfma_f32_16x16x32_bf16 v[84:87], a[56:59], a[116:119], v[84:87]
    ds_read_b128 a[56:59], v2 offset:34816
    s_waitcnt lgkmcnt(7)
    v_mfma_f32_16x16x32_bf16 v[92:95], a[60:63], a[116:119], v[92:95]
    v_mfma_f32_16x16x32_bf16 v[88:91], a[60:63], a[112:115], v[88:91]
    ds_read_b128 a[60:63], v2 offset:35840
    s_waitcnt vmcnt(12)
    s_waitcnt lgkmcnt(7)
    v_mfma_f32_16x16x32_bf16 v[64:67], a[64:67], a[120:123], v[64:67]
    buffer_load_dwordx4 a[112:115], v8, s[4:7], s62 offen offset:1024 sc1
    v_mfma_f32_16x16x32_bf16 v[68:71], a[64:67], a[124:127], v[68:71]
    ds_read_b128 a[64:67], v2 offset:36864
    s_waitcnt lgkmcnt(7)
    v_mfma_f32_16x16x32_bf16 v[76:79], a[68:71], a[124:127], v[76:79]
    v_mfma_f32_16x16x32_bf16 v[72:75], a[68:71], a[120:123], v[72:75]
    ds_read_b128 a[68:71], v2 offset:37888
    s_waitcnt lgkmcnt(7)
    v_mfma_f32_16x16x32_bf16 v[80:83], a[72:75], a[120:123], v[80:83]
    buffer_load_dwordx4 a[116:119], v9, s[4:7], s62 offen offset:1024 sc1
    v_mfma_f32_16x16x32_bf16 v[84:87], a[72:75], a[124:127], v[84:87]
    ds_read_b128 a[72:75], v2 offset:38912
    s_waitcnt lgkmcnt(7)
    v_mfma_f32_16x16x32_bf16 v[92:95], a[76:79], a[124:127], v[92:95]
    v_mfma_f32_16x16x32_bf16 v[88:91], a[76:79], a[120:123], v[88:91]
    ds_read_b128 a[76:79], v2 offset:39936
    s_waitcnt vmcnt(11)
    s_waitcnt lgkmcnt(7)
    v_mfma_f32_16x16x32_bf16 v[64:67], a[48:51], a[128:131], v[64:67]
    buffer_load_dwordx4 a[120:123], v8, s[4:7], s62 offen offset:2048 sc1
    v_mfma_f32_16x16x32_bf16 v[68:71], a[48:51], a[132:135], v[68:71]
    ds_read_b128 a[48:51], v2 offset:40960
    s_waitcnt lgkmcnt(7)
    v_mfma_f32_16x16x32_bf16 v[76:79], a[52:55], a[132:135], v[76:79]
    v_mfma_f32_16x16x32_bf16 v[72:75], a[52:55], a[128:131], v[72:75]
    ds_read_b128 a[52:55], v2 offset:41984
    s_waitcnt lgkmcnt(7)
    v_mfma_f32_16x16x32_bf16 v[80:83], a[56:59], a[128:131], v[80:83]
    buffer_load_dwordx4 a[124:127], v9, s[4:7], s62 offen offset:2048 sc1
    v_mfma_f32_16x16x32_bf16 v[84:87], a[56:59], a[132:135], v[84:87]
    ds_read_b128 a[56:59], v2 offset:43008
    s_waitcnt lgkmcnt(7)
    v_mfma_f32_16x16x32_bf16 v[92:95], a[60:63], a[132:135], v[92:95]
    v_mfma_f32_16x16x32_bf16 v[88:91], a[60:63], a[128:131], v[88:91]
    ds_read_b128 a[60:63], v2 offset:44032
    s_waitcnt vmcnt(11)
    s_waitcnt lgkmcnt(7)
    v_mfma_f32_16x16x32_bf16 v[64:67], a[64:67], a[80:83], v[64:67]
    buffer_load_dwordx4 a[128:131], v8, s[4:7], s62 offen offset:3072 sc1
    v_mfma_f32_16x16x32_bf16 v[68:71], a[64:67], a[84:87], v[68:71]
    ds_read_b128 a[64:67], v2 offset:45056
    s_waitcnt lgkmcnt(7)
    v_mfma_f32_16x16x32_bf16 v[76:79], a[68:71], a[84:87], v[76:79]
    v_mfma_f32_16x16x32_bf16 v[72:75], a[68:71], a[80:83], v[72:75]
    ds_read_b128 a[68:71], v2 offset:46080
    s_waitcnt lgkmcnt(7)
    v_mfma_f32_16x16x32_bf16 v[80:83], a[72:75], a[80:83], v[80:83]
    buffer_load_dwordx4 a[132:135], v9, s[4:7], s62 offen offset:3072 sc1
    v_mfma_f32_16x16x32_bf16 v[84:87], a[72:75], a[84:87], v[84:87]
    ds_read_b128 a[72:75], v2 offset:47104
    s_waitcnt lgkmcnt(7)
    v_mfma_f32_16x16x32_bf16 v[92:95], a[76:79], a[84:87], v[92:95]
    v_mfma_f32_16x16x32_bf16 v[88:91], a[76:79], a[80:83], v[88:91]
    ds_read_b128 a[76:79], v2 offset:48128
    s_waitcnt vmcnt(11)
    s_waitcnt lgkmcnt(7)
    v_mfma_f32_16x16x32_bf16 v[64:67], a[48:51], a[88:91], v[64:67]
    s_mov_b32 s62, 29388800
    buffer_load_dwordx4 a[80:83], v8, s[4:7], s62 offen offset:0 sc1
    v_mfma_f32_16x16x32_bf16 v[68:71], a[48:51], a[92:95], v[68:71]
    ds_read_b128 a[48:51], v2 offset:49152
    s_waitcnt lgkmcnt(7)
    v_mfma_f32_16x16x32_bf16 v[76:79], a[52:55], a[92:95], v[76:79]
    v_mfma_f32_16x16x32_bf16 v[72:75], a[52:55], a[88:91], v[72:75]
    ds_read_b128 a[52:55], v2 offset:50176
    s_waitcnt lgkmcnt(7)
    v_mfma_f32_16x16x32_bf16 v[80:83], a[56:59], a[88:91], v[80:83]
    buffer_load_dwordx4 a[84:87], v9, s[4:7], s62 offen offset:0 sc1
    v_mfma_f32_16x16x32_bf16 v[84:87], a[56:59], a[92:95], v[84:87]
    ds_read_b128 a[56:59], v2 offset:51200
    s_waitcnt lgkmcnt(7)
    v_mfma_f32_16x16x32_bf16 v[92:95], a[60:63], a[92:95], v[92:95]
    v_mfma_f32_16x16x32_bf16 v[88:91], a[60:63], a[88:91], v[88:91]
    ds_read_b128 a[60:63], v2 offset:52224
    s_waitcnt vmcnt(11)
    s_waitcnt lgkmcnt(7)
    v_mfma_f32_16x16x32_bf16 v[64:67], a[64:67], a[96:99], v[64:67]
    buffer_load_dwordx4 a[88:91], v8, s[4:7], s62 offen offset:1024 sc1
    v_mfma_f32_16x16x32_bf16 v[68:71], a[64:67], a[100:103], v[68:71]
    ds_read_b128 a[64:67], v2 offset:53248
    s_waitcnt lgkmcnt(7)
    v_mfma_f32_16x16x32_bf16 v[76:79], a[68:71], a[100:103], v[76:79]
    v_mfma_f32_16x16x32_bf16 v[72:75], a[68:71], a[96:99], v[72:75]
    ds_read_b128 a[68:71], v2 offset:54272
    s_waitcnt lgkmcnt(7)
    v_mfma_f32_16x16x32_bf16 v[80:83], a[72:75], a[96:99], v[80:83]
    buffer_load_dwordx4 a[92:95], v8, s[4:7], s62 offen offset:2048 sc1
    v_mfma_f32_16x16x32_bf16 v[84:87], a[72:75], a[100:103], v[84:87]
    ds_read_b128 a[72:75], v2 offset:55296
    s_waitcnt lgkmcnt(7)
    v_mfma_f32_16x16x32_bf16 v[92:95], a[76:79], a[100:103], v[92:95]
    v_mfma_f32_16x16x32_bf16 v[88:91], a[76:79], a[96:99], v[88:91]
    ds_read_b128 a[76:79], v2 offset:56320
    s_waitcnt vmcnt(10)
    s_waitcnt lgkmcnt(7)
    v_mfma_f32_16x16x32_bf16 v[64:67], a[48:51], a[104:107], v[64:67]
    buffer_load_dwordx4 a[96:99], v8, s[4:7], s62 offen offset:3072 sc1
    v_mfma_f32_16x16x32_bf16 v[68:71], a[48:51], a[108:111], v[68:71]
    ds_read_b128 a[48:51], v2 offset:57344
    s_waitcnt lgkmcnt(7)
    v_mfma_f32_16x16x32_bf16 v[76:79], a[52:55], a[108:111], v[76:79]
    v_mfma_f32_16x16x32_bf16 v[72:75], a[52:55], a[104:107], v[72:75]
    ds_read_b128 a[52:55], v2 offset:58368
    s_waitcnt lgkmcnt(7)
    v_mfma_f32_16x16x32_bf16 v[80:83], a[56:59], a[104:107], v[80:83]
    buffer_load_dwordx4 a[100:103], v9, s[4:7], s62 offen offset:1024 sc1
    v_mfma_f32_16x16x32_bf16 v[84:87], a[56:59], a[108:111], v[84:87]
    ds_read_b128 a[56:59], v2 offset:59392
    s_waitcnt lgkmcnt(7)
    v_mfma_f32_16x16x32_bf16 v[92:95], a[60:63], a[108:111], v[92:95]
    v_mfma_f32_16x16x32_bf16 v[88:91], a[60:63], a[104:107], v[88:91]
    ds_read_b128 a[60:63], v2 offset:60416
    s_waitcnt vmcnt(10)
    s_waitcnt lgkmcnt(7)
    v_mfma_f32_16x16x32_bf16 v[64:67], a[64:67], a[112:115], v[64:67]
    buffer_load_dwordx4 a[104:107], v9, s[4:7], s62 offen offset:2048 sc1
    v_mfma_f32_16x16x32_bf16 v[68:71], a[64:67], a[116:119], v[68:71]
    ds_read_b128 a[64:67], v2 offset:61440
    s_waitcnt lgkmcnt(7)
    v_mfma_f32_16x16x32_bf16 v[76:79], a[68:71], a[116:119], v[76:79]
    v_mfma_f32_16x16x32_bf16 v[72:75], a[68:71], a[112:115], v[72:75]
    ds_read_b128 a[68:71], v2 offset:62464
    s_waitcnt lgkmcnt(7)
    v_mfma_f32_16x16x32_bf16 v[80:83], a[72:75], a[112:115], v[80:83]
    buffer_load_dwordx4 a[108:111], v9, s[4:7], s62 offen offset:3072 sc1
    v_mfma_f32_16x16x32_bf16 v[84:87], a[72:75], a[116:119], v[84:87]
    ds_read_b128 a[72:75], v2 offset:63488
    s_waitcnt lgkmcnt(7)
    v_mfma_f32_16x16x32_bf16 v[92:95], a[76:79], a[116:119], v[92:95]
    v_mfma_f32_16x16x32_bf16 v[88:91], a[76:79], a[112:115], v[88:91]
    ds_read_b128 a[76:79], v2 offset:64512
    s_waitcnt vmcnt(10)
    s_waitcnt lgkmcnt(7)
    v_mfma_f32_16x16x32_bf16 v[64:67], a[48:51], a[120:123], v[64:67]
    s_add_u32 m0, s57, 49152
    s_add_u32 s63, s95, 14680064
    buffer_load_dwordx4 v10, s[4:7], s63 offen offset:0 lds
    v_mfma_f32_16x16x32_bf16 v[68:71], a[48:51], a[124:127], v[68:71]
    ds_read_b128 a[48:51], v3 offset:0
    s_waitcnt lgkmcnt(7)
    v_mfma_f32_16x16x32_bf16 v[76:79], a[52:55], a[124:127], v[76:79]
    v_mfma_f32_16x16x32_bf16 v[72:75], a[52:55], a[120:123], v[72:75]
    ds_read_b128 a[52:55], v3 offset:1024
    s_waitcnt lgkmcnt(7)
    v_mfma_f32_16x16x32_bf16 v[80:83], a[56:59], a[120:123], v[80:83]
    buffer_load_dwordx4 v10, s[4:7], s63 offen offset:1024 lds
    v_mfma_f32_16x16x32_bf16 v[84:87], a[56:59], a[124:127], v[84:87]
    ds_read_b128 a[56:59], v3 offset:2048
    s_waitcnt lgkmcnt(7)
    v_mfma_f32_16x16x32_bf16 v[92:95], a[60:63], a[124:127], v[92:95]
    v_mfma_f32_16x16x32_bf16 v[88:91], a[60:63], a[120:123], v[88:91]
    ds_read_b128 a[60:63], v3 offset:3072
    s_waitcnt vmcnt(10)
    s_barrier
    s_waitcnt lgkmcnt(7)
    v_mfma_f32_16x16x32_bf16 v[64:67], a[64:67], a[128:131], v[64:67]
    buffer_load_dwordx4 v10, s[4:7], s63 offen offset:2048 lds
    v_mfma_f32_16x16x32_bf16 v[68:71], a[64:67], a[132:135], v[68:71]
    ds_read_b128 a[64:67], v3 offset:4096
    s_waitcnt lgkmcnt(7)
    v_mfma_f32_16x16x32_bf16 v[76:79], a[68:71], a[132:135], v[76:79]
    v_mfma_f32_16x16x32_bf16 v[72:75], a[68:71], a[128:131], v[72:75]
    ds_read_b128 a[68:71], v3 offset:5120
    s_waitcnt lgkmcnt(7)
    v_mfma_f32_16x16x32_bf16 v[80:83], a[72:75], a[128:131], v[80:83]
    buffer_load_dwordx4 v10, s[4:7], s63 offen offset:3072 lds
    v_mfma_f32_16x16x32_bf16 v[84:87], a[72:75], a[132:135], v[84:87]
    ds_read_b128 a[72:75], v3 offset:6144
    s_waitcnt lgkmcnt(7)
    v_mfma_f32_16x16x32_bf16 v[92:95], a[76:79], a[132:135], v[92:95]
    v_mfma_f32_16x16x32_bf16 v[88:91], a[76:79], a[128:131], v[88:91]
    ds_read_b128 a[76:79], v3 offset:7168
    s_waitcnt vmcnt(10)
    s_waitcnt lgkmcnt(7)
    v_mfma_f32_16x16x32_bf16 v[64:67], a[48:51], a[80:83], v[64:67]
    s_add_u32 m0, s57, 53248
    s_add_u32 s63, s95, 14684160
    buffer_load_dwordx4 v10, s[4:7], s63 offen offset:0 lds
    v_mfma_f32_16x16x32_bf16 v[68:71], a[48:51], a[84:87], v[68:71]
    ds_read_b128 a[48:51], v3 offset:8192
    s_waitcnt lgkmcnt(7)
    v_mfma_f32_16x16x32_bf16 v[76:79], a[52:55], a[84:87], v[76:79]
    v_mfma_f32_16x16x32_bf16 v[72:75], a[52:55], a[80:83], v[72:75]
    ds_read_b128 a[52:55], v3 offset:9216
    s_waitcnt lgkmcnt(7)
    v_mfma_f32_16x16x32_bf16 v[80:83], a[56:59], a[80:83], v[80:83]
    buffer_load_dwordx4 v10, s[4:7], s63 offen offset:1024 lds
    v_mfma_f32_16x16x32_bf16 v[84:87], a[56:59], a[84:87], v[84:87]
    ds_read_b128 a[56:59], v3 offset:10240
    s_waitcnt lgkmcnt(7)
    v_mfma_f32_16x16x32_bf16 v[92:95], a[60:63], a[84:87], v[92:95]
    v_mfma_f32_16x16x32_bf16 v[88:91], a[60:63], a[80:83], v[88:91]
    ds_read_b128 a[60:63], v3 offset:11264
    s_waitcnt vmcnt(11)
    s_waitcnt lgkmcnt(7)
    v_mfma_f32_16x16x32_bf16 v[64:67], a[64:67], a[88:91], v[64:67]
    ds_read_b128 a[64:67], v3 offset:12288
    s_waitcnt lgkmcnt(7)
    v_mfma_f32_16x16x32_bf16 v[72:75], a[68:71], a[88:91], v[72:75]
    ds_read_b128 a[68:71], v3 offset:13312
    s_waitcnt lgkmcnt(7)
    v_mfma_f32_16x16x32_bf16 v[80:83], a[72:75], a[88:91], v[80:83]
    ds_read_b128 a[72:75], v3 offset:14336
    s_waitcnt lgkmcnt(7)
    v_mfma_f32_16x16x32_bf16 v[88:91], a[76:79], a[88:91], v[88:91]
    ds_read_b128 a[76:79], v3 offset:15360
    s_waitcnt vmcnt(10)
    s_waitcnt lgkmcnt(7)
    v_mfma_f32_16x16x32_bf16 v[64:67], a[48:51], a[92:95], v[64:67]
    ds_read_b128 a[48:51], v3 offset:4096
    s_waitcnt lgkmcnt(7)
    v_mfma_f32_16x16x32_bf16 v[72:75], a[52:55], a[92:95], v[72:75]
    ds_read_b128 a[52:55], v3 offset:5120
    s_waitcnt lgkmcnt(7)
    v_mfma_f32_16x16x32_bf16 v[80:83], a[56:59], a[92:95], v[80:83]
    ds_read_b128 a[56:59], v3 offset:6144
    s_waitcnt lgkmcnt(7)
    v_mfma_f32_16x16x32_bf16 v[88:91], a[60:63], a[92:95], v[88:91]
    ds_read_b128 a[60:63], v3 offset:7168
    s_waitcnt vmcnt(9)
    s_waitcnt lgkmcnt(7)
    v_mfma_f32_16x16x32_bf16 v[64:67], a[64:67], a[96:99], v[64:67]
    ds_read_b128 a[64:67], v3 offset:8192
    s_waitcnt lgkmcnt(7)
    v_mfma_f32_16x16x32_bf16 v[72:75], a[68:71], a[96:99], v[72:75]
    ds_read_b128 a[68:71], v3 offset:9216
    s_waitcnt lgkmcnt(7)
    v_mfma_f32_16x16x32_bf16 v[80:83], a[72:75], a[96:99], v[80:83]
    ds_read_b128 a[72:75], v3 offset:10240
    s_waitcnt lgkmcnt(7)
    v_mfma_f32_16x16x32_bf16 v[88:91], a[76:79], a[96:99], v[88:91]
    ds_read_b128 a[76:79], v3 offset:11264
    s_waitcnt vmcnt(8)
    s_waitcnt lgkmcnt(7)
    v_mfma_f32_16x16x32_bf16 v[68:71], a[48:51], a[100:103], v[68:71]
    ds_read_b128 a[48:51], v3 offset:12288
    s_waitcnt lgkmcnt(7)
    v_mfma_f32_16x16x32_bf16 v[76:79], a[52:55], a[100:103], v[76:79]
    v_cvt_pk_bf16_f32 v16, v64, v65
    v_cvt_pk_bf16_f32 v17, v66, v67
    ds_read_b128 a[52:55], v3 offset:13312
    s_waitcnt lgkmcnt(7)
    v_mfma_f32_16x16x32_bf16 v[84:87], a[56:59], a[100:103], v[84:87]
    v_cvt_pk_bf16_f32 v18, v72, v73
    v_cvt_pk_bf16_f32 v19, v74, v75
    ds_read_b128 a[56:59], v3 offset:14336
    s_waitcnt lgkmcnt(7)
    v_mfma_f32_16x16x32_bf16 v[92:95], a[60:63], a[100:103], v[92:95]
    v_cvt_pk_bf16_f32 v20, v80, v81
    v_cvt_pk_bf16_f32 v21, v82, v83
    ds_read_b128 a[60:63], v3 offset:15360
    s_waitcnt vmcnt(7)
    s_waitcnt lgkmcnt(7)
    v_mfma_f32_16x16x32_bf16 v[68:71], a[64:67], a[104:107], v[68:71]
    v_cvt_pk_bf16_f32 v22, v88, v89
    v_cvt_pk_bf16_f32 v23, v90, v91
    s_waitcnt lgkmcnt(6)
    v_mfma_f32_16x16x32_bf16 v[76:79], a[68:71], a[104:107], v[76:79]
    v_mfma_f32_16x16x32_bf16 v[164:167], v[16:19], v[16:19], 0
    s_waitcnt lgkmcnt(5)
    v_mfma_f32_16x16x32_bf16 v[84:87], a[72:75], a[104:107], v[84:87]
    s_cmp_lg_u32 s15, 0
    s_cbranch_scc1 L_slow_71
    buffer_store_dwordx4 v[16:19], v8, s[4:7], s35 offen offset:0
L_done_72:
    s_waitcnt lgkmcnt(4)
    v_mfma_f32_16x16x32_bf16 v[92:95], a[76:79], a[104:107], v[92:95]
    v_mfma_f32_16x16x32_bf16 v[160:163], v[40:43], v[16:19], 0
    s_waitcnt vmcnt(7)
    s_waitcnt lgkmcnt(3)
    v_mfma_f32_16x16x32_bf16 v[68:71], a[48:51], a[108:111], v[68:71]
    v_mfma_f32_16x16x32_bf16 v[164:167], v[20:23], v[20:23], v[164:167]
    s_waitcnt lgkmcnt(2)
    v_mfma_f32_16x16x32_bf16 v[76:79], a[52:55], a[108:111], v[76:79]
    s_cmp_lg_u32 s15, 0
    s_cbranch_scc1 L_slow_73
    buffer_store_dwordx4 v[20:23], v8, s[4:7], s35 offen offset:1024
L_done_74:
    s_waitcnt lgkmcnt(1)
    v_mfma_f32_16x16x32_bf16 v[84:87], a[56:59], a[108:111], v[84:87]
    v_mfma_f32_16x16x32_bf16 v[160:163], v[40:43], v[20:23], v[160:163]
    s_waitcnt lgkmcnt(0)
    v_mfma_f32_16x16x32_bf16 v[92:95], a[60:63], a[108:111], v[92:95]
    s_cmp_lg_u32 s15, 0
    s_cbranch_scc1 L_slow_75
    v_cndmask_b32 v164, v164, v165, s[36:37]
    v_cndmask_b32 v166, v166, v167, s[36:37]
    s_nop 1
    v_cndmask_b32 v161, v164, v166, s[38:39]
    s_mov_b64 exec, s[40:41]
    buffer_store_dwordx2 v[160:161], v14, s[4:7], s56 offen offset:0
    s_mov_b64 exec, -1
L_done_76:
    v_cvt_pk_bf16_f32 v24, v68, v69
    v_cvt_pk_bf16_f32 v25, v70, v71
    v_cvt_pk_bf16_f32 v26, v76, v77
    v_cvt_pk_bf16_f32 v27, v78, v79
    v_cvt_pk_bf16_f32 v28, v84, v85
    v_cvt_pk_bf16_f32 v29, v86, v87
    v_cvt_pk_bf16_f32 v30, v92, v93
    v_cvt_pk_bf16_f32 v31, v94, v95
    s_cmp_lg_u32 s15, 0
    s_cbranch_scc1 L_slow_77
    v_mfma_f32_16x16x32_bf16 v[172:175], v[24:27], v[24:27], 0
    buffer_store_dwordx4 v[24:27], v9, s[4:7], s35 offen offset:0
    v_mfma_f32_16x16x32_bf16 v[168:171], v[40:43], v[24:27], 0
    v_mfma_f32_16x16x32_bf16 v[172:175], v[28:31], v[28:31], v[172:175]
    buffer_store_dwordx4 v[28:31], v9, s[4:7], s35 offen offset:1024
    v_mfma_f32_16x16x32_bf16 v[168:171], v[40:43], v[28:31], v[168:171]
    s_nop 5
    v_cndmask_b32 v172, v172, v173, s[36:37]
    v_cndmask_b32 v174, v174, v175, s[36:37]
    v_cndmask_b32 v169, v172, v174, s[38:39]
    s_mov_b64 exec, s[40:41]
    buffer_store_dwordx2 v[168:169], v14, s[4:7], s56 offen offset:128
    s_mov_b64 exec, -1
L_done_78:
    ds_write_b128 v0, a[24:27] offset:24576
    ds_write_b128 v0, a[28:31] offset:25600
    ds_write_b128 v0, a[32:35] offset:26624
    ds_write_b128 v0, a[36:39] offset:27648
    buffer_load_dword v216, v12, s[4:7], s32 offen sc1
    ds_write_b128 v0, a[40:43] offset:28672
    ds_write_b128 v0, a[44:47] offset:29696
    ds_write_b128 v34, a[216:219] offset:0
    ds_write_b128 v34, a[220:223] offset:1024
    ds_write_b128 v34, a[224:227] offset:2048
    ds_write_b128 v34, a[228:231] offset:3072
    ds_write_b128 v34, a[232:235] offset:4096
    ds_write_b128 v34, a[236:239] offset:5120
    s_mov_b64 exec, 1
    s_waitcnt vmcnt(1)
    s_cmp_lg_u32 s15, 0
    s_cbranch_scc1 L_slow_80
    buffer_store_dword v63, off, s[4:7], s33
L_done_81:
    s_mov_b64 exec, -1
    ds_write_b128 v34, a[168:171] offset:24576
    ds_write_b128 v34, a[172:175] offset:25600
    ds_write_b128 v34, a[176:179] offset:26624
    ds_write_b128 v34, a[180:183] offset:27648
    ds_write_b128 v34, a[184:187] offset:28672
    ds_write_b128 v34, a[188:191] offset:29696
    s_waitcnt vmcnt(1)
    s_mov_b64 exec, s[66:67]
    v_cmp_gt_u32 vcc, 3, v216
    s_mov_b64 exec, -1
    s_cbranch_vccz L_hd_79
    s_mov_b32 s61, 1048576
L_spin_82:
    buffer_load_dword v216, v12, s[4:7], s32 offen sc1
    s_sub_u32 s61, s61, 1
    s_waitcnt vmcnt(0)
    s_mov_b64 exec, s[68:69]
    v_cmp_gt_u32 vcc, 3, v216
    s_mov_b64 exec, -1
    s_cbranch_scc1 L_spind_83
    s_cbranch_vccnz L_spin_82
L_spind_83:
L_hd_79:
L_layer3:
    buffer_load_dwordx4 a[48:51], v4, s[4:7], s86 offen offset:0 sc1
    buffer_load_dwordx4 a[52:55], v5, s[4:7], s86 offen offset:0 sc1
    buffer_load_dwordx4 a[56:59], v6, s[4:7], s86 offen offset:0 sc1
    buffer_load_dwordx4 a[60:63], v7, s[4:7], s86 offen offset:0 sc1
    buffer_load_dwordx4 a[64:67], v4, s[4:7], s86 offen offset:1024 sc1
    buffer_load_dwordx4 a[68:71], v5, s[4:7], s86 offen offset:1024 sc1
    buffer_load_dwordx4 a[72:75], v6, s[4:7], s86 offen offset:1024 sc1
    buffer_load_dwordx4 a[76:79], v7, s[4:7], s86 offen offset:1024 sc1
    buffer_load_dwordx4 a[80:83], v4, s[4:7], s86 offen offset:2048 sc1
    buffer_load_dwordx4 a[84:87], v5, s[4:7], s86 offen offset:2048 sc1
    buffer_load_dwordx4 a[88:91], v6, s[4:7], s86 offen offset:2048 sc1
    buffer_load_dwordx4 a[92:95], v7, s[4:7], s86 offen offset:2048 sc1
    buffer_load_dword v216, v12, s[4:7], s32 offen sc1
    s_waitcnt lgkmcnt(0)
    s_barrier
    ds_read_b128 v[192:195], v1 offset:24576
    ds_read_b128 v[196:199], v1 offset:25600
    ds_read_b128 v[200:203], v1 offset:26624
    ds_read_b128 v[204:207], v1 offset:27648
    ds_read_b128 v[208:211], v1 offset:28672
    ds_read_b128 v[212:215], v1 offset:29696
    s_waitcnt vmcnt(9)
    s_waitcnt lgkmcnt(5)
    v_mfma_f32_16x16x32_bf16 v[64:67], v[192:195], a[48:51], 0
    v_mfma_f32_16x16x32_bf16 v[68:71], v[192:195], a[52:55], 0
    buffer_load_dwordx4 a[96:99], v4, s[4:7], s86 offen offset:3072 sc1
    v_mfma_f32_16x16x32_bf16 v[72:75], v[192:195], a[56:59], 0
    v_mfma_f32_16x16x32_bf16 v[76:79], v[192:195], a[60:63], 0
    ds_read_b128 v[192:195], v1 offset:30720
    s_waitcnt lgkmcnt(5)
    v_mfma_f32_16x16x32_bf16 v[92:95], v[196:199], a[60:63], 0
    v_mfma_f32_16x16x32_bf16 v[88:91], v[196:199], a[56:59], 0
    buffer_load_dwordx4 a[100:103], v5, s[4:7], s86 offen offset:3072 sc1
    v_mfma_f32_16x16x32_bf16 v[84:87], v[196:199], a[52:55], 0
    v_mfma_f32_16x16x32_bf16 v[80:83], v[196:199], a[48:51], 0
    ds_read_b128 v[196:199], v1 offset:31744
    s_waitcnt lgkmcnt(5)
    v_mfma_f32_16x16x32_bf16 v[96:99], v[200:203], a[48:51], 0
    v_mfma_f32_16x16x32_bf16 v[100:103], v[200:203], a[52:55], 0
    buffer_load_dwordx4 a[104:107], v6, s[4:7], s86 offen offset:3072 sc1
    v_mfma_f32_16x16x32_bf16 v[104:107], v[200:203], a[56:59], 0
    v_mfma_f32_16x16x32_bf16 v[108:111], v[200:203], a[60:63], 0
    ds_read_b128 v[200:203], v1 offset:32768
    s_waitcnt lgkmcnt(5)
    v_mfma_f32_16x16x32_bf16 v[124:127], v[204:207], a[60:63], 0
    v_mfma_f32_16x16x32_bf16 v[120:123], v[204:207], a[56:59], 0
    buffer_load_dwordx4 a[108:111], v7, s[4:7], s86 offen offset:3072 sc1
    v_mfma_f32_16x16x32_bf16 v[116:119], v[204:207], a[52:55], 0
    v_mfma_f32_16x16x32_bf16 v[112:115], v[204:207], a[48:51], 0
    ds_read_b128 v[204:207], v1 offset:33792
    s_waitcnt lgkmcnt(5)
    v_mfma_f32_16x16x32_bf16 v[128:131], a[48:51], v[208:211], 0
    v_mfma_f32_16x16x32_bf16 v[132:135], a[52:55], v[208:211], 0
    v_mfma_f32_16x16x32_bf16 v[136:139], a[56:59], v[208:211], 0
    v_mfma_f32_16x16x32_bf16 v[140:143], a[60:63], v[208:211], 0
    ds_read_b128 v[208:211], v1 offset:34816
    s_waitcnt lgkmcnt(5)
    v_mfma_f32_16x16x32_bf16 v[156:159], a[60:63], v[212:215], 0
    v_mfma_f32_16x16x32_bf16 v[152:155], a[56:59], v[212:215], 0
    v_mfma_f32_16x16x32_bf16 v[148:151], a[52:55], v[212:215], 0
    v_mfma_f32_16x16x32_bf16 v[144:147], a[48:51], v[212:215], 0
    ds_read_b128 v[212:215], v1 offset:35840
    s_waitcnt vmcnt(9)
    s_waitcnt vmcnt(4)
    v_cmp_gt_u32 vcc, 3, v216
    s_cbranch_vccnz L_p2_84
L_p2_84_r:
    s_waitcnt lgkmcnt(5)
    v_mfma_f32_16x16x32_bf16 v[64:67], v[192:195], a[64:67], v[64:67]
    v_mfma_f32_16x16x32_bf16 v[68:71], v[192:195], a[68:71], v[68:71]
    buffer_load_dwordx4 a[48:51], v4, s[4:7], s87 offen offset:0 sc1
    v_mfma_f32_16x16x32_bf16 v[72:75], v[192:195], a[72:75], v[72:75]
    v_mfma_f32_16x16x32_bf16 v[76:79], v[192:195], a[76:79], v[76:79]
    ds_read_b128 v[192:195], v1 offset:36864
    s_waitcnt lgkmcnt(5)
    v_mfma_f32_16x16x32_bf16 v[92:95], v[196:199], a[76:79], v[92:95]
    s_mov_b32 s19, 1048576
    v_mfma_f32_16x16x32_bf16 v[88:91], v[196:199], a[72:75], v[88:91]
    buffer_load_dwordx4 v[160:163], v13, s[4:7], s19 offen sc1
    v_mfma_f32_16x16x32_bf16 v[84:87], v[196:199], a[68:71], v[84:87]
    v_mfma_f32_16x16x32_bf16 v[80:83], v[196:199], a[64:67], v[80:83]
    ds_read_b128 v[196:199], v1 offset:37888
    s_waitcnt lgkmcnt(5)
    v_mfma_f32_16x16x32_bf16 v[96:99], v[200:203], a[64:67], v[96:99]
    v_mfma_f32_16x16x32_bf16 v[100:103], v[200:203], a[68:71], v[100:103]
    buffer_load_dwordx4 a[52:55], v5, s[4:7], s87 offen offset:0 sc1
    v_mfma_f32_16x16x32_bf16 v[104:107], v[200:203], a[72:75], v[104:107]
    v_mfma_f32_16x16x32_bf16 v[108:111], v[200:203], a[76:79], v[108:111]
    ds_read_b128 v[200:203], v1 offset:38912
    s_waitcnt lgkmcnt(5)
    v_mfma_f32_16x16x32_bf16 v[124:127], v[204:207], a[76:79], v[124:127]
    v_mfma_f32_16x16x32_bf16 v[120:123], v[204:207], a[72:75], v[120:123]
    buffer_load_dwordx4 a[56:59], v6, s[4:7], s87 offen offset:0 sc1
    v_mfma_f32_16x16x32_bf16 v[116:119], v[204:207], a[68:71], v[116:119]
    v_mfma_f32_16x16x32_bf16 v[112:115], v[204:207], a[64:67], v[112:115]
    ds_read_b128 v[204:207], v1 offset:39936
    s_waitcnt lgkmcnt(5)
    v_mfma_f32_16x16x32_bf16 v[128:131], a[64:67], v[208:211], v[128:131]
    s_mov_b32 s19, 1064960
    v_mfma_f32_16x16x32_bf16 v[132:135], a[68:71], v[208:211], v[132:135]
    buffer_load_dwordx4 v[164:167], v13, s[4:7], s19 offen sc1
    v_mfma_f32_16x16x32_bf16 v[136:139], a[72:75], v[208:211], v[136:139]
    v_mfma_f32_16x16x32_bf16 v[140:143], a[76:79], v[208:211], v[140:143]
    ds_read_b128 v[208:211], v1 offset:40960
    s_waitcnt lgkmcnt(5)
    v_mfma_f32_16x16x32_bf16 v[156:159], a[76:79], v[212:215], v[156:159]
    v_mfma_f32_16x16x32_bf16 v[152:155], a[72:75], v[212:215], v[152:155]
    buffer_load_dwordx4 a[60:63], v7, s[4:7], s87 offen offset:0 sc1
    v_mfma_f32_16x16x32_bf16 v[148:151], a[68:71], v[212:215], v[148:151]
    v_mfma_f32_16x16x32_bf16 v[144:147], a[64:67], v[212:215], v[144:147]
    ds_read_b128 v[212:215], v1 offset:41984
    s_waitcnt lgkmcnt(5)
    v_mfma_f32_16x16x32_bf16 v[64:67], v[192:195], a[80:83], v[64:67]
    v_mfma_f32_16x16x32_bf16 v[68:71], v[192:195], a[84:87], v[68:71]
    buffer_load_dwordx4 a[64:67], v4, s[4:7], s87 offen offset:1024 sc1
    v_mfma_f32_16x16x32_bf16 v[72:75], v[192:195], a[88:91], v[72:75]
    v_mfma_f32_16x16x32_bf16 v[76:79], v[192:195], a[92:95], v[76:79]
    ds_read_b128 v[192:195], v1 offset:43008
    s_waitcnt lgkmcnt(5)
    v_mfma_f32_16x16x32_bf16 v[92:95], v[196:199], a[92:95], v[92:95]
    s_add_u32 m0, s57, 122880
    s_add_u32 s63, s98, 14680064
    v_mfma_f32_16x16x32_bf16 v[88:91], v[196:199], a[88:91], v[88:91]
    buffer_load_dwordx4 v10, s[4:7], s63 offen offset:0 lds
    v_mfma_f32_16x16x32_bf16 v[84:87], v[196:199], a[84:87], v[84:87]
    v_mfma_f32_16x16x32_bf16 v[80:83], v[196:199], a[80:83], v[80:83]
    ds_read_b128 v[196:199], v1 offset:44032
    s_waitcnt lgkmcnt(5)
    v_mfma_f32_16x16x32_bf16 v[96:99], v[200:203], a[80:83], v[96:99]
    v_mfma_f32_16x16x32_bf16 v[100:103], v[200:203], a[84:87], v[100:103]
    buffer_load_dwordx4 a[68:71], v5, s[4:7], s87 offen offset:1024 sc1
    v_mfma_f32_16x16x32_bf16 v[104:107], v[200:203], a[88:91], v[104:107]
    v_mfma_f32_16x16x32_bf16 v[108:111], v[200:203], a[92:95], v[108:111]
    ds_read_b128 v[200:203], v1 offset:45056
    s_waitcnt lgkmcnt(5)
    v_mfma_f32_16x16x32_bf16 v[124:127], v[204:207], a[92:95], v[124:127]
    v_mfma_f32_16x16x32_bf16 v[120:123], v[204:207], a[88:91], v[120:123]
    buffer_load_dwordx4 a[72:75], v6, s[4:7], s87 offen offset:1024 sc1
    v_mfma_f32_16x16x32_bf16 v[116:119], v[204:207], a[84:87], v[116:119]
    v_mfma_f32_16x16x32_bf16 v[112:115], v[204:207], a[80:83], v[112:115]
    ds_read_b128 v[204:207], v1 offset:46080
    s_waitcnt lgkmcnt(5)
    v_mfma_f32_16x16x32_bf16 v[128:131], a[80:83], v[208:211], v[128:131]
    s_mov_b32 s19, 1081344
    v_mfma_f32_16x16x32_bf16 v[132:135], a[84:87], v[208:211], v[132:135]
    buffer_load_dwordx4 v[168:171], v13, s[4:7], s19 offen sc1
    v_mfma_f32_16x16x32_bf16 v[136:139], a[88:91], v[208:211], v[136:139]
    v_mfma_f32_16x16x32_bf16 v[140:143], a[92:95], v[208:211], v[140:143]
    ds_read_b128 v[208:211], v1 offset:47104
    s_waitcnt lgkmcnt(5)
    v_mfma_f32_16x16x32_bf16 v[156:159], a[92:95], v[212:215], v[156:159]
    v_mfma_f32_16x16x32_bf16 v[152:155], a[88:91], v[212:215], v[152:155]
    buffer_load_dwordx4 a[76:79], v7, s[4:7], s87 offen offset:1024 sc1
    v_mfma_f32_16x16x32_bf16 v[148:151], a[84:87], v[212:215], v[148:151]
    v_mfma_f32_16x16x32_bf16 v[144:147], a[80:83], v[212:215], v[144:147]
    ds_read_b128 v[212:215], v1 offset:48128
    s_waitcnt vmcnt(12)
    s_barrier
    s_waitcnt lgkmcnt(5)
    v_mfma_f32_16x16x32_bf16 v[64:67], v[192:195], a[96:99], v[64:67]
    v_mfma_f32_16x16x32_bf16 v[68:71], v[192:195], a[100:103], v[68:71]
    buffer_load_dwordx4 a[80:83], v4, s[4:7], s87 offen offset:2048 sc1
    v_mfma_f32_16x16x32_bf16 v[72:75], v[192:195], a[104:107], v[72:75]
    v_mfma_f32_16x16x32_bf16 v[76:79], v[192:195], a[108:111], v[76:79]
    ds_read_b128 v[192:195], v1 offset:49152
    s_waitcnt lgkmcnt(5)
    v_mfma_f32_16x16x32_bf16 v[92:95], v[196:199], a[108:111], v[92:95]
    v_mfma_f32_16x16x32_bf16 v[88:91], v[196:199], a[104:107], v[88:91]
    buffer_load_dwordx4 v10, s[4:7], s63 offen offset:1024 lds
    v_mfma_f32_16x16x32_bf16 v[84:87], v[196:199], a[100:103], v[84:87]
    v_mfma_f32_16x16x32_bf16 v[80:83], v[196:199], a[96:99], v[80:83]
    ds_read_b128 v[196:199], v1 offset:50176
    s_waitcnt lgkmcnt(5)
    v_mfma_f32_16x16x32_bf16 v[96:99], v[200:203], a[96:99], v[96:99]
    v_mfma_f32_16x16x32_bf16 v[100:103], v[200:203], a[100:103], v[100:103]
    buffer_load_dwordx4 a[84:87], v5, s[4:7], s87 offen offset:2048 sc1
    v_mfma_f32_16x16x32_bf16 v[104:107], v[200:203], a[104:107], v[104:107]
    v_mfma_f32_16x16x32_bf16 v[108:111], v[200:203], a[108:111], v[108:111]
    ds_read_b128 v[200:203], v1 offset:51200
    s_waitcnt lgkmcnt(5)
    v_mfma_f32_16x16x32_bf16 v[124:127], v[204:207], a[108:111], v[124:127]
    v_mfma_f32_16x16x32_bf16 v[120:123], v[204:207], a[104:107], v[120:123]
    buffer_load_dwordx4 a[88:91], v6, s[4:7], s87 offen offset:2048 sc1
    v_mfma_f32_16x16x32_bf16 v[116:119], v[204:207], a[100:103], v[116:119]
    v_mfma_f32_16x16x32_bf16 v[112:115], v[204:207], a[96:99], v[112:115]
    ds_read_b128 v[204:207], v1 offset:52224
    s_waitcnt lgkmcnt(5)
    v_mfma_f32_16x16x32_bf16 v[128:131], a[96:99], v[208:211], v[128:131]
    s_mov_b32 s19, 1097728
    v_mfma_f32_16x16x32_bf16 v[132:135], a[100:103], v[208:211], v[132:135]
    buffer_load_dwordx4 v[172:175], v13, s[4:7], s19 offen sc1
    v_mfma_f32_16x16x32_bf16 v[136:139], a[104:107], v[208:211], v[136:139]
    v_mfma_f32_16x16x32_bf16 v[140:143], a[108:111], v[208:211], v[140:143]
    ds_read_b128 v[208:211], v1 offset:53248
    s_waitcnt lgkmcnt(5)
    v_mfma_f32_16x16x32_bf16 v[156:159], a[108:111], v[212:215], v[156:159]
    v_mfma_f32_16x16x32_bf16 v[152:155], a[104:107], v[212:215], v[152:155]
    buffer_load_dwordx4 a[92:95], v7, s[4:7], s87 offen offset:2048 sc1
    v_mfma_f32_16x16x32_bf16 v[148:151], a[100:103], v[212:215], v[148:151]
    v_mfma_f32_16x16x32_bf16 v[144:147], a[96:99], v[212:215], v[144:147]
    ds_read_b128 v[212:215], v1 offset:54272
    s_waitcnt vmcnt(12)
    s_waitcnt lgkmcnt(5)
    v_mfma_f32_16x16x32_bf16 v[64:67], v[192:195], a[48:51], v[64:67]
    v_mfma_f32_16x16x32_bf16 v[68:71], v[192:195], a[52:55], v[68:71]
    buffer_load_dwordx4 a[96:99], v4, s[4:7], s87 offen offset:3072 sc1
    v_mfma_f32_16x16x32_bf16 v[72:75], v[192:195], a[56:59], v[72:75]
    v_mfma_f32_16x16x32_bf16 v[76:79], v[192:195], a[60:63], v[76:79]
    ds_read_b128 v[192:195], v1 offset:55296
    s_waitcnt lgkmcnt(5)
    v_mfma_f32_16x16x32_bf16 v[92:95], v[196:199], a[60:63], v[92:95]
    v_mfma_f32_16x16x32_bf16 v[88:91], v[196:199], a[56:59], v[88:91]
    buffer_load_dwordx4 v10, s[4:7], s63 offen offset:2048 lds
    v_mfma_f32_16x16x32_bf16 v[84:87], v[196:199], a[52:55], v[84:87]
    v_mfma_f32_16x16x32_bf16 v[80:83], v[196:199], a[48:51], v[80:83]
    ds_read_b128 v[196:199], v1 offset:56320
    s_waitcnt lgkmcnt(5)
    v_mfma_f32_16x16x32_bf16 v[96:99], v[200:203], a[48:51], v[96:99]
    v_mfma_f32_16x16x32_bf16 v[100:103], v[200:203], a[52:55], v[100:103]
    buffer_load_dwordx4 a[100:103], v5, s[4:7], s87 offen offset:3072 sc1
    v_mfma_f32_16x16x32_bf16 v[104:107], v[200:203], a[56:59], v[104:107]
    v_mfma_f32_16x16x32_bf16 v[108:111], v[200:203], a[60:63], v[108:111]
    ds_read_b128 v[200:203], v1 offset:57344
    s_waitcnt lgkmcnt(5)
    v_mfma_f32_16x16x32_bf16 v[124:127], v[204:207], a[60:63], v[124:127]
    v_mfma_f32_16x16x32_bf16 v[120:123], v[204:207], a[56:59], v[120:123]
    buffer_load_dwordx4 a[104:107], v6, s[4:7], s87 offen offset:3072 sc1
    v_mfma_f32_16x16x32_bf16 v[116:119], v[204:207], a[52:55], v[116:119]
    v_mfma_f32_16x16x32_bf16 v[112:115], v[204:207], a[48:51], v[112:115]
    ds_read_b128 v[204:207], v1 offset:58368
    s_waitcnt lgkmcnt(5)
    v_mfma_f32_16x16x32_bf16 v[128:131], a[48:51], v[208:211], v[128:131]
    s_mov_b32 s19, 1114112
    v_mfma_f32_16x16x32_bf16 v[132:135], a[52:55], v[208:211], v[132:135]
    buffer_load_dwordx4 v[176:179], v13, s[4:7], s19 offen sc1
    v_mfma_f32_16x16x32_bf16 v[136:139], a[56:59], v[208:211], v[136:139]
    v_mfma_f32_16x16x32_bf16 v[140:143], a[60:63], v[208:211], v[140:143]
    ds_read_b128 v[208:211], v1 offset:59392
    s_waitcnt lgkmcnt(5)
    v_mfma_f32_16x16x32_bf16 v[156:159], a[60:63], v[212:215], v[156:159]
    v_mfma_f32_16x16x32_bf16 v[152:155], a[56:59], v[212:215], v[152:155]
    buffer_load_dwordx4 a[108:111], v7, s[4:7], s87 offen offset:3072 sc1
    v_mfma_f32_16x16x32_bf16 v[148:151], a[52:55], v[212:215], v[148:151]
    v_mfma_f32_16x16x32_bf16 v[144:147], a[48:51], v[212:215], v[144:147]
    ds_read_b128 v[212:215], v1 offset:60416
    s_waitcnt vmcnt(12)
    s_waitcnt lgkmcnt(5)
    v_mfma_f32_16x16x32_bf16 v[64:67], v[192:195], a[64:67], v[64:67]
    v_mfma_f32_16x16x32_bf16 v[68:71], v[192:195], a[68:71], v[68:71]
    buffer_load_dwordx4 a[48:51], v4, s[4:7], s88 offen offset:0 sc1
    v_mfma_f32_16x16x32_bf16 v[72:75], v[192:195], a[72:75], v[72:75]
    v_mfma_f32_16x16x32_bf16 v[76:79], v[192:195], a[76:79], v[76:79]
    ds_read_b128 v[192:195], v1 offset:61440
    s_waitcnt lgkmcnt(5)
    v_mfma_f32_16x16x32_bf16 v[92:95], v[196:199], a[76:79], v[92:95]
    v_mfma_f32_16x16x32_bf16 v[88:91], v[196:199], a[72:75], v[88:91]
    buffer_load_dwordx4 v10, s[4:7], s63 offen offset:3072 lds
    v_mfma_f32_16x16x32_bf16 v[84:87], v[196:199], a[68:71], v[84:87]
    v_mfma_f32_16x16x32_bf16 v[80:83], v[196:199], a[64:67], v[80:83]
    ds_read_b128 v[196:199], v1 offset:62464
    s_waitcnt lgkmcnt(5)
    v_mfma_f32_16x16x32_bf16 v[96:99], v[200:203], a[64:67], v[96:99]
    v_mfma_f32_16x16x32_bf16 v[100:103], v[200:203], a[68:71], v[100:103]
    buffer_load_dwordx4 a[52:55], v5, s[4:7], s88 offen offset:0 sc1
    v_mfma_f32_16x16x32_bf16 v[104:107], v[200:203], a[72:75], v[104:107]
    v_mfma_f32_16x16x32_bf16 v[108:111], v[200:203], a[76:79], v[108:111]
    ds_read_b128 v[200:203], v1 offset:63488
    s_waitcnt lgkmcnt(5)
    v_mfma_f32_16x16x32_bf16 v[124:127], v[204:207], a[76:79], v[124:127]
    v_mfma_f32_16x16x32_bf16 v[120:123], v[204:207], a[72:75], v[120:123]
    buffer_load_dwordx4 a[56:59], v6, s[4:7], s88 offen offset:0 sc1
    v_mfma_f32_16x16x32_bf16 v[116:119], v[204:207], a[68:71], v[116:119]
    v_mfma_f32_16x16x32_bf16 v[112:115], v[204:207], a[64:67], v[112:115]
    ds_read_b128 v[204:207], v1 offset:64512
    s_waitcnt lgkmcnt(5)
    v_mfma_f32_16x16x32_bf16 v[128:131], a[64:67], v[208:211], v[128:131]
    s_mov_b32 s19, 1130496
    v_mfma_f32_16x16x32_bf16 v[132:135], a[68:71], v[208:211], v[132:135]
    buffer_load_dwordx4 v[180:183], v13, s[4:7], s19 offen sc1
    v_mfma_f32_16x16x32_bf16 v[136:139], a[72:75], v[208:211], v[136:139]
    v_mfma_f32_16x16x32_bf16 v[140:143], a[76:79], v[208:211], v[140:143]
    ds_read_b128 v[208:211], v2 offset:0
    s_waitcnt lgkmcnt(5)
    v_mfma_f32_16x16x32_bf16 v[156:159], a[76:79], v[212:215], v[156:159]
    v_mfma_f32_16x16x32_bf16 v[152:155], a[72:75], v[212:215], v[152:155]
    buffer_load_dwordx4 a[60:63], v7, s[4:7], s88 offen offset:0 sc1
    v_mfma_f32_16x16x32_bf16 v[148:151], a[68:71], v[212:215], v[148:151]
    v_mfma_f32_16x16x32_bf16 v[144:147], a[64:67], v[212:215], v[144:147]
    ds_read_b128 v[212:215], v2 offset:1024
    s_waitcnt vmcnt(12)
    s_waitcnt lgkmcnt(5)
    v_mfma_f32_16x16x32_bf16 v[64:67], v[192:195], a[80:83], v[64:67]
    v_mfma_f32_16x16x32_bf16 v[68:71], v[192:195], a[84:87], v[68:71]
    buffer_load_dwordx4 a[64:67], v4, s[4:7], s88 offen offset:1024 sc1
    v_mfma_f32_16x16x32_bf16 v[72:75], v[192:195], a[88:91], v[72:75]
    v_mfma_f32_16x16x32_bf16 v[76:79], v[192:195], a[92:95], v[76:79]
    ds_read_b128 v[192:195], v2 offset:2048
    s_waitcnt lgkmcnt(5)
    v_mfma_f32_16x16x32_bf16 v[92:95], v[196:199], a[92:95], v[92:95]
    s_add_u32 m0, s57, 126976
    s_add_u32 s63, s98, 14684160
    v_mfma_f32_16x16x32_bf16 v[88:91], v[196:199], a[88:91], v[88:91]
    buffer_load_dwordx4 v10, s[4:7], s63 offen offset:0 lds
    v_mfma_f32_16x16x32_bf16 v[84:87], v[196:199], a[84:87], v[84:87]
    v_mfma_f32_16x16x32_bf16 v[80:83], v[196:199], a[80:83], v[80:83]
    ds_read_b128 v[196:199], v2 offset:3072
    s_waitcnt lgkmcnt(5)
    v_mfma_f32_16x16x32_bf16 v[96:99], v[200:203], a[80:83], v[96:99]
    v_mfma_f32_16x16x32_bf16 v[100:103], v[200:203], a[84:87], v[100:103]
    buffer_load_dwordx4 a[68:71], v5, s[4:7], s88 offen offset:1024 sc1
    v_mfma_f32_16x16x32_bf16 v[104:107], v[200:203], a[88:91], v[104:107]
    v_mfma_f32_16x16x32_bf16 v[108:111], v[200:203], a[92:95], v[108:111]
    ds_read_b128 v[200:203], v2 offset:4096
    s_waitcnt lgkmcnt(5)
    v_mfma_f32_16x16x32_bf16 v[124:127], v[204:207], a[92:95], v[124:127]
    v_mfma_f32_16x16x32_bf16 v[120:123], v[204:207], a[88:91], v[120:123]
    buffer_load_dwordx4 a[72:75], v6, s[4:7], s88 offen offset:1024 sc1
    v_mfma_f32_16x16x32_bf16 v[116:119], v[204:207], a[84:87], v[116:119]
    v_mfma_f32_16x16x32_bf16 v[112:115], v[204:207], a[80:83], v[112:115]
    ds_read_b128 v[204:207], v2 offset:5120
    s_waitcnt lgkmcnt(5)
    v_mfma_f32_16x16x32_bf16 v[128:131], a[80:83], v[208:211], v[128:131]
    s_mov_b32 s19, 1146880
    v_mfma_f32_16x16x32_bf16 v[132:135], a[84:87], v[208:211], v[132:135]
    buffer_load_dwordx4 v[184:187], v13, s[4:7], s19 offen sc1
    v_mfma_f32_16x16x32_bf16 v[136:139], a[88:91], v[208:211], v[136:139]
    v_mfma_f32_16x16x32_bf16 v[140:143], a[92:95], v[208:211], v[140:143]
    ds_read_b128 v[208:211], v2 offset:6144
    s_waitcnt lgkmcnt(5)
    v_mfma_f32_16x16x32_bf16 v[156:159], a[92:95], v[212:215], v[156:159]
    v_mfma_f32_16x16x32_bf16 v[152:155], a[88:91], v[212:215], v[152:155]
    buffer_load_dwordx4 a[76:79], v7, s[4:7], s88 offen offset:1024 sc1
    v_mfma_f32_16x16x32_bf16 v[148:151], a[84:87], v[212:215], v[148:151]
    v_mfma_f32_16x16x32_bf16 v[144:147], a[80:83], v[212:215], v[144:147]
    ds_read_b128 v[212:215], v2 offset:7168
    s_waitcnt vmcnt(12)
    s_barrier
    s_waitcnt lgkmcnt(5)
    v_mfma_f32_16x16x32_bf16 v[64:67], v[192:195], a[96:99], v[64:67]
    v_mfma_f32_16x16x32_bf16 v[68:71], v[192:195], a[100:103], v[68:71]
    buffer_load_dwordx4 a[80:83], v4, s[4:7], s88 offen offset:2048 sc1
    v_mfma_f32_16x16x32_bf16 v[72:75], v[192:195], a[104:107], v[72:75]
    v_mfma_f32_16x16x32_bf16 v[76:79], v[192:195], a[108:111], v[76:79]
    ds_read_b128 v[192:195], v2 offset:8192
    s_waitcnt lgkmcnt(5)
    v_mfma_f32_16x16x32_bf16 v[92:95], v[196:199], a[108:111], v[92:95]
    v_mfma_f32_16x16x32_bf16 v[88:91], v[196:199], a[104:107], v[88:91]
    buffer_load_dwordx4 v10, s[4:7], s63 offen offset:1024 lds
    v_mfma_f32_16x16x32_bf16 v[84:87], v[196:199], a[100:103], v[84:87]
    v_mfma_f32_16x16x32_bf16 v[80:83], v[196:199], a[96:99], v[80:83]
    ds_read_b128 v[196:199], v2 offset:9216
    s_waitcnt lgkmcnt(5)
    v_mfma_f32_16x16x32_bf16 v[96:99], v[200:203], a[96:99], v[96:99]
    v_mfma_f32_16x16x32_bf16 v[100:103], v[200:203], a[100:103], v[100:103]
    buffer_load_dwordx4 a[84:87], v5, s[4:7], s88 offen offset:2048 sc1
    v_mfma_f32_16x16x32_bf16 v[104:107], v[200:203], a[104:107], v[104:107]
    v_mfma_f32_16x16x32_bf16 v[108:111], v[200:203], a[108:111], v[108:111]
    ds_read_b128 v[200:203], v2 offset:10240
    s_waitcnt lgkmcnt(5)
    v_mfma_f32_16x16x32_bf16 v[124:127], v[204:207], a[108:111], v[124:127]
    v_mfma_f32_16x16x32_bf16 v[120:123], v[204:207], a[104:107], v[120:123]
    buffer_load_dwordx4 a[88:91], v6, s[4:7], s88 offen offset:2048 sc1
    v_mfma_f32_16x16x32_bf16 v[116:119], v[204:207], a[100:103], v[116:119]
    v_mfma_f32_16x16x32_bf16 v[112:115], v[204:207], a[96:99], v[112:115]
    ds_read_b128 v[204:207], v2 offset:11264
    s_waitcnt lgkmcnt(5)
    v_mfma_f32_16x16x32_bf16 v[128:131], a[96:99], v[208:211], v[128:131]
    s_mov_b32 s19, 1163264
    v_mfma_f32_16x16x32_bf16 v[132:135], a[100:103], v[208:211], v[132:135]
    buffer_load_dwordx4 v[188:191], v13, s[4:7], s19 offen sc1
    v_mfma_f32_16x16x32_bf16 v[136:139], a[104:107], v[208:211], v[136:139]
    v_mfma_f32_16x16x32_bf16 v[140:143], a[108:111], v[208:211], v[140:143]
    ds_read_b128 v[208:211], v2 offset:12288
    s_waitcnt lgkmcnt(5)
    v_mfma_f32_16x16x32_bf16 v[156:159], a[108:111], v[212:215], v[156:159]
    v_mfma_f32_16x16x32_bf16 v[152:155], a[104:107], v[212:215], v[152:155]
    buffer_load_dwordx4 a[92:95], v7, s[4:7], s88 offen offset:2048 sc1
    v_mfma_f32_16x16x32_bf16 v[148:151], a[100:103], v[212:215], v[148:151]
    v_mfma_f32_16x16x32_bf16 v[144:147], a[96:99], v[212:215], v[144:147]
    ds_read_b128 v[212:215], v2 offset:13312
    s_waitcnt vmcnt(12)
    s_waitcnt lgkmcnt(5)
    v_mfma_f32_16x16x32_bf16 v[64:67], v[192:195], a[48:51], v[64:67]
    v_mfma_f32_16x16x32_bf16 v[68:71], v[192:195], a[52:55], v[68:71]
    buffer_load_dwordx4 a[96:99], v4, s[4:7], s88 offen offset:3072 sc1
    v_mfma_f32_16x16x32_bf16 v[72:75], v[192:195], a[56:59], v[72:75]
    v_mfma_f32_16x16x32_bf16 v[76:79], v[192:195], a[60:63], v[76:79]
    ds_read_b128 v[192:195], v2 offset:14336
    s_waitcnt lgkmcnt(5)
    v_mfma_f32_16x16x32_bf16 v[92:95], v[196:199], a[60:63], v[92:95]
    v_mfma_f32_16x16x32_bf16 v[88:91], v[196:199], a[56:59], v[88:91]
    buffer_load_dwordx4 a[100:103], v5, s[4:7], s88 offen offset:3072 sc1
    v_mfma_f32_16x16x32_bf16 v[84:87], v[196:199], a[52:55], v[84:87]
    v_mfma_f32_16x16x32_bf16 v[80:83], v[196:199], a[48:51], v[80:83]
    ds_read_b128 v[196:199], v2 offset:15360
    s_waitcnt lgkmcnt(5)
    v_mfma_f32_16x16x32_bf16 v[96:99], v[200:203], a[48:51], v[96:99]
    s_add_u32 m0, s57, 0
    s_add_u32 s63, s99, 14680064
    v_mfma_f32_16x16x32_bf16 v[100:103], v[200:203], a[52:55], v[100:103]
    buffer_load_dwordx4 v10, s[4:7], s63 offen offset:0 lds
    v_mfma_f32_16x16x32_bf16 v[104:107], v[200:203], a[56:59], v[104:107]
    v_mfma_f32_16x16x32_bf16 v[108:111], v[200:203], a[60:63], v[108:111]
    ds_read_b128 v[200:203], v2 offset:16384
    s_waitcnt lgkmcnt(5)
    v_mfma_f32_16x16x32_bf16 v[124:127], v[204:207], a[60:63], v[124:127]
    v_mfma_f32_16x16x32_bf16 v[120:123], v[204:207], a[56:59], v[120:123]
    buffer_load_dwordx4 a[104:107], v6, s[4:7], s88 offen offset:3072 sc1
    v_mfma_f32_16x16x32_bf16 v[116:119], v[204:207], a[52:55], v[116:119]
    v_mfma_f32_16x16x32_bf16 v[112:115], v[204:207], a[48:51], v[112:115]
    ds_read_b128 v[204:207], v2 offset:17408
    s_waitcnt lgkmcnt(5)
    v_mfma_f32_16x16x32_bf16 v[128:131], a[48:51], v[208:211], v[128:131]
    v_mfma_f32_16x16x32_bf16 v[132:135], a[52:55], v[208:211], v[132:135]
    buffer_load_dwordx4 a[108:111], v7, s[4:7], s88 offen offset:3072 sc1
    v_mfma_f32_16x16x32_bf16 v[136:139], a[56:59], v[208:211], v[136:139]
    v_mfma_f32_16x16x32_bf16 v[140:143], a[60:63], v[208:211], v[140:143]
    ds_read_b128 v[208:211], v2 offset:18432
    s_waitcnt lgkmcnt(5)
    v_mfma_f32_16x16x32_bf16 v[156:159], a[60:63], v[212:215], v[156:159]
    v_mfma_f32_16x16x32_bf16 v[152:155], a[56:59], v[212:215], v[152:155]
    v_mfma_f32_16x16x32_bf16 v[148:151], a[52:55], v[212:215], v[148:151]
    v_mfma_f32_16x16x32_bf16 v[144:147], a[48:51], v[212:215], v[144:147]
    ds_read_b128 v[212:215], v2 offset:19456
    s_waitcnt vmcnt(11)
    s_waitcnt lgkmcnt(5)
    v_mfma_f32_16x16x32_bf16 v[64:67], v[192:195], a[64:67], v[64:67]
    v_mfma_f32_16x16x32_bf16 v[68:71], v[192:195], a[68:71], v[68:71]
    buffer_load_dwordx4 a[48:51], v4, s[4:7], s89 offen offset:0 sc1
    v_mfma_f32_16x16x32_bf16 v[72:75], v[192:195], a[72:75], v[72:75]
    v_mfma_f32_16x16x32_bf16 v[76:79], v[192:195], a[76:79], v[76:79]
    ds_read_b128 v[192:195], v2 offset:20480
    s_waitcnt lgkmcnt(5)
    v_mfma_f32_16x16x32_bf16 v[92:95], v[196:199], a[76:79], v[92:95]
    v_mfma_f32_16x16x32_bf16 v[88:91], v[196:199], a[72:75], v[88:91]
    buffer_load_dwordx4 a[52:55], v5, s[4:7], s89 offen offset:0 sc1
    v_mfma_f32_16x16x32_bf16 v[84:87], v[196:199], a[68:71], v[84:87]
    v_mfma_f32_16x16x32_bf16 v[80:83], v[196:199], a[64:67], v[80:83]
    ds_read_b128 v[196:199], v2 offset:21504
    s_waitcnt lgkmcnt(5)
    v_mfma_f32_16x16x32_bf16 v[96:99], v[200:203], a[64:67], v[96:99]
    v_mfma_f32_16x16x32_bf16 v[100:103], v[200:203], a[68:71], v[100:103]
    buffer_load_dwordx4 v10, s[4:7], s63 offen offset:1024 lds
    v_mfma_f32_16x16x32_bf16 v[104:107], v[200:203], a[72:75], v[104:107]
    v_mfma_f32_16x16x32_bf16 v[108:111], v[200:203], a[76:79], v[108:111]
    ds_read_b128 v[200:203], v2 offset:22528
    s_waitcnt lgkmcnt(5)
    v_mfma_f32_16x16x32_bf16 v[124:127], v[204:207], a[76:79], v[124:127]
    v_mfma_f32_16x16x32_bf16 v[120:123], v[204:207], a[72:75], v[120:123]
    buffer_load_dwordx4 a[56:59], v6, s[4:7], s89 offen offset:0 sc1
    v_mfma_f32_16x16x32_bf16 v[116:119], v[204:207], a[68:71], v[116:119]
    v_mfma_f32_16x16x32_bf16 v[112:115], v[204:207], a[64:67], v[112:115]
    ds_read_b128 v[204:207], v2 offset:23552
    s_waitcnt lgkmcnt(5)
    v_mfma_f32_16x16x32_bf16 v[128:131], a[64:67], v[208:211], v[128:131]
    v_mfma_f32_16x16x32_bf16 v[132:135], a[68:71], v[208:211], v[132:135]
    buffer_load_dwordx4 a[60:63], v7, s[4:7], s89 offen offset:0 sc1
    v_mfma_f32_16x16x32_bf16 v[136:139], a[72:75], v[208:211], v[136:139]
    v_mfma_f32_16x16x32_bf16 v[140:143], a[76:79], v[208:211], v[140:143]
    ds_read_b128 v[208:211], v2 offset:24576
    s_waitcnt lgkmcnt(5)
    v_mfma_f32_16x16x32_bf16 v[156:159], a[76:79], v[212:215], v[156:159]
    v_mfma_f32_16x16x32_bf16 v[152:155], a[72:75], v[212:215], v[152:155]
    v_mfma_f32_16x16x32_bf16 v[148:151], a[68:71], v[212:215], v[148:151]
    v_mfma_f32_16x16x32_bf16 v[144:147], a[64:67], v[212:215], v[144:147]
    ds_read_b128 v[212:215], v2 offset:25600
    s_waitcnt vmcnt(10)
    s_waitcnt lgkmcnt(5)
    v_mfma_f32_16x16x32_bf16 v[64:67], v[192:195], a[80:83], v[64:67]
    v_add_f32 v160, v160, v176
    v_add_f32 v161, v161, v177
    v_mfma_f32_16x16x32_bf16 v[68:71], v[192:195], a[84:87], v[68:71]
    buffer_load_dwordx4 a[64:67], v4, s[4:7], s89 offen offset:1024 sc1
    v_mfma_f32_16x16x32_bf16 v[72:75], v[192:195], a[88:91], v[72:75]
    v_add_f32 v162, v162, v178
    v_add_f32 v163, v163, v179
    v_mfma_f32_16x16x32_bf16 v[76:79], v[192:195], a[92:95], v[76:79]
    ds_read_b128 v[192:195], v2 offset:26624
    s_waitcnt lgkmcnt(5)
    v_mfma_f32_16x16x32_bf16 v[92:95], v[196:199], a[92:95], v[92:95]
    v_add_f32 v164, v164, v180
    v_add_f32 v165, v165, v181
    v_mfma_f32_16x16x32_bf16 v[88:91], v[196:199], a[88:91], v[88:91]
    buffer_load_dwordx4 a[68:71], v5, s[4:7], s89 offen offset:1024 sc1
    v_mfma_f32_16x16x32_bf16 v[84:87], v[196:199], a[84:87], v[84:87]
    v_add_f32 v166, v166, v182
    v_add_f32 v167, v167, v183
    v_mfma_f32_16x16x32_bf16 v[80:83], v[196:199], a[80:83], v[80:83]
    ds_read_b128 v[196:199], v2 offset:27648
    s_waitcnt lgkmcnt(5)
    v_mfma_f32_16x16x32_bf16 v[96:99], v[200:203], a[80:83], v[96:99]
    v_add_f32 v168, v168, v184
    v_add_f32 v169, v169, v185
    v_mfma_f32_16x16x32_bf16 v[100:103], v[200:203], a[84:87], v[100:103]
    buffer_load_dwordx4 v10, s[4:7], s63 offen offset:2048 lds
    v_mfma_f32_16x16x32_bf16 v[104:107], v[200:203], a[88:91], v[104:107]
    v_add_f32 v170, v170, v186
    v_add_f32 v171, v171, v187
    v_mfma_f32_16x16x32_bf16 v[108:111], v[200:203], a[92:95], v[108:111]
    ds_read_b128 v[200:203], v2 offset:28672
    s_waitcnt lgkmcnt(5)
    v_mfma_f32_16x16x32_bf16 v[124:127], v[204:207], a[92:95], v[124:127]
    v_add_f32 v172, v172, v188
    v_add_f32 v173, v173, v189
    v_mfma_f32_16x16x32_bf16 v[120:123], v[204:207], a[88:91], v[120:123]
    buffer_load_dwordx4 a[72:75], v6, s[4:7], s89 offen offset:1024 sc1
    v_mfma_f32_16x16x32_bf16 v[116:119], v[204:207], a[84:87], v[116:119]
    v_add_f32 v174, v174, v190
    v_add_f32 v175, v175, v191
    v_mfma_f32_16x16x32_bf16 v[112:115], v[204:207], a[80:83], v[112:115]
    ds_read_b128 v[204:207], v2 offset:29696
    s_waitcnt lgkmcnt(5)
    v_mfma_f32_16x16x32_bf16 v[128:131], a[80:83], v[208:211], v[128:131]
    v_add_f32 v160, v160, v168
    v_add_f32 v161, v161, v169
    v_mfma_f32_16x16x32_bf16 v[132:135], a[84:87], v[208:211], v[132:135]
    buffer_load_dwordx4 a[76:79], v7, s[4:7], s89 offen offset:1024 sc1
    v_mfma_f32_16x16x32_bf16 v[136:139], a[88:91], v[208:211], v[136:139]
    v_add_f32 v162, v162, v170
    v_add_f32 v163, v163, v171
    v_mfma_f32_16x16x32_bf16 v[140:143], a[92:95], v[208:211], v[140:143]
    ds_read_b128 v[208:211], v2 offset:30720
    s_waitcnt lgkmcnt(5)
    v_mfma_f32_16x16x32_bf16 v[156:159], a[92:95], v[212:215], v[156:159]
    v_add_f32 v164, v164, v172
    v_add_f32 v165, v165, v173
    v_mfma_f32_16x16x32_bf16 v[152:155], a[88:91], v[212:215], v[152:155]
    v_add_f32 v166, v166, v174
    v_add_f32 v167, v167, v175
    v_mfma_f32_16x16x32_bf16 v[148:151], a[84:87], v[212:215], v[148:151]
    v_add_f32 v160, v160, v164
    v_add_f32 v161, v161, v165
    v_mfma_f32_16x16x32_bf16 v[144:147], a[80:83], v[212:215], v[144:147]
    ds_read_b128 v[212:215], v2 offset:31744
    s_waitcnt vmcnt(10)
    s_barrier
    s_waitcnt lgkmcnt(5)
    v_mfma_f32_16x16x32_bf16 v[64:67], v[192:195], a[96:99], v[64:67]
    v_add_f32 v162, v162, v166
    v_add_f32 v163, v163, v167
    v_mfma_f32_16x16x32_bf16 v[68:71], v[192:195], a[100:103], v[68:71]
    buffer_load_dwordx4 a[80:83], v4, s[4:7], s89 offen offset:2048 sc1
    v_mfma_f32_16x16x32_bf16 v[72:75], v[192:195], a[104:107], v[72:75]
    s_nop 0
    v_mfma_f32_16x16x32_bf16 v[76:79], v[192:195], a[108:111], v[76:79]
    ds_read_b128 v[192:195], v2 offset:32768
    s_waitcnt lgkmcnt(5)
    v_mfma_f32_16x16x32_bf16 v[92:95], v[196:199], a[108:111], v[92:95]
    v_permlane32_swap_b32 v160, v162
    v_mfma_f32_16x16x32_bf16 v[88:91], v[196:199], a[104:107], v[88:91]
    buffer_load_dwordx4 v10, s[4:7], s63 offen offset:3072 lds
    v_mfma_f32_16x16x32_bf16 v[84:87], v[196:199], a[100:103], v[84:87]
    v_permlane32_swap_b32 v161, v163
    v_mfma_f32_16x16x32_bf16 v[80:83], v[196:199], a[96:99], v[80:83]
    ds_read_b128 v[196:199], v2 offset:33792
    s_waitcnt lgkmcnt(5)
    v_mfma_f32_16x16x32_bf16 v[96:99], v[200:203], a[96:99], v[96:99]
    v_add_f32 v160, v160, v162
    v_add_f32 v161, v161, v163
    v_mfma_f32_16x16x32_bf16 v[100:103], v[200:203], a[100:103], v[100:103]
    buffer_load_dwordx4 a[84:87], v5, s[4:7], s89 offen offset:2048 sc1
    v_mfma_f32_16x16x32_bf16 v[104:107], v[200:203], a[104:107], v[104:107]
    v_mul_f32 v163, 0xba800000, v160
    v_mul_f32 v161, 0x3a800000, v161
    v_mfma_f32_16x16x32_bf16 v[108:111], v[200:203], a[108:111], v[108:111]
    ds_read_b128 v[200:203], v2 offset:34816
    s_waitcnt lgkmcnt(5)
    v_mfma_f32_16x16x32_bf16 v[124:127], v[204:207], a[108:111], v[124:127]
    v_fma_f32 v161, -v163, v163, v161
    v_max_f32 v161, 0, v161
    v_mfma_f32_16x16x32_bf16 v[120:123], v[204:207], a[104:107], v[120:123]
    buffer_load_dwordx4 a[88:91], v6, s[4:7], s89 offen offset:2048 sc1
    v_mfma_f32_16x16x32_bf16 v[116:119], v[204:207], a[100:103], v[116:119]
    v_add_f32 v161, 0x3727c5ac, v161
    v_mfma_f32_16x16x32_bf16 v[112:115], v[204:207], a[96:99], v[112:115]
    ds_read_b128 v[204:207], v2 offset:35840
    s_waitcnt lgkmcnt(5)
    v_mfma_f32_16x16x32_bf16 v[128:131], a[96:99], v[208:211], v[128:131]
    s_add_u32 m0, s57, 4096
    s_add_u32 s63, s99, 14684160
    v_mfma_f32_16x16x32_bf16 v[132:135], a[100:103], v[208:211], v[132:135]
    buffer_load_dwordx4 v10, s[4:7], s63 offen offset:0 lds
    v_mfma_f32_16x16x32_bf16 v[136:139], a[104:107], v[208:211], v[136:139]
    v_rsq_f32 v162, v161
    v_mfma_f32_16x16x32_bf16 v[140:143], a[108:111], v[208:211], v[140:143]
    ds_read_b128 v[208:211], v2 offset:36864
    s_waitcnt lgkmcnt(5)
    v_mfma_f32_16x16x32_bf16 v[156:159], a[108:111], v[212:215], v[156:159]
    ds_write2_b32 v58, v162, v163 offset0:0 offset1:64
    v_mfma_f32_16x16x32_bf16 v[152:155], a[104:107], v[212:215], v[152:155]
    buffer_load_dwordx4 a[92:95], v7, s[4:7], s89 offen offset:2048 sc1
    v_mfma_f32_16x16x32_bf16 v[148:151], a[100:103], v[212:215], v[148:151]
    ds_read2_b32 v[160:161], v59 offset0:0 offset1:64
    v_mfma_f32_16x16x32_bf16 v[144:147], a[96:99], v[212:215], v[144:147]
    ds_read_b128 v[212:215], v2 offset:37888
    s_waitcnt vmcnt(11)
    s_waitcnt lgkmcnt(7)
    v_mfma_f32_16x16x32_bf16 v[64:67], v[192:195], a[48:51], v[64:67]
    ds_read2_b32 v[162:163], v59 offset0:16 offset1:80
    v_mfma_f32_16x16x32_bf16 v[68:71], v[192:195], a[52:55], v[68:71]
    buffer_load_dwordx4 a[96:99], v4, s[4:7], s89 offen offset:3072 sc1
    v_mfma_f32_16x16x32_bf16 v[72:75], v[192:195], a[56:59], v[72:75]
    ds_read2_b32 v[164:165], v59 offset0:32 offset1:96
    v_mfma_f32_16x16x32_bf16 v[76:79], v[192:195], a[60:63], v[76:79]
    ds_read_b128 v[192:195], v2 offset:38912
    s_waitcnt lgkmcnt(9)
    v_mfma_f32_16x16x32_bf16 v[92:95], v[196:199], a[60:63], v[92:95]
    ds_read2_b32 v[166:167], v59 offset0:48 offset1:112
    v_mfma_f32_16x16x32_bf16 v[88:91], v[196:199], a[56:59], v[88:91]
    buffer_load_dwordx4 a[100:103], v5, s[4:7], s89 offen offset:3072 sc1
    v_mfma_f32_16x16x32_bf16 v[84:87], v[196:199], a[52:55], v[84:87]
    ds_read_b128 v[224:227], v51 offset:0
    v_mfma_f32_16x16x32_bf16 v[80:83], v[196:199], a[48:51], v[80:83]
    ds_read_b128 v[196:199], v2 offset:39936
    s_waitcnt lgkmcnt(11)
    v_mfma_f32_16x16x32_bf16 v[96:99], v[200:203], a[48:51], v[96:99]
    ds_read_b128 v[228:231], v51 offset:64
    v_mfma_f32_16x16x32_bf16 v[100:103], v[200:203], a[52:55], v[100:103]
    buffer_load_dwordx4 v10, s[4:7], s63 offen offset:1024 lds
    v_mfma_f32_16x16x32_bf16 v[104:107], v[200:203], a[56:59], v[104:107]
    ds_read_b128 v[232:235], v51 offset:128
    v_mfma_f32_16x16x32_bf16 v[108:111], v[200:203], a[60:63], v[108:111]
    ds_read_b128 v[200:203], v2 offset:40960
    s_waitcnt lgkmcnt(13)
    v_mfma_f32_16x16x32_bf16 v[124:127], v[204:207], a[60:63], v[124:127]
    ds_read_b128 v[236:239], v51 offset:192
    v_mfma_f32_16x16x32_bf16 v[120:123], v[204:207], a[56:59], v[120:123]
    buffer_load_dwordx4 a[104:107], v6, s[4:7], s89 offen offset:3072 sc1
    v_mfma_f32_16x16x32_bf16 v[116:119], v[204:207], a[52:55], v[116:119]
    ds_read_b128 v[240:243], v51 offset:256
    v_mfma_f32_16x16x32_bf16 v[112:115], v[204:207], a[48:51], v[112:115]
    ds_read_b128 v[204:207], v2 offset:41984
    s_waitcnt lgkmcnt(15)
    v_mfma_f32_16x16x32_bf16 v[128:131], a[48:51], v[208:211], v[128:131]
    ds_read_b128 v[244:247], v51 offset:320
    v_mfma_f32_16x16x32_bf16 v[132:135], a[52:55], v[208:211], v[132:135]
    buffer_load_dwordx4 a[108:111], v7, s[4:7], s89 offen offset:3072 sc1
    v_mfma_f32_16x16x32_bf16 v[136:139], a[56:59], v[208:211], v[136:139]
    ds_read_b128 v[248:251], v51 offset:384
    v_mfma_f32_16x16x32_bf16 v[140:143], a[60:63], v[208:211], v[140:143]
    ds_read_b128 v[208:211], v2 offset:43008
    s_waitcnt lgkmcnt(15)
    v_mfma_f32_16x16x32_bf16 v[156:159], a[60:63], v[212:215], v[156:159]
    ds_read_b128 v[252:255], v51 offset:448
    v_mfma_f32_16x16x32_bf16 v[152:155], a[56:59], v[212:215], v[152:155]
    ds_read_b128 v[168:171], v56 offset:448
    v_mfma_f32_16x16x32_bf16 v[148:151], a[52:55], v[212:215], v[148:151]
    ds_read_b128 v[172:175], v56 offset:512
    v_mfma_f32_16x16x32_bf16 v[144:147], a[48:51], v[212:215], v[144:147]
    ds_read_b128 v[212:215], v2 offset:44032
    s_waitcnt vmcnt(11)
    s_waitcnt lgkmcnt(15)
    v_mfma_f32_16x16x32_bf16 v[64:67], v[192:195], a[64:67], v[64:67]
    ds_read_b128 v[176:179], v56 offset:576
    v_mfma_f32_16x16x32_bf16 v[68:71], v[192:195], a[68:71], v[68:71]
    buffer_load_dwordx4 a[48:51], v4, s[4:7], s90 offen offset:0 sc1
    v_mfma_f32_16x16x32_bf16 v[72:75], v[192:195], a[72:75], v[72:75]
    ds_read_b128 v[180:183], v56 offset:640
    v_mfma_f32_16x16x32_bf16 v[76:79], v[192:195], a[76:79], v[76:79]
    ds_read_b128 v[192:195], v2 offset:45056
    s_waitcnt lgkmcnt(15)
    v_mfma_f32_16x16x32_bf16 v[92:95], v[196:199], a[76:79], v[92:95]
    ds_read2_b32 v[184:185], v53 offset0:160 offset1:176
    v_mfma_f32_16x16x32_bf16 v[88:91], v[196:199], a[72:75], v[88:91]
    buffer_load_dwordx4 a[52:55], v5, s[4:7], s90 offen offset:0 sc1
    v_mfma_f32_16x16x32_bf16 v[84:87], v[196:199], a[68:71], v[84:87]
    v_mfma_f32_16x16x32_bf16 v[80:83], v[196:199], a[64:67], v[80:83]
    ds_read_b128 v[196:199], v2 offset:46080
    s_waitcnt lgkmcnt(15)
    v_mfma_f32_16x16x32_bf16 v[96:99], v[200:203], a[64:67], v[96:99]
    s_add_u32 m0, s57, 24576
    s_add_u32 s63, s100, 14680064
    v_mfma_f32_16x16x32_bf16 v[100:103], v[200:203], a[68:71], v[100:103]
    buffer_load_dwordx4 v10, s[4:7], s63 offen offset:0 lds
    v_mfma_f32_16x16x32_bf16 v[104:107], v[200:203], a[72:75], v[104:107]
    v_mfma_f32_16x16x32_bf16 v[108:111], v[200:203], a[76:79], v[108:111]
    ds_read_b128 v[200:203], v2 offset:47104
    s_waitcnt lgkmcnt(13)
    v_mfma_f32_16x16x32_bf16 v[124:127], v[204:207], a[76:79], v[124:127]
    v_mfma_f32_16x16x32_bf16 v[120:123], v[204:207], a[72:75], v[120:123]
    buffer_load_dwordx4 a[56:59], v6, s[4:7], s90 offen offset:0 sc1
    v_mfma_f32_16x16x32_bf16 v[116:119], v[204:207], a[68:71], v[116:119]
    v_mfma_f32_16x16x32_bf16 v[112:115], v[204:207], a[64:67], v[112:115]
    ds_read_b128 v[204:207], v2 offset:48128
    s_waitcnt lgkmcnt(11)
    v_mfma_f32_16x16x32_bf16 v[128:131], a[64:67], v[208:211], v[128:131]
    v_mfma_f32_16x16x32_bf16 v[132:135], a[68:71], v[208:211], v[132:135]
    buffer_load_dwordx4 a[60:63], v7, s[4:7], s90 offen offset:0 sc1
    v_mfma_f32_16x16x32_bf16 v[136:139], a[72:75], v[208:211], v[136:139]
    v_mfma_f32_16x16x32_bf16 v[140:143], a[76:79], v[208:211], v[140:143]
    ds_read_b128 v[208:211], v2 offset:49152
    s_waitcnt lgkmcnt(8)
    v_mfma_f32_16x16x32_bf16 v[156:159], a[76:79], v[212:215], v[156:159]
    v_mfma_f32_16x16x32_bf16 v[152:155], a[72:75], v[212:215], v[152:155]
    v_mfma_f32_16x16x32_bf16 v[148:151], a[68:71], v[212:215], v[148:151]
    v_mfma_f32_16x16x32_bf16 v[144:147], a[64:67], v[212:215], v[144:147]
    ds_read_b128 v[212:215], v2 offset:50176
    s_waitcnt vmcnt(10)
    s_waitcnt lgkmcnt(6)
    v_mfma_f32_16x16x32_bf16 v[64:67], v[192:195], a[80:83], v[64:67]
    v_mfma_f32_16x16x32_bf16 v[68:71], v[192:195], a[84:87], v[68:71]
    buffer_load_dwordx4 a[64:67], v4, s[4:7], s90 offen offset:1024 sc1
    v_mfma_f32_16x16x32_bf16 v[72:75], v[192:195], a[88:91], v[72:75]
    v_mfma_f32_16x16x32_bf16 v[76:79], v[192:195], a[92:95], v[76:79]
    ds_read_b128 v[192:195], v2 offset:51200
    s_waitcnt lgkmcnt(5)
    v_mfma_f32_16x16x32_bf16 v[92:95], v[196:199], a[92:95], v[92:95]
    v_fmac_f32 v140, v184, v252
    v_fmac_f32 v141, v184, v253
    v_mfma_f32_16x16x32_bf16 v[88:91], v[196:199], a[88:91], v[88:91]
    buffer_load_dwordx4 a[68:71], v5, s[4:7], s90 offen offset:1024 sc1
    v_mfma_f32_16x16x32_bf16 v[84:87], v[196:199], a[84:87], v[84:87]
    v_fmac_f32 v142, v184, v254
    v_fmac_f32 v143, v184, v255
    v_mfma_f32_16x16x32_bf16 v[80:83], v[196:199], a[80:83], v[80:83]
    ds_read_b128 v[196:199], v2 offset:52224
    s_waitcnt lgkmcnt(5)
    v_mfma_f32_16x16x32_bf16 v[96:99], v[200:203], a[80:83], v[96:99]
    v_fmac_f32 v156, v185, v252
    v_fmac_f32 v157, v185, v253
    v_mfma_f32_16x16x32_bf16 v[100:103], v[200:203], a[84:87], v[100:103]
    buffer_load_dwordx4 v10, s[4:7], s63 offen offset:1024 lds
    v_mfma_f32_16x16x32_bf16 v[104:107], v[200:203], a[88:91], v[104:107]
    v_fmac_f32 v158, v185, v254
    v_fmac_f32 v159, v185, v255
    v_mfma_f32_16x16x32_bf16 v[108:111], v[200:203], a[92:95], v[108:111]
    ds_read_b128 v[200:203], v2 offset:53248
    s_waitcnt lgkmcnt(5)
    v_mfma_f32_16x16x32_bf16 v[124:127], v[204:207], a[92:95], v[124:127]
    v_fmac_f32 v76, v168, v167
    v_fmac_f32 v77, v169, v167
    v_mfma_f32_16x16x32_bf16 v[120:123], v[204:207], a[88:91], v[120:123]
    buffer_load_dwordx4 a[72:75], v6, s[4:7], s90 offen offset:1024 sc1
    v_mfma_f32_16x16x32_bf16 v[116:119], v[204:207], a[84:87], v[116:119]
    v_fmac_f32 v78, v170, v167
    v_fmac_f32 v79, v171, v167
    v_mfma_f32_16x16x32_bf16 v[112:115], v[204:207], a[80:83], v[112:115]
    ds_read_b128 v[204:207], v2 offset:54272
    s_waitcnt lgkmcnt(5)
    v_mfma_f32_16x16x32_bf16 v[128:131], a[80:83], v[208:211], v[128:131]
    v_fmac_f32 v92, v172, v167
    v_fmac_f32 v93, v173, v167
    v_mfma_f32_16x16x32_bf16 v[132:135], a[84:87], v[208:211], v[132:135]
    buffer_load_dwordx4 a[76:79], v7, s[4:7], s90 offen offset:1024 sc1
    v_mfma_f32_16x16x32_bf16 v[136:139], a[88:91], v[208:211], v[136:139]
    v_fmac_f32 v94, v174, v167
    v_fmac_f32 v95, v175, v167
    v_mfma_f32_16x16x32_bf16 v[140:143], a[92:95], v[208:211], v[140:143]
    ds_read_b128 v[208:211], v2 offset:55296
    s_waitcnt lgkmcnt(5)
    v_mfma_f32_16x16x32_bf16 v[156:159], a[92:95], v[212:215], v[156:159]
    v_fmac_f32 v108, v176, v167
    v_fmac_f32 v109, v177, v167
    v_mfma_f32_16x16x32_bf16 v[152:155], a[88:91], v[212:215], v[152:155]
    v_fmac_f32 v110, v178, v167
    v_fmac_f32 v111, v179, v167
    v_mfma_f32_16x16x32_bf16 v[148:151], a[84:87], v[212:215], v[148:151]
    v_fmac_f32 v104, v176, v165
    v_fmac_f32 v105, v177, v165
    v_mfma_f32_16x16x32_bf16 v[144:147], a[80:83], v[212:215], v[144:147]
    ds_read_b128 v[212:215], v2 offset:56320
    s_waitcnt vmcnt(10)
    s_barrier
    s_waitcnt lgkmcnt(5)
    v_mfma_f32_16x16x32_bf16 v[64:67], v[192:195], a[96:99], v[64:67]
    v_fmac_f32 v124, v180, v167
    v_fmac_f32 v125, v181, v167
    v_mfma_f32_16x16x32_bf16 v[68:71], v[192:195], a[100:103], v[68:71]
    buffer_load_dwordx4 a[80:83], v4, s[4:7], s90 offen offset:2048 sc1
    v_mfma_f32_16x16x32_bf16 v[72:75], v[192:195], a[104:107], v[72:75]
    v_fmac_f32 v126, v182, v167
    v_fmac_f32 v127, v183, v167
    v_mfma_f32_16x16x32_bf16 v[76:79], v[192:195], a[108:111], v[76:79]
    ds_read_b128 v[192:195], v2 offset:57344
    s_waitcnt lgkmcnt(5)
    v_mfma_f32_16x16x32_bf16 v[92:95], v[196:199], a[108:111], v[92:95]
    v_fmac_f32 v136, v184, v248
    v_fmac_f32 v137, v184, v249
    v_mfma_f32_16x16x32_bf16 v[88:91], v[196:199], a[104:107], v[88:91]
    buffer_load_dwordx4 a[84:87], v5, s[4:7], s90 offen offset:2048 sc1
    v_mfma_f32_16x16x32_bf16 v[84:87], v[196:199], a[100:103], v[84:87]
    v_fmac_f32 v138, v184, v250
    v_fmac_f32 v139, v184, v251
    v_mfma_f32_16x16x32_bf16 v[80:83], v[196:199], a[96:99], v[80:83]
    ds_read_b128 v[196:199], v2 offset:58368
    s_waitcnt lgkmcnt(5)
    v_mfma_f32_16x16x32_bf16 v[96:99], v[200:203], a[96:99], v[96:99]
    v_fmac_f32 v152, v185, v248
    v_fmac_f32 v153, v185, v249
    v_mfma_f32_16x16x32_bf16 v[100:103], v[200:203], a[100:103], v[100:103]
    buffer_load_dwordx4 v10, s[4:7], s63 offen offset:2048 lds
    v_mfma_f32_16x16x32_bf16 v[104:107], v[200:203], a[104:107], v[104:107]
    v_fmac_f32 v154, v185, v250
    v_fmac_f32 v155, v185, v251
    v_mfma_f32_16x16x32_bf16 v[108:111], v[200:203], a[108:111], v[108:111]
    ds_read_b128 v[200:203], v2 offset:59392
    s_waitcnt lgkmcnt(5)
    v_mfma_f32_16x16x32_bf16 v[124:127], v[204:207], a[108:111], v[124:127]
    v_fmac_f32 v72, v168, v165
    v_fmac_f32 v73, v169, v165
    v_mfma_f32_16x16x32_bf16 v[120:123], v[204:207], a[104:107], v[120:123]
    buffer_load_dwordx4 a[88:91], v6, s[4:7], s90 offen offset:2048 sc1
    v_mfma_f32_16x16x32_bf16 v[116:119], v[204:207], a[100:103], v[116:119]
    v_fmac_f32 v74, v170, v165
    v_fmac_f32 v75, v171, v165
    v_mfma_f32_16x16x32_bf16 v[112:115], v[204:207], a[96:99], v[112:115]
    ds_read_b128 v[204:207], v2 offset:60416
    s_waitcnt lgkmcnt(5)
    v_mfma_f32_16x16x32_bf16 v[128:131], a[96:99], v[208:211], v[128:131]
    v_fmac_f32 v88, v172, v165
    v_fmac_f32 v89, v173, v165
    v_mfma_f32_16x16x32_bf16 v[132:135], a[100:103], v[208:211], v[132:135]
    buffer_load_dwordx4 a[92:95], v7, s[4:7], s90 offen offset:2048 sc1
    v_mfma_f32_16x16x32_bf16 v[136:139], a[104:107], v[208:211], v[136:139]
    v_fmac_f32 v90, v174, v165
    v_fmac_f32 v91, v175, v165
    v_mfma_f32_16x16x32_bf16 v[140:143], a[108:111], v[208:211], v[140:143]
    ds_read_b128 v[208:211], v2 offset:61440
    s_waitcnt lgkmcnt(5)
    v_mfma_f32_16x16x32_bf16 v[156:159], a[108:111], v[212:215], v[156:159]
    v_fmac_f32 v106, v178, v165
    v_fmac_f32 v107, v179, v165
    v_mfma_f32_16x16x32_bf16 v[152:155], a[104:107], v[212:215], v[152:155]
    v_fmac_f32 v100, v176, v163
    v_fmac_f32 v101, v177, v163
    v_mfma_f32_16x16x32_bf16 v[148:151], a[100:103], v[212:215], v[148:151]
    v_fmac_f32 v102, v178, v163
    v_fmac_f32 v103, v179, v163
    v_mfma_f32_16x16x32_bf16 v[144:147], a[96:99], v[212:215], v[144:147]
    ds_read_b128 v[212:215], v2 offset:62464
    s_waitcnt vmcnt(10)
    s_waitcnt lgkmcnt(5)
    v_mfma_f32_16x16x32_bf16 v[64:67], v[192:195], a[48:51], v[64:67]
    v_fmac_f32 v120, v180, v165
    v_fmac_f32 v121, v181, v165
    v_mfma_f32_16x16x32_bf16 v[68:71], v[192:195], a[52:55], v[68:71]
    buffer_load_dwordx4 a[96:99], v4, s[4:7], s90 offen offset:3072 sc1
    v_mfma_f32_16x16x32_bf16 v[72:75], v[192:195], a[56:59], v[72:75]
    v_fmac_f32 v122, v182, v165
    v_fmac_f32 v123, v183, v165
    v_mfma_f32_16x16x32_bf16 v[76:79], v[192:195], a[60:63], v[76:79]
    ds_read_b128 v[192:195], v2 offset:63488
    s_waitcnt lgkmcnt(5)
    v_mfma_f32_16x16x32_bf16 v[92:95], v[196:199], a[60:63], v[92:95]
    v_fmac_f32 v132, v184, v244
    v_fmac_f32 v133, v184, v245
    v_mfma_f32_16x16x32_bf16 v[88:91], v[196:199], a[56:59], v[88:91]
    buffer_load_dwordx4 a[100:103], v5, s[4:7], s90 offen offset:3072 sc1
    v_mfma_f32_16x16x32_bf16 v[84:87], v[196:199], a[52:55], v[84:87]
    v_fmac_f32 v134, v184, v246
    v_fmac_f32 v135, v184, v247
    v_mfma_f32_16x16x32_bf16 v[80:83], v[196:199], a[48:51], v[80:83]
    ds_read_b128 v[196:199], v2 offset:64512
    s_waitcnt lgkmcnt(5)
    v_mfma_f32_16x16x32_bf16 v[96:99], v[200:203], a[48:51], v[96:99]
    v_fmac_f32 v148, v185, v244
    v_fmac_f32 v149, v185, v245
    v_mfma_f32_16x16x32_bf16 v[100:103], v[200:203], a[52:55], v[100:103]
    buffer_load_dwordx4 v10, s[4:7], s63 offen offset:3072 lds
    v_mfma_f32_16x16x32_bf16 v[104:107], v[200:203], a[56:59], v[104:107]
    v_fmac_f32 v150, v185, v246
    v_fmac_f32 v151, v185, v247
    v_mfma_f32_16x16x32_bf16 v[108:111], v[200:203], a[60:63], v[108:111]
    ds_read_b128 v[200:203], v3 offset:0
    s_waitcnt lgkmcnt(5)
    v_mfma_f32_16x16x32_bf16 v[124:127], v[204:207], a[60:63], v[124:127]
    v_fmac_f32 v68, v168, v163
    v_fmac_f32 v69, v169, v163
    v_mfma_f32_16x16x32_bf16 v[120:123], v[204:207], a[56:59], v[120:123]
    buffer_load_dwordx4 a[104:107], v6, s[4:7], s90 offen offset:3072 sc1
    v_mfma_f32_16x16x32_bf16 v[116:119], v[204:207], a[52:55], v[116:119]
    v_fmac_f32 v70, v170, v163
    v_fmac_f32 v71, v171, v163
    v_mfma_f32_16x16x32_bf16 v[112:115], v[204:207], a[48:51], v[112:115]
    ds_read_b128 v[204:207], v3 offset:1024
    s_waitcnt lgkmcnt(5)
    v_mfma_f32_16x16x32_bf16 v[128:131], a[48:51], v[208:211], v[128:131]
    v_fmac_f32 v84, v172, v163
    v_fmac_f32 v85, v173, v163
    v_mfma_f32_16x16x32_bf16 v[132:135], a[52:55], v[208:211], v[132:135]
    buffer_load_dwordx4 a[108:111], v7, s[4:7], s90 offen offset:3072 sc1
    v_mfma_f32_16x16x32_bf16 v[136:139], a[56:59], v[208:211], v[136:139]
    v_fmac_f32 v86, v174, v163
    v_fmac_f32 v87, v175, v163
    v_mfma_f32_16x16x32_bf16 v[140:143], a[60:63], v[208:211], v[140:143]
    ds_read_b128 v[208:211], v3 offset:2048
    s_waitcnt lgkmcnt(5)
    v_mfma_f32_16x16x32_bf16 v[156:159], a[60:63], v[212:215], v[156:159]
    v_fmac_f32 v96, v176, v161
    v_fmac_f32 v97, v177, v161
    v_mfma_f32_16x16x32_bf16 v[152:155], a[56:59], v[212:215], v[152:155]
    v_fmac_f32 v98, v178, v161
    v_fmac_f32 v99, v179, v161
    v_mfma_f32_16x16x32_bf16 v[148:151], a[52:55], v[212:215], v[148:151]
    v_mul_f32 v220, 0x3e8293ee, v160
    v_mul_f32 v221, 0x3e8293ee, v162
    v_mfma_f32_16x16x32_bf16 v[144:147], a[48:51], v[212:215], v[144:147]
    ds_read_b128 v[212:215], v3 offset:3072
    s_waitcnt vmcnt(10)
    s_waitcnt lgkmcnt(5)
    v_mfma_f32_16x16x32_bf16 v[64:67], v[192:195], a[64:67], v[64:67]
    v_fmac_f32 v116, v180, v163
    v_fmac_f32 v117, v181, v163
    v_mfma_f32_16x16x32_bf16 v[68:71], v[192:195], a[68:71], v[68:71]
    buffer_load_dwordx4 a[48:51], v4, s[4:7], s91 offen offset:0 sc1
    v_mfma_f32_16x16x32_bf16 v[72:75], v[192:195], a[72:75], v[72:75]
    v_fmac_f32 v118, v182, v163
    v_fmac_f32 v119, v183, v163
    v_mfma_f32_16x16x32_bf16 v[76:79], v[192:195], a[76:79], v[76:79]
    ds_read_b128 v[192:195], v3 offset:4096
    s_waitcnt lgkmcnt(5)
    v_mfma_f32_16x16x32_bf16 v[92:95], v[196:199], a[76:79], v[92:95]
    v_fmac_f32 v128, v184, v240
    v_fmac_f32 v129, v184, v241
    v_mfma_f32_16x16x32_bf16 v[88:91], v[196:199], a[72:75], v[88:91]
    buffer_load_dwordx4 a[52:55], v5, s[4:7], s91 offen offset:0 sc1
    v_mfma_f32_16x16x32_bf16 v[84:87], v[196:199], a[68:71], v[84:87]
    v_fmac_f32 v130, v184, v242
    v_fmac_f32 v131, v184, v243
    v_mfma_f32_16x16x32_bf16 v[80:83], v[196:199], a[64:67], v[80:83]
    ds_read_b128 v[196:199], v3 offset:5120
    s_waitcnt lgkmcnt(5)
    v_mfma_f32_16x16x32_bf16 v[96:99], v[200:203], a[64:67], v[96:99]
    s_add_u32 m0, s57, 28672
    s_add_u32 s63, s100, 14684160
    v_mfma_f32_16x16x32_bf16 v[100:103], v[200:203], a[68:71], v[100:103]
    buffer_load_dwordx4 v10, s[4:7], s63 offen offset:0 lds
    v_mfma_f32_16x16x32_bf16 v[104:107], v[200:203], a[72:75], v[104:107]
    v_fmac_f32 v144, v185, v240
    v_fmac_f32 v145, v185, v241
    v_mfma_f32_16x16x32_bf16 v[108:111], v[200:203], a[76:79], v[108:111]
    ds_read_b128 v[200:203], v3 offset:6144
    s_waitcnt lgkmcnt(5)
    v_mfma_f32_16x16x32_bf16 v[124:127], v[204:207], a[76:79], v[124:127]
    v_fmac_f32 v64, v168, v161
    v_fmac_f32 v65, v169, v161
    v_mfma_f32_16x16x32_bf16 v[120:123], v[204:207], a[72:75], v[120:123]
    buffer_load_dwordx4 a[56:59], v6, s[4:7], s91 offen offset:0 sc1
    v_mfma_f32_16x16x32_bf16 v[116:119], v[204:207], a[68:71], v[116:119]
    v_fmac_f32 v66, v170, v161
    v_fmac_f32 v67, v171, v161
    v_mfma_f32_16x16x32_bf16 v[112:115], v[204:207], a[64:67], v[112:115]
    ds_read_b128 v[204:207], v3 offset:7168
    s_waitcnt lgkmcnt(5)
    v_mfma_f32_16x16x32_bf16 v[128:131], a[64:67], v[208:211], v[128:131]
    v_fmac_f32 v80, v172, v161
    v_fmac_f32 v81, v173, v161
    v_mfma_f32_16x16x32_bf16 v[132:135], a[68:71], v[208:211], v[132:135]
    buffer_load_dwordx4 a[60:63], v7, s[4:7], s91 offen offset:0 sc1
    v_mfma_f32_16x16x32_bf16 v[136:139], a[72:75], v[208:211], v[136:139]
    v_fmac_f32 v82, v174, v161
    v_fmac_f32 v83, v175, v161
    v_mfma_f32_16x16x32_bf16 v[140:143], a[76:79], v[208:211], v[140:143]
    ds_read_b128 v[208:211], v3 offset:8192
    s_waitcnt lgkmcnt(5)
    v_mfma_f32_16x16x32_bf16 v[156:159], a[76:79], v[212:215], v[156:159]
    v_mul_f32 v222, 0x3e8293ee, v164
    v_mul_f32 v223, 0x3e8293ee, v166
    v_mfma_f32_16x16x32_bf16 v[152:155], a[72:75], v[212:215], v[152:155]
    v_mfma_f32_16x16x32_bf16 v[148:151], a[68:71], v[212:215], v[148:151]
    v_mfma_f32_16x16x32_bf16 v[144:147], a[64:67], v[212:215], v[144:147]
    ds_read_b128 v[212:215], v3 offset:9216
    s_waitcnt vmcnt(10)
    s_waitcnt lgkmcnt(5)
    v_mfma_f32_16x16x32_bf16 v[64:67], v[192:195], a[80:83], v[64:67]
    v_fmac_f32 v112, v180, v161
    v_fmac_f32 v113, v181, v161
    v_mfma_f32_16x16x32_bf16 v[68:71], v[192:195], a[84:87], v[68:71]
    buffer_load_dwordx4 a[64:67], v4, s[4:7], s91 offen offset:1024 sc1
    v_mfma_f32_16x16x32_bf16 v[72:75], v[192:195], a[88:91], v[72:75]
    v_fmac_f32 v114, v182, v161
    v_fmac_f32 v115, v183, v161
    v_mfma_f32_16x16x32_bf16 v[76:79], v[192:195], a[92:95], v[76:79]
    ds_read_b128 v[192:195], v3 offset:10240
    s_waitcnt lgkmcnt(5)
    v_mfma_f32_16x16x32_bf16 v[92:95], v[196:199], a[92:95], v[92:95]
    v_mfma_f32_16x16x32_bf16 v[88:91], v[196:199], a[88:91], v[88:91]
    buffer_load_dwordx4 a[68:71], v5, s[4:7], s91 offen offset:1024 sc1
    v_mfma_f32_16x16x32_bf16 v[84:87], v[196:199], a[84:87], v[84:87]
    v_mfma_f32_16x16x32_bf16 v[80:83], v[196:199], a[80:83], v[80:83]
    ds_read_b128 v[196:199], v3 offset:11264
    s_waitcnt lgkmcnt(5)
    v_mfma_f32_16x16x32_bf16 v[96:99], v[200:203], a[80:83], v[96:99]
    v_fmac_f32 v146, v185, v242
    v_fmac_f32 v147, v185, v243
    v_mfma_f32_16x16x32_bf16 v[100:103], v[200:203], a[84:87], v[100:103]
    buffer_load_dwordx4 v10, s[4:7], s63 offen offset:1024 lds
    v_mfma_f32_16x16x32_bf16 v[104:107], v[200:203], a[88:91], v[104:107]
    v_mfma_f32_16x16x32_bf16 v[108:111], v[200:203], a[92:95], v[108:111]
    ds_read_b128 v[200:203], v3 offset:12288
    s_waitcnt lgkmcnt(5)
    v_mfma_f32_16x16x32_bf16 v[124:127], v[204:207], a[92:95], v[124:127]
    v_mfma_f32_16x16x32_bf16 v[120:123], v[204:207], a[88:91], v[120:123]
    buffer_load_dwordx4 a[72:75], v6, s[4:7], s91 offen offset:1024 sc1
    v_mfma_f32_16x16x32_bf16 v[116:119], v[204:207], a[84:87], v[116:119]
    v_mfma_f32_16x16x32_bf16 v[112:115], v[204:207], a[80:83], v[112:115]
    ds_read_b128 v[204:207], v3 offset:13312
    s_waitcnt lgkmcnt(5)
    v_mfma_f32_16x16x32_bf16 v[128:131], a[80:83], v[208:211], v[128:131]
    v_mfma_f32_16x16x32_bf16 v[132:135], a[84:87], v[208:211], v[132:135]
    buffer_load_dwordx4 a[76:79], v7, s[4:7], s91 offen offset:1024 sc1
    v_mfma_f32_16x16x32_bf16 v[136:139], a[88:91], v[208:211], v[136:139]
    v_mfma_f32_16x16x32_bf16 v[140:143], a[92:95], v[208:211], v[140:143]
    ds_read_b128 v[208:211], v3 offset:14336
    s_waitcnt lgkmcnt(5)
    v_mfma_f32_16x16x32_bf16 v[156:159], a[92:95], v[212:215], v[156:159]
    v_mfma_f32_16x16x32_bf16 v[152:155], a[88:91], v[212:215], v[152:155]
    v_mfma_f32_16x16x32_bf16 v[148:151], a[84:87], v[212:215], v[148:151]
    v_mfma_f32_16x16x32_bf16 v[144:147], a[80:83], v[212:215], v[144:147]
    ds_read_b128 v[212:215], v3 offset:15360
    s_waitcnt vmcnt(10)
    s_barrier
    s_waitcnt lgkmcnt(5)
    v_mfma_f32_16x16x32_bf16 v[64:67], v[192:195], a[96:99], v[64:67]
    v_mfma_f32_16x16x32_bf16 v[68:71], v[192:195], a[100:103], v[68:71]
    buffer_load_dwordx4 a[80:83], v4, s[4:7], s91 offen offset:2048 sc1
    v_mfma_f32_16x16x32_bf16 v[72:75], v[192:195], a[104:107], v[72:75]
    v_mfma_f32_16x16x32_bf16 v[76:79], v[192:195], a[108:111], v[76:79]
    ds_read_b128 v[192:195], v1 offset:0
    s_waitcnt lgkmcnt(5)
    v_mfma_f32_16x16x32_bf16 v[92:95], v[196:199], a[108:111], v[92:95]
    v_mfma_f32_16x16x32_bf16 v[88:91], v[196:199], a[104:107], v[88:91]
    buffer_load_dwordx4 a[84:87], v5, s[4:7], s91 offen offset:2048 sc1
    v_mfma_f32_16x16x32_bf16 v[84:87], v[196:199], a[100:103], v[84:87]
    v_mfma_f32_16x16x32_bf16 v[80:83], v[196:199], a[96:99], v[80:83]
    ds_read_b128 v[196:199], v1 offset:1024
    s_waitcnt lgkmcnt(5)
    v_mfma_f32_16x16x32_bf16 v[96:99], v[200:203], a[96:99], v[96:99]
    s_add_u32 m0, s57, 49152
    s_add_u32 s63, s101, 14680064
    v_mfma_f32_16x16x32_bf16 v[100:103], v[200:203], a[100:103], v[100:103]
    buffer_load_dwordx4 v10, s[4:7], s63 offen offset:0 lds
    v_mfma_f32_16x16x32_bf16 v[104:107], v[200:203], a[104:107], v[104:107]
    v_mfma_f32_16x16x32_bf16 v[108:111], v[200:203], a[108:111], v[108:111]
    ds_read_b128 v[200:203], v1 offset:2048
    s_waitcnt lgkmcnt(5)
    v_mfma_f32_16x16x32_bf16 v[124:127], v[204:207], a[108:111], v[124:127]
    v_mfma_f32_16x16x32_bf16 v[120:123], v[204:207], a[104:107], v[120:123]
    buffer_load_dwordx4 a[88:91], v6, s[4:7], s91 offen offset:2048 sc1
    v_mfma_f32_16x16x32_bf16 v[116:119], v[204:207], a[100:103], v[116:119]
    v_mfma_f32_16x16x32_bf16 v[112:115], v[204:207], a[96:99], v[112:115]
    ds_read_b128 v[204:207], v1 offset:3072
    s_waitcnt lgkmcnt(5)
    v_mfma_f32_16x16x32_bf16 v[128:131], a[96:99], v[208:211], v[128:131]
    v_mfma_f32_16x16x32_bf16 v[132:135], a[100:103], v[208:211], v[132:135]
    buffer_load_dwordx4 a[92:95], v7, s[4:7], s91 offen offset:2048 sc1
    v_mfma_f32_16x16x32_bf16 v[136:139], a[104:107], v[208:211], v[136:139]
    v_mfma_f32_16x16x32_bf16 v[140:143], a[108:111], v[208:211], v[140:143]
    ds_read_b128 v[208:211], v1 offset:4096
    s_waitcnt lgkmcnt(5)
    v_mfma_f32_16x16x32_bf16 v[156:159], a[108:111], v[212:215], v[156:159]
    v_mfma_f32_16x16x32_bf16 v[152:155], a[104:107], v[212:215], v[152:155]
    v_mfma_f32_16x16x32_bf16 v[148:151], a[100:103], v[212:215], v[148:151]
    v_mfma_f32_16x16x32_bf16 v[144:147], a[96:99], v[212:215], v[144:147]
    ds_read_b128 v[212:215], v1 offset:5120
    s_waitcnt vmcnt(10)
    s_waitcnt lgkmcnt(5)
    v_mfma_f32_16x16x32_bf16 v[64:67], v[192:195], a[48:51], v[64:67]
    v_mfma_f32_16x16x32_bf16 v[68:71], v[192:195], a[52:55], v[68:71]
    buffer_load_dwordx4 a[96:99], v4, s[4:7], s91 offen offset:3072 sc1
    v_mfma_f32_16x16x32_bf16 v[72:75], v[192:195], a[56:59], v[72:75]
    v_mfma_f32_16x16x32_bf16 v[76:79], v[192:195], a[60:63], v[76:79]
    ds_read_b128 v[192:195], v1 offset:6144
    s_waitcnt lgkmcnt(5)
    v_mfma_f32_16x16x32_bf16 v[92:95], v[196:199], a[60:63], v[92:95]
    v_mfma_f32_16x16x32_bf16 v[88:91], v[196:199], a[56:59], v[88:91]
    buffer_load_dwordx4 a[100:103], v5, s[4:7], s91 offen offset:3072 sc1
    v_mfma_f32_16x16x32_bf16 v[84:87], v[196:199], a[52:55], v[84:87]
    v_mfma_f32_16x16x32_bf16 v[80:83], v[196:199], a[48:51], v[80:83]
    ds_read_b128 v[196:199], v1 offset:7168
    s_waitcnt lgkmcnt(5)
    v_mfma_f32_16x16x32_bf16 v[96:99], v[200:203], a[48:51], v[96:99]
    v_mfma_f32_16x16x32_bf16 v[100:103], v[200:203], a[52:55], v[100:103]
    buffer_load_dwordx4 v10, s[4:7], s63 offen offset:1024 lds
    v_mfma_f32_16x16x32_bf16 v[104:107], v[200:203], a[56:59], v[104:107]
    v_mfma_f32_16x16x32_bf16 v[108:111], v[200:203], a[60:63], v[108:111]
    ds_read_b128 v[200:203], v1 offset:8192
    s_waitcnt lgkmcnt(5)
    v_mfma_f32_16x16x32_bf16 v[124:127], v[204:207], a[60:63], v[124:127]
    v_mfma_f32_16x16x32_bf16 v[120:123], v[204:207], a[56:59], v[120:123]
    buffer_load_dwordx4 a[104:107], v6, s[4:7], s91 offen offset:3072 sc1
    v_mfma_f32_16x16x32_bf16 v[116:119], v[204:207], a[52:55], v[116:119]
    v_mfma_f32_16x16x32_bf16 v[112:115], v[204:207], a[48:51], v[112:115]
    ds_read_b128 v[204:207], v1 offset:9216
    s_waitcnt lgkmcnt(5)
    v_mfma_f32_16x16x32_bf16 v[128:131], a[48:51], v[208:211], v[128:131]
    v_mfma_f32_16x16x32_bf16 v[132:135], a[52:55], v[208:211], v[132:135]
    buffer_load_dwordx4 a[108:111], v7, s[4:7], s91 offen offset:3072 sc1
    v_mfma_f32_16x16x32_bf16 v[136:139], a[56:59], v[208:211], v[136:139]
    v_mfma_f32_16x16x32_bf16 v[140:143], a[60:63], v[208:211], v[140:143]
    ds_read_b128 v[208:211], v1 offset:10240
    s_waitcnt lgkmcnt(5)
    v_mfma_f32_16x16x32_bf16 v[156:159], a[60:63], v[212:215], v[156:159]
    v_mfma_f32_16x16x32_bf16 v[152:155], a[56:59], v[212:215], v[152:155]
    v_mfma_f32_16x16x32_bf16 v[148:151], a[52:55], v[212:215], v[148:151]
    v_mfma_f32_16x16x32_bf16 v[144:147], a[48:51], v[212:215], v[144:147]
    ds_read_b128 v[212:215], v1 offset:11264
    s_waitcnt vmcnt(10)
    s_waitcnt lgkmcnt(5)
    v_mfma_f32_16x16x32_bf16 v[64:67], v[192:195], a[64:67], v[64:67]
    v_mfma_f32_16x16x32_bf16 v[68:71], v[192:195], a[68:71], v[68:71]
    buffer_load_dwordx4 a[48:51], v4, s[4:7], s92 offen offset:0 sc1
    v_mfma_f32_16x16x32_bf16 v[72:75], v[192:195], a[72:75], v[72:75]
    v_mfma_f32_16x16x32_bf16 v[76:79], v[192:195], a[76:79], v[76:79]
    ds_read_b128 v[192:195], v1 offset:12288
    s_waitcnt lgkmcnt(5)
    v_mfma_f32_16x16x32_bf16 v[92:95], v[196:199], a[76:79], v[92:95]
    v_mfma_f32_16x16x32_bf16 v[88:91], v[196:199], a[72:75], v[88:91]
    buffer_load_dwordx4 v10, s[4:7], s63 offen offset:2048 lds
    v_mfma_f32_16x16x32_bf16 v[84:87], v[196:199], a[68:71], v[84:87]
    v_mfma_f32_16x16x32_bf16 v[80:83], v[196:199], a[64:67], v[80:83]
    ds_read_b128 v[196:199], v1 offset:13312
    s_waitcnt lgkmcnt(5)
    v_mfma_f32_16x16x32_bf16 v[96:99], v[200:203], a[64:67], v[96:99]
    v_mfma_f32_16x16x32_bf16 v[100:103], v[200:203], a[68:71], v[100:103]
    buffer_load_dwordx4 a[52:55], v5, s[4:7], s92 offen offset:0 sc1
    v_mfma_f32_16x16x32_bf16 v[104:107], v[200:203], a[72:75], v[104:107]
    v_mfma_f32_16x16x32_bf16 v[108:111], v[200:203], a[76:79], v[108:111]
    ds_read_b128 v[200:203], v1 offset:14336
    s_waitcnt lgkmcnt(5)
    v_mfma_f32_16x16x32_bf16 v[124:127], v[204:207], a[76:79], v[124:127]
    v_mfma_f32_16x16x32_bf16 v[120:123], v[204:207], a[72:75], v[120:123]
    buffer_load_dwordx4 a[56:59], v6, s[4:7], s92 offen offset:0 sc1
    v_mfma_f32_16x16x32_bf16 v[116:119], v[204:207], a[68:71], v[116:119]
    v_mfma_f32_16x16x32_bf16 v[112:115], v[204:207], a[64:67], v[112:115]
    ds_read_b128 v[204:207], v1 offset:15360
    s_waitcnt lgkmcnt(5)
    v_mfma_f32_16x16x32_bf16 v[128:131], a[64:67], v[208:211], v[128:131]
    v_mfma_f32_16x16x32_bf16 v[132:135], a[68:71], v[208:211], v[132:135]
    buffer_load_dwordx4 v10, s[4:7], s63 offen offset:3072 lds
    v_mfma_f32_16x16x32_bf16 v[136:139], a[72:75], v[208:211], v[136:139]
    v_mfma_f32_16x16x32_bf16 v[140:143], a[76:79], v[208:211], v[140:143]
    ds_read_b128 v[208:211], v1 offset:16384
    s_waitcnt lgkmcnt(5)
    v_mfma_f32_16x16x32_bf16 v[156:159], a[76:79], v[212:215], v[156:159]
    v_mfma_f32_16x16x32_bf16 v[152:155], a[72:75], v[212:215], v[152:155]
    buffer_load_dwordx4 a[60:63], v7, s[4:7], s92 offen offset:0 sc1
    v_mfma_f32_16x16x32_bf16 v[148:151], a[68:71], v[212:215], v[148:151]
    v_mfma_f32_16x16x32_bf16 v[144:147], a[64:67], v[212:215], v[144:147]
    ds_read_b128 v[212:215], v1 offset:17408
    s_waitcnt vmcnt(11)
    s_waitcnt lgkmcnt(5)
    v_mfma_f32_16x16x32_bf16 v[64:67], v[192:195], a[80:83], v[64:67]
    v_mfma_f32_16x16x32_bf16 v[68:71], v[192:195], a[84:87], v[68:71]
    buffer_load_dwordx4 a[64:67], v4, s[4:7], s92 offen offset:1024 sc1
    v_mfma_f32_16x16x32_bf16 v[72:75], v[192:195], a[88:91], v[72:75]
    v_mfma_f32_16x16x32_bf16 v[76:79], v[192:195], a[92:95], v[76:79]
    ds_read_b128 v[192:195], v1 offset:18432
    s_waitcnt lgkmcnt(5)
    v_mfma_f32_16x16x32_bf16 v[92:95], v[196:199], a[92:95], v[92:95]
    v_mfma_f32_16x16x32_bf16 v[88:91], v[196:199], a[88:91], v[88:91]
    buffer_load_dwordx4 a[68:71], v5, s[4:7], s92 offen offset:1024 sc1
    v_mfma_f32_16x16x32_bf16 v[84:87], v[196:199], a[84:87], v[84:87]
    v_mfma_f32_16x16x32_bf16 v[80:83], v[196:199], a[80:83], v[80:83]
    ds_read_b128 v[196:199], v1 offset:19456
    s_waitcnt lgkmcnt(5)
    v_mfma_f32_16x16x32_bf16 v[96:99], v[200:203], a[80:83], v[96:99]
    s_add_u32 m0, s57, 53248
    s_add_u32 s63, s101, 14684160
    v_mfma_f32_16x16x32_bf16 v[100:103], v[200:203], a[84:87], v[100:103]
    buffer_load_dwordx4 v10, s[4:7], s63 offen offset:0 lds
    v_mfma_f32_16x16x32_bf16 v[104:107], v[200:203], a[88:91], v[104:107]
    v_mfma_f32_16x16x32_bf16 v[108:111], v[200:203], a[92:95], v[108:111]
    ds_read_b128 v[200:203], v1 offset:20480
    s_waitcnt lgkmcnt(5)
    v_mfma_f32_16x16x32_bf16 v[124:127], v[204:207], a[92:95], v[124:127]
    v_mfma_f32_16x16x32_bf16 v[120:123], v[204:207], a[88:91], v[120:123]
    buffer_load_dwordx4 a[72:75], v6, s[4:7], s92 offen offset:1024 sc1
    v_mfma_f32_16x16x32_bf16 v[116:119], v[204:207], a[84:87], v[116:119]
    v_mfma_f32_16x16x32_bf16 v[112:115], v[204:207], a[80:83], v[112:115]
    ds_read_b128 v[204:207], v1 offset:21504
    s_waitcnt lgkmcnt(5)
    v_mfma_f32_16x16x32_bf16 v[128:131], a[80:83], v[208:211], v[128:131]
    v_mfma_f32_16x16x32_bf16 v[132:135], a[84:87], v[208:211], v[132:135]
    buffer_load_dwordx4 a[76:79], v7, s[4:7], s92 offen offset:1024 sc1
    v_mfma_f32_16x16x32_bf16 v[136:139], a[88:91], v[208:211], v[136:139]
    v_mfma_f32_16x16x32_bf16 v[140:143], a[92:95], v[208:211], v[140:143]
    ds_read_b128 v[208:211], v1 offset:22528
    s_waitcnt lgkmcnt(5)
    v_mfma_f32_16x16x32_bf16 v[156:159], a[92:95], v[212:215], v[156:159]
    v_mfma_f32_16x16x32_bf16 v[152:155], a[88:91], v[212:215], v[152:155]
    v_mfma_f32_16x16x32_bf16 v[148:151], a[84:87], v[212:215], v[148:151]
    v_mfma_f32_16x16x32_bf16 v[144:147], a[80:83], v[212:215], v[144:147]
    ds_read_b128 v[212:215], v1 offset:23552
    s_waitcnt vmcnt(11)
    s_barrier
    s_waitcnt lgkmcnt(5)
    v_mfma_f32_16x16x32_bf16 v[64:67], v[192:195], a[96:99], v[64:67]
    v_mfma_f32_16x16x32_bf16 v[68:71], v[192:195], a[100:103], v[68:71]
    buffer_load_dwordx4 a[80:83], v6, s[4:7], s92 offen offset:2048 sc1
    v_mfma_f32_16x16x32_bf16 v[72:75], v[192:195], a[104:107], v[72:75]
    v_mfma_f32_16x16x32_bf16 v[76:79], v[192:195], a[108:111], v[76:79]
    ds_read_b128 v[192:195], v1 offset:24576
    s_waitcnt lgkmcnt(5)
    v_mfma_f32_16x16x32_bf16 v[92:95], v[196:199], a[108:111], v[92:95]
    v_mfma_f32_16x16x32_bf16 v[88:91], v[196:199], a[104:107], v[88:91]
    buffer_load_dwordx4 a[84:87], v7, s[4:7], s92 offen offset:2048 sc1
    v_mfma_f32_16x16x32_bf16 v[84:87], v[196:199], a[100:103], v[84:87]
    v_mfma_f32_16x16x32_bf16 v[80:83], v[196:199], a[96:99], v[80:83]
    ds_read_b128 v[196:199], v1 offset:25600
    s_waitcnt lgkmcnt(5)
    v_mfma_f32_16x16x32_bf16 v[96:99], v[200:203], a[96:99], v[96:99]
    v_mfma_f32_16x16x32_bf16 v[100:103], v[200:203], a[100:103], v[100:103]
    buffer_load_dwordx4 v10, s[4:7], s63 offen offset:1024 lds
    v_mfma_f32_16x16x32_bf16 v[104:107], v[200:203], a[104:107], v[104:107]
    v_mfma_f32_16x16x32_bf16 v[108:111], v[200:203], a[108:111], v[108:111]
    ds_read_b128 v[200:203], v1 offset:26624
    s_waitcnt lgkmcnt(5)
    v_mfma_f32_16x16x32_bf16 v[124:127], v[204:207], a[108:111], v[124:127]
    v_mfma_f32_16x16x32_bf16 v[120:123], v[204:207], a[104:107], v[120:123]
    buffer_load_dwordx4 a[88:91], v6, s[4:7], s92 offen offset:3072 sc1
    v_mfma_f32_16x16x32_bf16 v[116:119], v[204:207], a[100:103], v[116:119]
    v_mfma_f32_16x16x32_bf16 v[112:115], v[204:207], a[96:99], v[112:115]
    ds_read_b128 v[204:207], v1 offset:27648
    s_waitcnt lgkmcnt(5)
    v_mfma_f32_16x16x32_bf16 v[128:131], a[96:99], v[208:211], v[128:131]
    v_mfma_f32_16x16x32_bf16 v[132:135], a[100:103], v[208:211], v[132:135]
    buffer_load_dwordx4 a[92:95], v7, s[4:7], s92 offen offset:3072 sc1
    v_mfma_f32_16x16x32_bf16 v[136:139], a[104:107], v[208:211], v[136:139]
    v_mfma_f32_16x16x32_bf16 v[140:143], a[108:111], v[208:211], v[140:143]
    ds_read_b128 v[208:211], v1 offset:28672
    s_waitcnt lgkmcnt(5)
    v_mfma_f32_16x16x32_bf16 v[156:159], a[108:111], v[212:215], v[156:159]
    v_mfma_f32_16x16x32_bf16 v[152:155], a[104:107], v[212:215], v[152:155]
    v_mfma_f32_16x16x32_bf16 v[148:151], a[100:103], v[212:215], v[148:151]
    v_mfma_f32_16x16x32_bf16 v[144:147], a[96:99], v[212:215], v[144:147]
    ds_read_b128 v[212:215], v1 offset:29696
    s_waitcnt vmcnt(10)
    s_waitcnt lgkmcnt(5)
    v_mfma_f32_16x16x32_bf16 v[64:67], v[192:195], a[48:51], v[64:67]
    v_mfma_f32_16x16x32_bf16 v[68:71], v[192:195], a[52:55], v[68:71]
    buffer_load_dwordx4 a[96:99], v6, s[4:7], s93 offen offset:0 sc1
    v_mfma_f32_16x16x32_bf16 v[72:75], v[192:195], a[56:59], v[72:75]
    v_mfma_f32_16x16x32_bf16 v[76:79], v[192:195], a[60:63], v[76:79]
    ds_read_b128 v[192:195], v1 offset:30720
    s_waitcnt lgkmcnt(5)
    v_mfma_f32_16x16x32_bf16 v[92:95], v[196:199], a[60:63], v[92:95]
    s_add_u32 m0, s57, 73728
    s_mov_b32 s63, 23126016
    v_mfma_f32_16x16x32_bf16 v[88:91], v[196:199], a[56:59], v[88:91]
    buffer_load_dwordx4 v11, s[4:7], s63 offen offset:0 lds
    v_mfma_f32_16x16x32_bf16 v[84:87], v[196:199], a[52:55], v[84:87]
    v_mfma_f32_16x16x32_bf16 v[80:83], v[196:199], a[48:51], v[80:83]
    ds_read_b128 v[196:199], v1 offset:31744
    s_waitcnt lgkmcnt(5)
    v_mfma_f32_16x16x32_bf16 v[96:99], v[200:203], a[48:51], v[96:99]
    v_mfma_f32_16x16x32_bf16 v[100:103], v[200:203], a[52:55], v[100:103]
    buffer_load_dwordx4 a[100:103], v7, s[4:7], s93 offen offset:0 sc1
    v_mfma_f32_16x16x32_bf16 v[104:107], v[200:203], a[56:59], v[104:107]
    v_mfma_f32_16x16x32_bf16 v[108:111], v[200:203], a[60:63], v[108:111]
    ds_read_b128 v[200:203], v1 offset:32768
    s_waitcnt lgkmcnt(5)
    v_mfma_f32_16x16x32_bf16 v[124:127], v[204:207], a[60:63], v[124:127]
    v_mfma_f32_16x16x32_bf16 v[120:123], v[204:207], a[56:59], v[120:123]
    buffer_load_dwordx4 a[104:107], v6, s[4:7], s93 offen offset:1024 sc1
    v_mfma_f32_16x16x32_bf16 v[116:119], v[204:207], a[52:55], v[116:119]
    s_add_u32 s20, s48, L_epi3-L_pc
    s_addc_u32 s21, s49, 0
    global_load_dword v52, v35, s[20:21]
    v_mfma_f32_16x16x32_bf16 v[112:115], v[204:207], a[48:51], v[112:115]
    ds_read_b128 v[204:207], v1 offset:33792
    s_waitcnt lgkmcnt(5)
    v_mfma_f32_16x16x32_bf16 v[128:131], a[48:51], v[208:211], v[128:131]
    v_mfma_f32_16x16x32_bf16 v[132:135], a[52:55], v[208:211], v[132:135]
    buffer_load_dwordx4 v11, s[4:7], s63 offen offset:1024 lds
    v_mfma_f32_16x16x32_bf16 v[136:139], a[56:59], v[208:211], v[136:139]
    v_mfma_f32_16x16x32_bf16 v[140:143], a[60:63], v[208:211], v[140:143]
    ds_read_b128 v[208:211], v1 offset:34816
    s_waitcnt lgkmcnt(5)
    v_mfma_f32_16x16x32_bf16 v[156:159], a[60:63], v[212:215], v[156:159]
    v_mfma_f32_16x16x32_bf16 v[152:155], a[56:59], v[212:215], v[152:155]
    buffer_load_dwordx4 a[108:111], v7, s[4:7], s93 offen offset:1024 sc1
    v_mfma_f32_16x16x32_bf16 v[148:151], a[52:55], v[212:215], v[148:151]
    v_mfma_f32_16x16x32_bf16 v[144:147], a[48:51], v[212:215], v[144:147]
    ds_read_b128 v[212:215], v1 offset:35840
    s_waitcnt vmcnt(12)
    s_waitcnt lgkmcnt(5)
    v_mfma_f32_16x16x32_bf16 v[64:67], v[192:195], a[64:67], v[64:67]
    v_mfma_f32_16x16x32_bf16 v[68:71], v[192:195], a[68:71], v[68:71]
    buffer_load_dwordx4 a[48:51], v6, s[4:7], s93 offen offset:2048 sc1
    v_mfma_f32_16x16x32_bf16 v[72:75], v[192:195], a[72:75], v[72:75]
    v_mfma_f32_16x16x32_bf16 v[76:79], v[192:195], a[76:79], v[76:79]
    ds_read_b128 v[192:195], v1 offset:36864
    s_waitcnt lgkmcnt(5)
    v_mfma_f32_16x16x32_bf16 v[92:95], v[196:199], a[76:79], v[92:95]
    v_mfma_f32_16x16x32_bf16 v[88:91], v[196:199], a[72:75], v[88:91]
    buffer_load_dwordx4 v11, s[4:7], s63 offen offset:2048 lds
    v_mfma_f32_16x16x32_bf16 v[84:87], v[196:199], a[68:71], v[84:87]
    v_mfma_f32_16x16x32_bf16 v[80:83], v[196:199], a[64:67], v[80:83]
    ds_read_b128 v[196:199], v1 offset:37888
    s_waitcnt lgkmcnt(5)
    v_mfma_f32_16x16x32_bf16 v[96:99], v[200:203], a[64:67], v[96:99]
    v_mfma_f32_16x16x32_bf16 v[100:103], v[200:203], a[68:71], v[100:103]
    buffer_load_dwordx4 a[52:55], v7, s[4:7], s93 offen offset:2048 sc1
    v_mfma_f32_16x16x32_bf16 v[104:107], v[200:203], a[72:75], v[104:107]
    v_mfma_f32_16x16x32_bf16 v[108:111], v[200:203], a[76:79], v[108:111]
    ds_read_b128 v[200:203], v1 offset:38912
    s_waitcnt lgkmcnt(5)
    v_mfma_f32_16x16x32_bf16 v[124:127], v[204:207], a[76:79], v[124:127]
    v_mfma_f32_16x16x32_bf16 v[120:123], v[204:207], a[72:75], v[120:123]
    buffer_load_dwordx4 a[56:59], v6, s[4:7], s93 offen offset:3072 sc1
    v_mfma_f32_16x16x32_bf16 v[116:119], v[204:207], a[68:71], v[116:119]
    v_mfma_f32_16x16x32_bf16 v[112:115], v[204:207], a[64:67], v[112:115]
    ds_read_b128 v[204:207], v1 offset:39936
    s_waitcnt lgkmcnt(5)
    v_mfma_f32_16x16x32_bf16 v[128:131], a[64:67], v[208:211], v[128:131]
    v_mfma_f32_16x16x32_bf16 v[132:135], a[68:71], v[208:211], v[132:135]
    buffer_load_dwordx4 v11, s[4:7], s63 offen offset:3072 lds
    v_mfma_f32_16x16x32_bf16 v[136:139], a[72:75], v[208:211], v[136:139]
    v_mfma_f32_16x16x32_bf16 v[140:143], a[76:79], v[208:211], v[140:143]
    ds_read_b128 v[208:211], v1 offset:40960
    s_waitcnt lgkmcnt(5)
    v_mfma_f32_16x16x32_bf16 v[156:159], a[76:79], v[212:215], v[156:159]
    v_mfma_f32_16x16x32_bf16 v[152:155], a[72:75], v[212:215], v[152:155]
    buffer_load_dwordx4 a[60:63], v7, s[4:7], s93 offen offset:3072 sc1
    v_mfma_f32_16x16x32_bf16 v[148:151], a[68:71], v[212:215], v[148:151]
    v_mfma_f32_16x16x32_bf16 v[144:147], a[64:67], v[212:215], v[144:147]
    ds_read_b128 v[212:215], v1 offset:41984
    s_waitcnt vmcnt(16)
    s_waitcnt lgkmcnt(5)
    v_mfma_f32_16x16x32_bf16 v[72:75], v[192:195], a[80:83], v[72:75]
    buffer_load_dwordx4 a[64:67], v4, s[4:7], s92 offen offset:2048 sc1
    v_mfma_f32_16x16x32_bf16 v[76:79], v[192:195], a[84:87], v[76:79]
    ds_read_b128 v[192:195], v1 offset:43008
    s_waitcnt lgkmcnt(5)
    v_mfma_f32_16x16x32_bf16 v[92:95], v[196:199], a[84:87], v[92:95]
    v_mfma_f32_16x16x32_bf16 v[88:91], v[196:199], a[80:83], v[88:91]
    ds_read_b128 v[196:199], v1 offset:44032
    s_waitcnt lgkmcnt(5)
    v_mfma_f32_16x16x32_bf16 v[104:107], v[200:203], a[80:83], v[104:107]
    s_add_u32 m0, s57, 77824
    s_mov_b32 s63, 23130112
    buffer_load_dwordx4 v11, s[4:7], s63 offen offset:0 lds
    v_mfma_f32_16x16x32_bf16 v[108:111], v[200:203], a[84:87], v[108:111]
    ds_read_b128 v[200:203], v1 offset:45056
    s_waitcnt lgkmcnt(5)
    v_mfma_f32_16x16x32_bf16 v[124:127], v[204:207], a[84:87], v[124:127]
    v_mfma_f32_16x16x32_bf16 v[120:123], v[204:207], a[80:83], v[120:123]
    ds_read_b128 v[204:207], v1 offset:46080
    s_waitcnt lgkmcnt(5)
    v_mfma_f32_16x16x32_bf16 v[136:139], a[80:83], v[208:211], v[136:139]
    buffer_load_dwordx4 a[68:71], v5, s[4:7], s92 offen offset:2048 sc1
    v_mfma_f32_16x16x32_bf16 v[140:143], a[84:87], v[208:211], v[140:143]
    ds_read_b128 v[208:211], v1 offset:47104
    s_waitcnt lgkmcnt(5)
    v_mfma_f32_16x16x32_bf16 v[156:159], a[84:87], v[212:215], v[156:159]
    v_mfma_f32_16x16x32_bf16 v[152:155], a[80:83], v[212:215], v[152:155]
    ds_read_b128 v[212:215], v1 offset:48128
    s_waitcnt vmcnt(16)
    s_barrier
    s_waitcnt lgkmcnt(5)
    v_mfma_f32_16x16x32_bf16 v[72:75], v[192:195], a[88:91], v[72:75]
    buffer_load_dwordx4 a[72:75], v4, s[4:7], s92 offen offset:3072 sc1
    v_mfma_f32_16x16x32_bf16 v[76:79], v[192:195], a[92:95], v[76:79]
    ds_read_b128 v[192:195], v1 offset:49152
    s_waitcnt lgkmcnt(5)
    v_mfma_f32_16x16x32_bf16 v[92:95], v[196:199], a[92:95], v[92:95]
    v_mfma_f32_16x16x32_bf16 v[88:91], v[196:199], a[88:91], v[88:91]
    ds_read_b128 v[196:199], v1 offset:50176
    s_waitcnt lgkmcnt(5)
    v_mfma_f32_16x16x32_bf16 v[104:107], v[200:203], a[88:91], v[104:107]
    buffer_load_dwordx4 v11, s[4:7], s63 offen offset:1024 lds
    v_mfma_f32_16x16x32_bf16 v[108:111], v[200:203], a[92:95], v[108:111]
    ds_read_b128 v[200:203], v1 offset:51200
    s_waitcnt lgkmcnt(5)
    v_mfma_f32_16x16x32_bf16 v[124:127], v[204:207], a[92:95], v[124:127]
    v_mfma_f32_16x16x32_bf16 v[120:123], v[204:207], a[88:91], v[120:123]
    ds_read_b128 v[204:207], v1 offset:52224
    s_waitcnt lgkmcnt(5)
    v_mfma_f32_16x16x32_bf16 v[136:139], a[88:91], v[208:211], v[136:139]
    buffer_load_dwordx4 a[76:79], v5, s[4:7], s92 offen offset:3072 sc1
    v_mfma_f32_16x16x32_bf16 v[140:143], a[92:95], v[208:211], v[140:143]
    ds_read_b128 v[208:211], v1 offset:53248
    s_waitcnt lgkmcnt(5)
    v_mfma_f32_16x16x32_bf16 v[156:159], a[92:95], v[212:215], v[156:159]
    v_mfma_f32_16x16x32_bf16 v[152:155], a[88:91], v[212:215], v[152:155]
    ds_read_b128 v[212:215], v1 offset:54272
    s_waitcnt vmcnt(16)
    s_waitcnt lgkmcnt(5)
    v_mfma_f32_16x16x32_bf16 v[72:75], v[192:195], a[96:99], v[72:75]
    buffer_load_dwordx4 a[80:83], v4, s[4:7], s93 offen offset:0 sc1
    v_mfma_f32_16x16x32_bf16 v[76:79], v[192:195], a[100:103], v[76:79]
    ds_read_b128 v[192:195], v1 offset:55296
    s_waitcnt lgkmcnt(5)
    v_mfma_f32_16x16x32_bf16 v[92:95], v[196:199], a[100:103], v[92:95]
    v_mfma_f32_16x16x32_bf16 v[88:91], v[196:199], a[96:99], v[88:91]
    ds_read_b128 v[196:199], v1 offset:56320
    s_waitcnt lgkmcnt(5)
    v_mfma_f32_16x16x32_bf16 v[104:107], v[200:203], a[96:99], v[104:107]
    s_add_u32 m0, s57, 98304
    s_mov_b32 s63, 23150592
    buffer_load_dwordx4 v11, s[4:7], s63 offen offset:0 lds
    v_mfma_f32_16x16x32_bf16 v[108:111], v[200:203], a[100:103], v[108:111]
    ds_read_b128 v[200:203], v1 offset:57344
    s_waitcnt lgkmcnt(5)
    v_mfma_f32_16x16x32_bf16 v[124:127], v[204:207], a[100:103], v[124:127]
    s_mov_b32 s20, 29360128
    buffer_load_dword v52, v50, s[4:7], s20 offen sc1
    v_mfma_f32_16x16x32_bf16 v[120:123], v[204:207], a[96:99], v[120:123]
    ds_read_b128 v[204:207], v1 offset:58368
    s_waitcnt lgkmcnt(5)
    v_mfma_f32_16x16x32_bf16 v[136:139], a[96:99], v[208:211], v[136:139]
    buffer_load_dwordx4 a[84:87], v5, s[4:7], s93 offen offset:0 sc1
    v_mfma_f32_16x16x32_bf16 v[140:143], a[100:103], v[208:211], v[140:143]
    ds_read_b128 v[208:211], v1 offset:59392
    s_waitcnt lgkmcnt(5)
    v_mfma_f32_16x16x32_bf16 v[156:159], a[100:103], v[212:215], v[156:159]
    v_mfma_f32_16x16x32_bf16 v[152:155], a[96:99], v[212:215], v[152:155]
    ds_read_b128 v[212:215], v1 offset:60416
    s_waitcnt vmcnt(16)
    s_waitcnt lgkmcnt(5)
    v_mfma_f32_16x16x32_bf16 v[72:75], v[192:195], a[104:107], v[72:75]
    buffer_load_dwordx4 a[88:91], v4, s[4:7], s93 offen offset:1024 sc1
    v_mfma_f32_16x16x32_bf16 v[76:79], v[192:195], a[108:111], v[76:79]
    ds_read_b128 v[192:195], v1 offset:61440
    s_waitcnt lgkmcnt(5)
    v_mfma_f32_16x16x32_bf16 v[92:95], v[196:199], a[108:111], v[92:95]
    v_mfma_f32_16x16x32_bf16 v[88:91], v[196:199], a[104:107], v[88:91]
    ds_read_b128 v[196:199], v1 offset:62464
    s_waitcnt lgkmcnt(5)
    v_mfma_f32_16x16x32_bf16 v[104:107], v[200:203], a[104:107], v[104:107]
    buffer_load_dwordx4 v11, s[4:7], s63 offen offset:1024 lds
    v_mfma_f32_16x16x32_bf16 v[108:111], v[200:203], a[108:111], v[108:111]
    ds_read_b128 v[200:203], v1 offset:63488
    s_waitcnt lgkmcnt(5)
    v_mfma_f32_16x16x32_bf16 v[124:127], v[204:207], a[108:111], v[124:127]
    v_mfma_f32_16x16x32_bf16 v[120:123], v[204:207], a[104:107], v[120:123]
    ds_read_b128 v[204:207], v1 offset:64512
    s_waitcnt lgkmcnt(5)
    v_mfma_f32_16x16x32_bf16 v[136:139], a[104:107], v[208:211], v[136:139]
    buffer_load_dwordx4 a[92:95], v5, s[4:7], s93 offen offset:1024 sc1
    v_mfma_f32_16x16x32_bf16 v[140:143], a[108:111], v[208:211], v[140:143]
    ds_read_b128 v[208:211], v2 offset:0
    s_waitcnt lgkmcnt(5)
    v_mfma_f32_16x16x32_bf16 v[156:159], a[108:111], v[212:215], v[156:159]
    v_mfma_f32_16x16x32_bf16 v[152:155], a[104:107], v[212:215], v[152:155]
    ds_read_b128 v[212:215], v2 offset:1024
    s_waitcnt vmcnt(16)
    s_waitcnt lgkmcnt(5)
    v_mfma_f32_16x16x32_bf16 v[72:75], v[192:195], a[48:51], v[72:75]
    buffer_load_dwordx4 a[96:99], v4, s[4:7], s93 offen offset:2048 sc1
    v_mfma_f32_16x16x32_bf16 v[76:79], v[192:195], a[52:55], v[76:79]
    ds_read_b128 v[192:195], v2 offset:2048
    s_waitcnt lgkmcnt(5)
    v_mfma_f32_16x16x32_bf16 v[92:95], v[196:199], a[52:55], v[92:95]
    v_mfma_f32_16x16x32_bf16 v[88:91], v[196:199], a[48:51], v[88:91]
    ds_read_b128 v[196:199], v2 offset:3072
    s_waitcnt lgkmcnt(5)
    v_mfma_f32_16x16x32_bf16 v[104:107], v[200:203], a[48:51], v[104:107]
    buffer_load_dwordx4 v11, s[4:7], s63 offen offset:2048 lds
    v_mfma_f32_16x16x32_bf16 v[108:111], v[200:203], a[52:55], v[108:111]
    ds_read_b128 v[200:203], v2 offset:4096
    s_waitcnt lgkmcnt(5)
    v_mfma_f32_16x16x32_bf16 v[124:127], v[204:207], a[52:55], v[124:127]
    v_mfma_f32_16x16x32_bf16 v[120:123], v[204:207], a[48:51], v[120:123]
    ds_read_b128 v[204:207], v2 offset:5120
    s_waitcnt lgkmcnt(5)
    v_mfma_f32_16x16x32_bf16 v[136:139], a[48:51], v[208:211], v[136:139]
    buffer_load_dwordx4 a[100:103], v5, s[4:7], s93 offen offset:2048 sc1
    v_mfma_f32_16x16x32_bf16 v[140:143], a[52:55], v[208:211], v[140:143]
    ds_read_b128 v[208:211], v2 offset:6144
    s_waitcnt lgkmcnt(5)
    v_mfma_f32_16x16x32_bf16 v[156:159], a[52:55], v[212:215], v[156:159]
    v_mfma_f32_16x16x32_bf16 v[152:155], a[48:51], v[212:215], v[152:155]
    ds_read_b128 v[212:215], v2 offset:7168
    s_waitcnt vmcnt(16)
    s_waitcnt lgkmcnt(5)
    v_mfma_f32_16x16x32_bf16 v[72:75], v[192:195], a[56:59], v[72:75]
    buffer_load_dwordx4 a[104:107], v4, s[4:7], s93 offen offset:3072 sc1
    v_mfma_f32_16x16x32_bf16 v[76:79], v[192:195], a[60:63], v[76:79]
    ds_read_b128 v[192:195], v1 offset:36864
    s_waitcnt lgkmcnt(5)
    v_mfma_f32_16x16x32_bf16 v[92:95], v[196:199], a[60:63], v[92:95]
    v_mfma_f32_16x16x32_bf16 v[88:91], v[196:199], a[56:59], v[88:91]
    ds_read_b128 v[196:199], v1 offset:37888
    s_waitcnt lgkmcnt(5)
    v_mfma_f32_16x16x32_bf16 v[104:107], v[200:203], a[56:59], v[104:107]
    buffer_load_dwordx4 v11, s[4:7], s63 offen offset:3072 lds
    v_mfma_f32_16x16x32_bf16 v[108:111], v[200:203], a[60:63], v[108:111]
    ds_read_b128 v[200:203], v1 offset:38912
    s_waitcnt lgkmcnt(5)
    v_mfma_f32_16x16x32_bf16 v[124:127], v[204:207], a[60:63], v[124:127]
    v_mfma_f32_16x16x32_bf16 v[120:123], v[204:207], a[56:59], v[120:123]
    ds_read_b128 v[204:207], v1 offset:39936
    s_waitcnt lgkmcnt(5)
    v_mfma_f32_16x16x32_bf16 v[136:139], a[56:59], v[208:211], v[136:139]
    buffer_load_dwordx4 a[108:111], v5, s[4:7], s93 offen offset:3072 sc1
    v_mfma_f32_16x16x32_bf16 v[140:143], a[60:63], v[208:211], v[140:143]
    ds_read_b128 v[208:211], v1 offset:40960
    s_waitcnt lgkmcnt(5)
    v_mfma_f32_16x16x32_bf16 v[156:159], a[60:63], v[212:215], v[156:159]
    v_mfma_f32_16x16x32_bf16 v[152:155], a[56:59], v[212:215], v[152:155]
    ds_read_b128 v[212:215], v1 offset:41984
    s_waitcnt vmcnt(16)
    s_waitcnt lgkmcnt(5)
    v_mfma_f32_16x16x32_bf16 v[64:67], v[192:195], a[64:67], v[64:67]
    s_add_u32 m0, s57, 102400
    s_mov_b32 s63, 23154688
    buffer_load_dwordx4 v11, s[4:7], s63 offen offset:0 lds
    v_mfma_f32_16x16x32_bf16 v[68:71], v[192:195], a[68:71], v[68:71]
    ds_read_b128 v[192:195], v1 offset:43008
    v_mul_f32 v108, v108, v166
    v_mul_f32 v109, v109, v166
    s_waitcnt lgkmcnt(5)
    v_mfma_f32_16x16x32_bf16 v[84:87], v[196:199], a[68:71], v[84:87]
    v_mul_f32 v110, v110, v166
    v_mul_f32 v111, v111, v166
    v_mfma_f32_16x16x32_bf16 v[80:83], v[196:199], a[64:67], v[80:83]
    ds_read_b128 v[196:199], v1 offset:44032
    v_mul_f32 v124, v124, v166
    v_mul_f32 v125, v125, v166
    s_waitcnt lgkmcnt(5)
    v_mfma_f32_16x16x32_bf16 v[96:99], v[200:203], a[64:67], v[96:99]
    buffer_load_dwordx4 v11, s[4:7], s63 offen offset:1024 lds
    v_mfma_f32_16x16x32_bf16 v[100:103], v[200:203], a[68:71], v[100:103]
    ds_read_b128 v[200:203], v1 offset:45056
    v_mul_f32 v126, v126, v166
    v_mul_f32 v127, v127, v166
    s_waitcnt lgkmcnt(5)
    v_mfma_f32_16x16x32_bf16 v[116:119], v[204:207], a[68:71], v[116:119]
    v_cvt_pk_bf16_f32 v108, v108, v109
    v_cvt_pk_bf16_f32 v109, v110, v111
    v_mfma_f32_16x16x32_bf16 v[112:115], v[204:207], a[64:67], v[112:115]
    ds_read_b128 v[204:207], v1 offset:46080
    v_cvt_pk_bf16_f32 v110, v124, v125
    v_cvt_pk_bf16_f32 v111, v126, v127
    s_waitcnt lgkmcnt(5)
    v_mfma_f32_16x16x32_bf16 v[128:131], a[64:67], v[208:211], v[128:131]
    s_add_u32 m0, s57, 122880
    s_mov_b32 s63, 23175168
    buffer_load_dwordx4 v11, s[4:7], s63 offen offset:0 lds
    v_mfma_f32_16x16x32_bf16 v[132:135], a[68:71], v[208:211], v[132:135]
    ds_read_b128 v[208:211], v1 offset:47104
    buffer_store_dwordx4 v[108:111], v1, s[4:7], s16 offen sc1
    s_waitcnt lgkmcnt(5)
    v_mfma_f32_16x16x32_bf16 v[148:151], a[68:71], v[212:215], v[148:151]
    v_mul_f32 v140, v140, v236
    v_mul_f32 v141, v141, v237
    v_mfma_f32_16x16x32_bf16 v[144:147], a[64:67], v[212:215], v[144:147]
    ds_read_b128 v[212:215], v1 offset:48128
    v_mul_f32 v142, v142, v238
    v_mul_f32 v143, v143, v239
    s_waitcnt vmcnt(17)
    s_waitcnt lgkmcnt(5)
    v_mfma_f32_16x16x32_bf16 v[64:67], v[192:195], a[72:75], v[64:67]
    buffer_load_dwordx4 v11, s[4:7], s63 offen offset:1024 lds
    v_mfma_f32_16x16x32_bf16 v[68:71], v[192:195], a[76:79], v[68:71]
    ds_read_b128 v[192:195], v1 offset:49152
    v_mul_f32 v156, v156, v236
    v_mul_f32 v157, v157, v237
    s_waitcnt lgkmcnt(5)
    v_mfma_f32_16x16x32_bf16 v[84:87], v[196:199], a[76:79], v[84:87]
    v_mul_f32 v158, v158, v238
    v_mul_f32 v159, v159, v239
    v_mfma_f32_16x16x32_bf16 v[80:83], v[196:199], a[72:75], v[80:83]
    ds_read_b128 v[196:199], v1 offset:50176
    v_cvt_pk_bf16_f32 v248, v140, v141
    v_cvt_pk_bf16_f32 v249, v142, v143
    s_waitcnt lgkmcnt(5)
    v_mfma_f32_16x16x32_bf16 v[96:99], v[200:203], a[72:75], v[96:99]
    buffer_load_dwordx4 v11, s[4:7], s63 offen offset:2048 lds
    v_mfma_f32_16x16x32_bf16 v[100:103], v[200:203], a[76:79], v[100:103]
    ds_read_b128 v[200:203], v1 offset:51200
    v_cvt_pk_bf16_f32 v250, v156, v157
    v_cvt_pk_bf16_f32 v251, v158, v159
    s_waitcnt lgkmcnt(5)
    v_mfma_f32_16x16x32_bf16 v[116:119], v[204:207], a[76:79], v[116:119]
    buffer_store_dwordx4 v[248:251], v1, s[4:7], s16 offen offset:1024 sc1
    v_mfma_f32_16x16x32_bf16 v[112:115], v[204:207], a[72:75], v[112:115]
    ds_read_b128 v[204:207], v1 offset:52224
    ds_write_b128 v55, v[108:111] offset:1024
    s_waitcnt lgkmcnt(6)
    v_mfma_f32_16x16x32_bf16 v[128:131], a[72:75], v[208:211], v[128:131]
    buffer_load_dwordx4 v11, s[4:7], s63 offen offset:3072 lds
    v_mfma_f32_16x16x32_bf16 v[132:135], a[76:79], v[208:211], v[132:135]
    ds_read_b128 v[208:211], v1 offset:53248
    v_cvt_pk_bf16_f32 v176, v140, v141
    v_cvt_pk_bf16_f32 v177, v142, v143
    s_waitcnt lgkmcnt(6)
    v_mfma_f32_16x16x32_bf16 v[148:151], a[76:79], v[212:215], v[148:151]
    v_cvt_pk_bf16_f32 v186, v156, v157
    v_cvt_pk_bf16_f32 v187, v158, v159
    v_mfma_f32_16x16x32_bf16 v[144:147], a[72:75], v[212:215], v[144:147]
    ds_read_b128 v[212:215], v1 offset:54272
    ds_write_b128 v55, v[248:251] offset:8192
    s_waitcnt vmcnt(17)
    s_waitcnt lgkmcnt(7)
    v_mfma_f32_16x16x32_bf16 v[64:67], v[192:195], a[80:83], v[64:67]
    s_add_u32 m0, s57, 126976
    s_mov_b32 s63, 23179264
    buffer_load_dwordx4 v11, s[4:7], s63 offen offset:0 lds
    v_mfma_f32_16x16x32_bf16 v[68:71], v[192:195], a[84:87], v[68:71]
    ds_read_b128 v[192:195], v1 offset:55296
    v_mul_f32 v104, v104, v164
    v_mul_f32 v105, v105, v164
    s_waitcnt lgkmcnt(7)
    v_mfma_f32_16x16x32_bf16 v[84:87], v[196:199], a[84:87], v[84:87]
    v_mul_f32 v106, v106, v164
    v_mul_f32 v107, v107, v164
    v_mfma_f32_16x16x32_bf16 v[80:83], v[196:199], a[80:83], v[80:83]
    ds_read_b128 v[196:199], v1 offset:56320
    v_mul_f32 v120, v120, v164
    v_mul_f32 v121, v121, v164
    s_waitcnt lgkmcnt(7)
    v_mfma_f32_16x16x32_bf16 v[96:99], v[200:203], a[80:83], v[96:99]
    buffer_load_dwordx4 v11, s[4:7], s63 offen offset:1024 lds
    v_mfma_f32_16x16x32_bf16 v[100:103], v[200:203], a[84:87], v[100:103]
    ds_read_b128 v[200:203], v1 offset:57344
    v_mul_f32 v122, v122, v164
    v_mul_f32 v123, v123, v164
    s_waitcnt lgkmcnt(7)
    v_mfma_f32_16x16x32_bf16 v[116:119], v[204:207], a[84:87], v[116:119]
    v_cvt_pk_bf16_f32 v104, v104, v105
    v_cvt_pk_bf16_f32 v105, v106, v107
    v_mfma_f32_16x16x32_bf16 v[112:115], v[204:207], a[80:83], v[112:115]
    ds_read_b128 v[204:207], v1 offset:58368
    v_cvt_pk_bf16_f32 v106, v120, v121
    v_cvt_pk_bf16_f32 v107, v122, v123
    s_waitcnt lgkmcnt(6)
    v_mfma_f32_16x16x32_bf16 v[128:131], a[80:83], v[208:211], v[128:131]
    v_cvt_pk_bf16_f32 v76, v76, v77
    v_cvt_pk_bf16_f32 v77, v78, v79
    v_mfma_f32_16x16x32_bf16 v[132:135], a[84:87], v[208:211], v[132:135]
    ds_read_b128 v[208:211], v1 offset:59392
    v_cvt_pk_bf16_f32 v78, v92, v93
    v_cvt_pk_bf16_f32 v79, v94, v95
    s_waitcnt lgkmcnt(6)
    v_mfma_f32_16x16x32_bf16 v[148:151], a[84:87], v[212:215], v[148:151]
    v_mfma_f32_16x16x32_bf16 v[124:127], v[108:111], v[76:79], 0
    v_mfma_f32_16x16x32_bf16 v[144:147], a[80:83], v[212:215], v[144:147]
    ds_read_b128 v[212:215], v1 offset:60416
    v_mfma_f32_16x16x32_bf16 v[92:95], v[104:107], v[76:79], 0
    s_waitcnt vmcnt(16)
    s_waitcnt lgkmcnt(5)
    v_mfma_f32_16x16x32_bf16 v[64:67], v[192:195], a[88:91], v[64:67]
    s_add_u32 m0, s57, 0
    s_mov_b32 s63, 23068672
    buffer_load_dwordx4 v11, s[4:7], s63 offen offset:0 lds
    v_mfma_f32_16x16x32_bf16 v[68:71], v[192:195], a[92:95], v[68:71]
    ds_read_b128 v[192:195], v1 offset:61440
    v_mul_f32 v136, v136, v232
    v_mul_f32 v137, v137, v233
    s_waitcnt lgkmcnt(5)
    v_mfma_f32_16x16x32_bf16 v[84:87], v[196:199], a[92:95], v[84:87]
    v_mul_f32 v138, v138, v234
    v_mul_f32 v139, v139, v235
    v_mfma_f32_16x16x32_bf16 v[80:83], v[196:199], a[88:91], v[80:83]
    ds_read_b128 v[196:199], v1 offset:62464
    v_mul_f32 v152, v152, v232
    v_mul_f32 v153, v153, v233
    s_waitcnt lgkmcnt(5)
    v_mfma_f32_16x16x32_bf16 v[96:99], v[200:203], a[88:91], v[96:99]
    buffer_load_dwordx4 v11, s[4:7], s63 offen offset:1024 lds
    v_mfma_f32_16x16x32_bf16 v[100:103], v[200:203], a[92:95], v[100:103]
    ds_read_b128 v[200:203], v1 offset:63488
    v_mul_f32 v154, v154, v234
    v_mul_f32 v155, v155, v235
    s_waitcnt lgkmcnt(5)
    v_mfma_f32_16x16x32_bf16 v[116:119], v[204:207], a[92:95], v[116:119]
    v_cvt_pk_bf16_f32 v174, v136, v137
    v_cvt_pk_bf16_f32 v175, v138, v139
    v_mfma_f32_16x16x32_bf16 v[112:115], v[204:207], a[88:91], v[112:115]
    ds_read_b128 v[204:207], v1 offset:64512
    v_cvt_pk_bf16_f32 v184, v152, v153
    v_cvt_pk_bf16_f32 v185, v154, v155
    s_waitcnt lgkmcnt(5)
    v_mfma_f32_16x16x32_bf16 v[128:131], a[88:91], v[208:211], v[128:131]
    s_barrier
    v_mfma_f32_16x16x32_bf16 v[132:135], a[92:95], v[208:211], v[132:135]
    ds_read_b128 v[208:211], v2 offset:0
    ds_read_b128 v[188:191], v55
    s_waitcnt lgkmcnt(6)
    v_mfma_f32_16x16x32_bf16 v[148:151], a[92:95], v[212:215], v[148:151]
    ds_read_b64 v[168:169], v55 offset:7168
    v_mfma_f32_16x16x32_bf16 v[144:147], a[88:91], v[212:215], v[144:147]
    ds_read_b128 v[212:215], v2 offset:1024
    ds_read_b64 v[178:179], v55 offset:7176
    s_waitcnt vmcnt(15)
    s_waitcnt lgkmcnt(8)
    v_mfma_f32_16x16x32_bf16 v[64:67], v[192:195], a[96:99], v[64:67]
    buffer_load_dwordx4 v11, s[4:7], s63 offen offset:2048 lds
    v_mfma_f32_16x16x32_bf16 v[68:71], v[192:195], a[100:103], v[68:71]
    ds_read_b128 v[192:195], v2 offset:2048
    v_cndmask_b32 v124, v124, v125, s[36:37]
    v_cndmask_b32 v126, v126, v127, s[36:37]
    s_waitcnt lgkmcnt(8)
    v_mfma_f32_16x16x32_bf16 v[84:87], v[196:199], a[100:103], v[84:87]
    v_cndmask_b32 v92, v92, v93, s[36:37]
    v_cndmask_b32 v94, v94, v95, s[36:37]
    v_mfma_f32_16x16x32_bf16 v[80:83], v[196:199], a[96:99], v[80:83]
    ds_read_b128 v[196:199], v2 offset:3072
    v_cndmask_b32 v156, v92, v124, s[44:45]
    v_cndmask_b32 v157, v94, v126, s[46:47]
    s_waitcnt lgkmcnt(8)
    v_mfma_f32_16x16x32_bf16 v[96:99], v[200:203], a[96:99], v[96:99]
    buffer_load_dwordx4 v11, s[4:7], s63 offen offset:3072 lds
    v_mfma_f32_16x16x32_bf16 v[100:103], v[200:203], a[100:103], v[100:103]
    ds_read_b128 v[200:203], v2 offset:4096
    v_max_f32 v158, v156, v157
    s_waitcnt lgkmcnt(8)
    v_mfma_f32_16x16x32_bf16 v[116:119], v[204:207], a[100:103], v[116:119]
    v_mov_b32 v159, v158
    v_mfma_f32_16x16x32_bf16 v[112:115], v[204:207], a[96:99], v[112:115]
    ds_read_b128 v[204:207], v2 offset:5120
    v_cvt_pk_bf16_f32 v72, v72, v73
    v_cvt_pk_bf16_f32 v73, v74, v75
    s_waitcnt lgkmcnt(8)
    v_mfma_f32_16x16x32_bf16 v[128:131], a[96:99], v[208:211], v[128:131]
    v_permlane32_swap_b32 v158, v159
    v_mfma_f32_16x16x32_bf16 v[132:135], a[100:103], v[208:211], v[132:135]
    ds_read_b128 v[208:211], v2 offset:6144
    v_max_f32 v158, v158, v159
    v_mov_b32 v159, v158
    s_waitcnt lgkmcnt(6)
    v_mfma_f32_16x16x32_bf16 v[148:151], a[100:103], v[212:215], v[148:151]
    v_cvt_pk_bf16_f32 v74, v88, v89
    v_cvt_pk_bf16_f32 v75, v90, v91
    v_mfma_f32_16x16x32_bf16 v[144:147], a[96:99], v[212:215], v[144:147]
    ds_read_b128 v[212:215], v2 offset:7168
    v_permlane16_swap_b32 v158, v159
    s_waitcnt vmcnt(14)
    s_waitcnt lgkmcnt(5)
    v_mfma_f32_16x16x32_bf16 v[64:67], v[192:195], a[104:107], v[64:67]
    s_add_u32 m0, s57, 4096
    s_mov_b32 s63, 23072768
    buffer_load_dwordx4 v11, s[4:7], s63 offen offset:0 lds
    v_mfma_f32_16x16x32_bf16 v[68:71], v[192:195], a[108:111], v[68:71]
    v_max_f32 v158, v158, v159
    s_waitcnt lgkmcnt(4)
    v_mfma_f32_16x16x32_bf16 v[84:87], v[196:199], a[108:111], v[84:87]
    v_mfma_f32_16x16x32_bf16 v[120:123], v[104:107], v[72:75], 0
    v_mfma_f32_16x16x32_bf16 v[80:83], v[196:199], a[104:107], v[80:83]
    v_sub_f32 v156, v156, v158
    v_sub_f32 v157, v157, v158
    s_waitcnt lgkmcnt(3)
    v_mfma_f32_16x16x32_bf16 v[96:99], v[200:203], a[104:107], v[96:99]
    buffer_load_dwordx4 v11, s[4:7], s63 offen offset:1024 lds
    v_mfma_f32_16x16x32_bf16 v[100:103], v[200:203], a[108:111], v[100:103]
    v_mul_f32 v156, v156, v223
    v_mul_f32 v157, v157, v223
    s_waitcnt lgkmcnt(2)
    v_mfma_f32_16x16x32_bf16 v[116:119], v[204:207], a[108:111], v[116:119]
    v_exp_f32 v156, v156
    v_mfma_f32_16x16x32_bf16 v[112:115], v[204:207], a[104:107], v[112:115]
    v_exp_f32 v157, v157
    s_waitcnt lgkmcnt(1)
    v_mfma_f32_16x16x32_bf16 v[128:131], a[104:107], v[208:211], v[128:131]
    v_cvt_pk_bf16_f32 v156, v156, v156
    v_cvt_pk_bf16_f32 v157, v157, v157
    v_mfma_f32_16x16x32_bf16 v[132:135], a[108:111], v[208:211], v[132:135]
    v_and_b32 v140, v156, v44
    v_and_b32 v141, v157, v45
    s_waitcnt lgkmcnt(0)
    v_mfma_f32_16x16x32_bf16 v[148:151], a[108:111], v[212:215], v[148:151]
    v_and_b32 v142, v156, v46
    v_and_b32 v143, v157, v47
    v_mfma_f32_16x16x32_bf16 v[144:147], a[104:107], v[212:215], v[144:147]
    v_mov_b32 v217, 0xff61b1e6
L_epi3:
    s_waitcnt lgkmcnt(0)
    s_add_u32 m0, s57, 24576
    s_mov_b32 s63, 23093248
    buffer_load_dwordx4 v11, s[4:7], s63 offen offset:0 lds
    v_mfma_f32_16x16x32_bf16 v[156:159], v[40:43], v[140:143], 0
    buffer_load_dwordx4 v[240:243], v1, s[4:7], s28 offen sc1
    buffer_load_dwordx4 v[244:247], v1, s[4:7], s28 offen offset:1024 sc1
    v_mfma_f32_16x16x32_bf16 v[92:95], v[174:177], v[140:143], 0
    v_mfma_f32_16x16x32_bf16 v[124:127], v[184:187], v[140:143], 0
    s_nop 3
    v_rcp_f32 v156, v156
    s_nop 1
    v_mul_f32 v92, v92, v156
    v_mul_f32 v93, v93, v156
    v_mul_f32 v94, v94, v156
    v_mul_f32 v95, v95, v156
    v_mul_f32 v124, v124, v156
    v_mul_f32 v125, v125, v156
    v_mul_f32 v126, v126, v156
    buffer_load_dwordx4 v11, s[4:7], s63 offen offset:1024 lds
    v_mul_f32 v127, v127, v156
    v_cvt_pk_bf16_f32 v236, v92, v93
    v_cvt_pk_bf16_f32 v237, v94, v95
    v_cvt_pk_bf16_f32 v238, v124, v125
    v_cvt_pk_bf16_f32 v239, v126, v127
    s_cmp_lg_u32 s15, 0
    s_cbranch_scc1 L_slow_85
    buffer_store_dwordx4 v[236:239], v7, s[4:7], s34 offen
L_done_86:
    v_pk_mul_f32 v[100:101], v[100:101], v[162:163] op_sel:[0,0] op_sel_hi:[1,0]
    v_pk_mul_f32 v[102:103], v[102:103], v[162:163] op_sel:[0,0] op_sel_hi:[1,0]
    v_pk_mul_f32 v[116:117], v[116:117], v[162:163] op_sel:[0,0] op_sel_hi:[1,0]
    v_pk_mul_f32 v[118:119], v[118:119], v[162:163] op_sel:[0,0] op_sel_hi:[1,0]
    v_pk_mul_f32 v[96:97], v[96:97], v[160:161] op_sel:[0,0] op_sel_hi:[1,0]
    v_pk_mul_f32 v[98:99], v[98:99], v[160:161] op_sel:[0,0] op_sel_hi:[1,0]
    v_pk_mul_f32 v[112:113], v[112:113], v[160:161] op_sel:[0,0] op_sel_hi:[1,0]
    v_pk_mul_f32 v[114:115], v[114:115], v[160:161] op_sel:[0,0] op_sel_hi:[1,0]
    v_pk_mul_f32 v[132:133], v[132:133], v[228:229]
    v_pk_mul_f32 v[134:135], v[134:135], v[230:231]
    v_pk_mul_f32 v[148:149], v[148:149], v[228:229]
    v_pk_mul_f32 v[150:151], v[150:151], v[230:231]
    v_pk_mul_f32 v[128:129], v[128:129], v[224:225]
    v_pk_mul_f32 v[130:131], v[130:131], v[226:227]
    v_pk_mul_f32 v[144:145], v[144:145], v[224:225]
    buffer_load_dwordx4 v11, s[4:7], s63 offen offset:2048 lds
    v_pk_mul_f32 v[146:147], v[146:147], v[226:227]
    v_cvt_pk_bf16_f32 v100, v100, v101
    v_cvt_pk_bf16_f32 v101, v102, v103
    v_cvt_pk_bf16_f32 v102, v116, v117
    v_cvt_pk_bf16_f32 v103, v118, v119
    v_cvt_pk_bf16_f32 v68, v68, v69
    v_cvt_pk_bf16_f32 v69, v70, v71
    v_cvt_pk_bf16_f32 v70, v84, v85
    v_cvt_pk_bf16_f32 v71, v86, v87
    v_mfma_f32_16x16x32_bf16 v[88:91], v[100:103], v[72:75], 0
    v_cvt_pk_bf16_f32 v96, v96, v97
    v_cvt_pk_bf16_f32 v97, v98, v99
    v_mfma_f32_16x16x32_bf16 v[116:119], v[100:103], v[68:71], 0
    v_cvt_pk_bf16_f32 v98, v112, v113
    v_cvt_pk_bf16_f32 v99, v114, v115
    v_cvt_pk_bf16_f32 v64, v64, v65
    v_cvt_pk_bf16_f32 v65, v66, v67
    buffer_load_dwordx4 v11, s[4:7], s63 offen offset:3072 lds
    v_cvt_pk_bf16_f32 v66, v80, v81
    v_cvt_pk_bf16_f32 v67, v82, v83
    v_mfma_f32_16x16x32_bf16 v[84:87], v[96:99], v[68:71], 0
    v_cvt_pk_bf16_f32 v172, v132, v133
    v_cvt_pk_bf16_f32 v173, v134, v135
    v_mfma_f32_16x16x32_bf16 v[112:115], v[96:99], v[64:67], 0
    v_cvt_pk_bf16_f32 v182, v148, v149
    v_cvt_pk_bf16_f32 v183, v150, v151
    v_cvt_pk_bf16_f32 v170, v128, v129
    v_cvt_pk_bf16_f32 v171, v130, v131
    v_cvt_pk_bf16_f32 v180, v144, v145
    v_cvt_pk_bf16_f32 v181, v146, v147
    v_cndmask_b32 v120, v120, v121, s[36:37]
    v_cndmask_b32 v122, v122, v123, s[36:37]
    v_cndmask_b32 v88, v88, v89, s[36:37]
    v_cndmask_b32 v90, v90, v91, s[36:37]
    v_cndmask_b32 v152, v88, v120, s[44:45]
    s_add_u32 m0, s57, 28672
    s_mov_b32 s63, 23097344
    buffer_load_dwordx4 v11, s[4:7], s63 offen offset:0 lds
    v_cndmask_b32 v153, v90, v122, s[46:47]
    v_max_f32 v154, v152, v153
    s_waitcnt lgkmcnt(0)
    s_cmp_lg_u32 s12, 0
    s_cbranch_scc1 L_halod3
    s_waitcnt vmcnt(5)
    v_max_u32 v218, v240, v244
    v_cmp_eq_u32 vcc, -1, v218
    s_cbranch_vccz L_halow3
    s_mov_b32 s61, 1048576
L_spin_87:
    buffer_load_dwordx4 v[240:243], v1, s[4:7], s28 offen sc1
    buffer_load_dwordx4 v[244:247], v1, s[4:7], s28 offen offset:1024 sc1
    s_sub_u32 s61, s61, 1
    s_waitcnt vmcnt(0)
    v_max_u32 v218, v240, v244
    v_cmp_eq_u32 vcc, -1, v218
    s_cbranch_scc1 L_spind_88
    s_cbranch_vccnz L_spin_87
L_spind_88:
L_halow3:
    v_mov_b32 v188, v240
    v_mov_b32 v168, v244
    v_mov_b32 v189, v241
    v_mov_b32 v169, v245
    v_mov_b32 v190, v242
    v_mov_b32 v178, v246
    v_mov_b32 v191, v243
    v_mov_b32 v179, v247
L_halod3:
    s_nop 1
    v_mfma_f32_16x16x32_bf16 v[80:83], v[188:191], v[64:67], 0
    v_cndmask_b32 v116, v116, v117, s[36:37]
    v_cndmask_b32 v118, v118, v119, s[36:37]
    v_cndmask_b32 v84, v84, v85, s[36:37]
    v_cndmask_b32 v86, v86, v87, s[36:37]
    v_cndmask_b32 v148, v84, v116, s[44:45]
    v_cndmask_b32 v149, v86, v118, s[46:47]
    v_max_f32 v150, v148, v149
    v_cndmask_b32 v112, v112, v113, s[36:37]
    v_cndmask_b32 v114, v114, v115, s[36:37]
    v_cndmask_b32 v80, v80, v81, s[36:37]
    v_cndmask_b32 v82, v82, v83, s[36:37]
    v_cndmask_b32 v80, v80, v217, s[50:51]
    v_cndmask_b32 v82, v82, v217, s[50:51]
    v_cndmask_b32 v144, v80, v112, s[44:45]
    v_cndmask_b32 v145, v82, v114, s[46:47]
    v_max_f32 v146, v144, v145
    s_nop 1
    v_permlane32_swap_b32 v146, v150
    v_permlane32_swap_b32 v154, v158
    v_max_f32 v146, v146, v150
    buffer_load_dwordx4 v11, s[4:7], s63 offen offset:1024 lds
    v_max_f32 v154, v154, v158
    s_nop 1
    v_permlane16_swap_b32 v146, v154
    v_max_f32 v150, v146, v154
    v_max_f32 v154, v146, v154
    s_nop 1
    v_permlane16_swap_b32 v150, v154
    v_mov_b32 v146, v150
    v_mov_b32 v158, v154
    s_nop 0
    v_permlane32_swap_b32 v146, v150
    v_permlane32_swap_b32 v154, v158
    v_sub_f32 v152, v152, v154
    v_sub_f32 v153, v153, v154
    v_sub_f32 v148, v148, v150
    v_sub_f32 v149, v149, v150
    v_sub_f32 v144, v144, v146
    v_sub_f32 v145, v145, v146
    v_mul_f32 v152, v152, v222
    v_mul_f32 v153, v153, v222
    v_mul_f32 v148, v148, v221
    v_mul_f32 v149, v149, v221
    s_add_u32 m0, s2, 49152
    s_sub_u32 s63, 23117824, s0
    buffer_load_dwordx4 v11, s[4:7], s63 offen offset:0 lds
    v_mul_f32 v144, v144, v220
    v_mul_f32 v145, v145, v220
    v_exp_f32 v152, v152
    v_exp_f32 v153, v153
    v_exp_f32 v148, v148
    v_exp_f32 v149, v149
    v_exp_f32 v144, v144
    v_exp_f32 v145, v145
    v_cvt_pk_bf16_f32 v152, v152, v152
    v_cvt_pk_bf16_f32 v153, v153, v153
    v_cvt_pk_bf16_f32 v148, v148, v148
    v_cvt_pk_bf16_f32 v149, v149, v149
    v_cvt_pk_bf16_f32 v144, v144, v144
    v_cvt_pk_bf16_f32 v145, v145, v145
    v_and_b32 v136, v152, v44
    v_and_b32 v137, v153, v45
    v_and_b32 v138, v152, v46
    buffer_load_dwordx4 v11, s[4:7], s63 offen offset:1024 lds
    v_and_b32 v139, v153, v47
    v_and_b32 v132, v148, v44
    v_and_b32 v133, v149, v45
    v_and_b32 v134, v148, v46
    v_and_b32 v135, v149, v47
    v_and_b32 v128, v144, v44
    v_and_b32 v129, v145, v45
    v_and_b32 v130, v144, v46
    v_and_b32 v131, v145, v47
    v_mfma_f32_16x16x32_bf16 v[152:155], v[40:43], v[136:139], 0
    v_mfma_f32_16x16x32_bf16 v[88:91], v[172:175], v[136:139], 0
    v_mfma_f32_16x16x32_bf16 v[120:123], v[182:185], v[136:139], 0
    v_mfma_f32_16x16x32_bf16 v[148:151], v[40:43], v[132:135], 0
    v_mfma_f32_16x16x32_bf16 v[84:87], v[170:173], v[132:135], 0
    v_mfma_f32_16x16x32_bf16 v[116:119], v[180:183], v[132:135], 0
    v_mfma_f32_16x16x32_bf16 v[144:147], v[40:43], v[128:131], 0
    v_mfma_f32_16x16x32_bf16 v[80:83], v[168:171], v[128:131], 0
    v_mfma_f32_16x16x32_bf16 v[112:115], v[178:181], v[128:131], 0
    v_rcp_f32 v152, v152
    s_nop 0
    v_pk_mul_f32 v[88:89], v[88:89], v[152:153] op_sel:[0,0] op_sel_hi:[1,0]
    v_pk_mul_f32 v[90:91], v[90:91], v[152:153] op_sel:[0,0] op_sel_hi:[1,0]
    v_pk_mul_f32 v[120:121], v[120:121], v[152:153] op_sel:[0,0] op_sel_hi:[1,0]
    v_pk_mul_f32 v[122:123], v[122:123], v[152:153] op_sel:[0,0] op_sel_hi:[1,0]
    v_cvt_pk_bf16_f32 v232, v88, v89
    v_cvt_pk_bf16_f32 v233, v90, v91
    v_cvt_pk_bf16_f32 v234, v120, v121
    v_cvt_pk_bf16_f32 v235, v122, v123
    s_cmp_lg_u32 s15, 0
    s_cbranch_scc1 L_slow_89
    buffer_store_dwordx4 v[232:235], v6, s[4:7], s34 offen
L_done_90:
    v_rcp_f32 v148, v148
    s_nop 0
    v_pk_mul_f32 v[84:85], v[84:85], v[148:149] op_sel:[0,0] op_sel_hi:[1,0]
    v_pk_mul_f32 v[86:87], v[86:87], v[148:149] op_sel:[0,0] op_sel_hi:[1,0]
    v_pk_mul_f32 v[116:117], v[116:117], v[148:149] op_sel:[0,0] op_sel_hi:[1,0]
    v_pk_mul_f32 v[118:119], v[118:119], v[148:149] op_sel:[0,0] op_sel_hi:[1,0]
    v_cvt_pk_bf16_f32 v228, v84, v85
    v_cvt_pk_bf16_f32 v229, v86, v87
    v_cvt_pk_bf16_f32 v230, v116, v117
    v_cvt_pk_bf16_f32 v231, v118, v119
    s_cmp_lg_u32 s15, 0
    s_cbranch_scc1 L_slow_91
    buffer_store_dwordx4 v[228:231], v5, s[4:7], s34 offen
L_done_92:
    v_rcp_f32 v144, v144
    s_nop 0
    v_pk_mul_f32 v[80:81], v[80:81], v[144:145] op_sel:[0,0] op_sel_hi:[1,0]
    v_pk_mul_f32 v[82:83], v[82:83], v[144:145] op_sel:[0,0] op_sel_hi:[1,0]
    v_pk_mul_f32 v[112:113], v[112:113], v[144:145] op_sel:[0,0] op_sel_hi:[1,0]
    v_pk_mul_f32 v[114:115], v[114:115], v[144:145] op_sel:[0,0] op_sel_hi:[1,0]
    v_cvt_pk_bf16_f32 v224, v80, v81
    v_cvt_pk_bf16_f32 v225, v82, v83
    v_cvt_pk_bf16_f32 v226, v112, v113
    v_cvt_pk_bf16_f32 v227, v114, v115
    s_cmp_lg_u32 s15, 0
    s_cbranch_scc1 L_slow_93
    buffer_store_dwordx4 v[224:227], v4, s[4:7], s34 offen
L_done_94:
    v_mov_b32 v63, 4
    v_lshlrev_b32 v64, 16, v16
    v_and_b32 v65, 0xffff0000, v16
    v_lshlrev_b32 v66, 16, v17
    buffer_load_dword v216, v12, s[4:7], s30 offen sc1
    v_and_b32 v67, 0xffff0000, v17
    v_lshlrev_b32 v72, 16, v18
    v_and_b32 v73, 0xffff0000, v18
    v_lshlrev_b32 v74, 16, v19
    v_and_b32 v75, 0xffff0000, v19
    v_lshlrev_b32 v80, 16, v20
    v_and_b32 v81, 0xffff0000, v20
    v_lshlrev_b32 v82, 16, v21
    v_and_b32 v83, 0xffff0000, v21
    v_lshlrev_b32 v88, 16, v22
    v_and_b32 v89, 0xffff0000, v22
    v_lshlrev_b32 v90, 16, v23
    v_and_b32 v91, 0xffff0000, v23
    v_lshlrev_b32 v68, 16, v24
    v_and_b32 v69, 0xffff0000, v24
    v_lshlrev_b32 v70, 16, v25
    v_and_b32 v71, 0xffff0000, v25
    v_lshlrev_b32 v76, 16, v26
    v_and_b32 v77, 0xffff0000, v26
    v_lshlrev_b32 v78, 16, v27
    v_and_b32 v79, 0xffff0000, v27
    v_lshlrev_b32 v84, 16, v28
    v_and_b32 v85, 0xffff0000, v28
    v_lshlrev_b32 v86, 16, v29
    v_and_b32 v87, 0xffff0000, v29
    v_lshlrev_b32 v92, 16, v30
    v_and_b32 v93, 0xffff0000, v30
    v_lshlrev_b32 v94, 16, v31
    v_and_b32 v95, 0xffff0000, v31
    s_mov_b64 exec, 1
    s_waitcnt vmcnt(1)
    s_cmp_lg_u32 s15, 0
    s_cbranch_scc1 L_slow_96
    buffer_store_dword v63, off, s[4:7], s31
L_done_97:
    s_mov_b64 exec, -1
    s_waitcnt vmcnt(1)
    s_mov_b64 exec, s[82:83]
    v_cmp_gt_u32 vcc, 4, v216
    s_mov_b64 exec, -1
    s_cbranch_vccz L_hd_95
    s_mov_b32 s61, 1048576
L_spin_98:
    buffer_load_dword v216, v12, s[4:7], s30 offen sc1
    s_sub_u32 s61, s61, 1
    s_waitcnt vmcnt(0)
    s_mov_b64 exec, 63
    v_cmp_gt_u32 vcc, 4, v216
    s_mov_b64 exec, -1
    s_cbranch_scc1 L_spind_99
    s_cbranch_vccnz L_spin_98
L_spind_99:
L_hd_95:
    s_mov_b32 s62, 29360128
    buffer_load_dwordx4 a[80:83], v8, s[4:7], s62 offen offset:0 sc1
    buffer_load_dwordx4 a[84:87], v9, s[4:7], s62 offen offset:0 sc1
    buffer_load_dwordx4 a[88:91], v8, s[4:7], s62 offen offset:1024 sc1
    buffer_load_dword v216, v12, s[4:7], s30 offen sc1
    buffer_load_dwordx4 a[92:95], v9, s[4:7], s62 offen offset:1024 sc1
    buffer_load_dwordx4 a[96:99], v8, s[4:7], s62 offen offset:2048 sc1
    buffer_load_dwordx4 a[100:103], v9, s[4:7], s62 offen offset:2048 sc1
    buffer_load_dwordx4 a[104:107], v8, s[4:7], s62 offen offset:3072 sc1
    buffer_load_dwordx4 a[108:111], v9, s[4:7], s62 offen offset:3072 sc1
    s_mov_b32 s62, 29364224
    buffer_load_dwordx4 a[112:115], v8, s[4:7], s62 offen offset:0 sc1
    buffer_load_dwordx4 a[116:119], v9, s[4:7], s62 offen offset:0 sc1
    buffer_load_dwordx4 a[120:123], v8, s[4:7], s62 offen offset:1024 sc1
    buffer_load_dwordx4 a[124:127], v9, s[4:7], s62 offen offset:1024 sc1
    s_barrier
    ds_read_b128 a[48:51], v1 offset:0
    ds_read_b128 a[52:55], v1 offset:1024
    ds_read_b128 a[56:59], v1 offset:2048
    ds_read_b128 a[60:63], v1 offset:3072
    ds_read_b128 a[64:67], v1 offset:4096
    ds_read_b128 a[68:71], v1 offset:5120
    ds_read_b128 a[72:75], v1 offset:6144
    ds_read_b128 a[76:79], v1 offset:7168
    s_waitcnt vmcnt(9)
    v_cmp_gt_u32 vcc, 4, v216
    s_cbranch_vccnz L_p2_100
L_p2_100_r:
    s_waitcnt lgkmcnt(7)
    v_mfma_f32_16x16x32_bf16 v[64:67], a[48:51], a[80:83], v[64:67]
    buffer_load_dwordx4 a[128:131], v8, s[4:7], s62 offen offset:2048 sc1
    v_mfma_f32_16x16x32_bf16 v[68:71], a[48:51], a[84:87], v[68:71]
    ds_read_b128 a[48:51], v1 offset:8192
    s_waitcnt lgkmcnt(7)
    v_mfma_f32_16x16x32_bf16 v[76:79], a[52:55], a[84:87], v[76:79]
    v_bfe_u32 v200, v1, 4, 4
    v_and_b32 v201, 0x70, v1
    v_mfma_f32_16x16x32_bf16 v[72:75], a[52:55], a[80:83], v[72:75]
    ds_read_b128 a[52:55], v1 offset:9216
    s_waitcnt lgkmcnt(7)
    v_mfma_f32_16x16x32_bf16 v[80:83], a[56:59], a[80:83], v[80:83]
    buffer_load_dwordx4 a[132:135], v9, s[4:7], s62 offen offset:2048 sc1
    v_mfma_f32_16x16x32_bf16 v[84:87], a[56:59], a[84:87], v[84:87]
    ds_read_b128 a[56:59], v1 offset:10240
    s_waitcnt lgkmcnt(7)
    v_mfma_f32_16x16x32_bf16 v[92:95], a[60:63], a[84:87], v[92:95]
    v_xor_b32 v201, v201, v60
    v_lshl_add_u32 v200, v200, 7, v201
    v_mfma_f32_16x16x32_bf16 v[88:91], a[60:63], a[80:83], v[88:91]
    ds_read_b128 a[60:63], v1 offset:11264
    s_waitcnt vmcnt(10)
    s_waitcnt lgkmcnt(7)
    v_mfma_f32_16x16x32_bf16 v[64:67], a[64:67], a[88:91], v[64:67]
    buffer_load_dwordx4 a[80:83], v8, s[4:7], s62 offen offset:3072 sc1
    v_mfma_f32_16x16x32_bf16 v[68:71], a[64:67], a[92:95], v[68:71]
    ds_read_b128 a[64:67], v1 offset:12288
    s_waitcnt lgkmcnt(7)
    v_mfma_f32_16x16x32_bf16 v[76:79], a[68:71], a[92:95], v[76:79]
    v_add_u32 v200, s57, v200
    v_lshrrev_b32 v202, 7, v1
    v_mfma_f32_16x16x32_bf16 v[72:75], a[68:71], a[88:91], v[72:75]
    ds_read_b128 a[68:71], v1 offset:13312
    s_waitcnt lgkmcnt(7)
    v_mfma_f32_16x16x32_bf16 v[80:83], a[72:75], a[88:91], v[80:83]
    buffer_load_dwordx4 a[84:87], v9, s[4:7], s62 offen offset:3072 sc1
    v_mfma_f32_16x16x32_bf16 v[84:87], a[72:75], a[92:95], v[84:87]
    ds_read_b128 a[72:75], v1 offset:14336
    s_waitcnt lgkmcnt(7)
    v_mfma_f32_16x16x32_bf16 v[92:95], a[76:79], a[92:95], v[92:95]
    v_and_b32 v203, 0x70, v1
    v_lshlrev_b32 v204, 4, v202
    v_mfma_f32_16x16x32_bf16 v[88:91], a[76:79], a[88:91], v[88:91]
    ds_read_b128 a[76:79], v1 offset:15360
    s_waitcnt vmcnt(10)
    s_waitcnt lgkmcnt(7)
    v_mfma_f32_16x16x32_bf16 v[64:67], a[48:51], a[96:99], v[64:67]
    s_mov_b32 s62, 29368320
    buffer_load_dwordx4 a[88:91], v8, s[4:7], s62 offen offset:0 sc1
    v_mfma_f32_16x16x32_bf16 v[68:71], a[48:51], a[100:103], v[68:71]
    ds_read_b128 a[48:51], v1 offset:16384
    s_waitcnt lgkmcnt(7)
    v_mfma_f32_16x16x32_bf16 v[76:79], a[52:55], a[100:103], v[76:79]
    v_xor_b32 v201, 64, v200
    v_xor_b32 v203, v203, v204
    v_mfma_f32_16x16x32_bf16 v[72:75], a[52:55], a[96:99], v[72:75]
    ds_read_b128 a[52:55], v1 offset:17408
    s_waitcnt lgkmcnt(7)
    v_mfma_f32_16x16x32_bf16 v[80:83], a[56:59], a[96:99], v[80:83]
    buffer_load_dwordx4 a[92:95], v9, s[4:7], s62 offen offset:0 sc1
    v_mfma_f32_16x16x32_bf16 v[84:87], a[56:59], a[100:103], v[84:87]
    ds_read_b128 a[56:59], v1 offset:18432
    s_waitcnt lgkmcnt(7)
    v_mfma_f32_16x16x32_bf16 v[92:95], a[60:63], a[100:103], v[92:95]
    v_lshl_add_u32 v202, v202, 11, v203
    v_mfma_f32_16x16x32_bf16 v[88:91], a[60:63], a[96:99], v[88:91]
    ds_read_b128 a[60:63], v1 offset:19456
    s_waitcnt vmcnt(10)
    s_waitcnt lgkmcnt(7)
    v_mfma_f32_16x16x32_bf16 v[64:67], a[64:67], a[104:107], v[64:67]
    buffer_load_dwordx4 a[96:99], v8, s[4:7], s62 offen offset:1024 sc1
    v_mfma_f32_16x16x32_bf16 v[68:71], a[64:67], a[108:111], v[68:71]
    ds_read_b128 a[64:67], v1 offset:20480
    s_waitcnt lgkmcnt(7)
    v_mfma_f32_16x16x32_bf16 v[76:79], a[68:71], a[108:111], v[76:79]
    s_mov_b32 s8, s78
    s_mov_b32 s9, s79
    v_mfma_f32_16x16x32_bf16 v[72:75], a[68:71], a[104:107], v[72:75]
    ds_read_b128 a[68:71], v1 offset:21504
    s_waitcnt lgkmcnt(7)
    v_mfma_f32_16x16x32_bf16 v[80:83], a[72:75], a[104:107], v[80:83]
    buffer_load_dwordx4 a[100:103], v9, s[4:7], s62 offen offset:1024 sc1
    v_mfma_f32_16x16x32_bf16 v[84:87], a[72:75], a[108:111], v[84:87]
    ds_read_b128 a[72:75], v1 offset:22528
    s_waitcnt lgkmcnt(7)
    v_mfma_f32_16x16x32_bf16 v[92:95], a[76:79], a[108:111], v[92:95]
    s_mov_b32 s10, 0x400000
    s_mov_b32 s11, 0x20000
    v_mfma_f32_16x16x32_bf16 v[88:91], a[76:79], a[104:107], v[88:91]
    ds_read_b128 a[76:79], v1 offset:23552
    s_waitcnt vmcnt(10)
    s_waitcnt lgkmcnt(7)
    v_mfma_f32_16x16x32_bf16 v[64:67], a[48:51], a[112:115], v[64:67]
    buffer_load_dwordx4 a[104:107], v8, s[4:7], s62 offen offset:2048 sc1
    v_mfma_f32_16x16x32_bf16 v[68:71], a[48:51], a[116:119], v[68:71]
    ds_read_b128 a[48:51], v1 offset:24576
    s_waitcnt lgkmcnt(7)
    v_mfma_f32_16x16x32_bf16 v[76:79], a[52:55], a[116:119], v[76:79]
    s_lshl_b32 s19, s18, 2
    s_add_u32 s19, s19, s12
    v_mfma_f32_16x16x32_bf16 v[72:75], a[52:55], a[112:115], v[72:75]
    ds_read_b128 a[52:55], v1 offset:25600
    s_waitcnt lgkmcnt(7)
    v_mfma_f32_16x16x32_bf16 v[80:83], a[56:59], a[112:115], v[80:83]
    buffer_load_dwordx4 a[108:111], v9, s[4:7], s62 offen offset:2048 sc1
    v_mfma_f32_16x16x32_bf16 v[84:87], a[56:59], a[116:119], v[84:87]
    ds_read_b128 a[56:59], v1 offset:26624
    s_waitcnt lgkmcnt(7)
    v_mfma_f32_16x16x32_bf16 v[92:95], a[60:63], a[116:119], v[92:95]
    s_lshl_b32 s19, s19, 16
    s_lshl_b32 s20, s17, 7
    v_mfma_f32_16x16x32_bf16 v[88:91], a[60:63], a[112:115], v[88:91]
    ds_read_b128 a[60:63], v1 offset:27648
    s_waitcnt vmcnt(10)
    s_waitcnt lgkmcnt(7)
    v_mfma_f32_16x16x32_bf16 v[64:67], a[64:67], a[120:123], v[64:67]
    buffer_load_dwordx4 a[112:115], v8, s[4:7], s62 offen offset:3072 sc1
    v_mfma_f32_16x16x32_bf16 v[68:71], a[64:67], a[124:127], v[68:71]
    ds_read_b128 a[64:67], v1 offset:28672
    s_waitcnt lgkmcnt(7)
    v_mfma_f32_16x16x32_bf16 v[76:79], a[68:71], a[124:127], v[76:79]
    s_add_u32 s19, s19, s20
    v_mfma_f32_16x16x32_bf16 v[72:75], a[68:71], a[120:123], v[72:75]
    ds_read_b128 a[68:71], v1 offset:29696
    s_waitcnt lgkmcnt(7)
    v_mfma_f32_16x16x32_bf16 v[80:83], a[72:75], a[120:123], v[80:83]
    buffer_load_dwordx4 a[116:119], v9, s[4:7], s62 offen offset:3072 sc1
    v_mfma_f32_16x16x32_bf16 v[84:87], a[72:75], a[124:127], v[84:87]
    ds_read_b128 a[72:75], v1 offset:30720
    s_waitcnt lgkmcnt(7)
    v_mfma_f32_16x16x32_bf16 v[92:95], a[76:79], a[124:127], v[92:95]
    v_mfma_f32_16x16x32_bf16 v[88:91], a[76:79], a[120:123], v[88:91]
    ds_read_b128 a[76:79], v1 offset:31744
    s_waitcnt vmcnt(10)
    s_waitcnt lgkmcnt(7)
    v_mfma_f32_16x16x32_bf16 v[64:67], a[48:51], a[128:131], v[64:67]
    s_mov_b32 s62, 29372416
    buffer_load_dwordx4 a[120:123], v8, s[4:7], s62 offen offset:0 sc1
    v_mfma_f32_16x16x32_bf16 v[68:71], a[48:51], a[132:135], v[68:71]
    ds_read_b128 a[48:51], v1 offset:32768
    s_waitcnt lgkmcnt(7)
    v_mfma_f32_16x16x32_bf16 v[76:79], a[52:55], a[132:135], v[76:79]
    v_mfma_f32_16x16x32_bf16 v[72:75], a[52:55], a[128:131], v[72:75]
    ds_read_b128 a[52:55], v1 offset:33792
    s_waitcnt lgkmcnt(7)
    v_mfma_f32_16x16x32_bf16 v[80:83], a[56:59], a[128:131], v[80:83]
    buffer_load_dwordx4 a[124:127], v9, s[4:7], s62 offen offset:0 sc1
    v_mfma_f32_16x16x32_bf16 v[84:87], a[56:59], a[132:135], v[84:87]
    ds_read_b128 a[56:59], v1 offset:34816
    s_waitcnt lgkmcnt(7)
    v_mfma_f32_16x16x32_bf16 v[92:95], a[60:63], a[132:135], v[92:95]
    v_mfma_f32_16x16x32_bf16 v[88:91], a[60:63], a[128:131], v[88:91]
    ds_read_b128 a[60:63], v1 offset:35840
    s_waitcnt vmcnt(10)
    s_waitcnt lgkmcnt(7)
    v_mfma_f32_16x16x32_bf16 v[64:67], a[64:67], a[80:83], v[64:67]
    buffer_load_dwordx4 a[128:131], v8, s[4:7], s62 offen offset:1024 sc1
    v_mfma_f32_16x16x32_bf16 v[68:71], a[64:67], a[84:87], v[68:71]
    ds_read_b128 a[64:67], v1 offset:36864
    s_waitcnt lgkmcnt(7)
    v_mfma_f32_16x16x32_bf16 v[76:79], a[68:71], a[84:87], v[76:79]
    v_mfma_f32_16x16x32_bf16 v[72:75], a[68:71], a[80:83], v[72:75]
    ds_read_b128 a[68:71], v1 offset:37888
    s_waitcnt lgkmcnt(7)
    v_mfma_f32_16x16x32_bf16 v[80:83], a[72:75], a[80:83], v[80:83]
    buffer_load_dwordx4 a[132:135], v9, s[4:7], s62 offen offset:1024 sc1
    v_mfma_f32_16x16x32_bf16 v[84:87], a[72:75], a[84:87], v[84:87]
    ds_read_b128 a[72:75], v1 offset:38912
    s_waitcnt lgkmcnt(7)
    v_mfma_f32_16x16x32_bf16 v[92:95], a[76:79], a[84:87], v[92:95]
    v_mfma_f32_16x16x32_bf16 v[88:91], a[76:79], a[80:83], v[88:91]
    ds_read_b128 a[76:79], v1 offset:39936
    s_waitcnt vmcnt(10)
    s_waitcnt lgkmcnt(7)
    v_mfma_f32_16x16x32_bf16 v[64:67], a[48:51], a[88:91], v[64:67]
    buffer_load_dwordx4 a[80:83], v8, s[4:7], s62 offen offset:2048 sc1
    v_mfma_f32_16x16x32_bf16 v[68:71], a[48:51], a[92:95], v[68:71]
    ds_read_b128 a[48:51], v1 offset:40960
    s_waitcnt lgkmcnt(7)
    v_mfma_f32_16x16x32_bf16 v[76:79], a[52:55], a[92:95], v[76:79]
    v_mfma_f32_16x16x32_bf16 v[72:75], a[52:55], a[88:91], v[72:75]
    ds_read_b128 a[52:55], v1 offset:41984
    s_waitcnt lgkmcnt(7)
    v_mfma_f32_16x16x32_bf16 v[80:83], a[56:59], a[88:91], v[80:83]
    buffer_load_dwordx4 a[84:87], v9, s[4:7], s62 offen offset:2048 sc1
    v_mfma_f32_16x16x32_bf16 v[84:87], a[56:59], a[92:95], v[84:87]
    ds_read_b128 a[56:59], v1 offset:43008
    s_waitcnt lgkmcnt(7)
    v_mfma_f32_16x16x32_bf16 v[92:95], a[60:63], a[92:95], v[92:95]
    v_mfma_f32_16x16x32_bf16 v[88:91], a[60:63], a[88:91], v[88:91]
    ds_read_b128 a[60:63], v1 offset:44032
    s_waitcnt vmcnt(10)
    s_waitcnt lgkmcnt(7)
    v_mfma_f32_16x16x32_bf16 v[64:67], a[64:67], a[96:99], v[64:67]
    buffer_load_dwordx4 a[88:91], v8, s[4:7], s62 offen offset:3072 sc1
    v_mfma_f32_16x16x32_bf16 v[68:71], a[64:67], a[100:103], v[68:71]
    ds_read_b128 a[64:67], v1 offset:45056
    s_waitcnt lgkmcnt(7)
    v_mfma_f32_16x16x32_bf16 v[76:79], a[68:71], a[100:103], v[76:79]
    v_mfma_f32_16x16x32_bf16 v[72:75], a[68:71], a[96:99], v[72:75]
    ds_read_b128 a[68:71], v1 offset:46080
    s_waitcnt lgkmcnt(7)
    v_mfma_f32_16x16x32_bf16 v[80:83], a[72:75], a[96:99], v[80:83]
    buffer_load_dwordx4 a[92:95], v9, s[4:7], s62 offen offset:3072 sc1
    v_mfma_f32_16x16x32_bf16 v[84:87], a[72:75], a[100:103], v[84:87]
    ds_read_b128 a[72:75], v1 offset:47104
    s_waitcnt lgkmcnt(7)
    v_mfma_f32_16x16x32_bf16 v[92:95], a[76:79], a[100:103], v[92:95]
    v_mfma_f32_16x16x32_bf16 v[88:91], a[76:79], a[96:99], v[88:91]
    ds_read_b128 a[76:79], v1 offset:48128
    s_waitcnt vmcnt(10)
    s_waitcnt lgkmcnt(7)
    v_mfma_f32_16x16x32_bf16 v[64:67], a[48:51], a[104:107], v[64:67]
    s_mov_b32 s62, 29376512
    buffer_load_dwordx4 a[96:99], v8, s[4:7], s62 offen offset:0 sc1
    v_mfma_f32_16x16x32_bf16 v[68:71], a[48:51], a[108:111], v[68:71]
    ds_read_b128 a[48:51], v1 offset:49152
    s_waitcnt lgkmcnt(7)
    v_mfma_f32_16x16x32_bf16 v[76:79], a[52:55], a[108:111], v[76:79]
    v_mfma_f32_16x16x32_bf16 v[72:75], a[52:55], a[104:107], v[72:75]
    ds_read_b128 a[52:55], v1 offset:50176
    s_waitcnt lgkmcnt(7)
    v_mfma_f32_16x16x32_bf16 v[80:83], a[56:59], a[104:107], v[80:83]
    buffer_load_dwordx4 a[100:103], v9, s[4:7], s62 offen offset:0 sc1
    v_mfma_f32_16x16x32_bf16 v[84:87], a[56:59], a[108:111], v[84:87]
    ds_read_b128 a[56:59], v1 offset:51200
    s_waitcnt lgkmcnt(7)
    v_mfma_f32_16x16x32_bf16 v[92:95], a[60:63], a[108:111], v[92:95]
    v_mfma_f32_16x16x32_bf16 v[88:91], a[60:63], a[104:107], v[88:91]
    ds_read_b128 a[60:63], v1 offset:52224
    s_waitcnt vmcnt(10)
    s_waitcnt lgkmcnt(7)
    v_mfma_f32_16x16x32_bf16 v[64:67], a[64:67], a[112:115], v[64:67]
    buffer_load_dwordx4 a[104:107], v8, s[4:7], s62 offen offset:1024 sc1
    v_mfma_f32_16x16x32_bf16 v[68:71], a[64:67], a[116:119], v[68:71]
    ds_read_b128 a[64:67], v1 offset:53248
    s_waitcnt lgkmcnt(7)
    v_mfma_f32_16x16x32_bf16 v[76:79], a[68:71], a[116:119], v[76:79]
    v_mfma_f32_16x16x32_bf16 v[72:75], a[68:71], a[112:115], v[72:75]
    ds_read_b128 a[68:71], v1 offset:54272
    s_waitcnt lgkmcnt(7)
    v_mfma_f32_16x16x32_bf16 v[80:83], a[72:75], a[112:115], v[80:83]
    buffer_load_dwordx4 a[108:111], v9, s[4:7], s62 offen offset:1024 sc1
    v_mfma_f32_16x16x32_bf16 v[84:87], a[72:75], a[116:119], v[84:87]
    ds_read_b128 a[72:75], v1 offset:55296
    s_waitcnt lgkmcnt(7)
    v_mfma_f32_16x16x32_bf16 v[92:95], a[76:79], a[116:119], v[92:95]
    v_mfma_f32_16x16x32_bf16 v[88:91], a[76:79], a[112:115], v[88:91]
    ds_read_b128 a[76:79], v1 offset:56320
    s_waitcnt vmcnt(10)
    s_waitcnt lgkmcnt(7)
    v_mfma_f32_16x16x32_bf16 v[64:67], a[48:51], a[120:123], v[64:67]
    buffer_load_dwordx4 a[112:115], v8, s[4:7], s62 offen offset:2048 sc1
    v_mfma_f32_16x16x32_bf16 v[68:71], a[48:51], a[124:127], v[68:71]
    ds_read_b128 a[48:51], v2 offset:8192
    s_waitcnt lgkmcnt(7)
    v_mfma_f32_16x16x32_bf16 v[76:79], a[52:55], a[124:127], v[76:79]
    v_mfma_f32_16x16x32_bf16 v[72:75], a[52:55], a[120:123], v[72:75]
    ds_read_b128 a[52:55], v2 offset:9216
    s_waitcnt lgkmcnt(7)
    v_mfma_f32_16x16x32_bf16 v[80:83], a[56:59], a[120:123], v[80:83]
    buffer_load_dwordx4 a[116:119], v9, s[4:7], s62 offen offset:2048 sc1
    v_mfma_f32_16x16x32_bf16 v[84:87], a[56:59], a[124:127], v[84:87]
    ds_read_b128 a[56:59], v2 offset:10240
    s_waitcnt lgkmcnt(7)
    v_mfma_f32_16x16x32_bf16 v[92:95], a[60:63], a[124:127], v[92:95]
    v_mfma_f32_16x16x32_bf16 v[88:91], a[60:63], a[120:123], v[88:91]
    ds_read_b128 a[60:63], v2 offset:11264
    s_waitcnt vmcnt(10)
    s_waitcnt lgkmcnt(7)
    v_mfma_f32_16x16x32_bf16 v[64:67], a[64:67], a[128:131], v[64:67]
    buffer_load_dwordx4 a[120:123], v8, s[4:7], s62 offen offset:3072 sc1
    v_mfma_f32_16x16x32_bf16 v[68:71], a[64:67], a[132:135], v[68:71]
    ds_read_b128 a[64:67], v2 offset:12288
    s_waitcnt lgkmcnt(7)
    v_mfma_f32_16x16x32_bf16 v[76:79], a[68:71], a[132:135], v[76:79]
    v_mfma_f32_16x16x32_bf16 v[72:75], a[68:71], a[128:131], v[72:75]
    ds_read_b128 a[68:71], v2 offset:13312
    s_waitcnt lgkmcnt(7)
    v_mfma_f32_16x16x32_bf16 v[80:83], a[72:75], a[128:131], v[80:83]
    buffer_load_dwordx4 a[124:127], v9, s[4:7], s62 offen offset:3072 sc1
    v_mfma_f32_16x16x32_bf16 v[84:87], a[72:75], a[132:135], v[84:87]
    ds_read_b128 a[72:75], v2 offset:14336
    s_waitcnt lgkmcnt(7)
    v_mfma_f32_16x16x32_bf16 v[92:95], a[76:79], a[132:135], v[92:95]
    v_mfma_f32_16x16x32_bf16 v[88:91], a[76:79], a[128:131], v[88:91]
    ds_read_b128 a[76:79], v2 offset:15360
    s_waitcnt vmcnt(10)
    s_waitcnt lgkmcnt(7)
    v_mfma_f32_16x16x32_bf16 v[64:67], a[48:51], a[80:83], v[64:67]
    s_mov_b32 s62, 29380608
    buffer_load_dwordx4 a[128:131], v8, s[4:7], s62 offen offset:0 sc1
    v_mfma_f32_16x16x32_bf16 v[68:71], a[48:51], a[84:87], v[68:71]
    ds_read_b128 a[48:51], v2 offset:16384
    s_waitcnt lgkmcnt(7)
    v_mfma_f32_16x16x32_bf16 v[76:79], a[52:55], a[84:87], v[76:79]
    v_mfma_f32_16x16x32_bf16 v[72:75], a[52:55], a[80:83], v[72:75]
    ds_read_b128 a[52:55], v2 offset:17408
    s_waitcnt lgkmcnt(7)
    v_mfma_f32_16x16x32_bf16 v[80:83], a[56:59], a[80:83], v[80:83]
    buffer_load_dwordx4 a[132:135], v9, s[4:7], s62 offen offset:0 sc1
    v_mfma_f32_16x16x32_bf16 v[84:87], a[56:59], a[84:87], v[84:87]
    ds_read_b128 a[56:59], v2 offset:18432
    s_waitcnt lgkmcnt(7)
    v_mfma_f32_16x16x32_bf16 v[92:95], a[60:63], a[84:87], v[92:95]
    v_mfma_f32_16x16x32_bf16 v[88:91], a[60:63], a[80:83], v[88:91]
    ds_read_b128 a[60:63], v2 offset:19456
    s_waitcnt vmcnt(10)
    s_barrier
    s_waitcnt lgkmcnt(7)
    v_mfma_f32_16x16x32_bf16 v[64:67], a[64:67], a[88:91], v[64:67]
    buffer_load_dwordx4 a[80:83], v8, s[4:7], s62 offen offset:1024 sc1
    v_mfma_f32_16x16x32_bf16 v[68:71], a[64:67], a[92:95], v[68:71]
    ds_read_b128 a[64:67], v2 offset:20480
    s_waitcnt lgkmcnt(7)
    v_mfma_f32_16x16x32_bf16 v[76:79], a[68:71], a[92:95], v[76:79]
    v_mfma_f32_16x16x32_bf16 v[72:75], a[68:71], a[88:91], v[72:75]
    ds_read_b128 a[68:71], v2 offset:21504
    s_waitcnt lgkmcnt(7)
    v_mfma_f32_16x16x32_bf16 v[80:83], a[72:75], a[88:91], v[80:83]
    buffer_load_dwordx4 a[84:87], v9, s[4:7], s62 offen offset:1024 sc1
    v_mfma_f32_16x16x32_bf16 v[84:87], a[72:75], a[92:95], v[84:87]
    ds_read_b128 a[72:75], v2 offset:22528
    s_waitcnt lgkmcnt(7)
    v_mfma_f32_16x16x32_bf16 v[92:95], a[76:79], a[92:95], v[92:95]
    v_mfma_f32_16x16x32_bf16 v[88:91], a[76:79], a[88:91], v[88:91]
    ds_read_b128 a[76:79], v2 offset:23552
    s_waitcnt vmcnt(10)
    s_waitcnt lgkmcnt(7)
    v_mfma_f32_16x16x32_bf16 v[64:67], a[48:51], a[96:99], v[64:67]
    buffer_load_dwordx4 a[88:91], v8, s[4:7], s62 offen offset:2048 sc1
    v_mfma_f32_16x16x32_bf16 v[68:71], a[48:51], a[100:103], v[68:71]
    ds_read_b128 a[48:51], v2 offset:24576
    s_waitcnt lgkmcnt(7)
    v_mfma_f32_16x16x32_bf16 v[76:79], a[52:55], a[100:103], v[76:79]
    v_mfma_f32_16x16x32_bf16 v[72:75], a[52:55], a[96:99], v[72:75]
    ds_read_b128 a[52:55], v2 offset:25600
    s_waitcnt lgkmcnt(7)
    v_mfma_f32_16x16x32_bf16 v[80:83], a[56:59], a[96:99], v[80:83]
    buffer_load_dwordx4 a[92:95], v9, s[4:7], s62 offen offset:2048 sc1
    v_mfma_f32_16x16x32_bf16 v[84:87], a[56:59], a[100:103], v[84:87]
    ds_read_b128 a[56:59], v2 offset:26624
    s_waitcnt lgkmcnt(7)
    v_mfma_f32_16x16x32_bf16 v[92:95], a[60:63], a[100:103], v[92:95]
    v_mfma_f32_16x16x32_bf16 v[88:91], a[60:63], a[96:99], v[88:91]
    ds_read_b128 a[60:63], v2 offset:27648
    s_waitcnt vmcnt(10)
    s_waitcnt lgkmcnt(7)
    v_mfma_f32_16x16x32_bf16 v[64:67], a[64:67], a[104:107], v[64:67]
    buffer_load_dwordx4 a[96:99], v8, s[4:7], s62 offen offset:3072 sc1
    v_mfma_f32_16x16x32_bf16 v[68:71], a[64:67], a[108:111], v[68:71]
    ds_read_b128 a[64:67], v2 offset:28672
    s_waitcnt lgkmcnt(7)
    v_mfma_f32_16x16x32_bf16 v[76:79], a[68:71], a[108:111], v[76:79]
    v_mfma_f32_16x16x32_bf16 v[72:75], a[68:71], a[104:107], v[72:75]
    ds_read_b128 a[68:71], v2 offset:29696
    s_waitcnt lgkmcnt(7)
    v_mfma_f32_16x16x32_bf16 v[80:83], a[72:75], a[104:107], v[80:83]
    buffer_load_dwordx4 a[100:103], v9, s[4:7], s62 offen offset:3072 sc1
    v_mfma_f32_16x16x32_bf16 v[84:87], a[72:75], a[108:111], v[84:87]
    ds_read_b128 a[72:75], v2 offset:30720
    s_waitcnt lgkmcnt(7)
    v_mfma_f32_16x16x32_bf16 v[92:95], a[76:79], a[108:111], v[92:95]
    v_mfma_f32_16x16x32_bf16 v[88:91], a[76:79], a[104:107], v[88:91]
    ds_read_b128 a[76:79], v2 offset:31744
    s_waitcnt vmcnt(10)
    s_waitcnt lgkmcnt(7)
    v_mfma_f32_16x16x32_bf16 v[64:67], a[48:51], a[112:115], v[64:67]
    s_mov_b32 s62, 29384704
    buffer_load_dwordx4 a[104:107], v8, s[4:7], s62 offen offset:0 sc1
    v_mfma_f32_16x16x32_bf16 v[68:71], a[48:51], a[116:119], v[68:71]
    ds_read_b128 a[48:51], v2 offset:32768
    s_waitcnt lgkmcnt(7)
    v_mfma_f32_16x16x32_bf16 v[76:79], a[52:55], a[116:119], v[76:79]
    v_mfma_f32_16x16x32_bf16 v[72:75], a[52:55], a[112:115], v[72:75]
    ds_read_b128 a[52:55], v2 offset:33792
    s_waitcnt lgkmcnt(7)
    v_mfma_f32_16x16x32_bf16 v[80:83], a[56:59], a[112:115], v[80:83]
    buffer_load_dwordx4 a[108:111], v9, s[4:7], s62 offen offset:0 sc1
    v_mfma_f32_16x16x32_bf16 v[84:87], a[56:59], a[116:119], v[84:87]
    ds_read_b128 a[56:59], v2 offset:34816
    s_waitcnt lgkmcnt(7)
    v_mfma_f32_16x16x32_bf16 v[92:95], a[60:63], a[116:119], v[92:95]
    v_mfma_f32_16x16x32_bf16 v[88:91], a[60:63], a[112:115], v[88:91]
    ds_read_b128 a[60:63], v2 offset:35840
    s_waitcnt vmcnt(10)
    s_waitcnt lgkmcnt(7)
    v_mfma_f32_16x16x32_bf16 v[64:67], a[64:67], a[120:123], v[64:67]
    buffer_load_dwordx4 a[112:115], v8, s[4:7], s62 offen offset:1024 sc1
    v_mfma_f32_16x16x32_bf16 v[68:71], a[64:67], a[124:127], v[68:71]
    ds_read_b128 a[64:67], v2 offset:36864
    s_waitcnt lgkmcnt(7)
    v_mfma_f32_16x16x32_bf16 v[76:79], a[68:71], a[124:127], v[76:79]
    v_mfma_f32_16x16x32_bf16 v[72:75], a[68:71], a[120:123], v[72:75]
    ds_read_b128 a[68:71], v2 offset:37888
    s_waitcnt lgkmcnt(7)
    v_mfma_f32_16x16x32_bf16 v[80:83], a[72:75], a[120:123], v[80:83]
    buffer_load_dwordx4 a[116:119], v9, s[4:7], s62 offen offset:1024 sc1
    v_mfma_f32_16x16x32_bf16 v[84:87], a[72:75], a[124:127], v[84:87]
    ds_read_b128 a[72:75], v2 offset:38912
    s_waitcnt lgkmcnt(7)
    v_mfma_f32_16x16x32_bf16 v[92:95], a[76:79], a[124:127], v[92:95]
    v_mfma_f32_16x16x32_bf16 v[88:91], a[76:79], a[120:123], v[88:91]
    ds_read_b128 a[76:79], v2 offset:39936
    s_waitcnt vmcnt(10)
    s_waitcnt lgkmcnt(7)
    v_mfma_f32_16x16x32_bf16 v[64:67], a[48:51], a[128:131], v[64:67]
    buffer_load_dwordx4 a[120:123], v8, s[4:7], s62 offen offset:2048 sc1
    v_mfma_f32_16x16x32_bf16 v[68:71], a[48:51], a[132:135], v[68:71]
    ds_read_b128 a[48:51], v2 offset:40960
    s_waitcnt lgkmcnt(7)
    v_mfma_f32_16x16x32_bf16 v[76:79], a[52:55], a[132:135], v[76:79]
    v_mfma_f32_16x16x32_bf16 v[72:75], a[52:55], a[128:131], v[72:75]
    ds_read_b128 a[52:55], v2 offset:41984
    s_waitcnt lgkmcnt(7)
    v_mfma_f32_16x16x32_bf16 v[80:83], a[56:59], a[128:131], v[80:83]
    buffer_load_dwordx4 a[124:127], v9, s[4:7], s62 offen offset:2048 sc1
    v_mfma_f32_16x16x32_bf16 v[84:87], a[56:59], a[132:135], v[84:87]
    ds_read_b128 a[56:59], v2 offset:43008
    s_waitcnt lgkmcnt(7)
    v_mfma_f32_16x16x32_bf16 v[92:95], a[60:63], a[132:135], v[92:95]
    v_mfma_f32_16x16x32_bf16 v[88:91], a[60:63], a[128:131], v[88:91]
    ds_read_b128 a[60:63], v2 offset:44032
    s_waitcnt vmcnt(10)
    s_waitcnt lgkmcnt(7)
    v_mfma_f32_16x16x32_bf16 v[64:67], a[64:67], a[80:83], v[64:67]
    buffer_load_dwordx4 a[128:131], v8, s[4:7], s62 offen offset:3072 sc1
    v_mfma_f32_16x16x32_bf16 v[68:71], a[64:67], a[84:87], v[68:71]
    ds_read_b128 a[64:67], v2 offset:45056
    s_waitcnt lgkmcnt(7)
    v_mfma_f32_16x16x32_bf16 v[76:79], a[68:71], a[84:87], v[76:79]
    v_mfma_f32_16x16x32_bf16 v[72:75], a[68:71], a[80:83], v[72:75]
    ds_read_b128 a[68:71], v2 offset:46080
    s_waitcnt lgkmcnt(7)
    v_mfma_f32_16x16x32_bf16 v[80:83], a[72:75], a[80:83], v[80:83]
    buffer_load_dwordx4 a[132:135], v9, s[4:7], s62 offen offset:3072 sc1
    v_mfma_f32_16x16x32_bf16 v[84:87], a[72:75], a[84:87], v[84:87]
    ds_read_b128 a[72:75], v2 offset:47104
    s_waitcnt lgkmcnt(7)
    v_mfma_f32_16x16x32_bf16 v[92:95], a[76:79], a[84:87], v[92:95]
    v_mfma_f32_16x16x32_bf16 v[88:91], a[76:79], a[80:83], v[88:91]
    ds_read_b128 a[76:79], v2 offset:48128
    s_waitcnt vmcnt(10)
    s_waitcnt lgkmcnt(7)
    v_mfma_f32_16x16x32_bf16 v[64:67], a[48:51], a[88:91], v[64:67]
    s_mov_b32 s62, 29388800
    buffer_load_dwordx4 a[80:83], v8, s[4:7], s62 offen offset:0 sc1
    v_mfma_f32_16x16x32_bf16 v[68:71], a[48:51], a[92:95], v[68:71]
    ds_read_b128 a[48:51], v2 offset:49152
    s_waitcnt lgkmcnt(7)
    v_mfma_f32_16x16x32_bf16 v[76:79], a[52:55], a[92:95], v[76:79]
    v_mfma_f32_16x16x32_bf16 v[72:75], a[52:55], a[88:91], v[72:75]
    ds_read_b128 a[52:55], v2 offset:50176
    s_waitcnt lgkmcnt(7)
    v_mfma_f32_16x16x32_bf16 v[80:83], a[56:59], a[88:91], v[80:83]
    buffer_load_dwordx4 a[84:87], v9, s[4:7], s62 offen offset:0 sc1
    v_mfma_f32_16x16x32_bf16 v[84:87], a[56:59], a[92:95], v[84:87]
    ds_read_b128 a[56:59], v2 offset:51200
    s_waitcnt lgkmcnt(7)
    v_mfma_f32_16x16x32_bf16 v[92:95], a[60:63], a[92:95], v[92:95]
    v_mfma_f32_16x16x32_bf16 v[88:91], a[60:63], a[88:91], v[88:91]
    ds_read_b128 a[60:63], v2 offset:52224
    s_waitcnt vmcnt(10)
    s_waitcnt lgkmcnt(7)
    v_mfma_f32_16x16x32_bf16 v[64:67], a[64:67], a[96:99], v[64:67]
    buffer_load_dwordx4 a[88:91], v8, s[4:7], s62 offen offset:1024 sc1
    v_mfma_f32_16x16x32_bf16 v[68:71], a[64:67], a[100:103], v[68:71]
    ds_read_b128 a[64:67], v2 offset:53248
    s_waitcnt lgkmcnt(7)
    v_mfma_f32_16x16x32_bf16 v[76:79], a[68:71], a[100:103], v[76:79]
    v_mfma_f32_16x16x32_bf16 v[72:75], a[68:71], a[96:99], v[72:75]
    ds_read_b128 a[68:71], v2 offset:54272
    s_waitcnt lgkmcnt(7)
    v_mfma_f32_16x16x32_bf16 v[80:83], a[72:75], a[96:99], v[80:83]
    buffer_load_dwordx4 a[92:95], v8, s[4:7], s62 offen offset:2048 sc1
    v_mfma_f32_16x16x32_bf16 v[84:87], a[72:75], a[100:103], v[84:87]
    ds_read_b128 a[72:75], v2 offset:55296
    s_waitcnt lgkmcnt(7)
    v_mfma_f32_16x16x32_bf16 v[92:95], a[76:79], a[100:103], v[92:95]
    v_mfma_f32_16x16x32_bf16 v[88:91], a[76:79], a[96:99], v[88:91]
    ds_read_b128 a[76:79], v2 offset:56320
    s_waitcnt vmcnt(10)
    s_waitcnt lgkmcnt(7)
    v_mfma_f32_16x16x32_bf16 v[64:67], a[48:51], a[104:107], v[64:67]
    buffer_load_dwordx4 a[96:99], v8, s[4:7], s62 offen offset:3072 sc1
    v_mfma_f32_16x16x32_bf16 v[68:71], a[48:51], a[108:111], v[68:71]
    ds_read_b128 a[48:51], v2 offset:57344
    s_waitcnt lgkmcnt(7)
    v_mfma_f32_16x16x32_bf16 v[76:79], a[52:55], a[108:111], v[76:79]
    v_mfma_f32_16x16x32_bf16 v[72:75], a[52:55], a[104:107], v[72:75]
    ds_read_b128 a[52:55], v2 offset:58368
    s_waitcnt lgkmcnt(7)
    v_mfma_f32_16x16x32_bf16 v[80:83], a[56:59], a[104:107], v[80:83]
    buffer_load_dwordx4 a[100:103], v9, s[4:7], s62 offen offset:1024 sc1
    v_mfma_f32_16x16x32_bf16 v[84:87], a[56:59], a[108:111], v[84:87]
    ds_read_b128 a[56:59], v2 offset:59392
    s_waitcnt lgkmcnt(7)
    v_mfma_f32_16x16x32_bf16 v[92:95], a[60:63], a[108:111], v[92:95]
    v_mfma_f32_16x16x32_bf16 v[88:91], a[60:63], a[104:107], v[88:91]
    ds_read_b128 a[60:63], v2 offset:60416
    s_waitcnt vmcnt(10)
    s_waitcnt lgkmcnt(7)
    v_mfma_f32_16x16x32_bf16 v[64:67], a[64:67], a[112:115], v[64:67]
    buffer_load_dwordx4 a[104:107], v9, s[4:7], s62 offen offset:2048 sc1
    v_mfma_f32_16x16x32_bf16 v[68:71], a[64:67], a[116:119], v[68:71]
    ds_read_b128 a[64:67], v2 offset:61440
    s_waitcnt lgkmcnt(7)
    v_mfma_f32_16x16x32_bf16 v[76:79], a[68:71], a[116:119], v[76:79]
    v_mfma_f32_16x16x32_bf16 v[72:75], a[68:71], a[112:115], v[72:75]
    ds_read_b128 a[68:71], v2 offset:62464
    s_waitcnt lgkmcnt(7)
    v_mfma_f32_16x16x32_bf16 v[80:83], a[72:75], a[112:115], v[80:83]
    buffer_load_dwordx4 a[108:111], v9, s[4:7], s62 offen offset:3072 sc1
    v_mfma_f32_16x16x32_bf16 v[84:87], a[72:75], a[116:119], v[84:87]
    ds_read_b128 a[72:75], v2 offset:63488
    s_waitcnt lgkmcnt(7)
    v_mfma_f32_16x16x32_bf16 v[92:95], a[76:79], a[116:119], v[92:95]
    v_mfma_f32_16x16x32_bf16 v[88:91], a[76:79], a[112:115], v[88:91]
    ds_read_b128 a[76:79], v2 offset:64512
    s_waitcnt vmcnt(10)
    s_waitcnt lgkmcnt(7)
    v_mfma_f32_16x16x32_bf16 v[64:67], a[48:51], a[120:123], v[64:67]
    v_mfma_f32_16x16x32_bf16 v[68:71], a[48:51], a[124:127], v[68:71]
    ds_read_b128 a[48:51], v3 offset:0
    s_waitcnt lgkmcnt(7)
    v_mfma_f32_16x16x32_bf16 v[76:79], a[52:55], a[124:127], v[76:79]
    v_mfma_f32_16x16x32_bf16 v[72:75], a[52:55], a[120:123], v[72:75]
    ds_read_b128 a[52:55], v3 offset:1024
    s_waitcnt lgkmcnt(7)
    v_mfma_f32_16x16x32_bf16 v[80:83], a[56:59], a[120:123], v[80:83]
    v_mfma_f32_16x16x32_bf16 v[84:87], a[56:59], a[124:127], v[84:87]
    ds_read_b128 a[56:59], v3 offset:2048
    s_waitcnt lgkmcnt(7)
    v_mfma_f32_16x16x32_bf16 v[92:95], a[60:63], a[124:127], v[92:95]
    v_mfma_f32_16x16x32_bf16 v[88:91], a[60:63], a[120:123], v[88:91]
    ds_read_b128 a[60:63], v3 offset:3072
    s_waitcnt vmcnt(8)
    s_waitcnt lgkmcnt(7)
    v_mfma_f32_16x16x32_bf16 v[64:67], a[64:67], a[128:131], v[64:67]
    v_mfma_f32_16x16x32_bf16 v[68:71], a[64:67], a[132:135], v[68:71]
    ds_read_b128 a[64:67], v3 offset:4096
    s_waitcnt lgkmcnt(7)
    v_mfma_f32_16x16x32_bf16 v[76:79], a[68:71], a[132:135], v[76:79]
    v_mfma_f32_16x16x32_bf16 v[72:75], a[68:71], a[128:131], v[72:75]
    ds_read_b128 a[68:71], v3 offset:5120
    s_waitcnt lgkmcnt(7)
    v_mfma_f32_16x16x32_bf16 v[80:83], a[72:75], a[128:131], v[80:83]
    v_mfma_f32_16x16x32_bf16 v[84:87], a[72:75], a[132:135], v[84:87]
    ds_read_b128 a[72:75], v3 offset:6144
    s_waitcnt lgkmcnt(7)
    v_mfma_f32_16x16x32_bf16 v[92:95], a[76:79], a[132:135], v[92:95]
    v_mfma_f32_16x16x32_bf16 v[88:91], a[76:79], a[128:131], v[88:91]
    ds_read_b128 a[76:79], v3 offset:7168
    s_waitcnt vmcnt(6)
    s_waitcnt lgkmcnt(7)
    v_mfma_f32_16x16x32_bf16 v[64:67], a[48:51], a[80:83], v[64:67]
    v_mfma_f32_16x16x32_bf16 v[68:71], a[48:51], a[84:87], v[68:71]
    ds_read_b128 a[48:51], v3 offset:8192
    s_waitcnt lgkmcnt(7)
    v_mfma_f32_16x16x32_bf16 v[76:79], a[52:55], a[84:87], v[76:79]
    v_mfma_f32_16x16x32_bf16 v[72:75], a[52:55], a[80:83], v[72:75]
    ds_read_b128 a[52:55], v3 offset:9216
    s_waitcnt lgkmcnt(7)
    v_mfma_f32_16x16x32_bf16 v[80:83], a[56:59], a[80:83], v[80:83]
    v_mfma_f32_16x16x32_bf16 v[84:87], a[56:59], a[84:87], v[84:87]
    ds_read_b128 a[56:59], v3 offset:10240
    s_waitcnt lgkmcnt(7)
    v_mfma_f32_16x16x32_bf16 v[92:95], a[60:63], a[84:87], v[92:95]
    v_mfma_f32_16x16x32_bf16 v[88:91], a[60:63], a[80:83], v[88:91]
    ds_read_b128 a[60:63], v3 offset:11264
    s_waitcnt vmcnt(5)
    s_waitcnt lgkmcnt(7)
    v_mfma_f32_16x16x32_bf16 v[64:67], a[64:67], a[88:91], v[64:67]
    ds_read_b128 a[64:67], v3 offset:12288
    s_waitcnt lgkmcnt(7)
    v_mfma_f32_16x16x32_bf16 v[72:75], a[68:71], a[88:91], v[72:75]
    ds_read_b128 a[68:71], v3 offset:13312
    s_waitcnt lgkmcnt(7)
    v_mfma_f32_16x16x32_bf16 v[80:83], a[72:75], a[88:91], v[80:83]
    ds_read_b128 a[72:75], v3 offset:14336
    s_waitcnt lgkmcnt(7)
    v_mfma_f32_16x16x32_bf16 v[88:91], a[76:79], a[88:91], v[88:91]
    ds_read_b128 a[76:79], v3 offset:15360
    s_waitcnt vmcnt(4)
    s_waitcnt lgkmcnt(7)
    v_mfma_f32_16x16x32_bf16 v[64:67], a[48:51], a[92:95], v[64:67]
    ds_read_b128 a[48:51], v3 offset:4096
    s_waitcnt lgkmcnt(7)
    v_mfma_f32_16x16x32_bf16 v[72:75], a[52:55], a[92:95], v[72:75]
    ds_read_b128 a[52:55], v3 offset:5120
    s_waitcnt lgkmcnt(7)
    v_mfma_f32_16x16x32_bf16 v[80:83], a[56:59], a[92:95], v[80:83]
    ds_read_b128 a[56:59], v3 offset:6144
    s_waitcnt lgkmcnt(7)
    v_mfma_f32_16x16x32_bf16 v[88:91], a[60:63], a[92:95], v[88:91]
    ds_read_b128 a[60:63], v3 offset:7168
    s_waitcnt vmcnt(3)
    s_waitcnt lgkmcnt(7)
    v_mfma_f32_16x16x32_bf16 v[64:67], a[64:67], a[96:99], v[64:67]
    ds_read_b128 a[64:67], v3 offset:8192
    s_waitcnt lgkmcnt(7)
    v_mfma_f32_16x16x32_bf16 v[72:75], a[68:71], a[96:99], v[72:75]
    ds_read_b128 a[68:71], v3 offset:9216
    s_waitcnt lgkmcnt(7)
    v_mfma_f32_16x16x32_bf16 v[80:83], a[72:75], a[96:99], v[80:83]
    ds_read_b128 a[72:75], v3 offset:10240
    s_waitcnt lgkmcnt(7)
    v_mfma_f32_16x16x32_bf16 v[88:91], a[76:79], a[96:99], v[88:91]
    ds_read_b128 a[76:79], v3 offset:11264
    s_waitcnt vmcnt(2)
    s_waitcnt lgkmcnt(7)
    v_mfma_f32_16x16x32_bf16 v[68:71], a[48:51], a[100:103], v[68:71]
    ds_read_b128 a[48:51], v3 offset:12288
    s_waitcnt lgkmcnt(7)
    v_mfma_f32_16x16x32_bf16 v[76:79], a[52:55], a[100:103], v[76:79]
    v_cvt_pk_bf16_f32 v16, v64, v65
    v_cvt_pk_bf16_f32 v17, v66, v67
    ds_read_b128 a[52:55], v3 offset:13312
    s_waitcnt lgkmcnt(7)
    v_mfma_f32_16x16x32_bf16 v[84:87], a[56:59], a[100:103], v[84:87]
    v_cvt_pk_bf16_f32 v18, v72, v73
    v_cvt_pk_bf16_f32 v19, v74, v75
    ds_read_b128 a[56:59], v3 offset:14336
    s_waitcnt lgkmcnt(7)
    v_mfma_f32_16x16x32_bf16 v[92:95], a[60:63], a[100:103], v[92:95]
    v_cvt_pk_bf16_f32 v20, v80, v81
    v_cvt_pk_bf16_f32 v21, v82, v83
    ds_read_b128 a[60:63], v3 offset:15360
    s_waitcnt vmcnt(1)
    s_waitcnt lgkmcnt(7)
    v_mfma_f32_16x16x32_bf16 v[68:71], a[64:67], a[104:107], v[68:71]
    v_cvt_pk_bf16_f32 v22, v88, v89
    v_cvt_pk_bf16_f32 v23, v90, v91
    s_waitcnt lgkmcnt(6)
    v_mfma_f32_16x16x32_bf16 v[76:79], a[68:71], a[104:107], v[76:79]
    ds_write_b128 v200, v[16:19] offset:0
    s_waitcnt lgkmcnt(6)
    v_mfma_f32_16x16x32_bf16 v[84:87], a[72:75], a[104:107], v[84:87]
    ds_write_b128 v201, v[20:23] offset:0
    s_waitcnt lgkmcnt(6)
    v_mfma_f32_16x16x32_bf16 v[92:95], a[76:79], a[104:107], v[92:95]
    ds_read_b128 v[96:99], v0 offset:0
    s_waitcnt vmcnt(0)
    s_waitcnt lgkmcnt(6)
    v_mfma_f32_16x16x32_bf16 v[68:71], a[48:51], a[108:111], v[68:71]
    ds_read_b128 v[100:103], v0 offset:1024
    s_waitcnt lgkmcnt(6)
    v_mfma_f32_16x16x32_bf16 v[76:79], a[52:55], a[108:111], v[76:79]
    s_waitcnt lgkmcnt(5)
    v_mfma_f32_16x16x32_bf16 v[84:87], a[56:59], a[108:111], v[84:87]
    s_waitcnt lgkmcnt(4)
    v_mfma_f32_16x16x32_bf16 v[92:95], a[60:63], a[108:111], v[92:95]
    s_waitcnt lgkmcnt(1)
    buffer_store_dwordx4 v[96:99], v202, s[8:11], s19 offen sc1
    s_add_u32 s19, s19, 16384
    s_waitcnt lgkmcnt(0)
    buffer_store_dwordx4 v[100:103], v202, s[8:11], s19 offen sc1
    s_add_u32 s19, s19, 16384
    v_cvt_pk_bf16_f32 v24, v68, v69
    v_cvt_pk_bf16_f32 v25, v70, v71
    v_cvt_pk_bf16_f32 v26, v76, v77
    v_cvt_pk_bf16_f32 v27, v78, v79
    v_cvt_pk_bf16_f32 v28, v84, v85
    v_cvt_pk_bf16_f32 v29, v86, v87
    v_cvt_pk_bf16_f32 v30, v92, v93
    v_cvt_pk_bf16_f32 v31, v94, v95
    ds_write_b128 v200, v[24:27] offset:2048
    ds_write_b128 v201, v[28:31] offset:2048
    ds_read_b128 v[104:107], v0 offset:2048
    ds_read_b128 v[108:111], v0 offset:3072
    s_waitcnt lgkmcnt(1)
    buffer_store_dwordx4 v[104:107], v202, s[8:11], s19 offen sc1
    s_add_u32 s19, s19, 16384
    s_waitcnt lgkmcnt(0)
    buffer_store_dwordx4 v[108:111], v202, s[8:11], s19 offen sc1
    s_add_u32 s19, s19, 16384
    s_endpgm
L_ool:
L_goslow:
    s_mov_b32 s8, s80
    s_mov_b32 s9, s81
    s_mov_b32 s10, 256
    s_mov_b32 s11, 0x20000
    s_waitcnt lgkmcnt(0)
    s_mov_b32 s61, 1048576
L_spin_101:
    buffer_load_dword v212, v253, s[8:11], 0 offen sc1
    s_sub_u32 s61, s61, 1
    s_waitcnt vmcnt(0)
    v_cmp_ne_u32 vcc, 1, v212
    s_cbranch_scc1 L_spind_102
    s_cbranch_vccnz L_spin_101
L_spind_102:
    s_branch L_gook
L_rt_3:
    s_mov_b32 s61, 1048576
L_spin_103:
    s_mov_b32 s20, 32768
    buffer_load_dwordx4 v[216:219], v1, s[4:7], s20 offen sc1
    s_sub_u32 s61, s61, 1
    s_waitcnt vmcnt(0)
    v_and_b32 v216, v216, v217
    v_and_b32 v218, v218, v219
    v_and_b32 v216, v216, v218
    v_cmp_ne_u32 vcc, 1, v216
    s_cbranch_scc1 L_spind_104
    s_cbranch_vccnz L_spin_103
L_spind_104:
    s_branch L_rtd_4
L_kvs0_0:
    s_sub_u32 s61, s61, 1
    s_cbranch_scc1 L_kvt0_0
    s_waitcnt vmcnt(6)
    s_add_u32 s19, s58, s87
    buffer_load_dwordx4 v[96:99], v1, s[4:7], s19 offen sc1
    v_cmp_eq_u32 vcc, -1, v100
    s_cbranch_vccz L_kvn0_0_1
    s_add_u32 s19, s58, s88
    buffer_load_dwordx4 v[100:103], v1, s[4:7], s19 offen sc1
L_kvn0_0_1:
    v_cmp_eq_u32 vcc, -1, v104
    s_cbranch_vccz L_kvn0_0_2
    s_add_u32 s19, s58, s89
    buffer_load_dwordx4 v[104:107], v1, s[4:7], s19 offen sc1
L_kvn0_0_2:
    v_cmp_eq_u32 vcc, -1, v108
    s_cbranch_vccz L_kvn0_0_3
    s_add_u32 s19, s58, s90
    buffer_load_dwordx4 v[108:111], v1, s[4:7], s19 offen sc1
L_kvn0_0_3:
    v_cmp_eq_u32 vcc, -1, v112
    s_cbranch_vccz L_kvn0_0_4
    s_add_u32 s19, s58, s91
    buffer_load_dwordx4 v[112:115], v1, s[4:7], s19 offen sc1
L_kvn0_0_4:
    v_cmp_eq_u32 vcc, -1, v116
    s_cbranch_vccz L_kvn0_0_5
    s_add_u32 s19, s58, s92
    buffer_load_dwordx4 v[116:119], v1, s[4:7], s19 offen sc1
L_kvn0_0_5:
    v_cmp_eq_u32 vcc, -1, v120
    s_cbranch_vccz L_kvn0_0_6
    s_add_u32 s19, s58, s93
    buffer_load_dwordx4 v[120:123], v1, s[4:7], s19 offen sc1
L_kvn0_0_6:
    buffer_load_dwordx4 v[192:195], v62, s[4:7], s59 offen sc1
    s_waitcnt vmcnt(0)
    s_branch L_kvc0_0
L_kvt0_0:
    s_mov_b32 s61, 0
    s_branch L_kvo0_0
L_kvs0_1:
    s_sub_u32 s61, s61, 1
    s_cbranch_scc1 L_kvt0_1
    s_waitcnt vmcnt(6)
    s_add_u32 s19, s58, s88
    buffer_load_dwordx4 v[100:103], v1, s[4:7], s19 offen sc1
    v_cmp_eq_u32 vcc, -1, v104
    s_cbranch_vccz L_kvn0_1_2
    s_add_u32 s19, s58, s89
    buffer_load_dwordx4 v[104:107], v1, s[4:7], s19 offen sc1
L_kvn0_1_2:
    v_cmp_eq_u32 vcc, -1, v108
    s_cbranch_vccz L_kvn0_1_3
    s_add_u32 s19, s58, s90
    buffer_load_dwordx4 v[108:111], v1, s[4:7], s19 offen sc1
L_kvn0_1_3:
    v_cmp_eq_u32 vcc, -1, v112
    s_cbranch_vccz L_kvn0_1_4
    s_add_u32 s19, s58, s91
    buffer_load_dwordx4 v[112:115], v1, s[4:7], s19 offen sc1
L_kvn0_1_4:
    v_cmp_eq_u32 vcc, -1, v116
    s_cbranch_vccz L_kvn0_1_5
    s_add_u32 s19, s58, s92
    buffer_load_dwordx4 v[116:119], v1, s[4:7], s19 offen sc1
L_kvn0_1_5:
    v_cmp_eq_u32 vcc, -1, v120
    s_cbranch_vccz L_kvn0_1_6
    s_add_u32 s19, s58, s93
    buffer_load_dwordx4 v[120:123], v1, s[4:7], s19 offen sc1
L_kvn0_1_6:
    buffer_load_dwordx4 v[192:195], v62, s[4:7], s59 offen sc1
    s_waitcnt vmcnt(0)
    s_branch L_kvc0_1
L_kvt0_1:
    s_mov_b32 s61, 0
    s_branch L_kvo0_1
L_kvs0_2:
    s_sub_u32 s61, s61, 1
    s_cbranch_scc1 L_kvt0_2
    s_waitcnt vmcnt(6)
    s_add_u32 s19, s58, s89
    buffer_load_dwordx4 v[104:107], v1, s[4:7], s19 offen sc1
    v_cmp_eq_u32 vcc, -1, v108
    s_cbranch_vccz L_kvn0_2_3
    s_add_u32 s19, s58, s90
    buffer_load_dwordx4 v[108:111], v1, s[4:7], s19 offen sc1
L_kvn0_2_3:
    v_cmp_eq_u32 vcc, -1, v112
    s_cbranch_vccz L_kvn0_2_4
    s_add_u32 s19, s58, s91
    buffer_load_dwordx4 v[112:115], v1, s[4:7], s19 offen sc1
L_kvn0_2_4:
    v_cmp_eq_u32 vcc, -1, v116
    s_cbranch_vccz L_kvn0_2_5
    s_add_u32 s19, s58, s92
    buffer_load_dwordx4 v[116:119], v1, s[4:7], s19 offen sc1
L_kvn0_2_5:
    v_cmp_eq_u32 vcc, -1, v120
    s_cbranch_vccz L_kvn0_2_6
    s_add_u32 s19, s58, s93
    buffer_load_dwordx4 v[120:123], v1, s[4:7], s19 offen sc1
L_kvn0_2_6:
    buffer_load_dwordx4 v[192:195], v62, s[4:7], s59 offen sc1
    s_waitcnt vmcnt(0)
    s_branch L_kvc0_2
L_kvt0_2:
    s_mov_b32 s61, 0
    s_branch L_kvo0_2
L_kvs0_3:
    s_sub_u32 s61, s61, 1
    s_cbranch_scc1 L_kvt0_3
    s_waitcnt vmcnt(6)
    s_add_u32 s19, s58, s90
    buffer_load_dwordx4 v[108:111], v1, s[4:7], s19 offen sc1
    v_cmp_eq_u32 vcc, -1, v112
    s_cbranch_vccz L_kvn0_3_4
    s_add_u32 s19, s58, s91
    buffer_load_dwordx4 v[112:115], v1, s[4:7], s19 offen sc1
L_kvn0_3_4:
    v_cmp_eq_u32 vcc, -1, v116
    s_cbranch_vccz L_kvn0_3_5
    s_add_u32 s19, s58, s92
    buffer_load_dwordx4 v[116:119], v1, s[4:7], s19 offen sc1
L_kvn0_3_5:
    v_cmp_eq_u32 vcc, -1, v120
    s_cbranch_vccz L_kvn0_3_6
    s_add_u32 s19, s58, s93
    buffer_load_dwordx4 v[120:123], v1, s[4:7], s19 offen sc1
L_kvn0_3_6:
    buffer_load_dwordx4 v[192:195], v62, s[4:7], s59 offen sc1
    s_waitcnt vmcnt(0)
    s_branch L_kvc0_3
L_kvt0_3:
    s_mov_b32 s61, 0
    s_branch L_kvo0_3
L_kvs0_4:
    s_sub_u32 s61, s61, 1
    s_cbranch_scc1 L_kvt0_4
    s_waitcnt vmcnt(6)
    s_add_u32 s19, s58, s91
    buffer_load_dwordx4 v[112:115], v1, s[4:7], s19 offen sc1
    v_cmp_eq_u32 vcc, -1, v116
    s_cbranch_vccz L_kvn0_4_5
    s_add_u32 s19, s58, s92
    buffer_load_dwordx4 v[116:119], v1, s[4:7], s19 offen sc1
L_kvn0_4_5:
    v_cmp_eq_u32 vcc, -1, v120
    s_cbranch_vccz L_kvn0_4_6
    s_add_u32 s19, s58, s93
    buffer_load_dwordx4 v[120:123], v1, s[4:7], s19 offen sc1
L_kvn0_4_6:
    buffer_load_dwordx4 v[192:195], v62, s[4:7], s59 offen sc1
    s_waitcnt vmcnt(0)
    s_branch L_kvc0_4
L_kvt0_4:
    s_mov_b32 s61, 0
    s_branch L_kvo0_4
L_kvs0_5:
    s_sub_u32 s61, s61, 1
    s_cbranch_scc1 L_kvt0_5
    s_waitcnt vmcnt(6)
    s_add_u32 s19, s58, s92
    buffer_load_dwordx4 v[116:119], v1, s[4:7], s19 offen sc1
    v_cmp_eq_u32 vcc, -1, v120
    s_cbranch_vccz L_kvn0_5_6
    s_add_u32 s19, s58, s93
    buffer_load_dwordx4 v[120:123], v1, s[4:7], s19 offen sc1
L_kvn0_5_6:
    buffer_load_dwordx4 v[192:195], v62, s[4:7], s59 offen sc1
    s_waitcnt vmcnt(0)
    s_branch L_kvc0_5
L_kvt0_5:
    s_mov_b32 s61, 0
    s_branch L_kvo0_5
L_kvs0_6:
    s_sub_u32 s61, s61, 1
    s_cbranch_scc1 L_kvt0_6
    s_waitcnt vmcnt(6)
    s_add_u32 s19, s58, s93
    buffer_load_dwordx4 v[120:123], v1, s[4:7], s19 offen sc1
    buffer_load_dwordx4 v[192:195], v62, s[4:7], s59 offen sc1
    s_waitcnt vmcnt(0)
    s_branch L_kvc0_6
L_kvt0_6:
    s_mov_b32 s61, 0
    s_branch L_kvo0_6
L_kvs0_7:
    s_sub_u32 s61, s61, 1
    s_cbranch_scc1 L_kvt0_7
    s_waitcnt vmcnt(6)
    buffer_load_dwordx4 v[192:195], v62, s[4:7], s59 offen sc1
    s_waitcnt vmcnt(0)
    s_branch L_kvc0_7
L_kvt0_7:
    s_mov_b32 s61, 0
    s_branch L_kvo0_7
L_slow_6:
    s_nop 7
    s_nop 3
    buffer_store_dword v63, off, s[4:7], s31 sc1
    s_nop 7
    s_branch L_done_7
L_p2_10:
    s_mov_b32 s61, 1048576
L_spin_105:
    buffer_load_dword v216, v12, s[4:7], s30 offen sc1
    s_sub_u32 s61, s61, 1
    s_waitcnt vmcnt(0)
    v_cmp_gt_u32 vcc, 1, v216
    s_cbranch_scc1 L_spind_106
    s_cbranch_vccnz L_spin_105
L_spind_106:
    s_branch L_p2_10_r
L_rt_11:
    s_mov_b32 s61, 1048576
L_spin_107:
    s_mov_b32 s20, 33792
    buffer_load_dwordx4 v[216:219], v1, s[4:7], s20 offen sc1
    s_sub_u32 s61, s61, 1
    s_waitcnt vmcnt(0)
    v_and_b32 v216, v216, v217
    v_and_b32 v218, v218, v219
    v_and_b32 v216, v216, v218
    v_cmp_ne_u32 vcc, 1, v216
    s_cbranch_scc1 L_spind_108
    s_cbranch_vccnz L_spin_107
L_spind_108:
    s_branch L_rtd_12
L_slow_13:
    s_nop 7
    s_nop 3
    buffer_store_dwordx4 v[16:19], v8, s[4:7], s35 offen offset:0 sc1
    s_nop 7
    s_branch L_done_14
L_slow_15:
    s_nop 7
    s_nop 3
    buffer_store_dwordx4 v[20:23], v8, s[4:7], s35 offen offset:1024 sc1
    s_nop 7
    s_branch L_done_16
L_slow_17:
    s_nop 7
    s_nop 3
    v_cndmask_b32 v164, v164, v165, s[36:37]
    v_cndmask_b32 v166, v166, v167, s[36:37]
    v_cndmask_b32 v161, v164, v166, s[38:39]
    s_mov_b64 exec, s[40:41]
    buffer_store_dwordx2 v[160:161], v14, s[4:7], s56 offen offset:0 sc1
    s_mov_b64 exec, -1
    s_nop 7
    s_branch L_done_18
L_slow_19:
    s_nop 7
    s_nop 3
    v_mfma_f32_16x16x32_bf16 v[172:175], v[24:27], v[24:27], 0
    buffer_store_dwordx4 v[24:27], v9, s[4:7], s35 offen offset:0 sc1
    v_mfma_f32_16x16x32_bf16 v[168:171], v[40:43], v[24:27], 0
    v_mfma_f32_16x16x32_bf16 v[172:175], v[28:31], v[28:31], v[172:175]
    buffer_store_dwordx4 v[28:31], v9, s[4:7], s35 offen offset:1024 sc1
    v_mfma_f32_16x16x32_bf16 v[168:171], v[40:43], v[28:31], v[168:171]
    s_nop 5
    v_cndmask_b32 v172, v172, v173, s[36:37]
    v_cndmask_b32 v174, v174, v175, s[36:37]
    v_cndmask_b32 v169, v172, v174, s[38:39]
    s_mov_b64 exec, s[40:41]
    buffer_store_dwordx2 v[168:169], v14, s[4:7], s56 offen offset:128 sc1
    s_mov_b64 exec, -1
    s_nop 7
    s_branch L_done_20
L_slow_22:
    s_nop 7
    s_nop 3
    buffer_store_dword v63, off, s[4:7], s33 sc1
    s_nop 7
    s_branch L_done_23
L_p2_26:
    s_mov_b32 s61, 1048576
L_spin_109:
    buffer_load_dword v216, v12, s[4:7], s32 offen sc1
    s_sub_u32 s61, s61, 1
    s_waitcnt vmcnt(0)
    v_cmp_gt_u32 vcc, 1, v216
    s_cbranch_scc1 L_spind_110
    s_cbranch_vccnz L_spin_109
L_spind_110:
    s_branch L_p2_26_r
L_slow_27:
    s_nop 7
    s_nop 3
    buffer_store_dwordx4 v[236:239], v7, s[4:7], s34 offen sc1
    s_nop 7
    s_branch L_done_28
L_slow_31:
    s_nop 7
    s_nop 3
    buffer_store_dwordx4 v[232:235], v6, s[4:7], s34 offen sc1
    s_nop 7
    s_branch L_done_32
L_slow_33:
    s_nop 7
    s_nop 3
    buffer_store_dwordx4 v[228:231], v5, s[4:7], s34 offen sc1
    s_nop 7
    s_branch L_done_34
L_slow_35:
    s_nop 7
    s_nop 3
    buffer_store_dwordx4 v[224:227], v4, s[4:7], s34 offen sc1
    s_nop 7
    s_branch L_done_36
L_slow_38:
    s_nop 7
    s_nop 3
    buffer_store_dword v63, off, s[4:7], s31 sc1
    s_nop 7
    s_branch L_done_39
L_p2_42:
    s_mov_b32 s61, 1048576
L_spin_111:
    buffer_load_dword v216, v12, s[4:7], s30 offen sc1
    s_sub_u32 s61, s61, 1
    s_waitcnt vmcnt(0)
    v_cmp_gt_u32 vcc, 2, v216
    s_cbranch_scc1 L_spind_112
    s_cbranch_vccnz L_spin_111
L_spind_112:
    s_branch L_p2_42_r
L_slow_43:
    s_nop 7
    s_nop 3
    buffer_store_dwordx4 v[16:19], v8, s[4:7], s35 offen offset:0 sc1
    s_nop 7
    s_branch L_done_44
L_slow_45:
    s_nop 7
    s_nop 3
    buffer_store_dwordx4 v[20:23], v8, s[4:7], s35 offen offset:1024 sc1
    s_nop 7
    s_branch L_done_46
L_slow_47:
    s_nop 7
    s_nop 3
    v_cndmask_b32 v164, v164, v165, s[36:37]
    v_cndmask_b32 v166, v166, v167, s[36:37]
    v_cndmask_b32 v161, v164, v166, s[38:39]
    s_mov_b64 exec, s[40:41]
    buffer_store_dwordx2 v[160:161], v14, s[4:7], s56 offen offset:0 sc1
    s_mov_b64 exec, -1
    s_nop 7
    s_branch L_done_48
L_slow_49:
    s_nop 7
    s_nop 3
    v_mfma_f32_16x16x32_bf16 v[172:175], v[24:27], v[24:27], 0
    buffer_store_dwordx4 v[24:27], v9, s[4:7], s35 offen offset:0 sc1
    v_mfma_f32_16x16x32_bf16 v[168:171], v[40:43], v[24:27], 0
    v_mfma_f32_16x16x32_bf16 v[172:175], v[28:31], v[28:31], v[172:175]
    buffer_store_dwordx4 v[28:31], v9, s[4:7], s35 offen offset:1024 sc1
    v_mfma_f32_16x16x32_bf16 v[168:171], v[40:43], v[28:31], v[168:171]
    s_nop 5
    v_cndmask_b32 v172, v172, v173, s[36:37]
    v_cndmask_b32 v174, v174, v175, s[36:37]
    v_cndmask_b32 v169, v172, v174, s[38:39]
    s_mov_b64 exec, s[40:41]
    buffer_store_dwordx2 v[168:169], v14, s[4:7], s56 offen offset:128 sc1
    s_mov_b64 exec, -1
    s_nop 7
    s_branch L_done_50
L_slow_52:
    s_nop 7
    s_nop 3
    buffer_store_dword v63, off, s[4:7], s33 sc1
    s_nop 7
    s_branch L_done_53
L_p2_56:
    s_mov_b32 s61, 1048576
L_spin_113:
    buffer_load_dword v216, v12, s[4:7], s32 offen sc1
    s_sub_u32 s61, s61, 1
    s_waitcnt vmcnt(0)
    v_cmp_gt_u32 vcc, 2, v216
    s_cbranch_scc1 L_spind_114
    s_cbranch_vccnz L_spin_113
L_spind_114:
    s_branch L_p2_56_r
L_kvs2_0:
    s_sub_u32 s61, s61, 1
    s_cbranch_scc1 L_kvt2_0
    s_waitcnt vmcnt(0)
    s_add_u32 s19, s58, s87
    buffer_load_dwordx4 v[96:99], v1, s[4:7], s19 offen sc1
    v_cmp_eq_u32 vcc, -1, v100
    s_cbranch_vccz L_kvn2_0_1
    s_add_u32 s19, s58, s88
    buffer_load_dwordx4 v[100:103], v1, s[4:7], s19 offen sc1
L_kvn2_0_1:
    v_cmp_eq_u32 vcc, -1, v104
    s_cbranch_vccz L_kvn2_0_2
    s_add_u32 s19, s58, s89
    buffer_load_dwordx4 v[104:107], v1, s[4:7], s19 offen sc1
L_kvn2_0_2:
    v_cmp_eq_u32 vcc, -1, v108
    s_cbranch_vccz L_kvn2_0_3
    s_add_u32 s19, s58, s90
    buffer_load_dwordx4 v[108:111], v1, s[4:7], s19 offen sc1
L_kvn2_0_3:
    v_cmp_eq_u32 vcc, -1, v112
    s_cbranch_vccz L_kvn2_0_4
    s_add_u32 s19, s58, s91
    buffer_load_dwordx4 v[112:115], v1, s[4:7], s19 offen sc1
L_kvn2_0_4:
    v_cmp_eq_u32 vcc, -1, v116
    s_cbranch_vccz L_kvn2_0_5
    s_add_u32 s19, s58, s92
    buffer_load_dwordx4 v[116:119], v1, s[4:7], s19 offen sc1
L_kvn2_0_5:
    v_cmp_eq_u32 vcc, -1, v120
    s_cbranch_vccz L_kvn2_0_6
    s_add_u32 s19, s58, s93
    buffer_load_dwordx4 v[120:123], v1, s[4:7], s19 offen sc1
L_kvn2_0_6:
    buffer_load_dwordx4 v[192:195], v62, s[4:7], s59 offen sc1
    s_waitcnt vmcnt(0)
    s_branch L_kvc2_0
L_kvt2_0:
    s_mov_b32 s61, 0
    s_branch L_kvo2_0
L_kvs2_1:
    s_sub_u32 s61, s61, 1
    s_cbranch_scc1 L_kvt2_1
    s_waitcnt vmcnt(0)
    s_add_u32 s19, s58, s88
    buffer_load_dwordx4 v[100:103], v1, s[4:7], s19 offen sc1
    v_cmp_eq_u32 vcc, -1, v104
    s_cbranch_vccz L_kvn2_1_2
    s_add_u32 s19, s58, s89
    buffer_load_dwordx4 v[104:107], v1, s[4:7], s19 offen sc1
L_kvn2_1_2:
    v_cmp_eq_u32 vcc, -1, v108
    s_cbranch_vccz L_kvn2_1_3
    s_add_u32 s19, s58, s90
    buffer_load_dwordx4 v[108:111], v1, s[4:7], s19 offen sc1
L_kvn2_1_3:
    v_cmp_eq_u32 vcc, -1, v112
    s_cbranch_vccz L_kvn2_1_4
    s_add_u32 s19, s58, s91
    buffer_load_dwordx4 v[112:115], v1, s[4:7], s19 offen sc1
L_kvn2_1_4:
    v_cmp_eq_u32 vcc, -1, v116
    s_cbranch_vccz L_kvn2_1_5
    s_add_u32 s19, s58, s92
    buffer_load_dwordx4 v[116:119], v1, s[4:7], s19 offen sc1
L_kvn2_1_5:
    v_cmp_eq_u32 vcc, -1, v120
    s_cbranch_vccz L_kvn2_1_6
    s_add_u32 s19, s58, s93
    buffer_load_dwordx4 v[120:123], v1, s[4:7], s19 offen sc1
L_kvn2_1_6:
    buffer_load_dwordx4 v[192:195], v62, s[4:7], s59 offen sc1
    s_waitcnt vmcnt(0)
    s_branch L_kvc2_1
L_kvt2_1:
    s_mov_b32 s61, 0
    s_branch L_kvo2_1
L_kvs2_2:
    s_sub_u32 s61, s61, 1
    s_cbranch_scc1 L_kvt2_2
    s_waitcnt vmcnt(0)
    s_add_u32 s19, s58, s89
    buffer_load_dwordx4 v[104:107], v1, s[4:7], s19 offen sc1
    v_cmp_eq_u32 vcc, -1, v108
    s_cbranch_vccz L_kvn2_2_3
    s_add_u32 s19, s58, s90
    buffer_load_dwordx4 v[108:111], v1, s[4:7], s19 offen sc1
L_kvn2_2_3:
    v_cmp_eq_u32 vcc, -1, v112
    s_cbranch_vccz L_kvn2_2_4
    s_add_u32 s19, s58, s91
    buffer_load_dwordx4 v[112:115], v1, s[4:7], s19 offen sc1
L_kvn2_2_4:
    v_cmp_eq_u32 vcc, -1, v116
    s_cbranch_vccz L_kvn2_2_5
    s_add_u32 s19, s58, s92
    buffer_load_dwordx4 v[116:119], v1, s[4:7], s19 offen sc1
L_kvn2_2_5:
    v_cmp_eq_u32 vcc, -1, v120
    s_cbranch_vccz L_kvn2_2_6
    s_add_u32 s19, s58, s93
    buffer_load_dwordx4 v[120:123], v1, s[4:7], s19 offen sc1
L_kvn2_2_6:
    buffer_load_dwordx4 v[192:195], v62, s[4:7], s59 offen sc1
    s_waitcnt vmcnt(0)
    s_branch L_kvc2_2
L_kvt2_2:
    s_mov_b32 s61, 0
    s_branch L_kvo2_2
L_kvs2_3:
    s_sub_u32 s61, s61, 1
    s_cbranch_scc1 L_kvt2_3
    s_waitcnt vmcnt(0)
    s_add_u32 s19, s58, s90
    buffer_load_dwordx4 v[108:111], v1, s[4:7], s19 offen sc1
    v_cmp_eq_u32 vcc, -1, v112
    s_cbranch_vccz L_kvn2_3_4
    s_add_u32 s19, s58, s91
    buffer_load_dwordx4 v[112:115], v1, s[4:7], s19 offen sc1
L_kvn2_3_4:
    v_cmp_eq_u32 vcc, -1, v116
    s_cbranch_vccz L_kvn2_3_5
    s_add_u32 s19, s58, s92
    buffer_load_dwordx4 v[116:119], v1, s[4:7], s19 offen sc1
L_kvn2_3_5:
    v_cmp_eq_u32 vcc, -1, v120
    s_cbranch_vccz L_kvn2_3_6
    s_add_u32 s19, s58, s93
    buffer_load_dwordx4 v[120:123], v1, s[4:7], s19 offen sc1
L_kvn2_3_6:
    buffer_load_dwordx4 v[192:195], v62, s[4:7], s59 offen sc1
    s_waitcnt vmcnt(0)
    s_branch L_kvc2_3
L_kvt2_3:
    s_mov_b32 s61, 0
    s_branch L_kvo2_3
L_kvs2_4:
    s_sub_u32 s61, s61, 1
    s_cbranch_scc1 L_kvt2_4
    s_waitcnt vmcnt(0)
    s_add_u32 s19, s58, s91
    buffer_load_dwordx4 v[112:115], v1, s[4:7], s19 offen sc1
    v_cmp_eq_u32 vcc, -1, v116
    s_cbranch_vccz L_kvn2_4_5
    s_add_u32 s19, s58, s92
    buffer_load_dwordx4 v[116:119], v1, s[4:7], s19 offen sc1
L_kvn2_4_5:
    v_cmp_eq_u32 vcc, -1, v120
    s_cbranch_vccz L_kvn2_4_6
    s_add_u32 s19, s58, s93
    buffer_load_dwordx4 v[120:123], v1, s[4:7], s19 offen sc1
L_kvn2_4_6:
    buffer_load_dwordx4 v[192:195], v62, s[4:7], s59 offen sc1
    s_waitcnt vmcnt(0)
    s_branch L_kvc2_4
L_kvt2_4:
    s_mov_b32 s61, 0
    s_branch L_kvo2_4
L_kvs2_5:
    s_sub_u32 s61, s61, 1
    s_cbranch_scc1 L_kvt2_5
    s_waitcnt vmcnt(0)
    s_add_u32 s19, s58, s92
    buffer_load_dwordx4 v[116:119], v1, s[4:7], s19 offen sc1
    v_cmp_eq_u32 vcc, -1, v120
    s_cbranch_vccz L_kvn2_5_6
    s_add_u32 s19, s58, s93
    buffer_load_dwordx4 v[120:123], v1, s[4:7], s19 offen sc1
L_kvn2_5_6:
    buffer_load_dwordx4 v[192:195], v62, s[4:7], s59 offen sc1
    s_waitcnt vmcnt(0)
    s_branch L_kvc2_5
L_kvt2_5:
    s_mov_b32 s61, 0
    s_branch L_kvo2_5
L_kvs2_6:
    s_sub_u32 s61, s61, 1
    s_cbranch_scc1 L_kvt2_6
    s_waitcnt vmcnt(0)
    s_add_u32 s19, s58, s93
    buffer_load_dwordx4 v[120:123], v1, s[4:7], s19 offen sc1
    buffer_load_dwordx4 v[192:195], v62, s[4:7], s59 offen sc1
    s_waitcnt vmcnt(0)
    s_branch L_kvc2_6
L_kvt2_6:
    s_mov_b32 s61, 0
    s_branch L_kvo2_6
L_kvs2_7:
    s_sub_u32 s61, s61, 1
    s_cbranch_scc1 L_kvt2_7
    s_waitcnt vmcnt(0)
    buffer_load_dwordx4 v[192:195], v62, s[4:7], s59 offen sc1
    s_waitcnt vmcnt(0)
    s_branch L_kvc2_7
L_kvt2_7:
    s_mov_b32 s61, 0
    s_branch L_kvo2_7
L_slow_57:
    s_nop 7
    s_nop 3
    buffer_store_dwordx4 v[224:227], v4, s[4:7], s34 offen sc1
    s_nop 7
    s_branch L_done_58
L_slow_59:
    s_nop 7
    s_nop 3
    buffer_store_dwordx4 v[228:231], v5, s[4:7], s34 offen sc1
    s_nop 7
    s_branch L_done_60
L_slow_61:
    s_nop 7
    s_nop 3
    buffer_store_dwordx4 v[232:235], v6, s[4:7], s34 offen sc1
    s_nop 7
    s_branch L_done_62
L_slow_63:
    s_nop 7
    s_nop 3
    buffer_store_dwordx4 v[236:239], v7, s[4:7], s34 offen sc1
    s_nop 7
    s_branch L_done_64
L_slow_66:
    s_nop 7
    s_nop 3
    buffer_store_dword v63, off, s[4:7], s31 sc1
    s_nop 7
    s_branch L_done_67
L_p2_70:
    s_mov_b32 s61, 1048576
L_spin_115:
    buffer_load_dword v216, v12, s[4:7], s30 offen sc1
    s_sub_u32 s61, s61, 1
    s_waitcnt vmcnt(0)
    v_cmp_gt_u32 vcc, 3, v216
    s_cbranch_scc1 L_spind_116
    s_cbranch_vccnz L_spin_115
L_spind_116:
    s_branch L_p2_70_r
L_slow_71:
    s_nop 7
    s_nop 3
    buffer_store_dwordx4 v[16:19], v8, s[4:7], s35 offen offset:0 sc1
    s_nop 7
    s_branch L_done_72
L_slow_73:
    s_nop 7
    s_nop 3
    buffer_store_dwordx4 v[20:23], v8, s[4:7], s35 offen offset:1024 sc1
    s_nop 7
    s_branch L_done_74
L_slow_75:
    s_nop 7
    s_nop 3
    v_cndmask_b32 v164, v164, v165, s[36:37]
    v_cndmask_b32 v166, v166, v167, s[36:37]
    v_cndmask_b32 v161, v164, v166, s[38:39]
    s_mov_b64 exec, s[40:41]
    buffer_store_dwordx2 v[160:161], v14, s[4:7], s56 offen offset:0 sc1
    s_mov_b64 exec, -1
    s_nop 7
    s_branch L_done_76
L_slow_77:
    s_nop 7
    s_nop 3
    v_mfma_f32_16x16x32_bf16 v[172:175], v[24:27], v[24:27], 0
    buffer_store_dwordx4 v[24:27], v9, s[4:7], s35 offen offset:0 sc1
    v_mfma_f32_16x16x32_bf16 v[168:171], v[40:43], v[24:27], 0
    v_mfma_f32_16x16x32_bf16 v[172:175], v[28:31], v[28:31], v[172:175]
    buffer_store_dwordx4 v[28:31], v9, s[4:7], s35 offen offset:1024 sc1
    v_mfma_f32_16x16x32_bf16 v[168:171], v[40:43], v[28:31], v[168:171]
    s_nop 5
    v_cndmask_b32 v172, v172, v173, s[36:37]
    v_cndmask_b32 v174, v174, v175, s[36:37]
    v_cndmask_b32 v169, v172, v174, s[38:39]
    s_mov_b64 exec, s[40:41]
    buffer_store_dwordx2 v[168:169], v14, s[4:7], s56 offen offset:128 sc1
    s_mov_b64 exec, -1
    s_nop 7
    s_branch L_done_78
L_slow_80:
    s_nop 7
    s_nop 3
    buffer_store_dword v63, off, s[4:7], s33 sc1
    s_nop 7
    s_branch L_done_81
L_p2_84:
    s_mov_b32 s61, 1048576
L_spin_117:
    buffer_load_dword v216, v12, s[4:7], s32 offen sc1
    s_sub_u32 s61, s61, 1
    s_waitcnt vmcnt(0)
    v_cmp_gt_u32 vcc, 3, v216
    s_cbranch_scc1 L_spind_118
    s_cbranch_vccnz L_spin_117
L_spind_118:
    s_branch L_p2_84_r
L_slow_85:
    s_nop 7
    s_nop 3
    buffer_store_dwordx4 v[236:239], v7, s[4:7], s34 offen sc1
    s_nop 7
    s_branch L_done_86
L_slow_89:
    s_nop 7
    s_nop 3
    buffer_store_dwordx4 v[232:235], v6, s[4:7], s34 offen sc1
    s_nop 7
    s_branch L_done_90
L_slow_91:
    s_nop 7
    s_nop 3
    buffer_store_dwordx4 v[228:231], v5, s[4:7], s34 offen sc1
    s_nop 7
    s_branch L_done_92
L_slow_93:
    s_nop 7
    s_nop 3
    buffer_store_dwordx4 v[224:227], v4, s[4:7], s34 offen sc1
    s_nop 7
    s_branch L_done_94
L_slow_96:
    s_nop 7
    s_nop 3
    buffer_store_dword v63, off, s[4:7], s31 sc1
    s_nop 7
    s_branch L_done_97
L_p2_100:
    s_mov_b32 s61, 1048576
L_spin_119:
    buffer_load_dword v216, v12, s[4:7], s30 offen sc1
    s_sub_u32 s61, s61, 1
    s_waitcnt vmcnt(0)
    v_cmp_gt_u32 vcc, 4, v216
    s_cbranch_scc1 L_spind_120
    s_cbranch_vccnz L_spin_119
L_spind_120:
    s_branch L_p2_100_r
L_exit:
    s_endpgm
.fill (16384 + 256 - (. - L_ool))/4, 4, 0xbf810000
.section .rodata,"a"
.p2align 6
.amdhsa_kernel interleave_layers__linear_kernel_hedgehog__sliding_local_dilated__prompt_kernel
  .amdhsa_next_free_vgpr 512
  .amdhsa_next_free_sgpr 102
  .amdhsa_accum_offset 256
  .amdhsa_group_segment_fixed_size 0
  .amdhsa_kernarg_size 80
  .amdhsa_user_sgpr_count 2
  .amdhsa_user_sgpr_kernarg_segment_ptr 1
  .amdhsa_system_sgpr_workgroup_id_x 1
.end_amdhsa_kernel
```
